```python
import torch

def _softmax(x, axis=-1):
    return torch.softmax(x, dim=axis)
def _gelu(x):
    return torch.nn.functional.gelu(x, approximate="tanh")
def _silu(x):
    return torch.nn.functional.silu(x)
def _sigmoid(x):
    return torch.sigmoid(x)
def _layernorm(x, axis=-1, eps=1e-5):
    m = x.mean(dim=axis, keepdim=True)
    v = x.var(dim=axis, keepdim=True, unbiased=False)
    return (x - m) / torch.sqrt(v + eps)
def _scatter_add(tgt, idx, src, axis=0):
    return tgt.clone().index_add_(axis, idx, src)
def _segment_sum(src, seg, n):
    out = torch.zeros((n,) + src.shape[1:], dtype=src.dtype)
    return out.index_add_(0, seg, src)
def _pad(x, pw):
    flat = tuple(v for pair in reversed(pw) for v in pair)
    return torch.nn.functional.pad(x, flat)

kernel_name = 'interleave_layers__ssm_conv_h3__geglu_ffn__prompt'

def setup_inputs():

    _w = (lambda a: (lambda t: t.to(torch.bfloat16) if t.is_floating_point() else t)(torch.as_tensor(a)))
    def _A_setup():
        B, S, D = 1, 2048, 1024
        ks = 4
        return {
            "q": _w((lambda *s: torch.randn(*s, dtype=torch.bfloat16) * 0.05)(B, S, D)),
            "k": _w((lambda *s: torch.randn(*s, dtype=torch.bfloat16) * 0.8)(B, S, D)),
            "v": _w((lambda *s: torch.randn(*s, dtype=torch.bfloat16) * 0.8)(B, S, D)),
            "shift_k": _w((lambda *s: torch.randn(*s, dtype=torch.bfloat16) * 0.8)(D, ks) * 0.5),
            "ssm_k": _w((lambda *s: torch.randn(*s, dtype=torch.bfloat16) * 0.8)(D, S) * (1.0 / S ** 0.5)),
            "ssm_D": _w((lambda *s: torch.randn(*s, dtype=torch.bfloat16) * 0.8)(D)),
        }
    _A_in = _A_setup()

    def _B_setup():
        B, S, D, F = 1, 2048, 1024, 3584
        return {
            "x": _w((lambda *s: torch.randn(*s, dtype=torch.bfloat16) * 0.05)(B, S, D)),
            "w_gate": _w((lambda *s: torch.randn(*s, dtype=torch.bfloat16) * 0.05)(D, F)),
            "w_up": _w((lambda *s: torch.randn(*s, dtype=torch.bfloat16) * 0.05)(D, F)),
            "w_down": _w((lambda *s: torch.randn(*s, dtype=torch.bfloat16) * 0.05)(F, D)),
        }
    _B_in = _B_setup()

    return {
        "A_q": _A_in["q"],
        "A_k": _A_in["k"],
        "A_v": _A_in["v"],
        "A_shift_k": _A_in["shift_k"],
        "A_ssm_k": _A_in["ssm_k"],
        "A_ssm_D": _A_in["ssm_D"],
        "B_x": _B_in["x"],
        "B_w_gate": _B_in["w_gate"],
        "B_w_up": _B_in["w_up"],
        "B_w_down": _B_in["w_down"],
    }

def reference(A_q, A_k, A_v, A_shift_k, A_ssm_k, A_ssm_D, B_x, B_w_gate, B_w_up, B_w_down):
    def _A_ref(q, k, v, shift_k, ssm_k, ssm_D):
        B, S, D = q.shape
        ks = shift_k.shape[-1]
        k_pad = _pad(k, ((0, 0), (ks - 1, 0), (0, 0)))
        k_shift = torch.zeros_like(k)
        for t in range(ks):
            k_shift = k_shift + k_pad[:, t:t + S, :] * shift_k[:, ks - 1 - t][None, None, :]
        kv = k_shift * v
        L = 2 * S
        kv_pad = _pad(kv, ((0, 0), (0, S), (0, 0)))
        kf_pad = _pad(ssm_k, ((0, 0), (0, S)))
        kv_f = (lambda x, axes=(-2,-1): torch.fft.rfft2(x.float(), dim=axes))(kv_pad[:, None, :, :], axes=(1, 2))
        kf_f = (lambda x, axes=(-2,-1): torch.fft.rfft2(x.float(), dim=axes))(kf_pad[:, None, :], axes=(1, 2))
        kf_f = (lambda x, *d: x.permute(*d))(kf_f, 1, 2, 0)
        y_f = kv_f * kf_f[None, :, :, :]
        y = (lambda x, s, axes=(-2,-1): torch.fft.irfft2(x, s=s, dim=axes).to(torch.bfloat16))(y_f, (1, L), axes=(1, 2))[:, 0, :S, :]
        y = y + kv * ssm_D[None, None, :]
        return q * y

    def _B_ref(x, w_gate, w_up, w_down):
        return (_gelu(x @ w_gate) * (x @ w_up)) @ w_down

    x = A_q
    x = x + _A_ref(_layernorm(x, axis=-1), A_k, A_v, A_shift_k, A_ssm_k, A_ssm_D)
    x = x + _B_ref(_layernorm(x, axis=-1), B_w_gate, B_w_up, B_w_down)
    x = x + _A_ref(_layernorm(x, axis=-1), A_k, A_v, A_shift_k, A_ssm_k, A_ssm_D)
    x = x + _B_ref(_layernorm(x, axis=-1), B_w_gate, B_w_up, B_w_down)
    return x
```

```asm
; @launch grid=(256,1,1) block=(256,1,1) lds=163840
.amdgcn_target "amdgcn-amd-amdhsa--gfx950"
.text
.globl interleave_layers__ssm_conv_h3__geglu_ffn__prompt_kernel
.p2align 8
.type interleave_layers__ssm_conv_h3__geglu_ffn__prompt_kernel,@function
interleave_layers__ssm_conv_h3__geglu_ffn__prompt_kernel:
    s_cmp_ge_u32 s2, 256
    s_cbranch_scc1 L_end
    s_load_dwordx2 s[4:5], s[0:1], 8
    s_load_dwordx2 s[12:13], s[0:1], 24
    s_load_dwordx2 s[28:29], s[0:1], 96
    s_load_dwordx2 s[8:9], s[0:1], 16
    s_load_dwordx2 s[50:51], s[0:1], 32
    s_load_dwordx2 s[24:25], s[0:1], 88
    s_load_dwordx2 s[20:21], s[0:1], 0
    s_load_dwordx2 s[58:59], s[0:1], 40
    s_and_b32 s37, s2, 7
    s_lshr_b32 s38, s2, 3
    v_cmp_le_u32 vcc, 0xc0, v0
    s_and_saveexec_b64 s[56:57], vcc
    s_cbranch_execz L_notouch
    s_getpc_b64 s[60:61]
L_pc:
    s_lshl_b32 s39, s38, 11
    v_and_b32 v6, 15, v0
    v_lshl_add_u32 v6, v6, 7, s39
    v_min_u32 v4, L_end - L_pc, v6
    v_mov_b32 v5, s61
    v_add_co_u32 v4, vcc, s60, v4
    s_nop 1
    v_addc_co_u32 v5, vcc, 0, v5, vcc
    global_load_dword v31, v[4:5], off
L_notouch:
    s_mov_b64 exec, s[56:57]
    s_and_b32 s43, s38, 15
    s_lshl_b32 s56, s43, 6
    v_and_b32 v18, 15, v0
    v_lshl_add_u32 v18, v18, 2, s56
    s_lshl_b32 s56, s37, 1
    s_lshr_b32 s57, s38, 4
    s_add_u32 s56, s56, s57
    s_lshl_b32 s56, s56, 7
    v_lshrrev_b32_e64 v20, 4, v0
    v_lshl_add_u32 v19, v20, 3, s56
    v_lshlrev_b32_e64 v20, 11, v19
    v_lshl_add_u32 v20, v18, 1, v20
    v_cmp_eq_u32 vcc, 0, v19
    v_add_u32 v21, 0xffffe800, v20
    v_mov_b32 v22, 0x40000000
    s_mov_b32 s6, 0x400000
    s_mov_b32 s7, 0x00020000
    v_cndmask_b32 v21, v21, v22, vcc
    v_lshlrev_b32 v22, 3, v18
    s_movk_i32 s14, 0x2000
    s_mov_b32 s15, 0x00020000
    s_movk_i32 s44, 0x1000
    s_movk_i32 s45, 0x2000
    s_movk_i32 s46, 0x3000
    s_waitcnt lgkmcnt(0)
    s_cmp_lg_u32 s2, 0
    s_cbranch_scc1 L_nopub
    v_cmp_gt_u32 vcc, 64, v0
    s_and_saveexec_b64 s[56:57], vcc
    s_cbranch_execz L_nopub1
    s_add_u32 s16, s28, 0x2c00000
    s_addc_u32 s17, s29, 0
    s_mov_b32 s18, 0x2000
    s_mov_b32 s19, 0x00020000
    v_lshrrev_b32 v4, 1, v0
    v_lshlrev_b32 v4, 8, v4
    v_and_b32 v5, 1, v0
    v_lshl_add_u32 v4, v5, 4, v4
    v_mov_b32 v24, 0
    v_mov_b32 v25, 0
    v_mov_b32 v26, 0
    v_mov_b32 v27, 0
    buffer_store_dwordx4 v[24:27], v4, s[16:19], 0 offen sc1
    buffer_store_dwordx4 v[24:27], v4, s[16:19], 0 offen offset:32 sc1
L_nopub1:
    s_mov_b64 exec, s[56:57]
L_nopub:
    buffer_load_dwordx4 v[138:141], v22, s[12:15], 0 offen
    buffer_load_dwordx4 v[142:145], v22, s[12:15], 0 offen offset:16
    buffer_load_dwordx2 v[106:107], v20, s[4:7], 0 offen offset:0 nt
    buffer_load_dwordx2 v[108:109], v20, s[4:7], 0 offen offset:2048 nt
    buffer_load_dwordx2 v[110:111], v20, s[4:7], s44 offen offset:0 nt
    buffer_load_dwordx2 v[112:113], v20, s[4:7], s44 offen offset:2048 nt
    buffer_load_dwordx2 v[114:115], v20, s[4:7], s45 offen offset:0 nt
    buffer_load_dwordx2 v[116:117], v20, s[4:7], s45 offen offset:2048 nt
    buffer_load_dwordx2 v[118:119], v20, s[4:7], s46 offen offset:0 nt
    buffer_load_dwordx2 v[120:121], v20, s[4:7], s46 offen offset:2048 nt
    buffer_load_dwordx2 v[100:101], v21, s[4:7], 0 offen offset:0 nt
    buffer_load_dwordx2 v[102:103], v21, s[4:7], 0 offen offset:2048 nt
    buffer_load_dwordx2 v[104:105], v21, s[4:7], s44 offen offset:0 nt
    s_mov_b32 s10, 0x400000
    s_mov_b32 s11, 0x00020000
    v_lshrrev_b32 v1, 6, v0
    v_and_b32 v0, 63, v0
    v_readfirstlane_b32 s3, v1
    v_lshlrev_b32 v2, 4, v0
    v_mov_b32 v1, 0
    s_movk_i32 s26, 0x100
    s_mov_b32 s27, 0x00020000
    s_mov_b32 s22, 0x400000
    s_mov_b32 s23, 0x00020000
    s_lshl_b32 s43, s43, 8
    s_add_u32 s43, s43, 0
    v_lshlrev_b32 v23, 12, v18
    v_lshlrev_b32 v19, 1, v19
    v_sub_u32 v23, v23, v19
    v_add_u32 v23, 4080, v23
    v_mov_b32 v29, 0x10000
    v_writelane_b32 v29, 0, 1
    s_and_b32 s31, s37, 1
    s_lshl_b32 s31, s31, 2
    s_and_b32 s39, s38, 3
    s_add_u32 s31, s31, s39
    s_lshr_b32 s33, s37, 1
    s_lshr_b32 s34, s38, 2
    s_lshl_b32 s32, s33, 3
    s_add_u32 s32, s32, s34
    s_lshl_b32 s36, s31, 5
    s_add_u32 s36, s36, s32
    s_mov_b32 s35, 0
    s_mul_i32 s42, s3, 7168
    s_lshl_b32 s39, s37, 5
    s_add_u32 s39, s39, s38
    s_lshl_b32 s40, s39, 2
    s_add_u32 s40, s40, s3
    s_lshl_b32 s41, s40, 12
    s_add_u32 s16, s50, s41
    s_addc_u32 s17, s51, 0
    s_mov_b32 s18, 0x1000
    s_mov_b32 s19, 0x00020000
    s_lshr_b32 s47, s40, 1
    s_lshl_b32 s47, s47, 2
    s_load_dword s48, s[58:59], s47
    s_load_dwordx4 s[12:15], s[0:1], 56
    buffer_load_dwordx2 v[122:123], v20, s[8:11], 0 offen offset:0 nt
    s_mul_i32 s50, s3, 21248
    s_add_u32 s51, s50, 16640
    v_mov_b32 v80, 0
    v_mov_b32 v81, 0
    buffer_load_dwordx2 v[124:125], v20, s[8:11], 0 offen offset:2048 nt
    v_mov_b32 v82, 0
    v_mov_b32 v83, 0
    v_lshl_add_u32 v4, v0, 3, s51
    ds_write_b64 v4, v[80:81] offset:4096
    buffer_load_dwordx2 v[126:127], v20, s[8:11], s44 offen offset:0 nt
    v_add_u32 v5, s50, v2
    v_and_b32 v6, 15, v0
    v_lshrrev_b32 v7, 4, v0
    v_add_u32 v18, 1, v6
    buffer_load_dwordx2 v[128:129], v20, s[8:11], s44 offen offset:2048 nt
    v_and_b32_e64 v19, 3, v18
    v_mul_u32_u24 v19, 4160, v19
    v_lshrrev_b32 v18, 2, v18
    v_lshlrev_b32 v18, 3, v18
    buffer_load_dwordx2 v[130:131], v20, s[8:11], s45 offen offset:0 nt
    v_add_u32_e64 v18, v18, v19
    v_lshl_add_u32 v18, v7, 4, v18
    v_add_u32 v18, s50, v18
    v_lshlrev_b32 v19, 5, v6
    buffer_load_dwordx2 v[132:133], v20, s[8:11], s45 offen offset:2048 nt
    v_sub_u32 v19, 480, v19
    v_lshl_add_u32 v19, v7, 4, v19
    v_add_u32 v19, s51, v19
    v_lshlrev_b32 v24, 5, v6
    buffer_load_dwordx2 v[134:135], v20, s[8:11], s46 offen offset:0 nt
    v_lshl_add_u32 v24, v7, 3, v24
    v_sub_u32 v25, 504, v24
    v_add_u32_e64 v25, s51, v25
    s_mul_i32 s52, s3, 4160
    buffer_load_dwordx2 v[136:137], v20, s[8:11], s46 offen offset:2048 nt
    s_add_u32 s52, s52, s50
    v_lshrrev_b32 v24, 1, v24
    v_add_u32_e64 v24, s52, v24
    s_mov_b32 s49, 0xffff0000
    s_waitcnt vmcnt(19)
    s_or_b32 s56, s2, s3
    s_cmp_lg_u32 s56, 0
    s_cbranch_scc1 L_nopub2
    v_mov_b32_e64 v4, 1
    buffer_store_dword v4, v1, s[24:27], 0 offen sc1
L_nopub2:
    v_lshlrev_b32 v146, 16, v138
    v_and_b32 v150, s49, v138
    v_lshlrev_b32 v154, 16, v139
    v_and_b32 v158, s49, v139
    v_lshlrev_b32 v147, 16, v140
    v_and_b32 v151, s49, v140
    v_lshlrev_b32 v155, 16, v141
    v_and_b32 v159, s49, v141
    v_lshlrev_b32 v148, 16, v142
    v_and_b32 v152, s49, v142
    v_lshlrev_b32 v156, 16, v143
    v_and_b32 v160, s49, v143
    v_lshlrev_b32 v149, 16, v144
    v_and_b32 v153, s49, v144
    v_lshlrev_b32 v157, 16, v145
    v_and_b32 v161, s49, v145
    s_waitcnt vmcnt(17)
    v_lshlrev_b32 v174, 16, v106
    v_and_b32 v175, s49, v106
    v_lshlrev_b32 v176, 16, v107
    v_and_b32 v177, s49, v107
    v_lshlrev_b32 v178, 16, v108
    v_and_b32 v179, s49, v108
    v_lshlrev_b32 v180, 16, v109
    v_and_b32 v181, s49, v109
    s_waitcnt vmcnt(15)
    v_lshlrev_b32 v182, 16, v110
    v_and_b32 v183, s49, v110
    v_lshlrev_b32 v184, 16, v111
    v_and_b32 v185, s49, v111
    v_lshlrev_b32 v186, 16, v112
    v_and_b32 v187, s49, v112
    v_lshlrev_b32 v188, 16, v113
    v_and_b32 v189, s49, v113
    s_waitcnt vmcnt(13)
    v_lshlrev_b32 v190, 16, v114
    v_and_b32 v191, s49, v114
    v_lshlrev_b32 v192, 16, v115
    v_and_b32 v193, s49, v115
    v_lshlrev_b32 v194, 16, v116
    v_and_b32 v195, s49, v116
    v_lshlrev_b32 v196, 16, v117
    v_and_b32 v197, s49, v117
    s_waitcnt vmcnt(11)
    v_lshlrev_b32 v198, 16, v118
    v_and_b32 v199, s49, v118
    v_lshlrev_b32 v200, 16, v119
    v_and_b32 v201, s49, v119
    v_lshlrev_b32 v202, 16, v120
    v_and_b32 v203, s49, v120
    v_lshlrev_b32 v204, 16, v121
    v_and_b32 v205, s49, v121
    s_waitcnt vmcnt(9)
    v_lshlrev_b32 v162, 16, v100
    v_and_b32 v163, s49, v100
    v_lshlrev_b32 v164, 16, v101
    v_and_b32 v165, s49, v101
    v_lshlrev_b32 v166, 16, v102
    v_and_b32 v167, s49, v102
    v_lshlrev_b32 v168, 16, v103
    v_and_b32 v169, s49, v103
    s_waitcnt vmcnt(8)
    v_lshlrev_b32 v170, 16, v104
    v_and_b32 v171, s49, v104
    v_lshlrev_b32 v172, 16, v105
    v_and_b32 v173, s49, v105
    buffer_load_dwordx4 v[32:35], v2, s[16:19], 0 offen offset:0 nt
    buffer_load_dwordx2 v[36:37], v2, s[16:19], 0 offen offset:16 nt
    buffer_load_dwordx4 v[44:47], v2, s[16:19], 0 offen offset:1024 nt
    buffer_load_dwordx2 v[48:49], v2, s[16:19], 0 offen offset:1040 nt
    buffer_load_dwordx4 v[56:59], v2, s[16:19], 0 offen offset:2048 nt
    buffer_load_dwordx2 v[60:61], v2, s[16:19], 0 offen offset:2064 nt
    buffer_load_dwordx4 v[68:71], v2, s[16:19], 0 offen offset:3072 nt
    buffer_load_dwordx2 v[72:73], v2, s[16:19], 0 offen offset:3088 nt
    buffer_load_dwordx2 v[84:85], v29, s[16:19], 0 offen
    v_and_b32 v26, 7, v0
    v_lshlrev_b32 v26, 11, v26
    v_bfe_u32 v4, v0, 3, 2
    v_lshl_add_u32 v26, v4, 4, v26
    v_lshrrev_b32_e64 v4, 5, v0
    v_lshl_add_u32 v26, v4, 8, v26
    s_lshl_b32 s47, s36, 14
    s_lshl_b32 s56, s3, 9
    s_add_u32 s47, s47, s56
    v_pk_mul_f32 v[206:207], v[174:175], v[146:147]
    v_pk_mul_f32 v[208:209], v[176:177], v[148:149]
    v_pk_mul_f32 v[210:211], v[178:179], v[146:147]
    v_pk_mul_f32 v[212:213], v[180:181], v[148:149]
    v_pk_mul_f32 v[214:215], v[182:183], v[146:147]
    v_pk_mul_f32 v[216:217], v[184:185], v[148:149]
    v_pk_mul_f32 v[218:219], v[186:187], v[146:147]
    v_pk_mul_f32 v[220:221], v[188:189], v[148:149]
    v_pk_mul_f32 v[222:223], v[190:191], v[146:147]
    v_pk_mul_f32 v[224:225], v[192:193], v[148:149]
    v_pk_mul_f32 v[226:227], v[194:195], v[146:147]
    v_pk_mul_f32 v[228:229], v[196:197], v[148:149]
    v_pk_mul_f32 v[230:231], v[198:199], v[146:147]
    v_pk_mul_f32 v[232:233], v[200:201], v[148:149]
    v_pk_mul_f32 v[234:235], v[202:203], v[146:147]
    v_pk_mul_f32 v[236:237], v[204:205], v[148:149]
    v_pk_fma_f32 v[206:207], v[170:171], v[150:151], v[206:207]
    v_pk_fma_f32 v[208:209], v[172:173], v[152:153], v[208:209]
    v_pk_fma_f32 v[210:211], v[174:175], v[150:151], v[210:211]
    v_pk_fma_f32 v[212:213], v[176:177], v[152:153], v[212:213]
    v_pk_fma_f32 v[214:215], v[178:179], v[150:151], v[214:215]
    v_pk_fma_f32 v[216:217], v[180:181], v[152:153], v[216:217]
    v_pk_fma_f32 v[218:219], v[182:183], v[150:151], v[218:219]
    v_pk_fma_f32 v[220:221], v[184:185], v[152:153], v[220:221]
    v_pk_fma_f32 v[222:223], v[186:187], v[150:151], v[222:223]
    v_pk_fma_f32 v[224:225], v[188:189], v[152:153], v[224:225]
    v_pk_fma_f32 v[226:227], v[190:191], v[150:151], v[226:227]
    v_pk_fma_f32 v[228:229], v[192:193], v[152:153], v[228:229]
    v_pk_fma_f32 v[230:231], v[194:195], v[150:151], v[230:231]
    v_pk_fma_f32 v[232:233], v[196:197], v[152:153], v[232:233]
    v_pk_fma_f32 v[234:235], v[198:199], v[150:151], v[234:235]
    v_pk_fma_f32 v[236:237], v[200:201], v[152:153], v[236:237]
    v_pk_fma_f32 v[206:207], v[166:167], v[154:155], v[206:207]
    v_pk_fma_f32 v[208:209], v[168:169], v[156:157], v[208:209]
    v_pk_fma_f32 v[210:211], v[170:171], v[154:155], v[210:211]
    v_pk_fma_f32 v[212:213], v[172:173], v[156:157], v[212:213]
    v_pk_fma_f32 v[214:215], v[174:175], v[154:155], v[214:215]
    v_pk_fma_f32 v[216:217], v[176:177], v[156:157], v[216:217]
    v_pk_fma_f32 v[218:219], v[178:179], v[154:155], v[218:219]
    v_pk_fma_f32 v[220:221], v[180:181], v[156:157], v[220:221]
    v_pk_fma_f32 v[222:223], v[182:183], v[154:155], v[222:223]
    v_pk_fma_f32 v[224:225], v[184:185], v[156:157], v[224:225]
    v_pk_fma_f32 v[226:227], v[186:187], v[154:155], v[226:227]
    v_pk_fma_f32 v[228:229], v[188:189], v[156:157], v[228:229]
    v_pk_fma_f32 v[230:231], v[190:191], v[154:155], v[230:231]
    v_pk_fma_f32 v[232:233], v[192:193], v[156:157], v[232:233]
    v_pk_fma_f32 v[234:235], v[194:195], v[154:155], v[234:235]
    v_pk_fma_f32 v[236:237], v[196:197], v[156:157], v[236:237]
    v_pk_fma_f32 v[206:207], v[162:163], v[158:159], v[206:207]
    v_pk_fma_f32 v[208:209], v[164:165], v[160:161], v[208:209]
    v_pk_fma_f32 v[210:211], v[166:167], v[158:159], v[210:211]
    v_pk_fma_f32 v[212:213], v[168:169], v[160:161], v[212:213]
    v_pk_fma_f32 v[214:215], v[170:171], v[158:159], v[214:215]
    v_pk_fma_f32 v[216:217], v[172:173], v[160:161], v[216:217]
    v_pk_fma_f32 v[218:219], v[174:175], v[158:159], v[218:219]
    v_pk_fma_f32 v[220:221], v[176:177], v[160:161], v[220:221]
    v_pk_fma_f32 v[222:223], v[178:179], v[158:159], v[222:223]
    v_pk_fma_f32 v[224:225], v[180:181], v[160:161], v[224:225]
    v_pk_fma_f32 v[226:227], v[182:183], v[158:159], v[226:227]
    v_pk_fma_f32 v[228:229], v[184:185], v[160:161], v[228:229]
    v_pk_fma_f32 v[230:231], v[186:187], v[158:159], v[230:231]
    v_pk_fma_f32 v[232:233], v[188:189], v[160:161], v[232:233]
    v_pk_fma_f32 v[234:235], v[190:191], v[158:159], v[234:235]
    v_pk_fma_f32 v[236:237], v[192:193], v[160:161], v[236:237]
    buffer_load_dword v30, v1, s[24:27], 0 offen sc1
    s_waitcnt vmcnt(10) lgkmcnt(0)
    v_lshlrev_b32 v162, 16, v122
    v_and_b32 v163, s49, v122
    v_lshlrev_b32 v164, 16, v123
    v_and_b32 v165, s49, v123
    v_lshlrev_b32 v166, 16, v124
    v_and_b32 v167, s49, v124
    v_lshlrev_b32 v168, 16, v125
    v_and_b32 v169, s49, v125
    v_lshlrev_b32 v170, 16, v126
    v_and_b32 v171, s49, v126
    v_lshlrev_b32 v172, 16, v127
    v_and_b32 v173, s49, v127
    v_lshlrev_b32 v174, 16, v128
    v_and_b32 v175, s49, v128
    v_lshlrev_b32 v176, 16, v129
    v_and_b32 v177, s49, v129
    v_lshlrev_b32 v178, 16, v130
    v_and_b32 v179, s49, v130
    v_lshlrev_b32 v180, 16, v131
    v_and_b32 v181, s49, v131
    v_lshlrev_b32 v182, 16, v132
    v_and_b32 v183, s49, v132
    v_lshlrev_b32 v184, 16, v133
    v_and_b32 v185, s49, v133
    v_lshlrev_b32 v186, 16, v134
    v_and_b32 v187, s49, v134
    v_lshlrev_b32 v188, 16, v135
    v_and_b32 v189, s49, v135
    v_lshlrev_b32 v190, 16, v136
    v_and_b32 v191, s49, v136
    v_lshlrev_b32 v192, 16, v137
    v_and_b32 v193, s49, v137
    s_lshr_b32 s62, s12, 7
    s_sub_u32 s62, 3, s62
    s_and_b32 s62, s62, 7
    s_cmp_ge_u32 s3, 2
    s_cselect_b32 s4, s14, s12
    s_cselect_b32 s5, s15, s13
    s_mov_b32 s6, 7340032
    s_mov_b32 s12, s28
    s_mov_b32 s13, s29
    s_mov_b32 s14, 0x400000
    s_mov_b32 s15, 0x00020000
    v_pk_mul_f32 v[206:207], v[206:207], v[162:163]
    v_pk_mul_f32 v[208:209], v[208:209], v[164:165]
    v_pk_mul_f32 v[210:211], v[210:211], v[166:167]
    v_pk_mul_f32 v[212:213], v[212:213], v[168:169]
    v_pk_mul_f32 v[214:215], v[214:215], v[170:171]
    v_pk_mul_f32 v[216:217], v[216:217], v[172:173]
    v_pk_mul_f32 v[218:219], v[218:219], v[174:175]
    v_pk_mul_f32 v[220:221], v[220:221], v[176:177]
    v_pk_mul_f32 v[222:223], v[222:223], v[178:179]
    v_pk_mul_f32 v[224:225], v[224:225], v[180:181]
    v_pk_mul_f32 v[226:227], v[226:227], v[182:183]
    v_pk_mul_f32 v[228:229], v[228:229], v[184:185]
    v_pk_mul_f32 v[230:231], v[230:231], v[186:187]
    v_pk_mul_f32 v[232:233], v[232:233], v[188:189]
    v_pk_mul_f32 v[234:235], v[234:235], v[190:191]
    v_pk_mul_f32 v[236:237], v[236:237], v[192:193]
    v_cvt_pk_bf16_f32 v100, v234, v230
    v_cvt_pk_bf16_f32 v101, v226, v222
    v_cvt_pk_bf16_f32 v102, v218, v214
    v_cvt_pk_bf16_f32 v103, v210, v206
    buffer_store_dwordx4 v[100:103], v23, s[12:15], 0 offen sc1
    v_cvt_pk_bf16_f32 v104, v235, v231
    v_cvt_pk_bf16_f32 v105, v227, v223
    v_cvt_pk_bf16_f32 v106, v219, v215
    v_cvt_pk_bf16_f32 v107, v211, v207
    buffer_store_dwordx4 v[104:107], v23, s[12:15], s44 offen sc1
    v_cvt_pk_bf16_f32 v108, v236, v232
    v_cvt_pk_bf16_f32 v109, v228, v224
    v_cvt_pk_bf16_f32 v110, v220, v216
    v_cvt_pk_bf16_f32 v111, v212, v208
    buffer_store_dwordx4 v[108:111], v23, s[12:15], s45 offen sc1
    v_cvt_pk_bf16_f32 v112, v237, v233
    v_cvt_pk_bf16_f32 v113, v229, v225
    v_cvt_pk_bf16_f32 v114, v221, v217
    v_cvt_pk_bf16_f32 v115, v213, v209
    buffer_store_dwordx4 v[112:115], v23, s[12:15], s46 offen sc1
    buffer_load_dwordx4 v[240:243], v26, s[20:23], s47 offen offset:0 nt
    buffer_load_dwordx4 v[244:247], v26, s[20:23], s47 offen offset:64 nt
    buffer_load_dwordx4 v[248:251], v26, s[20:23], s47 offen offset:128 nt
    buffer_load_dwordx4 v[252:255], v26, s[20:23], s47 offen offset:192 nt
    s_and_b32 s54, s40, 1
    s_lshl_b32 s53, s48, 16
    s_and_b32 s48, s48, 0xffff0000
    s_cmp_eq_u32 s54, 0
    s_cselect_b32 s48, s53, s48
    s_lshl_b32 s53, s2, 1
    s_and_b32 s54, s3, 1
    s_add_u32 s53, s53, s54
    s_mul_i32 s54, s53, 8960
    s_mul_i32 s53, s53, 896
    s_add_u32 s53, s53, 6881280
    v_lshlrev_b32 v22, 7, v0
    v_add_u32 v21, s53, v22
    v_add_u32 v22, s54, v22
    v_add_u32 v27, 7296, v22
    v_cmp_gt_u32 vcc, 7, v0
    v_mov_b32 v23, 0x40000000
    s_mov_b32 s54, 0
    v_cndmask_b32 v21, v27, v21, vcc
    v_cmp_gt_u32 vcc, 13, v0
    s_add_u32 s8, s28, 0x400000
    s_addc_u32 s9, s29, 0
    s_mov_b32 s10, 0x400000
    s_mov_b32 s11, 0x00020000
    v_cndmask_b32 v21, v23, v21, vcc
    v_cmp_gt_u32 vcc, 64, v0
    s_nop 1
    v_cndmask_b32 v22, v23, v22, vcc
    s_waitcnt vmcnt(8)
    v_readfirstlane_b32 s30, v30
    s_mov_b32 s56, 0
    s_cmp_ge_u32 s30, 1
    s_cbranch_scc1 L_ready
L_poll_1:
    buffer_load_dword v4, v1, s[24:27], s54 offen sc1
    s_add_u32 s56, s56, 1
    s_waitcnt vmcnt(0)
    v_readfirstlane_b32 s30, v4
    s_cmp_ge_u32 s30, 1
    s_cbranch_scc1 L_ready
    s_cmp_lt_u32 s56, 400000
    s_cbranch_scc1 L_poll_1
L_ready:
    s_add_u32 s24, s28, 0x2c00000
    s_addc_u32 s25, s29, 0
    s_mov_b32 s26, 0x2000
    s_mov_b32 s27, 0x00020000
    s_waitcnt vmcnt(4)
    s_barrier
    s_cmp_lg_u32 s3, 0
    s_cbranch_scc1 L_wf_2
    s_mov_b64 exec, 1
    v_mov_b32 v3, 0
    v_mov_b32_e64 v4, 1
    buffer_atomic_add v4, v3, s[24:27], s43 offen sc1
    s_mov_b64 exec, -1
L_wf_2:
    v_alignbit_b32 v38, v33, v32, 16
    v_alignbit_b32 v39, v34, v33, 16
    v_alignbit_b32 v40, v35, v34, 16
    v_alignbit_b32 v41, v36, v35, 16
    v_alignbit_b32 v42, v37, v36, 16
    ds_write_b128 v5, v[32:35] offset:32
    ds_write_b128 v5, v[38:41] offset:4192
    v_mov_b32 v92, v33
    v_mov_b32 v93, v34
    v_mov_b32 v94, v35
    v_mov_b32 v95, v36
    v_mov_b32 v96, v39
    v_mov_b32 v97, v40
    v_mov_b32 v98, v41
    v_mov_b32_e64 v99, v42
    ds_write_b128 v5, v[92:95] offset:8352
    ds_write_b128 v5, v[96:99] offset:12512
    v_alignbit_b32 v50, v45, v44, 16
    v_alignbit_b32 v51, v46, v45, 16
    v_alignbit_b32 v52, v47, v46, 16
    v_alignbit_b32 v53, v48, v47, 16
    v_alignbit_b32 v54, v49, v48, 16
    ds_write_b128 v5, v[44:47] offset:1056
    ds_write_b128 v5, v[50:53] offset:5216
    v_mov_b32 v92, v45
    v_mov_b32 v93, v46
    v_mov_b32 v94, v47
    v_mov_b32 v95, v48
    v_mov_b32 v96, v51
    v_mov_b32 v97, v52
    v_mov_b32 v98, v53
    v_mov_b32 v99, v54
    ds_write_b128 v5, v[92:95] offset:9376
    ds_write_b128 v5, v[96:99] offset:13536
    v_alignbit_b32 v62, v57, v56, 16
    v_alignbit_b32 v63, v58, v57, 16
    v_alignbit_b32 v64, v59, v58, 16
    v_alignbit_b32 v65, v60, v59, 16
    v_alignbit_b32 v66, v61, v60, 16
    ds_write_b128 v5, v[56:59] offset:2080
    ds_write_b128 v5, v[62:65] offset:6240
    v_mov_b32 v92, v57
    v_mov_b32 v93, v58
    v_mov_b32 v94, v59
    v_mov_b32 v95, v60
    v_mov_b32 v96, v63
    v_mov_b32 v97, v64
    v_mov_b32 v98, v65
    v_mov_b32 v99, v66
    ds_write_b128 v5, v[92:95] offset:10400
    ds_write_b128 v5, v[96:99] offset:14560
    v_alignbit_b32 v74, v69, v68, 16
    v_alignbit_b32 v75, v70, v69, 16
    v_alignbit_b32 v76, v71, v70, 16
    v_alignbit_b32 v77, v72, v71, 16
    v_alignbit_b32 v78, v73, v72, 16
    ds_write_b128 v5, v[68:71] offset:3104
    ds_write_b128 v5, v[74:77] offset:7264
    v_mov_b32 v92, v69
    v_mov_b32 v93, v70
    v_mov_b32 v94, v71
    v_mov_b32 v95, v72
    v_mov_b32 v96, v75
    v_mov_b32 v97, v76
    v_mov_b32 v98, v77
    v_mov_b32 v99, v78
    ds_write_b128 v5, v[92:95] offset:11424
    ds_write_b128 v5, v[96:99] offset:15584
    s_mov_b64 exec, 3
    v_alignbit_b32 v86, v81, v80, 16
    v_alignbit_b32 v87, v82, v81, 16
    v_alignbit_b32 v88, v83, v82, 16
    v_alignbit_b32 v89, v84, v83, 16
    v_alignbit_b32 v90, v85, v84, 16
    ds_write_b128 v5, v[80:83] offset:0
    ds_write_b128 v5, v[86:89] offset:4160
    v_mov_b32 v92, v81
    v_mov_b32 v93, v82
    v_mov_b32 v94, v83
    v_mov_b32 v95, v84
    v_mov_b32 v96, v87
    v_mov_b32 v97, v88
    v_mov_b32 v98, v89
    v_mov_b32_e64 v99, v90
    ds_write_b128 v5, v[92:95] offset:8320
    ds_write_b128 v5, v[96:99] offset:12480
    s_mov_b64 exec, -1
    s_lshr_b32 s43, s39, 4
    s_lshl_b32 s43, s43, 8
    s_add_u32 s43, s43, 0
    s_mov_b32 m0, s51
    s_cmp_lg_u32 s3, 1
    s_cbranch_scc1 L_upoll
    s_mov_b32 s56, 0
L_poll_3:
    buffer_load_dword v4, v1, s[24:27], s43 offen sc1
    s_add_u32 s56, s56, 1
    s_waitcnt vmcnt(0)
    v_readfirstlane_b32 s30, v4
    s_cmp_ge_u32 s30, 16
    s_cbranch_scc1 L_polld_4
    s_cmp_lt_u32 s56, 400000
    s_cbranch_scc1 L_poll_3
L_polld_4:
L_upoll:
    s_barrier
    buffer_load_dwordx4 v2, s[12:15], s41 offen offset:0 sc1 lds
    buffer_load_dwordx4 v2, s[12:15], s41 offen offset:1024 sc1 lds
    buffer_load_dwordx4 v2, s[12:15], s41 offen offset:2048 sc1 lds
    buffer_load_dwordx4 v2, s[12:15], s41 offen offset:3072 sc1 lds
    s_waitcnt vmcnt(0) lgkmcnt(0)
    ds_read_b64 a[0:1], v18 offset:0
    ds_read_b64 a[2:3], v18 offset:8
    ds_read_b128 a[32:35], v19 offset:3584
    ds_read_b128 a[36:39], v19 offset:3072
    ds_read_b128 a[40:43], v19 offset:2560
    ds_read_b128 a[44:47], v19 offset:2048
    ds_read_b128 a[48:51], v19 offset:1536
    ds_read_b128 a[52:55], v19 offset:1024
    ds_read_b128 a[56:59], v19 offset:512
    ds_read_b128 a[60:63], v19 offset:0
    ds_read_b64 a[4:5], v18 offset:512
    ds_read_b64 a[6:7], v18 offset:520
    ds_read_b64 a[8:9], v18 offset:1024
    ds_read_b64 a[10:11], v18 offset:1032
    ds_read_b64 a[12:13], v18 offset:1536
    ds_read_b64 a[14:15], v18 offset:1544
    ds_read_b64 a[16:17], v18 offset:2048
    ds_read_b64 a[18:19], v18 offset:2056
    ds_read_b64 a[20:21], v18 offset:2560
    ds_read_b64 a[22:23], v18 offset:2568
    ds_read_b64 a[24:25], v18 offset:3072
    ds_read_b64 a[26:27], v18 offset:3080
    ds_read_b64 a[28:29], v18 offset:3584
    ds_read_b64 a[30:31], v18 offset:3592
    s_waitcnt lgkmcnt(14)
    v_mfma_f32_16x16x32_bf16 v[100:103], a[0:3], a[32:35], 0
    ds_read_b64 a[64:65], v18 offset:64
    v_mfma_f32_16x16x32_bf16 v[104:107], a[0:3], a[36:39], 0
    ds_read_b64 a[66:67], v18 offset:72
    v_mfma_f32_16x16x32_bf16 v[108:111], a[0:3], a[40:43], 0
    ds_read_b128 a[96:99], v19 offset:3648
    v_mfma_f32_16x16x32_bf16 v[112:115], a[0:3], a[44:47], 0
    ds_read_b128 a[100:103], v19 offset:3136
    v_mfma_f32_16x16x32_bf16 v[116:119], a[0:3], a[48:51], 0
    ds_read_b128 a[104:107], v19 offset:2624
    v_mfma_f32_16x16x32_bf16 v[120:123], a[0:3], a[52:55], 0
    ds_read_b128 a[108:111], v19 offset:2112
    v_mfma_f32_16x16x32_bf16 v[124:127], a[0:3], a[56:59], 0
    ds_read_b128 a[112:115], v19 offset:1600
    v_mfma_f32_16x16x32_bf16 v[128:131], a[0:3], a[60:63], 0
    ds_read_b128 a[116:119], v19 offset:1088
    s_waitcnt lgkmcnt(15)
    v_mfma_f32_16x16x32_bf16 v[104:107], a[4:7], a[32:35], v[104:107]
    ds_read_b128 a[120:123], v19 offset:576
    s_and_b32 s56, s3, 1
    v_mfma_f32_16x16x32_bf16 v[108:111], a[4:7], a[36:39], v[108:111]
    ds_read_b128 a[124:127], v19 offset:64
    s_mul_i32 s56, s56, 448
    v_mfma_f32_16x16x32_bf16 v[112:115], a[4:7], a[40:43], v[112:115]
    ds_read_b64 a[68:69], v18 offset:576
    s_mul_i32 s57, s32, 224
    v_mfma_f32_16x16x32_bf16 v[116:119], a[4:7], a[44:47], v[116:119]
    ds_read_b64 a[70:71], v18 offset:584
    s_mov_b32 s60, s62
    v_mfma_f32_16x16x32_bf16 v[120:123], a[4:7], a[48:51], v[120:123]
    ds_read_b64 a[72:73], v18 offset:1088
    s_sub_u32 s61, 7, s62
    v_mfma_f32_16x16x32_bf16 v[124:127], a[4:7], a[52:55], v[124:127]
    ds_read_b64 a[74:75], v18 offset:1096
    v_add_u32 v200, 0, v0
    v_mfma_f32_16x16x32_bf16 v[128:131], a[4:7], a[56:59], v[128:131]
    ds_read_b64 a[76:77], v18 offset:1600
    v_add_u32 v200, s56, v200
    s_waitcnt lgkmcnt(15)
    v_mfma_f32_16x16x32_bf16 v[108:111], a[8:11], a[32:35], v[108:111]
    ds_read_b64 a[78:79], v18 offset:1608
    v_mul_u32_u24 v201, 4682, v200
    v_mfma_f32_16x16x32_bf16 v[112:115], a[8:11], a[36:39], v[112:115]
    ds_read_b64 a[80:81], v18 offset:2112
    v_lshrrev_b32_e64 v201, 16, v201
    v_mfma_f32_16x16x32_bf16 v[116:119], a[8:11], a[40:43], v[116:119]
    ds_read_b64 a[82:83], v18 offset:2120
    v_mul_u32_u24_e64 v202, 14, v201
    v_mfma_f32_16x16x32_bf16 v[120:123], a[8:11], a[44:47], v[120:123]
    ds_read_b64 a[84:85], v18 offset:2624
    v_sub_u32_e64 v202, v200, v202
    v_mfma_f32_16x16x32_bf16 v[124:127], a[8:11], a[48:51], v[124:127]
    ds_read_b64 a[86:87], v18 offset:2632
    v_and_b32_e64 v203, 0x33, v201
    v_mfma_f32_16x16x32_bf16 v[128:131], a[8:11], a[52:55], v[128:131]
    ds_read_b64 a[88:89], v18 offset:3136
    v_and_b32 v204, 4, v201
    s_waitcnt lgkmcnt(15)
    v_mfma_f32_16x16x32_bf16 v[112:115], a[12:15], a[32:35], v[112:115]
    ds_read_b64 a[90:91], v18 offset:3144
    v_lshl_or_b32 v203, v204, 1, v203
    v_mfma_f32_16x16x32_bf16 v[116:119], a[12:15], a[36:39], v[116:119]
    ds_read_b64 a[92:93], v18 offset:3648
    v_and_b32_e64 v204, 8, v201
    v_mfma_f32_16x16x32_bf16 v[120:123], a[12:15], a[40:43], v[120:123]
    ds_read_b64 a[94:95], v18 offset:3656
    v_lshrrev_b32_e64 v204, 1, v204
    v_mfma_f32_16x16x32_bf16 v[124:127], a[12:15], a[44:47], v[124:127]
    v_or_b32_e64 v203, v203, v204
    v_mfma_f32_16x16x32_bf16 v[128:131], a[12:15], a[48:51], v[128:131]
    v_mul_u32_u24 v203, 7168, v203
    s_waitcnt lgkmcnt(15)
    v_mfma_f32_16x16x32_bf16 v[116:119], a[16:19], a[32:35], v[116:119]
    v_lshl_add_u32 v202, v202, 4, s57
    v_mfma_f32_16x16x32_bf16 v[120:123], a[16:19], a[36:39], v[120:123]
    v_lshrrev_b32 v200, 7, v202
    v_mfma_f32_16x16x32_bf16 v[124:127], a[16:19], a[40:43], v[124:127]
    v_mul_u32_u24_e64 v201, 37, v200
    v_mfma_f32_16x16x32_bf16 v[128:131], a[16:19], a[44:47], v[128:131]
    v_lshrrev_b32 v201, 8, v201
    s_waitcnt lgkmcnt(15)
    v_mfma_f32_16x16x32_bf16 v[120:123], a[20:23], a[32:35], v[120:123]
    v_mul_u32_u24_e64 v204, 7, v201
    v_mfma_f32_16x16x32_bf16 v[124:127], a[20:23], a[36:39], v[124:127]
    v_cmp_eq_u32 vcc, v204, v200
    v_mfma_f32_16x16x32_bf16 v[128:131], a[20:23], a[40:43], v[128:131]
    v_lshl_add_u32 v204, v201, 3, s60
    s_waitcnt lgkmcnt(15)
    v_mfma_f32_16x16x32_bf16 v[124:127], a[24:27], a[32:35], v[124:127]
    v_add_u32_e64 v201, 1, v201
    v_mfma_f32_16x16x32_bf16 v[128:131], a[24:27], a[36:39], v[128:131]
    v_min_u32 v201, 7, v201
    s_waitcnt lgkmcnt(15)
    v_mfma_f32_16x16x32_bf16 v[128:131], a[28:31], a[32:35], v[128:131]
    v_sub_u32 v201, v200, v201
    s_waitcnt lgkmcnt(0)
    v_mfma_f32_16x16x32_bf16 v[100:103], a[64:67], a[96:99], v[100:103]
    ds_read_b64 a[0:1], v18 offset:128
    v_add_u32_e64 v205, s61, v201
    v_mfma_f32_16x16x32_bf16 v[104:107], a[64:67], a[100:103], v[104:107]
    ds_read_b64 a[2:3], v18 offset:136
    v_mul_u32_u24_e64 v205, 37, v205
    v_mfma_f32_16x16x32_bf16 v[108:111], a[64:67], a[104:107], v[108:111]
    ds_read_b128 a[32:35], v19 offset:3712
    v_lshrrev_b32_e64 v205, 8, v205
    v_mfma_f32_16x16x32_bf16 v[112:115], a[64:67], a[108:111], v[112:115]
    ds_read_b128 a[36:39], v19 offset:3200
    v_add_u32_e64 v201, v201, v205
    v_mfma_f32_16x16x32_bf16 v[116:119], a[64:67], a[112:115], v[116:119]
    ds_read_b128 a[40:43], v19 offset:2688
    v_cndmask_b32 v204, v201, v204, vcc
    v_mfma_f32_16x16x32_bf16 v[120:123], a[64:67], a[116:119], v[120:123]
    ds_read_b128 a[44:47], v19 offset:2176
    v_cmp_eq_u32 vcc, 49, v200
    v_mfma_f32_16x16x32_bf16 v[124:127], a[64:67], a[120:123], v[124:127]
    ds_read_b128 a[48:51], v19 offset:1664
    v_and_b32 v202, 127, v202
    v_mfma_f32_16x16x32_bf16 v[128:131], a[64:67], a[124:127], v[128:131]
    ds_read_b128 a[52:55], v19 offset:1152
    v_cndmask_b32 v204, v204, v201, vcc
    v_mfma_f32_16x16x32_bf16 v[104:107], a[68:71], a[96:99], v[104:107]
    ds_read_b128 a[56:59], v19 offset:640
    v_lshl_add_u32 v202, v204, 7, v202
    v_mfma_f32_16x16x32_bf16 v[108:111], a[68:71], a[100:103], v[108:111]
    ds_read_b128 a[60:63], v19 offset:128
    v_add_u32 v8, v202, v203
    v_mfma_f32_16x16x32_bf16 v[112:115], a[68:71], a[104:107], v[112:115]
    ds_read_b64 a[4:5], v18 offset:640
    v_add_u32_e64 v200, 64, v0
    v_mfma_f32_16x16x32_bf16 v[116:119], a[68:71], a[108:111], v[116:119]
    ds_read_b64 a[6:7], v18 offset:648
    v_add_u32_e64 v200, s56, v200
    v_mfma_f32_16x16x32_bf16 v[120:123], a[68:71], a[112:115], v[120:123]
    ds_read_b64 a[8:9], v18 offset:1152
    v_mul_u32_u24 v201, 4682, v200
    v_mfma_f32_16x16x32_bf16 v[124:127], a[68:71], a[116:119], v[124:127]
    ds_read_b64 a[10:11], v18 offset:1160
    v_lshrrev_b32_e64 v201, 16, v201
    v_mfma_f32_16x16x32_bf16 v[128:131], a[68:71], a[120:123], v[128:131]
    ds_read_b64 a[12:13], v18 offset:1664
    v_mul_u32_u24_e64 v202, 14, v201
    v_mfma_f32_16x16x32_bf16 v[108:111], a[72:75], a[96:99], v[108:111]
    ds_read_b64 a[14:15], v18 offset:1672
    v_sub_u32_e64 v202, v200, v202
    v_mfma_f32_16x16x32_bf16 v[112:115], a[72:75], a[100:103], v[112:115]
    ds_read_b64 a[16:17], v18 offset:2176
    v_and_b32_e64 v203, 0x33, v201
    v_mfma_f32_16x16x32_bf16 v[116:119], a[72:75], a[104:107], v[116:119]
    ds_read_b64 a[18:19], v18 offset:2184
    v_and_b32_e64 v204, 4, v201
    v_mfma_f32_16x16x32_bf16 v[120:123], a[72:75], a[108:111], v[120:123]
    ds_read_b64 a[20:21], v18 offset:2688
    v_lshl_or_b32 v203, v204, 1, v203
    v_mfma_f32_16x16x32_bf16 v[124:127], a[72:75], a[112:115], v[124:127]
    ds_read_b64 a[22:23], v18 offset:2696
    v_and_b32_e64 v204, 8, v201
    v_mfma_f32_16x16x32_bf16 v[128:131], a[72:75], a[116:119], v[128:131]
    ds_read_b64 a[24:25], v18 offset:3200
    v_lshrrev_b32_e64 v204, 1, v204
    v_mfma_f32_16x16x32_bf16 v[112:115], a[76:79], a[96:99], v[112:115]
    ds_read_b64 a[26:27], v18 offset:3208
    v_or_b32_e64 v203, v203, v204
    v_mfma_f32_16x16x32_bf16 v[116:119], a[76:79], a[100:103], v[116:119]
    ds_read_b64 a[28:29], v18 offset:3712
    v_mul_u32_u24 v203, 7168, v203
    v_mfma_f32_16x16x32_bf16 v[120:123], a[76:79], a[104:107], v[120:123]
    ds_read_b64 a[30:31], v18 offset:3720
    v_lshl_add_u32 v202, v202, 4, s57
    v_mfma_f32_16x16x32_bf16 v[124:127], a[76:79], a[108:111], v[124:127]
    v_lshrrev_b32_e64 v200, 7, v202
    v_mfma_f32_16x16x32_bf16 v[128:131], a[76:79], a[112:115], v[128:131]
    v_mul_u32_u24_e64 v201, 37, v200
    v_mfma_f32_16x16x32_bf16 v[116:119], a[80:83], a[96:99], v[116:119]
    v_lshrrev_b32_e64 v201, 8, v201
    v_mfma_f32_16x16x32_bf16 v[120:123], a[80:83], a[100:103], v[120:123]
    v_mul_u32_u24_e64 v204, 7, v201
    v_mfma_f32_16x16x32_bf16 v[124:127], a[80:83], a[104:107], v[124:127]
    v_cmp_eq_u32 vcc, v204, v200
    v_mfma_f32_16x16x32_bf16 v[128:131], a[80:83], a[108:111], v[128:131]
    v_lshl_add_u32 v204, v201, 3, s60
    v_mfma_f32_16x16x32_bf16 v[120:123], a[84:87], a[96:99], v[120:123]
    v_add_u32 v201, 1, v201
    v_mfma_f32_16x16x32_bf16 v[124:127], a[84:87], a[100:103], v[124:127]
    v_min_u32_e64 v201, 7, v201
    v_mfma_f32_16x16x32_bf16 v[128:131], a[84:87], a[104:107], v[128:131]
    v_sub_u32_e64 v201, v200, v201
    v_mfma_f32_16x16x32_bf16 v[124:127], a[88:91], a[96:99], v[124:127]
    v_add_u32_e64 v205, s61, v201
    v_mfma_f32_16x16x32_bf16 v[128:131], a[88:91], a[100:103], v[128:131]
    v_mul_u32_u24_e64 v205, 37, v205
    v_mfma_f32_16x16x32_bf16 v[128:131], a[92:95], a[96:99], v[128:131]
    v_lshrrev_b32 v205, 8, v205
    s_waitcnt lgkmcnt(0)
    v_mfma_f32_16x16x32_bf16 v[100:103], a[0:3], a[32:35], v[100:103]
    ds_read_b64 a[64:65], v18 offset:192
    v_add_u32_e64 v201, v201, v205
    v_mfma_f32_16x16x32_bf16 v[104:107], a[0:3], a[36:39], v[104:107]
    ds_read_b64 a[66:67], v18 offset:200
    v_cndmask_b32 v204, v201, v204, vcc
    v_mfma_f32_16x16x32_bf16 v[108:111], a[0:3], a[40:43], v[108:111]
    ds_read_b128 a[96:99], v19 offset:3776
    v_cmp_eq_u32 vcc, 49, v200
    v_mfma_f32_16x16x32_bf16 v[112:115], a[0:3], a[44:47], v[112:115]
    ds_read_b128 a[100:103], v19 offset:3264
    v_and_b32 v202, 127, v202
    v_mfma_f32_16x16x32_bf16 v[116:119], a[0:3], a[48:51], v[116:119]
    ds_read_b128 a[104:107], v19 offset:2752
    v_cndmask_b32 v204, v204, v201, vcc
    v_mfma_f32_16x16x32_bf16 v[120:123], a[0:3], a[52:55], v[120:123]
    ds_read_b128 a[108:111], v19 offset:2240
    v_lshl_add_u32 v202, v204, 7, v202
    v_mfma_f32_16x16x32_bf16 v[124:127], a[0:3], a[56:59], v[124:127]
    ds_read_b128 a[112:115], v19 offset:1728
    v_add_u32 v9, v202, v203
    v_mfma_f32_16x16x32_bf16 v[128:131], a[0:3], a[60:63], v[128:131]
    ds_read_b128 a[116:119], v19 offset:1216
    v_subrev_u32 v9, 1024, v9
    v_mfma_f32_16x16x32_bf16 v[104:107], a[4:7], a[32:35], v[104:107]
    ds_read_b128 a[120:123], v19 offset:704
    v_add_u32 v200, 128, v0
    v_mfma_f32_16x16x32_bf16 v[108:111], a[4:7], a[36:39], v[108:111]
    ds_read_b128 a[124:127], v19 offset:192
    v_add_u32_e64 v200, s56, v200
    v_mfma_f32_16x16x32_bf16 v[112:115], a[4:7], a[40:43], v[112:115]
    ds_read_b64 a[68:69], v18 offset:704
    v_mul_u32_u24 v201, 4682, v200
    v_mfma_f32_16x16x32_bf16 v[116:119], a[4:7], a[44:47], v[116:119]
    ds_read_b64 a[70:71], v18 offset:712
    v_lshrrev_b32_e64 v201, 16, v201
    v_mfma_f32_16x16x32_bf16 v[120:123], a[4:7], a[48:51], v[120:123]
    ds_read_b64 a[72:73], v18 offset:1216
    v_mul_u32_u24_e64 v202, 14, v201
    v_mfma_f32_16x16x32_bf16 v[124:127], a[4:7], a[52:55], v[124:127]
    ds_read_b64 a[74:75], v18 offset:1224
    v_sub_u32_e64 v202, v200, v202
    v_mfma_f32_16x16x32_bf16 v[128:131], a[4:7], a[56:59], v[128:131]
    ds_read_b64 a[76:77], v18 offset:1728
    v_and_b32_e64 v203, 0x33, v201
    v_mfma_f32_16x16x32_bf16 v[108:111], a[8:11], a[32:35], v[108:111]
    ds_read_b64 a[78:79], v18 offset:1736
    v_and_b32_e64 v204, 4, v201
    v_mfma_f32_16x16x32_bf16 v[112:115], a[8:11], a[36:39], v[112:115]
    ds_read_b64 a[80:81], v18 offset:2240
    v_lshl_or_b32 v203, v204, 1, v203
    v_mfma_f32_16x16x32_bf16 v[116:119], a[8:11], a[40:43], v[116:119]
    ds_read_b64 a[82:83], v18 offset:2248
    v_and_b32_e64 v204, 8, v201
    v_mfma_f32_16x16x32_bf16 v[120:123], a[8:11], a[44:47], v[120:123]
    ds_read_b64 a[84:85], v18 offset:2752
    v_lshrrev_b32_e64 v204, 1, v204
    v_mfma_f32_16x16x32_bf16 v[124:127], a[8:11], a[48:51], v[124:127]
    ds_read_b64 a[86:87], v18 offset:2760
    v_or_b32_e64 v203, v203, v204
    v_mfma_f32_16x16x32_bf16 v[128:131], a[8:11], a[52:55], v[128:131]
    ds_read_b64 a[88:89], v18 offset:3264
    v_mul_u32_u24 v203, 7168, v203
    v_mfma_f32_16x16x32_bf16 v[112:115], a[12:15], a[32:35], v[112:115]
    ds_read_b64 a[90:91], v18 offset:3272
    v_lshl_add_u32 v202, v202, 4, s57
    v_mfma_f32_16x16x32_bf16 v[116:119], a[12:15], a[36:39], v[116:119]
    ds_read_b64 a[92:93], v18 offset:3776
    v_lshrrev_b32_e64 v200, 7, v202
    v_mfma_f32_16x16x32_bf16 v[120:123], a[12:15], a[40:43], v[120:123]
    ds_read_b64 a[94:95], v18 offset:3784
    v_mul_u32_u24_e64 v201, 37, v200
    v_mfma_f32_16x16x32_bf16 v[124:127], a[12:15], a[44:47], v[124:127]
    v_lshrrev_b32_e64 v201, 8, v201
    v_mfma_f32_16x16x32_bf16 v[128:131], a[12:15], a[48:51], v[128:131]
    v_mul_u32_u24_e64 v204, 7, v201
    v_mfma_f32_16x16x32_bf16 v[116:119], a[16:19], a[32:35], v[116:119]
    v_cmp_eq_u32 vcc, v204, v200
    v_mfma_f32_16x16x32_bf16 v[120:123], a[16:19], a[36:39], v[120:123]
    v_lshl_add_u32 v204, v201, 3, s60
    v_mfma_f32_16x16x32_bf16 v[124:127], a[16:19], a[40:43], v[124:127]
    v_add_u32 v201, 1, v201
    v_mfma_f32_16x16x32_bf16 v[128:131], a[16:19], a[44:47], v[128:131]
    v_min_u32_e64 v201, 7, v201
    v_mfma_f32_16x16x32_bf16 v[120:123], a[20:23], a[32:35], v[120:123]
    v_sub_u32_e64 v201, v200, v201
    v_mfma_f32_16x16x32_bf16 v[124:127], a[20:23], a[36:39], v[124:127]
    v_add_u32_e64 v205, s61, v201
    v_mfma_f32_16x16x32_bf16 v[128:131], a[20:23], a[40:43], v[128:131]
    v_mul_u32_u24_e64 v205, 37, v205
    v_mfma_f32_16x16x32_bf16 v[124:127], a[24:27], a[32:35], v[124:127]
    v_lshrrev_b32_e64 v205, 8, v205
    v_mfma_f32_16x16x32_bf16 v[128:131], a[24:27], a[36:39], v[128:131]
    v_add_u32_e64 v201, v201, v205
    v_mfma_f32_16x16x32_bf16 v[128:131], a[28:31], a[32:35], v[128:131]
    v_cndmask_b32 v204, v201, v204, vcc
    s_waitcnt lgkmcnt(0)
    v_mfma_f32_16x16x32_bf16 v[100:103], a[64:67], a[96:99], v[100:103]
    ds_read_b64 a[0:1], v18 offset:256
    v_cmp_eq_u32 vcc, 49, v200
    v_mfma_f32_16x16x32_bf16 v[104:107], a[64:67], a[100:103], v[104:107]
    ds_read_b64 a[2:3], v18 offset:264
    v_and_b32 v202, 127, v202
    v_mfma_f32_16x16x32_bf16 v[108:111], a[64:67], a[104:107], v[108:111]
    ds_read_b128 a[32:35], v19 offset:3840
    v_cndmask_b32 v204, v204, v201, vcc
    v_mfma_f32_16x16x32_bf16 v[112:115], a[64:67], a[108:111], v[112:115]
    ds_read_b128 a[36:39], v19 offset:3328
    v_lshl_add_u32 v202, v204, 7, v202
    v_mfma_f32_16x16x32_bf16 v[116:119], a[64:67], a[112:115], v[116:119]
    ds_read_b128 a[40:43], v19 offset:2816
    v_add_u32_e64 v10, v202, v203
    v_mfma_f32_16x16x32_bf16 v[120:123], a[64:67], a[116:119], v[120:123]
    ds_read_b128 a[44:47], v19 offset:2304
    v_subrev_u32 v10, 2048, v10
    v_mfma_f32_16x16x32_bf16 v[124:127], a[64:67], a[120:123], v[124:127]
    ds_read_b128 a[48:51], v19 offset:1792
    v_add_u32 v200, 192, v0
    v_mfma_f32_16x16x32_bf16 v[128:131], a[64:67], a[124:127], v[128:131]
    ds_read_b128 a[52:55], v19 offset:1280
    v_add_u32_e64 v200, s56, v200
    v_mfma_f32_16x16x32_bf16 v[104:107], a[68:71], a[96:99], v[104:107]
    ds_read_b128 a[56:59], v19 offset:768
    v_mul_u32_u24 v201, 4682, v200
    v_mfma_f32_16x16x32_bf16 v[108:111], a[68:71], a[100:103], v[108:111]
    ds_read_b128 a[60:63], v19 offset:256
    v_lshrrev_b32_e64 v201, 16, v201
    v_mfma_f32_16x16x32_bf16 v[112:115], a[68:71], a[104:107], v[112:115]
    ds_read_b64 a[4:5], v18 offset:768
    v_mul_u32_u24_e64 v202, 14, v201
    v_mfma_f32_16x16x32_bf16 v[116:119], a[68:71], a[108:111], v[116:119]
    ds_read_b64 a[6:7], v18 offset:776
    v_sub_u32_e64 v202, v200, v202
    v_mfma_f32_16x16x32_bf16 v[120:123], a[68:71], a[112:115], v[120:123]
    ds_read_b64 a[8:9], v18 offset:1280
    v_and_b32_e64 v203, 0x33, v201
    v_mfma_f32_16x16x32_bf16 v[124:127], a[68:71], a[116:119], v[124:127]
    ds_read_b64 a[10:11], v18 offset:1288
    v_and_b32_e64 v204, 4, v201
    v_mfma_f32_16x16x32_bf16 v[128:131], a[68:71], a[120:123], v[128:131]
    ds_read_b64 a[12:13], v18 offset:1792
    v_lshl_or_b32 v203, v204, 1, v203
    v_mfma_f32_16x16x32_bf16 v[108:111], a[72:75], a[96:99], v[108:111]
    ds_read_b64 a[14:15], v18 offset:1800
    v_and_b32_e64 v204, 8, v201
    v_mfma_f32_16x16x32_bf16 v[112:115], a[72:75], a[100:103], v[112:115]
    ds_read_b64 a[16:17], v18 offset:2304
    v_lshrrev_b32_e64 v204, 1, v204
    v_mfma_f32_16x16x32_bf16 v[116:119], a[72:75], a[104:107], v[116:119]
    ds_read_b64 a[18:19], v18 offset:2312
    v_or_b32_e64 v203, v203, v204
    v_mfma_f32_16x16x32_bf16 v[120:123], a[72:75], a[108:111], v[120:123]
    ds_read_b64 a[20:21], v18 offset:2816
    v_mul_u32_u24 v203, 7168, v203
    v_mfma_f32_16x16x32_bf16 v[124:127], a[72:75], a[112:115], v[124:127]
    ds_read_b64 a[22:23], v18 offset:2824
    v_lshl_add_u32 v202, v202, 4, s57
    v_mfma_f32_16x16x32_bf16 v[128:131], a[72:75], a[116:119], v[128:131]
    ds_read_b64 a[24:25], v18 offset:3328
    v_lshrrev_b32_e64 v200, 7, v202
    v_mfma_f32_16x16x32_bf16 v[112:115], a[76:79], a[96:99], v[112:115]
    ds_read_b64 a[26:27], v18 offset:3336
    v_mul_u32_u24_e64 v201, 37, v200
    v_mfma_f32_16x16x32_bf16 v[116:119], a[76:79], a[100:103], v[116:119]
    ds_read_b64 a[28:29], v18 offset:3840
    v_lshrrev_b32_e64 v201, 8, v201
    v_mfma_f32_16x16x32_bf16 v[120:123], a[76:79], a[104:107], v[120:123]
    ds_read_b64 a[30:31], v18 offset:3848
    v_mul_u32_u24_e64 v204, 7, v201
    v_mfma_f32_16x16x32_bf16 v[124:127], a[76:79], a[108:111], v[124:127]
    v_cmp_eq_u32 vcc, v204, v200
    v_mfma_f32_16x16x32_bf16 v[128:131], a[76:79], a[112:115], v[128:131]
    v_lshl_add_u32 v204, v201, 3, s60
    v_mfma_f32_16x16x32_bf16 v[116:119], a[80:83], a[96:99], v[116:119]
    v_add_u32 v201, 1, v201
    v_mfma_f32_16x16x32_bf16 v[120:123], a[80:83], a[100:103], v[120:123]
    v_min_u32_e64 v201, 7, v201
    v_mfma_f32_16x16x32_bf16 v[124:127], a[80:83], a[104:107], v[124:127]
    v_sub_u32_e64 v201, v200, v201
    v_mfma_f32_16x16x32_bf16 v[128:131], a[80:83], a[108:111], v[128:131]
    v_add_u32_e64 v205, s61, v201
    v_mfma_f32_16x16x32_bf16 v[120:123], a[84:87], a[96:99], v[120:123]
    v_mul_u32_u24_e64 v205, 37, v205
    v_mfma_f32_16x16x32_bf16 v[124:127], a[84:87], a[100:103], v[124:127]
    v_lshrrev_b32_e64 v205, 8, v205
    v_mfma_f32_16x16x32_bf16 v[128:131], a[84:87], a[104:107], v[128:131]
    v_add_u32_e64 v201, v201, v205
    v_mfma_f32_16x16x32_bf16 v[124:127], a[88:91], a[96:99], v[124:127]
    v_cndmask_b32 v204, v201, v204, vcc
    v_mfma_f32_16x16x32_bf16 v[128:131], a[88:91], a[100:103], v[128:131]
    v_cmp_eq_u32 vcc, 49, v200
    v_mfma_f32_16x16x32_bf16 v[128:131], a[92:95], a[96:99], v[128:131]
    v_and_b32 v202, 127, v202
    s_waitcnt lgkmcnt(0)
    v_mfma_f32_16x16x32_bf16 v[100:103], a[0:3], a[32:35], v[100:103]
    ds_read_b64 a[64:65], v18 offset:320
    v_cndmask_b32 v204, v204, v201, vcc
    v_mfma_f32_16x16x32_bf16 v[104:107], a[0:3], a[36:39], v[104:107]
    ds_read_b64 a[66:67], v18 offset:328
    v_lshl_add_u32 v202, v204, 7, v202
    v_mfma_f32_16x16x32_bf16 v[108:111], a[0:3], a[40:43], v[108:111]
    ds_read_b128 a[96:99], v19 offset:3904
    v_add_u32_e64 v11, v202, v203
    v_mfma_f32_16x16x32_bf16 v[112:115], a[0:3], a[44:47], v[112:115]
    ds_read_b128 a[100:103], v19 offset:3392
    v_subrev_u32 v11, 3072, v11
    v_mfma_f32_16x16x32_bf16 v[116:119], a[0:3], a[48:51], v[116:119]
    ds_read_b128 a[104:107], v19 offset:2880
    v_add_u32 v200, 256, v0
    v_mfma_f32_16x16x32_bf16 v[120:123], a[0:3], a[52:55], v[120:123]
    ds_read_b128 a[108:111], v19 offset:2368
    v_add_u32_e64 v200, s56, v200
    v_mfma_f32_16x16x32_bf16 v[124:127], a[0:3], a[56:59], v[124:127]
    ds_read_b128 a[112:115], v19 offset:1856
    v_mul_u32_u24 v201, 4682, v200
    v_mfma_f32_16x16x32_bf16 v[128:131], a[0:3], a[60:63], v[128:131]
    ds_read_b128 a[116:119], v19 offset:1344
    v_lshrrev_b32_e64 v201, 16, v201
    v_mfma_f32_16x16x32_bf16 v[104:107], a[4:7], a[32:35], v[104:107]
    ds_read_b128 a[120:123], v19 offset:832
    v_mul_u32_u24_e64 v202, 14, v201
    v_mfma_f32_16x16x32_bf16 v[108:111], a[4:7], a[36:39], v[108:111]
    ds_read_b128 a[124:127], v19 offset:320
    v_sub_u32_e64 v202, v200, v202
    v_mfma_f32_16x16x32_bf16 v[112:115], a[4:7], a[40:43], v[112:115]
    ds_read_b64 a[68:69], v18 offset:832
    v_and_b32_e64 v203, 0x33, v201
    v_mfma_f32_16x16x32_bf16 v[116:119], a[4:7], a[44:47], v[116:119]
    ds_read_b64 a[70:71], v18 offset:840
    v_and_b32_e64 v204, 4, v201
    v_mfma_f32_16x16x32_bf16 v[120:123], a[4:7], a[48:51], v[120:123]
    ds_read_b64 a[72:73], v18 offset:1344
    v_lshl_or_b32 v203, v204, 1, v203
    v_mfma_f32_16x16x32_bf16 v[124:127], a[4:7], a[52:55], v[124:127]
    ds_read_b64 a[74:75], v18 offset:1352
    v_and_b32_e64 v204, 8, v201
    v_mfma_f32_16x16x32_bf16 v[128:131], a[4:7], a[56:59], v[128:131]
    ds_read_b64 a[76:77], v18 offset:1856
    v_lshrrev_b32_e64 v204, 1, v204
    v_mfma_f32_16x16x32_bf16 v[108:111], a[8:11], a[32:35], v[108:111]
    ds_read_b64 a[78:79], v18 offset:1864
    v_or_b32_e64 v203, v203, v204
    v_mfma_f32_16x16x32_bf16 v[112:115], a[8:11], a[36:39], v[112:115]
    ds_read_b64 a[80:81], v18 offset:2368
    v_mul_u32_u24 v203, 7168, v203
    v_mfma_f32_16x16x32_bf16 v[116:119], a[8:11], a[40:43], v[116:119]
    ds_read_b64 a[82:83], v18 offset:2376
    v_lshl_add_u32 v202, v202, 4, s57
    v_mfma_f32_16x16x32_bf16 v[120:123], a[8:11], a[44:47], v[120:123]
    ds_read_b64 a[84:85], v18 offset:2880
    v_lshrrev_b32_e64 v200, 7, v202
    v_mfma_f32_16x16x32_bf16 v[124:127], a[8:11], a[48:51], v[124:127]
    ds_read_b64 a[86:87], v18 offset:2888
    v_mul_u32_u24_e64 v201, 37, v200
    v_mfma_f32_16x16x32_bf16 v[128:131], a[8:11], a[52:55], v[128:131]
    ds_read_b64 a[88:89], v18 offset:3392
    v_lshrrev_b32_e64 v201, 8, v201
    v_mfma_f32_16x16x32_bf16 v[112:115], a[12:15], a[32:35], v[112:115]
    ds_read_b64 a[90:91], v18 offset:3400
    v_mul_u32_u24_e64 v204, 7, v201
    v_mfma_f32_16x16x32_bf16 v[116:119], a[12:15], a[36:39], v[116:119]
    ds_read_b64 a[92:93], v18 offset:3904
    v_cmp_eq_u32 vcc, v204, v200
    v_mfma_f32_16x16x32_bf16 v[120:123], a[12:15], a[40:43], v[120:123]
    ds_read_b64 a[94:95], v18 offset:3912
    v_lshl_add_u32 v204, v201, 3, s60
    v_mfma_f32_16x16x32_bf16 v[124:127], a[12:15], a[44:47], v[124:127]
    v_add_u32 v201, 1, v201
    v_mfma_f32_16x16x32_bf16 v[128:131], a[12:15], a[48:51], v[128:131]
    v_min_u32_e64 v201, 7, v201
    v_mfma_f32_16x16x32_bf16 v[116:119], a[16:19], a[32:35], v[116:119]
    v_sub_u32_e64 v201, v200, v201
    v_mfma_f32_16x16x32_bf16 v[120:123], a[16:19], a[36:39], v[120:123]
    v_add_u32_e64 v205, s61, v201
    v_mfma_f32_16x16x32_bf16 v[124:127], a[16:19], a[40:43], v[124:127]
    buffer_load_dword v31, v22, s[4:7], 0 offen
    v_mul_u32_u24_e64 v205, 37, v205
    v_mfma_f32_16x16x32_bf16 v[128:131], a[16:19], a[44:47], v[128:131]
    v_lshrrev_b32_e64 v205, 8, v205
    v_mfma_f32_16x16x32_bf16 v[120:123], a[20:23], a[32:35], v[120:123]
    v_add_u32_e64 v201, v201, v205
    v_mfma_f32_16x16x32_bf16 v[124:127], a[20:23], a[36:39], v[124:127]
    v_cndmask_b32 v204, v201, v204, vcc
    v_mfma_f32_16x16x32_bf16 v[128:131], a[20:23], a[40:43], v[128:131]
    buffer_load_dword v31, v21, s[4:7], 0 offen
    v_cmp_eq_u32 vcc, 49, v200
    v_mfma_f32_16x16x32_bf16 v[124:127], a[24:27], a[32:35], v[124:127]
    v_and_b32 v202, 127, v202
    v_mfma_f32_16x16x32_bf16 v[128:131], a[24:27], a[36:39], v[128:131]
    v_cndmask_b32 v204, v204, v201, vcc
    v_mfma_f32_16x16x32_bf16 v[128:131], a[28:31], a[32:35], v[128:131]
    v_lshl_add_u32 v202, v204, 7, v202
    s_waitcnt lgkmcnt(0)
    v_mfma_f32_16x16x32_bf16 v[100:103], a[64:67], a[96:99], v[100:103]
    ds_read_b64 a[0:1], v18 offset:384
    v_add_u32_e64 v12, v202, v203
    v_mfma_f32_16x16x32_bf16 v[104:107], a[64:67], a[100:103], v[104:107]
    ds_read_b64 a[2:3], v18 offset:392
    v_add_u32 v200, 320, v0
    v_mfma_f32_16x16x32_bf16 v[108:111], a[64:67], a[104:107], v[108:111]
    ds_read_b128 a[32:35], v19 offset:3968
    v_add_u32_e64 v200, s56, v200
    v_mfma_f32_16x16x32_bf16 v[112:115], a[64:67], a[108:111], v[112:115]
    ds_read_b128 a[36:39], v19 offset:3456
    v_mul_u32_u24 v201, 4682, v200
    v_mfma_f32_16x16x32_bf16 v[116:119], a[64:67], a[112:115], v[116:119]
    ds_read_b128 a[40:43], v19 offset:2944
    v_lshrrev_b32_e64 v201, 16, v201
    v_mfma_f32_16x16x32_bf16 v[120:123], a[64:67], a[116:119], v[120:123]
    ds_read_b128 a[44:47], v19 offset:2432
    v_mul_u32_u24_e64 v202, 14, v201
    v_mfma_f32_16x16x32_bf16 v[124:127], a[64:67], a[120:123], v[124:127]
    ds_read_b128 a[48:51], v19 offset:1920
    v_sub_u32_e64 v202, v200, v202
    v_mfma_f32_16x16x32_bf16 v[128:131], a[64:67], a[124:127], v[128:131]
    ds_read_b128 a[52:55], v19 offset:1408
    v_and_b32_e64 v203, 0x33, v201
    v_mfma_f32_16x16x32_bf16 v[104:107], a[68:71], a[96:99], v[104:107]
    ds_read_b128 a[56:59], v19 offset:896
    v_and_b32_e64 v204, 4, v201
    v_mfma_f32_16x16x32_bf16 v[108:111], a[68:71], a[100:103], v[108:111]
    ds_read_b128 a[60:63], v19 offset:384
    v_lshl_or_b32 v203, v204, 1, v203
    v_mfma_f32_16x16x32_bf16 v[112:115], a[68:71], a[104:107], v[112:115]
    ds_read_b64 a[4:5], v18 offset:896
    v_and_b32_e64 v204, 8, v201
    v_mfma_f32_16x16x32_bf16 v[116:119], a[68:71], a[108:111], v[116:119]
    ds_read_b64 a[6:7], v18 offset:904
    v_lshrrev_b32_e64 v204, 1, v204
    v_mfma_f32_16x16x32_bf16 v[120:123], a[68:71], a[112:115], v[120:123]
    ds_read_b64 a[8:9], v18 offset:1408
    v_or_b32_e64 v203, v203, v204
    v_mfma_f32_16x16x32_bf16 v[124:127], a[68:71], a[116:119], v[124:127]
    ds_read_b64 a[10:11], v18 offset:1416
    v_mul_u32_u24 v203, 7168, v203
    v_mfma_f32_16x16x32_bf16 v[128:131], a[68:71], a[120:123], v[128:131]
    ds_read_b64 a[12:13], v18 offset:1920
    v_lshl_add_u32 v202, v202, 4, s57
    v_mfma_f32_16x16x32_bf16 v[108:111], a[72:75], a[96:99], v[108:111]
    ds_read_b64 a[14:15], v18 offset:1928
    v_lshrrev_b32_e64 v200, 7, v202
    v_mfma_f32_16x16x32_bf16 v[112:115], a[72:75], a[100:103], v[112:115]
    ds_read_b64 a[16:17], v18 offset:2432
    v_mul_u32_u24_e64 v201, 37, v200
    v_mfma_f32_16x16x32_bf16 v[116:119], a[72:75], a[104:107], v[116:119]
    ds_read_b64 a[18:19], v18 offset:2440
    v_lshrrev_b32_e64 v201, 8, v201
    v_mfma_f32_16x16x32_bf16 v[120:123], a[72:75], a[108:111], v[120:123]
    ds_read_b64 a[20:21], v18 offset:2944
    v_mul_u32_u24_e64 v204, 7, v201
    v_mfma_f32_16x16x32_bf16 v[124:127], a[72:75], a[112:115], v[124:127]
    ds_read_b64 a[22:23], v18 offset:2952
    v_cmp_eq_u32 vcc, v204, v200
    v_mfma_f32_16x16x32_bf16 v[128:131], a[72:75], a[116:119], v[128:131]
    ds_read_b64 a[24:25], v18 offset:3456
    v_lshl_add_u32 v204, v201, 3, s60
    v_mfma_f32_16x16x32_bf16 v[112:115], a[76:79], a[96:99], v[112:115]
    ds_read_b64 a[26:27], v18 offset:3464
    v_add_u32 v201, 1, v201
    v_mfma_f32_16x16x32_bf16 v[116:119], a[76:79], a[100:103], v[116:119]
    ds_read_b64 a[28:29], v18 offset:3968
    v_min_u32_e64 v201, 7, v201
    v_mfma_f32_16x16x32_bf16 v[120:123], a[76:79], a[104:107], v[120:123]
    ds_read_b64 a[30:31], v18 offset:3976
    v_sub_u32_e64 v201, v200, v201
    v_mfma_f32_16x16x32_bf16 v[124:127], a[76:79], a[108:111], v[124:127]
    v_add_u32_e64 v205, s61, v201
    v_mfma_f32_16x16x32_bf16 v[128:131], a[76:79], a[112:115], v[128:131]
    v_mul_u32_u24_e64 v205, 37, v205
    v_mfma_f32_16x16x32_bf16 v[116:119], a[80:83], a[96:99], v[116:119]
    v_lshrrev_b32_e64 v205, 8, v205
    v_mfma_f32_16x16x32_bf16 v[120:123], a[80:83], a[100:103], v[120:123]
    v_add_u32_e64 v201, v201, v205
    v_mfma_f32_16x16x32_bf16 v[124:127], a[80:83], a[104:107], v[124:127]
    v_cndmask_b32 v204, v201, v204, vcc
    v_mfma_f32_16x16x32_bf16 v[128:131], a[80:83], a[108:111], v[128:131]
    v_cmp_eq_u32 vcc, 49, v200
    v_mfma_f32_16x16x32_bf16 v[120:123], a[84:87], a[96:99], v[120:123]
    v_and_b32 v202, 127, v202
    v_mfma_f32_16x16x32_bf16 v[124:127], a[84:87], a[100:103], v[124:127]
    v_cndmask_b32 v204, v204, v201, vcc
    v_mfma_f32_16x16x32_bf16 v[128:131], a[84:87], a[104:107], v[128:131]
    v_lshl_add_u32 v202, v204, 7, v202
    v_mfma_f32_16x16x32_bf16 v[124:127], a[88:91], a[96:99], v[124:127]
    v_add_u32 v13, v202, v203
    v_mfma_f32_16x16x32_bf16 v[128:131], a[88:91], a[100:103], v[128:131]
    v_subrev_u32 v13, 1024, v13
    v_mfma_f32_16x16x32_bf16 v[128:131], a[92:95], a[96:99], v[128:131]
    v_add_u32 v200, 384, v0
    s_waitcnt lgkmcnt(0)
    v_mfma_f32_16x16x32_bf16 v[100:103], a[0:3], a[32:35], v[100:103]
    ds_read_b64 a[64:65], v18 offset:448
    v_add_u32 v200, s56, v200
    v_mfma_f32_16x16x32_bf16 v[104:107], a[0:3], a[36:39], v[104:107]
    ds_read_b64 a[66:67], v18 offset:456
    v_mul_u32_u24 v201, 4682, v200
    v_mfma_f32_16x16x32_bf16 v[108:111], a[0:3], a[40:43], v[108:111]
    ds_read_b128 a[96:99], v19 offset:4032
    v_lshrrev_b32_e64 v201, 16, v201
    v_mfma_f32_16x16x32_bf16 v[112:115], a[0:3], a[44:47], v[112:115]
    ds_read_b128 a[100:103], v19 offset:3520
    v_mul_u32_u24_e64 v202, 14, v201
    v_mfma_f32_16x16x32_bf16 v[116:119], a[0:3], a[48:51], v[116:119]
    ds_read_b128 a[104:107], v19 offset:3008
    v_sub_u32_e64 v202, v200, v202
    v_mfma_f32_16x16x32_bf16 v[120:123], a[0:3], a[52:55], v[120:123]
    ds_read_b128 a[108:111], v19 offset:2496
    v_and_b32_e64 v203, 0x33, v201
    v_mfma_f32_16x16x32_bf16 v[124:127], a[0:3], a[56:59], v[124:127]
    ds_read_b128 a[112:115], v19 offset:1984
    v_and_b32_e64 v204, 4, v201
    v_mfma_f32_16x16x32_bf16 v[128:131], a[0:3], a[60:63], v[128:131]
    ds_read_b128 a[116:119], v19 offset:1472
    v_lshl_or_b32 v203, v204, 1, v203
    v_mfma_f32_16x16x32_bf16 v[104:107], a[4:7], a[32:35], v[104:107]
    ds_read_b128 a[120:123], v19 offset:960
    v_and_b32_e64 v204, 8, v201
    v_mfma_f32_16x16x32_bf16 v[108:111], a[4:7], a[36:39], v[108:111]
    ds_read_b128 a[124:127], v19 offset:448
    v_lshrrev_b32_e64 v204, 1, v204
    v_mfma_f32_16x16x32_bf16 v[112:115], a[4:7], a[40:43], v[112:115]
    ds_read_b64 a[68:69], v18 offset:960
    v_or_b32_e64 v203, v203, v204
    v_mfma_f32_16x16x32_bf16 v[116:119], a[4:7], a[44:47], v[116:119]
    ds_read_b64 a[70:71], v18 offset:968
    v_mul_u32_u24 v203, 7168, v203
    v_mfma_f32_16x16x32_bf16 v[120:123], a[4:7], a[48:51], v[120:123]
    ds_read_b64 a[72:73], v18 offset:1472
    v_lshl_add_u32 v202, v202, 4, s57
    v_mfma_f32_16x16x32_bf16 v[124:127], a[4:7], a[52:55], v[124:127]
    ds_read_b64 a[74:75], v18 offset:1480
    v_lshrrev_b32_e64 v200, 7, v202
    v_mfma_f32_16x16x32_bf16 v[128:131], a[4:7], a[56:59], v[128:131]
    ds_read_b64 a[76:77], v18 offset:1984
    v_mul_u32_u24_e64 v201, 37, v200
    v_mfma_f32_16x16x32_bf16 v[108:111], a[8:11], a[32:35], v[108:111]
    ds_read_b64 a[78:79], v18 offset:1992
    v_lshrrev_b32_e64 v201, 8, v201
    v_mfma_f32_16x16x32_bf16 v[112:115], a[8:11], a[36:39], v[112:115]
    ds_read_b64 a[80:81], v18 offset:2496
    v_mul_u32_u24_e64 v204, 7, v201
    v_mfma_f32_16x16x32_bf16 v[116:119], a[8:11], a[40:43], v[116:119]
    ds_read_b64 a[82:83], v18 offset:2504
    v_cmp_eq_u32 vcc, v204, v200
    v_mfma_f32_16x16x32_bf16 v[120:123], a[8:11], a[44:47], v[120:123]
    ds_read_b64 a[84:85], v18 offset:3008
    v_lshl_add_u32 v204, v201, 3, s60
    v_mfma_f32_16x16x32_bf16 v[124:127], a[8:11], a[48:51], v[124:127]
    ds_read_b64 a[86:87], v18 offset:3016
    v_add_u32 v201, 1, v201
    v_mfma_f32_16x16x32_bf16 v[128:131], a[8:11], a[52:55], v[128:131]
    ds_read_b64 a[88:89], v18 offset:3520
    v_min_u32_e64 v201, 7, v201
    v_mfma_f32_16x16x32_bf16 v[112:115], a[12:15], a[32:35], v[112:115]
    ds_read_b64 a[90:91], v18 offset:3528
    v_sub_u32_e64 v201, v200, v201
    v_mfma_f32_16x16x32_bf16 v[116:119], a[12:15], a[36:39], v[116:119]
    ds_read_b64 a[92:93], v18 offset:4032
    v_add_u32_e64 v205, s61, v201
    v_mfma_f32_16x16x32_bf16 v[120:123], a[12:15], a[40:43], v[120:123]
    ds_read_b64 a[94:95], v18 offset:4040
    v_mul_u32_u24_e64 v205, 37, v205
    v_mfma_f32_16x16x32_bf16 v[124:127], a[12:15], a[44:47], v[124:127]
    v_lshrrev_b32_e64 v205, 8, v205
    v_mfma_f32_16x16x32_bf16 v[128:131], a[12:15], a[48:51], v[128:131]
    v_add_u32_e64 v201, v201, v205
    v_mfma_f32_16x16x32_bf16 v[116:119], a[16:19], a[32:35], v[116:119]
    v_cndmask_b32 v204, v201, v204, vcc
    v_mfma_f32_16x16x32_bf16 v[120:123], a[16:19], a[36:39], v[120:123]
    v_cmp_eq_u32 vcc, 49, v200
    v_mfma_f32_16x16x32_bf16 v[124:127], a[16:19], a[40:43], v[124:127]
    v_and_b32 v202, 127, v202
    v_mfma_f32_16x16x32_bf16 v[128:131], a[16:19], a[44:47], v[128:131]
    v_cndmask_b32 v204, v204, v201, vcc
    v_mfma_f32_16x16x32_bf16 v[120:123], a[20:23], a[32:35], v[120:123]
    v_lshl_add_u32 v202, v204, 7, v202
    v_mfma_f32_16x16x32_bf16 v[124:127], a[20:23], a[36:39], v[124:127]
    v_add_u32 v14, v202, v203
    v_mfma_f32_16x16x32_bf16 v[128:131], a[20:23], a[40:43], v[128:131]
    v_subrev_u32 v14, 2048, v14
    v_mfma_f32_16x16x32_bf16 v[124:127], a[24:27], a[32:35], v[124:127]
    v_bfe_u32 v200, v0, 2, 3
    v_mfma_f32_16x16x32_bf16 v[128:131], a[24:27], a[36:39], v[128:131]
    v_lshrrev_b32_e64 v201, 5, v0
    v_mfma_f32_16x16x32_bf16 v[128:131], a[28:31], a[32:35], v[128:131]
    v_lshl_add_u32 v200, v201, 4, v200
    s_waitcnt lgkmcnt(0)
    v_mfma_f32_16x16x32_bf16 v[100:103], a[64:67], a[96:99], v[100:103]
    ds_read_b64 v[132:133], v25 offset:3584
    v_mul_u32_u24 v200, 224, v200
    v_mfma_f32_16x16x32_bf16 v[104:107], a[64:67], a[100:103], v[104:107]
    ds_read_b64 v[134:135], v25 offset:3072
    v_and_b32 v201, 3, v0
    v_mfma_f32_16x16x32_bf16 v[108:111], a[64:67], a[104:107], v[108:111]
    ds_read_b64 v[136:137], v25 offset:2560
    v_lshl_add_u32 v15, v201, 3, v200
    v_mfma_f32_16x16x32_bf16 v[112:115], a[64:67], a[108:111], v[112:115]
    ds_read_b64 v[138:139], v25 offset:2048
    v_add_u32 v16, 57344, v15
    v_mfma_f32_16x16x32_bf16 v[116:119], a[64:67], a[112:115], v[116:119]
    ds_read_b64 v[140:141], v25 offset:1536
    v_add_u32 v17, 114688, v15
    v_mfma_f32_16x16x32_bf16 v[120:123], a[64:67], a[116:119], v[120:123]
    ds_read_b64 v[142:143], v25 offset:1024
    v_mfma_f32_16x16x32_bf16 v[124:127], a[64:67], a[120:123], v[124:127]
    ds_read_b64 v[144:145], v25 offset:512
    v_mfma_f32_16x16x32_bf16 v[128:131], a[64:67], a[124:127], v[128:131]
    ds_read_b64 v[146:147], v25 offset:0
    v_mfma_f32_16x16x32_bf16 v[104:107], a[68:71], a[96:99], v[104:107]
    v_mfma_f32_16x16x32_bf16 v[108:111], a[68:71], a[100:103], v[108:111]
    v_mfma_f32_16x16x32_bf16 v[112:115], a[68:71], a[104:107], v[112:115]
    v_mfma_f32_16x16x32_bf16 v[116:119], a[68:71], a[108:111], v[116:119]
    v_mfma_f32_16x16x32_bf16 v[120:123], a[68:71], a[112:115], v[120:123]
    v_mfma_f32_16x16x32_bf16 v[124:127], a[68:71], a[116:119], v[124:127]
    v_mfma_f32_16x16x32_bf16 v[128:131], a[68:71], a[120:123], v[128:131]
    v_mfma_f32_16x16x32_bf16 v[108:111], a[72:75], a[96:99], v[108:111]
    v_mfma_f32_16x16x32_bf16 v[112:115], a[72:75], a[100:103], v[112:115]
    v_mfma_f32_16x16x32_bf16 v[116:119], a[72:75], a[104:107], v[116:119]
    v_mfma_f32_16x16x32_bf16 v[120:123], a[72:75], a[108:111], v[120:123]
    v_mfma_f32_16x16x32_bf16 v[124:127], a[72:75], a[112:115], v[124:127]
    v_mfma_f32_16x16x32_bf16 v[128:131], a[72:75], a[116:119], v[128:131]
    v_mfma_f32_16x16x32_bf16 v[112:115], a[76:79], a[96:99], v[112:115]
    v_mfma_f32_16x16x32_bf16 v[116:119], a[76:79], a[100:103], v[116:119]
    v_mfma_f32_16x16x32_bf16 v[120:123], a[76:79], a[104:107], v[120:123]
    v_mfma_f32_16x16x32_bf16 v[124:127], a[76:79], a[108:111], v[124:127]
    v_mfma_f32_16x16x32_bf16 v[128:131], a[76:79], a[112:115], v[128:131]
    v_mfma_f32_16x16x32_bf16 v[116:119], a[80:83], a[96:99], v[116:119]
    v_mfma_f32_16x16x32_bf16 v[120:123], a[80:83], a[100:103], v[120:123]
    v_mfma_f32_16x16x32_bf16 v[124:127], a[80:83], a[104:107], v[124:127]
    v_mfma_f32_16x16x32_bf16 v[128:131], a[80:83], a[108:111], v[128:131]
    v_mfma_f32_16x16x32_bf16 v[120:123], a[84:87], a[96:99], v[120:123]
    v_mfma_f32_16x16x32_bf16 v[124:127], a[84:87], a[100:103], v[124:127]
    v_mfma_f32_16x16x32_bf16 v[128:131], a[84:87], a[104:107], v[128:131]
    v_mfma_f32_16x16x32_bf16 v[124:127], a[88:91], a[96:99], v[124:127]
    v_mfma_f32_16x16x32_bf16 v[128:131], a[88:91], a[100:103], v[128:131]
    v_mfma_f32_16x16x32_bf16 v[128:131], a[92:95], a[96:99], v[128:131]
    s_waitcnt lgkmcnt(0)
    v_and_b32 v148, s49, v133
    v_lshlrev_b32 v149, 16, v133
    v_and_b32 v150, s49, v132
    v_lshlrev_b32 v151, 16, v132
    v_and_b32 v152, s49, v135
    v_lshlrev_b32 v153, 16, v135
    v_and_b32 v154, s49, v134
    v_lshlrev_b32 v155, 16, v134
    v_and_b32 v156, s49, v137
    v_lshlrev_b32 v157, 16, v137
    v_and_b32 v158, s49, v136
    v_lshlrev_b32 v159, 16, v136
    v_and_b32 v160, s49, v139
    v_lshlrev_b32 v161, 16, v139
    v_and_b32 v162, s49, v138
    v_lshlrev_b32 v163, 16, v138
    v_and_b32 v164, s49, v141
    v_lshlrev_b32 v165, 16, v141
    v_and_b32 v166, s49, v140
    v_lshlrev_b32 v167, 16, v140
    v_and_b32 v168, s49, v143
    v_lshlrev_b32 v169, 16, v143
    v_and_b32 v170, s49, v142
    v_lshlrev_b32 v171, 16, v142
    v_and_b32 v172, s49, v145
    v_lshlrev_b32 v173, 16, v145
    v_and_b32 v174, s49, v144
    v_lshlrev_b32 v175, 16, v144
    v_and_b32 v176, s49, v147
    v_lshlrev_b32 v177, 16, v147
    v_and_b32 v178, s49, v146
    v_lshlrev_b32_e64 v179, 16, v146
    v_pk_fma_f32 v[100:101], v[148:149], s[48:49], v[100:101] op_sel_hi:[1,0,1]
    v_pk_fma_f32 v[102:103], v[150:151], s[48:49], v[102:103] op_sel_hi:[1,0,1]
    v_cvt_pk_bf16_f32 v148, v100, v102
    v_cvt_pk_bf16_f32 v149, v101, v103
    ds_write2st64_b32 v24, v148, v149 offset0:0 offset1:8
    v_pk_fma_f32 v[104:105], v[152:153], s[48:49], v[104:105] op_sel_hi:[1,0,1]
    v_pk_fma_f32 v[106:107], v[154:155], s[48:49], v[106:107] op_sel_hi:[1,0,1]
    v_cvt_pk_bf16_f32 v152, v104, v106
    v_cvt_pk_bf16_f32 v153, v105, v107
    ds_write2st64_b32 v24, v152, v153 offset0:1 offset1:9
    v_pk_fma_f32 v[108:109], v[156:157], s[48:49], v[108:109] op_sel_hi:[1,0,1]
    v_pk_fma_f32 v[110:111], v[158:159], s[48:49], v[110:111] op_sel_hi:[1,0,1]
    v_cvt_pk_bf16_f32 v156, v108, v110
    v_cvt_pk_bf16_f32 v157, v109, v111
    ds_write2st64_b32 v24, v156, v157 offset0:2 offset1:10
    v_pk_fma_f32 v[112:113], v[160:161], s[48:49], v[112:113] op_sel_hi:[1,0,1]
    v_pk_fma_f32 v[114:115], v[162:163], s[48:49], v[114:115] op_sel_hi:[1,0,1]
    v_cvt_pk_bf16_f32 v160, v112, v114
    v_cvt_pk_bf16_f32 v161, v113, v115
    ds_write2st64_b32 v24, v160, v161 offset0:3 offset1:11
    v_pk_fma_f32 v[116:117], v[164:165], s[48:49], v[116:117] op_sel_hi:[1,0,1]
    v_pk_fma_f32 v[118:119], v[166:167], s[48:49], v[118:119] op_sel_hi:[1,0,1]
    v_cvt_pk_bf16_f32 v164, v116, v118
    v_cvt_pk_bf16_f32 v165, v117, v119
    ds_write2st64_b32 v24, v164, v165 offset0:4 offset1:12
    v_pk_fma_f32 v[120:121], v[168:169], s[48:49], v[120:121] op_sel_hi:[1,0,1]
    v_pk_fma_f32 v[122:123], v[170:171], s[48:49], v[122:123] op_sel_hi:[1,0,1]
    v_cvt_pk_bf16_f32 v168, v120, v122
    v_cvt_pk_bf16_f32 v169, v121, v123
    ds_write2st64_b32 v24, v168, v169 offset0:5 offset1:13
    v_pk_fma_f32 v[124:125], v[172:173], s[48:49], v[124:125] op_sel_hi:[1,0,1]
    v_pk_fma_f32 v[126:127], v[174:175], s[48:49], v[126:127] op_sel_hi:[1,0,1]
    v_cvt_pk_bf16_f32 v172, v124, v126
    v_cvt_pk_bf16_f32 v173, v125, v127
    ds_write2st64_b32 v24, v172, v173 offset0:6 offset1:14
    v_pk_fma_f32 v[128:129], v[176:177], s[48:49], v[128:129] op_sel_hi:[1,0,1]
    v_pk_fma_f32 v[130:131], v[178:179], s[48:49], v[130:131] op_sel_hi:[1,0,1]
    v_cvt_pk_bf16_f32 v176, v128, v130
    v_cvt_pk_bf16_f32 v177, v129, v131
    ds_write2st64_b32 v24, v176, v177 offset0:7 offset1:15
    v_bfe_u32 v24, v0, 2, 2
    v_mul_u32_u24 v24, 25408, v24
    v_lshl_add_u32 v24, v7, 5, v24
    v_and_b32_e64 v25, 3, v0
    v_lshl_add_u32 v24, v25, 3, v24
    s_lshl_b32 s53, s3, 9
    v_add_u32 v24, s53, v24
    v_lshrrev_b32 v25, 3, v0
    v_lshlrev_b32 v25, 15, v25
    v_and_b32_e64 v26, 7, v0
    v_lshl_add_u32 v25, v26, 4, v25
    s_lshl_b32 s53, s3, 20
    s_lshl_b32 s54, s39, 7
    s_add_u32 s53, s53, s54
    s_waitcnt lgkmcnt(0)
    s_barrier
    ds_read_b64_tr_b16 v[180:181], v24 offset:0
    ds_read_b64_tr_b16 v[182:183], v24 offset:2048
    ds_read_b64_tr_b16 v[184:185], v24 offset:128
    ds_read_b64_tr_b16 v[186:187], v24 offset:2176
    ds_read_b64_tr_b16 v[188:189], v24 offset:256
    ds_read_b64_tr_b16 v[190:191], v24 offset:2304
    ds_read_b64_tr_b16 v[192:193], v24 offset:384
    ds_read_b64_tr_b16 v[194:195], v24 offset:2432
    s_waitcnt lgkmcnt(6)
    buffer_store_dwordx4 v[180:183], v25, s[8:11], s53 offen sc1
    s_add_u32 s53, s53, 0x40000
    s_waitcnt lgkmcnt(4)
    buffer_store_dwordx4 v[184:187], v25, s[8:11], s53 offen sc1
    s_add_u32 s53, s53, 0x40000
    s_waitcnt lgkmcnt(2)
    buffer_store_dwordx4 v[188:191], v25, s[8:11], s53 offen sc1
    s_add_u32 s53, s53, 0x40000
    s_waitcnt lgkmcnt(0)
    buffer_store_dwordx4 v[192:195], v25, s[8:11], s53 offen sc1
    s_lshl_b32 s43, s37, 8
    s_add_u32 s44, s43, 6144
    s_add_u32 s43, s43, 4096
    s_movk_i32 s45, 6144
    s_waitcnt vmcnt(0)
    s_barrier
    s_cmp_lg_u32 s3, 0
    s_cbranch_scc1 L_layer
    s_mov_b64 exec, 1
    v_mov_b32_e64 v4, 1
    buffer_atomic_add v4, v1, s[24:27], s43 offen sc0 sc1
    s_waitcnt vmcnt(0)
    v_readfirstlane_b32 s30, v4
    s_mov_b64 exec, 0xff
    s_cmp_lg_u32 s30, 31
    s_cbranch_scc1 L_notlast
    v_lshlrev_b32 v3, 8, v0
    v_mov_b32 v4, 1
    buffer_atomic_add v4, v3, s[24:27], s45 offen sc1
L_notlast:
    s_mov_b64 exec, -1
    s_mov_b32 s56, 0
L_poll_5:
    buffer_load_dword v4, v1, s[24:27], s44 offen sc1
    s_add_u32 s56, s56, 1
    s_waitcnt vmcnt(0)
    v_readfirstlane_b32 s30, v4
    s_cmp_ge_u32 s30, 8
    s_cbranch_scc1 L_polld_6
    s_cmp_lt_u32 s56, 400000
    s_cbranch_scc1 L_poll_5
L_polld_6:
L_layer:
    s_load_dwordx4 s[16:19], s[0:1], 72
    s_mul_i32 s57, s35, 8388608
    s_lshl_b32 s53, s35, 2
    s_lshl_b32 s54, s31, 10
    s_add_u32 s53, s53, s54
    v_and_b32 v18, 7, v0
    v_bfe_u32 v19, v0, 3, 2
    v_lshrrev_b32 v25, 5, v0
    v_lshlrev_b32 v21, 8, v19
    v_lshl_add_u32 v22, v25, 14, v21
    v_lshl_add_u32 v22, v18, 4, v22
    v_lshl_add_u32 v21, v25, 12, v21
    v_lshl_add_u32 v20, v18, 4, v21
    v_lshl_add_u32 v21, v18, 3, v21
    s_lshr_b32 s44, s36, 1
    s_lshl_b32 s44, s44, 15
    s_lshl_b32 s46, s3, 13
    s_add_u32 s44, s44, s46
    s_and_b32 s45, s36, 1
    s_lshl_b32 s46, s45, 7
    s_add_u32 s47, s44, s46
    s_lshl_b32 s46, s45, 6
    s_add_u32 s44, s44, s46
    s_lshr_b32 s50, s36, 3
    s_lshl_b32 s50, s50, 17
    s_bfe_u32 s46, s36, 0x20001
    s_lshl_b32 s46, s46, 10
    s_add_u32 s50, s50, s46
    s_lshl_b32 s46, s45, 7
    s_add_u32 s50, s50, s46
    s_lshl_b32 s46, s3, 15
    s_add_u32 s50, s50, s46
    v_lshlrev_b32 v24, 5, v18
    v_add_u32 v24, 143360, v24
    s_lshl_b32 s46, s3, 3
    v_add_u32 v23, s46, v24
    s_mov_b32 s40, 0
    s_mov_b32 s49, 0xffff0000
    s_mov_b32 s51, 0x3a800000
    s_mov_b32 s52, 0x3727c5ac
    s_mov_b32 s54, 0x4091afa4
    s_add_u32 s8, s28, 0x800000
    s_addc_u32 s9, s29, 0
    s_add_u32 s8, s8, s57
    s_addc_u32 s9, s9, 0
    s_mov_b32 s10, 0x400000
    s_mov_b32 s11, 0x00020000
    s_mov_b32 s12, s28
    s_mov_b32 s13, s29
    s_mov_b32 s14, 0x1000000
    s_mov_b32 s15, 0x00020000
    s_add_u32 s20, s28, 0x400000
    s_addc_u32 s21, s29, 0
    s_mov_b32 s22, 0x400000
    s_mov_b32 s23, 0x00020000
    s_cmp_lg_u32 s3, 1
    s_cbranch_scc1 L_ln_b
    s_add_u32 m0, s42, 0
    s_nop 0
    buffer_load_dwordx4 v8, s[4:7], s40 offen offset:0 lds
    buffer_load_dwordx4 v9, s[4:7], s40 offen offset:1024 lds
    buffer_load_dwordx4 v10, s[4:7], s40 offen offset:2048 lds
    buffer_load_dwordx4 v11, s[4:7], s40 offen offset:3072 lds
    s_add_u32 m0, s42, 4096
    s_nop 0
    buffer_load_dwordx4 v12, s[4:7], s40 offen offset:0 lds
    buffer_load_dwordx4 v13, s[4:7], s40 offen offset:1024 lds
    buffer_load_dwordx4 v14, s[4:7], s40 offen offset:2048 lds
    s_add_u32 s40, s40, 458752
    s_add_u32 m0, s42, 28672
    s_nop 0
    buffer_load_dwordx4 v8, s[4:7], s40 offen offset:0 lds
    buffer_load_dwordx4 v9, s[4:7], s40 offen offset:1024 lds
    buffer_load_dwordx4 v10, s[4:7], s40 offen offset:2048 lds
    buffer_load_dwordx4 v11, s[4:7], s40 offen offset:3072 lds
    s_add_u32 m0, s42, 32768
    s_nop 0
    buffer_load_dwordx4 v12, s[4:7], s40 offen offset:0 lds
    buffer_load_dwordx4 v13, s[4:7], s40 offen offset:1024 lds
    buffer_load_dwordx4 v14, s[4:7], s40 offen offset:2048 lds
    s_add_u32 s40, s40, 458752
    s_add_u32 m0, s42, 57344
    s_nop 0
    buffer_load_dwordx4 v8, s[4:7], s40 offen offset:0 lds
    buffer_load_dwordx4 v9, s[4:7], s40 offen offset:1024 lds
    buffer_load_dwordx4 v10, s[4:7], s40 offen offset:2048 lds
    buffer_load_dwordx4 v11, s[4:7], s40 offen offset:3072 lds
    s_add_u32 m0, s42, 61440
    s_nop 0
    buffer_load_dwordx4 v12, s[4:7], s40 offen offset:0 lds
    buffer_load_dwordx4 v13, s[4:7], s40 offen offset:1024 lds
    buffer_load_dwordx4 v14, s[4:7], s40 offen offset:2048 lds
    s_add_u32 s40, s40, 458752
L_ln_b:
    s_cmp_lg_u32 s35, 0
    s_cbranch_scc1 L_ln_l1
    s_barrier
    buffer_load_dwordx2 a[240:241], v21, s[20:23], s44 offen offset:0 sc1
    buffer_load_dwordx2 a[242:243], v21, s[20:23], s44 offen offset:128 sc1
    buffer_load_dwordx2 a[244:245], v21, s[20:23], s44 offen offset:1024 sc1
    buffer_load_dwordx2 a[246:247], v21, s[20:23], s44 offen offset:1152 sc1
    buffer_load_dwordx2 a[248:249], v21, s[20:23], s44 offen offset:2048 sc1
    buffer_load_dwordx2 a[250:251], v21, s[20:23], s44 offen offset:2176 sc1
    buffer_load_dwordx2 a[252:253], v21, s[20:23], s44 offen offset:3072 sc1
    buffer_load_dwordx2 a[254:255], v21, s[20:23], s44 offen offset:3200 sc1
    v_lshlrev_b32 v48, 16, v240
    v_and_b32 v49, s49, v240
    v_lshlrev_b32 v50, 16, v241
    v_and_b32 v51, s49, v241
    v_lshlrev_b32 v52, 16, v242
    v_and_b32 v53, s49, v242
    v_lshlrev_b32 v54, 16, v243
    v_and_b32 v55, s49, v243
    v_lshlrev_b32 v56, 16, v244
    v_and_b32 v57, s49, v244
    v_lshlrev_b32 v58, 16, v245
    v_and_b32 v59, s49, v245
    v_lshlrev_b32 v60, 16, v246
    v_and_b32 v61, s49, v246
    v_lshlrev_b32 v62, 16, v247
    v_and_b32 v63, s49, v247
    v_lshlrev_b32 v64, 16, v248
    v_and_b32 v65, s49, v248
    v_lshlrev_b32 v66, 16, v249
    v_and_b32 v67, s49, v249
    v_lshlrev_b32 v68, 16, v250
    v_and_b32 v69, s49, v250
    v_lshlrev_b32 v70, 16, v251
    v_and_b32 v71, s49, v251
    v_lshlrev_b32 v72, 16, v252
    v_and_b32 v73, s49, v252
    v_lshlrev_b32 v74, 16, v253
    v_and_b32 v75, s49, v253
    v_lshlrev_b32 v76, 16, v254
    v_and_b32 v77, s49, v254
    v_lshlrev_b32 v78, 16, v255
    v_and_b32 v79, s49, v255
    s_branch L_ln_go
L_ln_l1:
    s_add_u32 s37, s47, 0x400000
    s_add_u32 s38, s47, 0x800000
    s_add_u32 s39, s47, 0xc00000
    v_accvgpr_read_b32 v32, a224
    v_accvgpr_read_b32 v33, a225
    v_accvgpr_read_b32 v34, a226
    v_accvgpr_read_b32 v35, a227
    v_accvgpr_read_b32 v36, a228
    v_accvgpr_read_b32 v37, a229
    v_accvgpr_read_b32 v38, a230
    v_accvgpr_read_b32 v39, a231
    v_accvgpr_read_b32 v40, a232
    v_accvgpr_read_b32 v41, a233
    v_accvgpr_read_b32 v42, a234
    v_accvgpr_read_b32 v43, a235
    v_accvgpr_read_b32 v44, a236
    v_accvgpr_read_b32 v45, a237
    v_accvgpr_read_b32 v46, a238
    v_accvgpr_read_b32 v47, a239
    v_lshlrev_b32 v48, 16, v32
    v_and_b32 v49, s49, v32
    v_lshlrev_b32 v50, 16, v33
    v_and_b32 v51, s49, v33
    v_lshlrev_b32 v52, 16, v34
    v_and_b32 v53, s49, v34
    v_lshlrev_b32 v54, 16, v35
    v_and_b32 v55, s49, v35
    v_lshlrev_b32 v56, 16, v36
    v_and_b32 v57, s49, v36
    v_lshlrev_b32 v58, 16, v37
    v_and_b32 v59, s49, v37
    v_lshlrev_b32 v60, 16, v38
    v_and_b32 v61, s49, v38
    v_lshlrev_b32 v62, 16, v39
    v_and_b32 v63, s49, v39
    v_lshlrev_b32 v64, 16, v40
    v_and_b32 v65, s49, v40
    v_lshlrev_b32 v66, 16, v41
    v_and_b32 v67, s49, v41
    v_lshlrev_b32 v68, 16, v42
    v_and_b32 v69, s49, v42
    v_lshlrev_b32 v70, 16, v43
    v_and_b32 v71, s49, v43
    v_lshlrev_b32 v72, 16, v44
    v_and_b32 v73, s49, v44
    v_lshlrev_b32 v74, 16, v45
    v_and_b32 v75, s49, v45
    v_lshlrev_b32 v76, 16, v46
    v_and_b32 v77, s49, v46
    v_lshlrev_b32 v78, 16, v47
    v_and_b32 v79, s49, v47
    s_barrier
    buffer_load_dwordx4 v[128:131], v20, s[12:15], s39 offen offset:0 sc1
    buffer_load_dwordx4 v[132:135], v20, s[12:15], s38 offen offset:0 sc1
    buffer_load_dwordx4 v[144:147], v20, s[12:15], s47 offen offset:1024 sc1
    buffer_load_dwordx4 v[148:151], v20, s[12:15], s39 offen offset:1024 sc1
    buffer_load_dwordx4 v[160:163], v20, s[12:15], s37 offen offset:2048 sc1
    buffer_load_dwordx4 v[164:167], v20, s[12:15], s47 offen offset:2048 sc1
    buffer_load_dwordx4 v[176:179], v20, s[12:15], s38 offen offset:3072 sc1
    buffer_load_dwordx4 v[180:183], v20, s[12:15], s37 offen offset:3072 sc1
    s_waitcnt vmcnt(7)
    v_lshlrev_b32 v80, 16, v128
    v_and_b32 v81, s49, v128
    v_lshlrev_b32 v82, 16, v129
    v_and_b32 v83, s49, v129
    v_lshlrev_b32 v84, 16, v130
    v_and_b32 v85, s49, v130
    v_lshlrev_b32 v86, 16, v131
    v_and_b32 v87, s49, v131
    s_waitcnt vmcnt(6)
    v_lshlrev_b32 v112, 16, v132
    v_and_b32 v113, s49, v132
    v_lshlrev_b32 v114, 16, v133
    v_and_b32 v115, s49, v133
    v_lshlrev_b32 v116, 16, v134
    v_and_b32 v117, s49, v134
    v_lshlrev_b32 v118, 16, v135
    v_and_b32_e64 v119, s49, v135
    v_pk_add_f32 v[80:81], v[80:81], v[112:113]
    v_pk_add_f32 v[82:83], v[82:83], v[114:115]
    v_pk_add_f32 v[84:85], v[84:85], v[116:117]
    v_pk_add_f32 v[86:87], v[86:87], v[118:119]
    s_waitcnt vmcnt(5)
    v_lshlrev_b32 v88, 16, v144
    v_and_b32 v89, s49, v144
    v_lshlrev_b32 v90, 16, v145
    v_and_b32 v91, s49, v145
    v_lshlrev_b32 v92, 16, v146
    v_and_b32 v93, s49, v146
    v_lshlrev_b32 v94, 16, v147
    v_and_b32 v95, s49, v147
    s_waitcnt vmcnt(4)
    v_lshlrev_b32 v112, 16, v148
    v_and_b32 v113, s49, v148
    v_lshlrev_b32 v114, 16, v149
    v_and_b32 v115, s49, v149
    v_lshlrev_b32 v116, 16, v150
    v_and_b32 v117, s49, v150
    v_lshlrev_b32 v118, 16, v151
    v_and_b32 v119, s49, v151
    v_pk_add_f32 v[88:89], v[88:89], v[112:113]
    v_pk_add_f32 v[90:91], v[90:91], v[114:115]
    v_pk_add_f32 v[92:93], v[92:93], v[116:117]
    v_pk_add_f32 v[94:95], v[94:95], v[118:119]
    s_waitcnt vmcnt(3)
    v_lshlrev_b32 v96, 16, v160
    v_and_b32 v97, s49, v160
    v_lshlrev_b32 v98, 16, v161
    v_and_b32 v99, s49, v161
    v_lshlrev_b32 v100, 16, v162
    v_and_b32 v101, s49, v162
    v_lshlrev_b32 v102, 16, v163
    v_and_b32 v103, s49, v163
    s_waitcnt vmcnt(2)
    v_lshlrev_b32 v112, 16, v164
    v_and_b32 v113, s49, v164
    v_lshlrev_b32 v114, 16, v165
    v_and_b32 v115, s49, v165
    v_lshlrev_b32 v116, 16, v166
    v_and_b32 v117, s49, v166
    v_lshlrev_b32 v118, 16, v167
    v_and_b32 v119, s49, v167
    v_pk_add_f32 v[96:97], v[96:97], v[112:113]
    v_pk_add_f32 v[98:99], v[98:99], v[114:115]
    v_pk_add_f32 v[100:101], v[100:101], v[116:117]
    v_pk_add_f32 v[102:103], v[102:103], v[118:119]
    s_waitcnt vmcnt(1)
    v_lshlrev_b32 v104, 16, v176
    v_and_b32 v105, s49, v176
    v_lshlrev_b32 v106, 16, v177
    v_and_b32 v107, s49, v177
    v_lshlrev_b32 v108, 16, v178
    v_and_b32 v109, s49, v178
    v_lshlrev_b32 v110, 16, v179
    v_and_b32 v111, s49, v179
    s_waitcnt vmcnt(0)
    v_lshlrev_b32 v112, 16, v180
    v_and_b32 v113, s49, v180
    v_lshlrev_b32 v114, 16, v181
    v_and_b32 v115, s49, v181
    v_lshlrev_b32 v116, 16, v182
    v_and_b32 v117, s49, v182
    v_lshlrev_b32 v118, 16, v183
    v_and_b32 v119, s49, v183
    v_pk_add_f32 v[104:105], v[104:105], v[112:113]
    v_pk_add_f32 v[106:107], v[106:107], v[114:115]
    v_pk_add_f32 v[108:109], v[108:109], v[116:117]
    v_pk_add_f32 v[110:111], v[110:111], v[118:119]
    s_cmp_lg_u32 s3, 0
    s_cbranch_scc1 L_ln_c
    s_mov_b32 s56, 0
L_poll_7:
    buffer_load_dword v4, v1, s[24:27], s60 offen sc1
    s_add_u32 s56, s56, 1
    s_waitcnt vmcnt(0)
    v_readfirstlane_b32 s30, v4
    s_cmp_ge_u32 s30, 32
    s_cbranch_scc1 L_polld_8
    s_cmp_lt_u32 s56, 400000
    s_cbranch_scc1 L_poll_7
L_polld_8:
L_ln_c:
    s_barrier
    buffer_load_dwordx4 v[136:139], v20, s[12:15], s37 offen offset:0 sc1
    buffer_load_dwordx4 v[140:143], v20, s[12:15], s47 offen offset:0 sc1
    buffer_load_dwordx4 v[152:155], v20, s[12:15], s38 offen offset:1024 sc1
    buffer_load_dwordx4 v[156:159], v20, s[12:15], s37 offen offset:1024 sc1
    buffer_load_dwordx4 v[168:171], v20, s[12:15], s39 offen offset:2048 sc1
    buffer_load_dwordx4 v[172:175], v20, s[12:15], s38 offen offset:2048 sc1
    buffer_load_dwordx4 v[184:187], v20, s[12:15], s47 offen offset:3072 sc1
    buffer_load_dwordx4 v[188:191], v20, s[12:15], s39 offen offset:3072 sc1
    s_waitcnt vmcnt(7)
    v_lshlrev_b32 v112, 16, v136
    v_and_b32 v113, s49, v136
    v_lshlrev_b32 v114, 16, v137
    v_and_b32 v115, s49, v137
    v_lshlrev_b32 v116, 16, v138
    v_and_b32 v117, s49, v138
    v_lshlrev_b32 v118, 16, v139
    v_and_b32_e64 v119, s49, v139
    v_pk_add_f32 v[80:81], v[80:81], v[112:113]
    v_pk_add_f32 v[82:83], v[82:83], v[114:115]
    v_pk_add_f32 v[84:85], v[84:85], v[116:117]
    v_pk_add_f32 v[86:87], v[86:87], v[118:119]
    s_waitcnt vmcnt(6)
    v_lshlrev_b32 v112, 16, v140
    v_and_b32 v113, s49, v140
    v_lshlrev_b32 v114, 16, v141
    v_and_b32 v115, s49, v141
    v_lshlrev_b32 v116, 16, v142
    v_and_b32 v117, s49, v142
    v_lshlrev_b32 v118, 16, v143
    v_and_b32_e64 v119, s49, v143
    v_pk_add_f32 v[80:81], v[80:81], v[112:113]
    v_pk_add_f32 v[82:83], v[82:83], v[114:115]
    v_pk_add_f32 v[84:85], v[84:85], v[116:117]
    v_pk_add_f32 v[86:87], v[86:87], v[118:119]
    v_pk_fma_f32 v[48:49], v[80:81], s[54:55], v[48:49] op_sel_hi:[1,0,1]
    v_pk_fma_f32 v[50:51], v[82:83], s[54:55], v[50:51] op_sel_hi:[1,0,1]
    v_pk_fma_f32 v[52:53], v[84:85], s[54:55], v[52:53] op_sel_hi:[1,0,1]
    v_pk_fma_f32 v[54:55], v[86:87], s[54:55], v[54:55] op_sel_hi:[1,0,1]
    s_waitcnt vmcnt(5)
    v_lshlrev_b32 v112, 16, v152
    v_and_b32 v113, s49, v152
    v_lshlrev_b32 v114, 16, v153
    v_and_b32 v115, s49, v153
    v_lshlrev_b32 v116, 16, v154
    v_and_b32 v117, s49, v154
    v_lshlrev_b32 v118, 16, v155
    v_and_b32_e64 v119, s49, v155
    v_pk_add_f32 v[88:89], v[88:89], v[112:113]
    v_pk_add_f32 v[90:91], v[90:91], v[114:115]
    v_pk_add_f32 v[92:93], v[92:93], v[116:117]
    v_pk_add_f32 v[94:95], v[94:95], v[118:119]
    s_waitcnt vmcnt(4)
    v_lshlrev_b32 v112, 16, v156
    v_and_b32 v113, s49, v156
    v_lshlrev_b32 v114, 16, v157
    v_and_b32 v115, s49, v157
    v_lshlrev_b32 v116, 16, v158
    v_and_b32 v117, s49, v158
    v_lshlrev_b32 v118, 16, v159
    v_and_b32_e64 v119, s49, v159
    v_pk_add_f32 v[88:89], v[88:89], v[112:113]
    v_pk_add_f32 v[90:91], v[90:91], v[114:115]
    v_pk_add_f32 v[92:93], v[92:93], v[116:117]
    v_pk_add_f32 v[94:95], v[94:95], v[118:119]
    v_pk_fma_f32 v[56:57], v[88:89], s[54:55], v[56:57] op_sel_hi:[1,0,1]
    v_pk_fma_f32 v[58:59], v[90:91], s[54:55], v[58:59] op_sel_hi:[1,0,1]
    v_pk_fma_f32 v[60:61], v[92:93], s[54:55], v[60:61] op_sel_hi:[1,0,1]
    v_pk_fma_f32 v[62:63], v[94:95], s[54:55], v[62:63] op_sel_hi:[1,0,1]
    s_waitcnt vmcnt(3)
    v_lshlrev_b32 v112, 16, v168
    v_and_b32 v113, s49, v168
    v_lshlrev_b32 v114, 16, v169
    v_and_b32 v115, s49, v169
    v_lshlrev_b32 v116, 16, v170
    v_and_b32 v117, s49, v170
    v_lshlrev_b32 v118, 16, v171
    v_and_b32_e64 v119, s49, v171
    v_pk_add_f32 v[96:97], v[96:97], v[112:113]
    v_pk_add_f32 v[98:99], v[98:99], v[114:115]
    v_pk_add_f32 v[100:101], v[100:101], v[116:117]
    v_pk_add_f32 v[102:103], v[102:103], v[118:119]
    s_waitcnt vmcnt(2)
    v_lshlrev_b32 v112, 16, v172
    v_and_b32 v113, s49, v172
    v_lshlrev_b32 v114, 16, v173
    v_and_b32 v115, s49, v173
    v_lshlrev_b32 v116, 16, v174
    v_and_b32 v117, s49, v174
    v_lshlrev_b32 v118, 16, v175
    v_and_b32_e64 v119, s49, v175
    v_pk_add_f32 v[96:97], v[96:97], v[112:113]
    v_pk_add_f32 v[98:99], v[98:99], v[114:115]
    v_pk_add_f32 v[100:101], v[100:101], v[116:117]
    v_pk_add_f32 v[102:103], v[102:103], v[118:119]
    v_pk_fma_f32 v[64:65], v[96:97], s[54:55], v[64:65] op_sel_hi:[1,0,1]
    v_pk_fma_f32 v[66:67], v[98:99], s[54:55], v[66:67] op_sel_hi:[1,0,1]
    v_pk_fma_f32 v[68:69], v[100:101], s[54:55], v[68:69] op_sel_hi:[1,0,1]
    v_pk_fma_f32 v[70:71], v[102:103], s[54:55], v[70:71] op_sel_hi:[1,0,1]
    s_waitcnt vmcnt(1)
    v_lshlrev_b32 v112, 16, v184
    v_and_b32 v113, s49, v184
    v_lshlrev_b32 v114, 16, v185
    v_and_b32 v115, s49, v185
    v_lshlrev_b32 v116, 16, v186
    v_and_b32 v117, s49, v186
    v_lshlrev_b32 v118, 16, v187
    v_and_b32_e64 v119, s49, v187
    v_pk_add_f32 v[104:105], v[104:105], v[112:113]
    v_pk_add_f32 v[106:107], v[106:107], v[114:115]
    v_pk_add_f32 v[108:109], v[108:109], v[116:117]
    v_pk_add_f32 v[110:111], v[110:111], v[118:119]
    s_waitcnt vmcnt(0)
    v_lshlrev_b32 v112, 16, v188
    v_and_b32 v113, s49, v188
    v_lshlrev_b32 v114, 16, v189
    v_and_b32 v115, s49, v189
    v_lshlrev_b32 v116, 16, v190
    v_and_b32 v117, s49, v190
    v_lshlrev_b32 v118, 16, v191
    v_and_b32_e64 v119, s49, v191
    v_pk_add_f32 v[104:105], v[104:105], v[112:113]
    v_pk_add_f32 v[106:107], v[106:107], v[114:115]
    v_pk_add_f32 v[108:109], v[108:109], v[116:117]
    v_pk_add_f32 v[110:111], v[110:111], v[118:119]
    v_pk_fma_f32 v[72:73], v[104:105], s[54:55], v[72:73] op_sel_hi:[1,0,1]
    v_pk_fma_f32 v[74:75], v[106:107], s[54:55], v[74:75] op_sel_hi:[1,0,1]
    v_pk_fma_f32 v[76:77], v[108:109], s[54:55], v[76:77] op_sel_hi:[1,0,1]
    v_pk_fma_f32 v[78:79], v[110:111], s[54:55], v[78:79] op_sel_hi:[1,0,1]
L_ln_go:
    v_pk_add_f32 v[112:113], v[48:49], v[50:51]
    v_pk_add_f32 v[116:117], v[52:53], v[54:55]
    v_pk_mul_f32 v[114:115], v[48:49], v[48:49]
    v_pk_mul_f32 v[118:119], v[50:51], v[50:51]
    v_pk_fma_f32 v[114:115], v[52:53], v[52:53], v[114:115]
    v_pk_fma_f32 v[118:119], v[54:55], v[54:55], v[118:119]
    v_pk_add_f32 v[112:113], v[112:113], v[56:57]
    v_pk_fma_f32 v[114:115], v[56:57], v[56:57], v[114:115]
    v_pk_add_f32 v[116:117], v[116:117], v[58:59]
    v_pk_fma_f32 v[118:119], v[58:59], v[58:59], v[118:119]
    v_pk_add_f32 v[112:113], v[112:113], v[60:61]
    v_pk_fma_f32 v[114:115], v[60:61], v[60:61], v[114:115]
    v_pk_add_f32 v[116:117], v[116:117], v[62:63]
    v_pk_fma_f32 v[118:119], v[62:63], v[62:63], v[118:119]
    v_pk_add_f32 v[112:113], v[112:113], v[64:65]
    v_pk_fma_f32 v[114:115], v[64:65], v[64:65], v[114:115]
    v_pk_add_f32 v[116:117], v[116:117], v[66:67]
    v_pk_fma_f32 v[118:119], v[66:67], v[66:67], v[118:119]
    v_pk_add_f32 v[112:113], v[112:113], v[68:69]
    v_pk_fma_f32 v[114:115], v[68:69], v[68:69], v[114:115]
    v_pk_add_f32 v[116:117], v[116:117], v[70:71]
    v_pk_fma_f32 v[118:119], v[70:71], v[70:71], v[118:119]
    v_pk_add_f32 v[112:113], v[112:113], v[72:73]
    v_pk_fma_f32 v[114:115], v[72:73], v[72:73], v[114:115]
    v_pk_add_f32 v[116:117], v[116:117], v[74:75]
    v_pk_fma_f32 v[118:119], v[74:75], v[74:75], v[118:119]
    v_pk_add_f32 v[112:113], v[112:113], v[76:77]
    v_pk_fma_f32 v[114:115], v[76:77], v[76:77], v[114:115]
    v_pk_add_f32 v[116:117], v[116:117], v[78:79]
    v_pk_fma_f32 v[118:119], v[78:79], v[78:79], v[118:119]
    v_pk_add_f32 v[112:113], v[112:113], v[116:117]
    v_pk_add_f32 v[114:115], v[114:115], v[118:119]
    v_add_f32 v112, v112, v113
    v_add_f32 v113, v114, v115
    s_nop 1
    v_add_f32_dpp v112, v112, v112 row_ror:8 row_mask:0xf bank_mask:0xf
    v_add_f32_dpp v113, v113, v113 row_ror:8 row_mask:0xf bank_mask:0xf
    v_mov_b32 v114, v112
    v_mov_b32 v115, v113
    s_nop 1
    v_permlane16_swap_b32 v112, v114
    v_permlane16_swap_b32 v113, v115
    s_nop 1
    v_pk_add_f32 v[112:113], v[112:113], v[114:115]
    v_mov_b32 v114, v112
    v_mov_b32 v115, v113
    s_nop 1
    v_permlane32_swap_b32 v112, v114
    v_permlane32_swap_b32 v113, v115
    s_nop 1
    v_pk_add_f32 v[112:113], v[112:113], v[114:115]
    ds_write_b64 v23, v[112:113] offset:0
    s_waitcnt vmcnt(0)
    v_accvgpr_read_b32 v32, a240
    v_accvgpr_read_b32 v33, a241
    v_accvgpr_read_b32 v34, a242
    v_accvgpr_read_b32 v35, a243
    v_accvgpr_read_b32 v36, a244
    v_accvgpr_read_b32 v37, a245
    v_accvgpr_read_b32 v38, a246
    v_accvgpr_read_b32 v39, a247
    v_accvgpr_read_b32 v40, a248
    v_accvgpr_read_b32 v41, a249
    v_accvgpr_read_b32 v42, a250
    v_accvgpr_read_b32 v43, a251
    v_accvgpr_read_b32 v44, a252
    v_accvgpr_read_b32 v45, a253
    v_accvgpr_read_b32 v46, a254
    v_accvgpr_read_b32 v47, a255
    v_lshlrev_b32 v80, 16, v32
    v_and_b32 v81, s49, v32
    v_lshlrev_b32 v82, 16, v33
    v_and_b32 v83, s49, v33
    v_lshlrev_b32 v84, 16, v34
    v_and_b32 v85, s49, v34
    v_lshlrev_b32 v86, 16, v35
    v_and_b32 v87, s49, v35
    v_lshlrev_b32 v88, 16, v36
    v_and_b32 v89, s49, v36
    v_lshlrev_b32 v90, 16, v37
    v_and_b32 v91, s49, v37
    v_lshlrev_b32 v92, 16, v38
    v_and_b32 v93, s49, v38
    v_lshlrev_b32 v94, 16, v39
    v_and_b32 v95, s49, v39
    v_lshlrev_b32 v96, 16, v40
    v_and_b32 v97, s49, v40
    v_lshlrev_b32 v98, 16, v41
    v_and_b32 v99, s49, v41
    v_lshlrev_b32 v100, 16, v42
    v_and_b32 v101, s49, v42
    v_lshlrev_b32 v102, 16, v43
    v_and_b32 v103, s49, v43
    v_lshlrev_b32 v104, 16, v44
    v_and_b32 v105, s49, v44
    v_lshlrev_b32 v106, 16, v45
    v_and_b32 v107, s49, v45
    v_lshlrev_b32 v108, 16, v46
    v_and_b32 v109, s49, v46
    v_lshlrev_b32 v110, 16, v47
    v_and_b32 v111, s49, v47
    s_waitcnt lgkmcnt(0)
    s_barrier
    ds_read_b128 v[112:115], v24 offset:0
    ds_read_b128 v[116:119], v24 offset:16
    s_waitcnt lgkmcnt(0)
    v_pk_add_f32 v[112:113], v[112:113], v[114:115]
    v_pk_add_f32 v[116:117], v[116:117], v[118:119]
    v_pk_add_f32 v[112:113], v[112:113], v[116:117]
    v_mul_f32 v114, s51, v112
    v_mul_f32_e64 v113, s51, v113
    v_fma_f32 v113, -v114, v114, v113
    v_max_f32 v113, 0, v113
    v_add_f32 v113, s52, v113
    v_rsq_f32 v112, v113
    s_nop 0
    v_mul_f32_e64 v114, v114, v112
    v_pk_fma_f32 v[116:117], v[48:49], v[112:113], v[114:115] op_sel_hi:[1,0,0] neg_lo:[0,0,1] neg_hi:[0,0,1]
    v_pk_fma_f32 v[118:119], v[50:51], v[112:113], v[114:115] op_sel_hi:[1,0,0] neg_lo:[0,0,1] neg_hi:[0,0,1]
    v_pk_fma_f32 v[120:121], v[52:53], v[112:113], v[114:115] op_sel_hi:[1,0,0] neg_lo:[0,0,1] neg_hi:[0,0,1]
    v_pk_fma_f32 v[48:49], v[116:117], v[80:81], v[48:49]
    v_pk_fma_f32 v[122:123], v[54:55], v[112:113], v[114:115] op_sel_hi:[1,0,0] neg_lo:[0,0,1] neg_hi:[0,0,1]
    v_pk_fma_f32 v[50:51], v[118:119], v[82:83], v[50:51]
    v_pk_fma_f32 v[116:117], v[56:57], v[112:113], v[114:115] op_sel_hi:[1,0,0] neg_lo:[0,0,1] neg_hi:[0,0,1]
    v_pk_fma_f32 v[52:53], v[120:121], v[84:85], v[52:53]
    v_pk_fma_f32 v[118:119], v[58:59], v[112:113], v[114:115] op_sel_hi:[1,0,0] neg_lo:[0,0,1] neg_hi:[0,0,1]
    v_pk_fma_f32 v[54:55], v[122:123], v[86:87], v[54:55]
    v_pk_fma_f32 v[120:121], v[60:61], v[112:113], v[114:115] op_sel_hi:[1,0,0] neg_lo:[0,0,1] neg_hi:[0,0,1]
    v_pk_fma_f32 v[56:57], v[116:117], v[88:89], v[56:57]
    v_pk_fma_f32 v[122:123], v[62:63], v[112:113], v[114:115] op_sel_hi:[1,0,0] neg_lo:[0,0,1] neg_hi:[0,0,1]
    v_pk_fma_f32 v[58:59], v[118:119], v[90:91], v[58:59]
    v_pk_fma_f32 v[116:117], v[64:65], v[112:113], v[114:115] op_sel_hi:[1,0,0] neg_lo:[0,0,1] neg_hi:[0,0,1]
    v_pk_fma_f32 v[60:61], v[120:121], v[92:93], v[60:61]
    v_pk_fma_f32 v[118:119], v[66:67], v[112:113], v[114:115] op_sel_hi:[1,0,0] neg_lo:[0,0,1] neg_hi:[0,0,1]
    v_pk_fma_f32 v[62:63], v[122:123], v[94:95], v[62:63]
    v_pk_fma_f32 v[120:121], v[68:69], v[112:113], v[114:115] op_sel_hi:[1,0,0] neg_lo:[0,0,1] neg_hi:[0,0,1]
    v_pk_fma_f32 v[64:65], v[116:117], v[96:97], v[64:65]
    v_pk_fma_f32 v[122:123], v[70:71], v[112:113], v[114:115] op_sel_hi:[1,0,0] neg_lo:[0,0,1] neg_hi:[0,0,1]
    v_pk_fma_f32 v[66:67], v[118:119], v[98:99], v[66:67]
    v_pk_fma_f32 v[116:117], v[72:73], v[112:113], v[114:115] op_sel_hi:[1,0,0] neg_lo:[0,0,1] neg_hi:[0,0,1]
    v_pk_fma_f32 v[68:69], v[120:121], v[100:101], v[68:69]
    v_pk_fma_f32 v[118:119], v[74:75], v[112:113], v[114:115] op_sel_hi:[1,0,0] neg_lo:[0,0,1] neg_hi:[0,0,1]
    v_pk_fma_f32 v[70:71], v[122:123], v[102:103], v[70:71]
    v_pk_fma_f32 v[120:121], v[76:77], v[112:113], v[114:115] op_sel_hi:[1,0,0] neg_lo:[0,0,1] neg_hi:[0,0,1]
    v_pk_fma_f32 v[72:73], v[116:117], v[104:105], v[72:73]
    v_pk_fma_f32 v[122:123], v[78:79], v[112:113], v[114:115] op_sel_hi:[1,0,0] neg_lo:[0,0,1] neg_hi:[0,0,1]
    v_pk_fma_f32 v[74:75], v[118:119], v[106:107], v[74:75]
    v_pk_fma_f32 v[76:77], v[120:121], v[108:109], v[76:77]
    v_pk_fma_f32 v[78:79], v[122:123], v[110:111], v[78:79]
    v_pk_add_f32 v[112:113], v[48:49], v[50:51]
    v_pk_add_f32 v[116:117], v[52:53], v[54:55]
    v_pk_mul_f32 v[114:115], v[48:49], v[48:49]
    v_pk_mul_f32 v[118:119], v[50:51], v[50:51]
    v_pk_fma_f32 v[114:115], v[52:53], v[52:53], v[114:115]
    v_pk_fma_f32 v[118:119], v[54:55], v[54:55], v[118:119]
    v_pk_add_f32 v[112:113], v[112:113], v[56:57]
    v_pk_fma_f32 v[114:115], v[56:57], v[56:57], v[114:115]
    v_pk_add_f32 v[116:117], v[116:117], v[58:59]
    v_pk_fma_f32 v[118:119], v[58:59], v[58:59], v[118:119]
    v_pk_add_f32 v[112:113], v[112:113], v[60:61]
    v_pk_fma_f32 v[114:115], v[60:61], v[60:61], v[114:115]
    v_pk_add_f32 v[116:117], v[116:117], v[62:63]
    v_pk_fma_f32 v[118:119], v[62:63], v[62:63], v[118:119]
    v_pk_add_f32 v[112:113], v[112:113], v[64:65]
    v_pk_fma_f32 v[114:115], v[64:65], v[64:65], v[114:115]
    v_pk_add_f32 v[116:117], v[116:117], v[66:67]
    v_pk_fma_f32 v[118:119], v[66:67], v[66:67], v[118:119]
    v_pk_add_f32 v[112:113], v[112:113], v[68:69]
    v_pk_fma_f32 v[114:115], v[68:69], v[68:69], v[114:115]
    v_pk_add_f32 v[116:117], v[116:117], v[70:71]
    v_pk_fma_f32 v[118:119], v[70:71], v[70:71], v[118:119]
    v_pk_add_f32 v[112:113], v[112:113], v[72:73]
    v_pk_fma_f32 v[114:115], v[72:73], v[72:73], v[114:115]
    v_pk_add_f32 v[116:117], v[116:117], v[74:75]
    v_pk_fma_f32 v[118:119], v[74:75], v[74:75], v[118:119]
    v_pk_add_f32 v[112:113], v[112:113], v[76:77]
    v_pk_fma_f32 v[114:115], v[76:77], v[76:77], v[114:115]
    v_pk_add_f32 v[116:117], v[116:117], v[78:79]
    v_pk_fma_f32 v[118:119], v[78:79], v[78:79], v[118:119]
    v_pk_add_f32 v[112:113], v[112:113], v[116:117]
    v_pk_add_f32 v[114:115], v[114:115], v[118:119]
    v_add_f32 v112, v112, v113
    v_add_f32 v113, v114, v115
    s_nop 1
    v_add_f32_dpp v112, v112, v112 row_ror:8 row_mask:0xf bank_mask:0xf
    v_add_f32_dpp v113, v113, v113 row_ror:8 row_mask:0xf bank_mask:0xf
    v_mov_b32 v114, v112
    v_mov_b32 v115, v113
    s_nop 1
    v_permlane16_swap_b32 v112, v114
    v_permlane16_swap_b32 v113, v115
    s_nop 1
    v_pk_add_f32 v[112:113], v[112:113], v[114:115]
    v_mov_b32 v114, v112
    v_mov_b32 v115, v113
    s_nop 1
    v_permlane32_swap_b32 v112, v114
    v_permlane32_swap_b32 v113, v115
    s_nop 1
    v_pk_add_f32 v[112:113], v[112:113], v[114:115]
    ds_write_b64 v23, v[112:113] offset:256
    v_cvt_pk_bf16_f32 v32, v48, v49
    v_cvt_pk_bf16_f32 v33, v50, v51
    v_cvt_pk_bf16_f32 v34, v52, v53
    v_cvt_pk_bf16_f32 v35, v54, v55
    v_cvt_pk_bf16_f32 v36, v56, v57
    v_cvt_pk_bf16_f32 v37, v58, v59
    v_cvt_pk_bf16_f32 v38, v60, v61
    v_cvt_pk_bf16_f32 v39, v62, v63
    v_cvt_pk_bf16_f32 v40, v64, v65
    v_cvt_pk_bf16_f32 v41, v66, v67
    v_cvt_pk_bf16_f32 v42, v68, v69
    v_cvt_pk_bf16_f32 v43, v70, v71
    v_cvt_pk_bf16_f32 v44, v72, v73
    v_cvt_pk_bf16_f32 v45, v74, v75
    v_cvt_pk_bf16_f32 v46, v76, v77
    v_cvt_pk_bf16_f32 v47, v78, v79
    s_cmp_lg_u32 s35, 0
    s_cbranch_scc1 L_keep1
    v_accvgpr_write_b32 a224, v32
    v_accvgpr_write_b32 a225, v33
    v_accvgpr_write_b32 a226, v34
    v_accvgpr_write_b32 a227, v35
    v_accvgpr_write_b32 a228, v36
    v_accvgpr_write_b32 a229, v37
    v_accvgpr_write_b32 a230, v38
    v_accvgpr_write_b32 a231, v39
    v_accvgpr_write_b32 a232, v40
    v_accvgpr_write_b32 a233, v41
    v_accvgpr_write_b32 a234, v42
    v_accvgpr_write_b32 a235, v43
    v_accvgpr_write_b32 a236, v44
    v_accvgpr_write_b32 a237, v45
    v_accvgpr_write_b32 a238, v46
    v_accvgpr_write_b32 a239, v47
    s_branch L_keep2
L_keep1:
    buffer_store_dwordx4 v[32:35], v20, s[12:15], s47 offen offset:0 sc1
    buffer_store_dwordx4 v[36:39], v20, s[12:15], s37 offen offset:1024 sc1
    buffer_store_dwordx4 v[40:43], v20, s[12:15], s38 offen offset:2048 sc1
    buffer_store_dwordx4 v[44:47], v20, s[12:15], s39 offen offset:3072 sc1
L_keep2:
    s_waitcnt lgkmcnt(0)
    s_barrier
    ds_read_b128 v[112:115], v24 offset:256
    ds_read_b128 v[116:119], v24 offset:272
    s_waitcnt lgkmcnt(0)
    v_pk_add_f32 v[112:113], v[112:113], v[114:115]
    v_pk_add_f32 v[116:117], v[116:117], v[118:119]
    v_pk_add_f32 v[112:113], v[112:113], v[116:117]
    v_mul_f32 v114, s51, v112
    v_mul_f32_e64 v113, s51, v113
    v_fma_f32 v113, -v114, v114, v113
    v_max_f32 v113, 0, v113
    v_add_f32 v113, s52, v113
    v_rsq_f32 v112, v113
    s_nop 0
    v_mul_f32 v112, 0x3eeff558, v112
    v_mul_f32_e64 v114, v114, v112
    v_pk_fma_f32 v[48:49], v[48:49], v[112:113], v[114:115] op_sel_hi:[1,0,0] neg_lo:[0,0,1] neg_hi:[0,0,1]
    v_pk_fma_f32 v[50:51], v[50:51], v[112:113], v[114:115] op_sel_hi:[1,0,0] neg_lo:[0,0,1] neg_hi:[0,0,1]
    v_pk_fma_f32 v[52:53], v[52:53], v[112:113], v[114:115] op_sel_hi:[1,0,0] neg_lo:[0,0,1] neg_hi:[0,0,1]
    v_pk_fma_f32 v[54:55], v[54:55], v[112:113], v[114:115] op_sel_hi:[1,0,0] neg_lo:[0,0,1] neg_hi:[0,0,1]
    v_cvt_pk_bf16_f32 v80, v48, v49
    v_cvt_pk_bf16_f32 v81, v50, v51
    v_cvt_pk_bf16_f32 v82, v52, v53
    v_cvt_pk_bf16_f32 v83, v54, v55
    buffer_store_dwordx4 v[80:83], v22, s[8:11], s50 offen sc1
    s_add_u32 s50, s50, 0x1000
    v_pk_fma_f32 v[56:57], v[56:57], v[112:113], v[114:115] op_sel_hi:[1,0,0] neg_lo:[0,0,1] neg_hi:[0,0,1]
    v_pk_fma_f32 v[58:59], v[58:59], v[112:113], v[114:115] op_sel_hi:[1,0,0] neg_lo:[0,0,1] neg_hi:[0,0,1]
    v_pk_fma_f32 v[60:61], v[60:61], v[112:113], v[114:115] op_sel_hi:[1,0,0] neg_lo:[0,0,1] neg_hi:[0,0,1]
    v_pk_fma_f32 v[62:63], v[62:63], v[112:113], v[114:115] op_sel_hi:[1,0,0] neg_lo:[0,0,1] neg_hi:[0,0,1]
    v_cvt_pk_bf16_f32 v84, v56, v57
    v_cvt_pk_bf16_f32 v85, v58, v59
    v_cvt_pk_bf16_f32 v86, v60, v61
    v_cvt_pk_bf16_f32 v87, v62, v63
    buffer_store_dwordx4 v[84:87], v22, s[8:11], s50 offen sc1
    s_add_u32 s50, s50, 0x1000
    v_pk_fma_f32 v[64:65], v[64:65], v[112:113], v[114:115] op_sel_hi:[1,0,0] neg_lo:[0,0,1] neg_hi:[0,0,1]
    v_pk_fma_f32 v[66:67], v[66:67], v[112:113], v[114:115] op_sel_hi:[1,0,0] neg_lo:[0,0,1] neg_hi:[0,0,1]
    v_pk_fma_f32 v[68:69], v[68:69], v[112:113], v[114:115] op_sel_hi:[1,0,0] neg_lo:[0,0,1] neg_hi:[0,0,1]
    v_pk_fma_f32 v[70:71], v[70:71], v[112:113], v[114:115] op_sel_hi:[1,0,0] neg_lo:[0,0,1] neg_hi:[0,0,1]
    v_cvt_pk_bf16_f32 v88, v64, v65
    v_cvt_pk_bf16_f32 v89, v66, v67
    v_cvt_pk_bf16_f32 v90, v68, v69
    v_cvt_pk_bf16_f32 v91, v70, v71
    buffer_store_dwordx4 v[88:91], v22, s[8:11], s50 offen sc1
    s_add_u32 s50, s50, 0x1000
    v_pk_fma_f32 v[72:73], v[72:73], v[112:113], v[114:115] op_sel_hi:[1,0,0] neg_lo:[0,0,1] neg_hi:[0,0,1]
    v_pk_fma_f32 v[74:75], v[74:75], v[112:113], v[114:115] op_sel_hi:[1,0,0] neg_lo:[0,0,1] neg_hi:[0,0,1]
    v_pk_fma_f32 v[76:77], v[76:77], v[112:113], v[114:115] op_sel_hi:[1,0,0] neg_lo:[0,0,1] neg_hi:[0,0,1]
    v_pk_fma_f32 v[78:79], v[78:79], v[112:113], v[114:115] op_sel_hi:[1,0,0] neg_lo:[0,0,1] neg_hi:[0,0,1]
    v_cvt_pk_bf16_f32 v92, v72, v73
    v_cvt_pk_bf16_f32 v93, v74, v75
    v_cvt_pk_bf16_f32 v94, v76, v77
    v_cvt_pk_bf16_f32 v95, v78, v79
    buffer_store_dwordx4 v[92:95], v22, s[8:11], s50 offen sc1
    s_add_u32 s52, s53, 8
    s_waitcnt vmcnt(0) lgkmcnt(0)
    s_barrier
    s_cmp_lg_u32 s3, 1
    s_cbranch_scc1 L_wf_9
    s_mov_b64 exec, 1
    v_mov_b32 v3, 0
    v_mov_b32 v4, 1
    buffer_atomic_add v4, v3, s[24:27], s52 offen sc1
    s_mov_b64 exec, -1
L_wf_9:
    s_cmp_eq_u32 s3, 1
    s_cbranch_scc1 L_p2v
    s_add_u32 m0, s42, 0
    s_nop 0
    buffer_load_dwordx4 v8, s[4:7], s40 offen offset:0 lds
    buffer_load_dwordx4 v9, s[4:7], s40 offen offset:1024 lds
    buffer_load_dwordx4 v10, s[4:7], s40 offen offset:2048 lds
    buffer_load_dwordx4 v11, s[4:7], s40 offen offset:3072 lds
    s_add_u32 m0, s42, 4096
    s_nop 0
    buffer_load_dwordx4 v12, s[4:7], s40 offen offset:0 lds
    buffer_load_dwordx4 v13, s[4:7], s40 offen offset:1024 lds
    buffer_load_dwordx4 v14, s[4:7], s40 offen offset:2048 lds
    s_add_u32 s40, s40, 458752
    s_add_u32 m0, s42, 28672
    s_nop 0
    buffer_load_dwordx4 v8, s[4:7], s40 offen offset:0 lds
    buffer_load_dwordx4 v9, s[4:7], s40 offen offset:1024 lds
    buffer_load_dwordx4 v10, s[4:7], s40 offen offset:2048 lds
    buffer_load_dwordx4 v11, s[4:7], s40 offen offset:3072 lds
    s_add_u32 m0, s42, 32768
    s_nop 0
    buffer_load_dwordx4 v12, s[4:7], s40 offen offset:0 lds
    buffer_load_dwordx4 v13, s[4:7], s40 offen offset:1024 lds
    buffer_load_dwordx4 v14, s[4:7], s40 offen offset:2048 lds
    s_add_u32 s40, s40, 458752
    s_add_u32 m0, s42, 57344
    s_nop 0
    buffer_load_dwordx4 v8, s[4:7], s40 offen offset:0 lds
    buffer_load_dwordx4 v9, s[4:7], s40 offen offset:1024 lds
    buffer_load_dwordx4 v10, s[4:7], s40 offen offset:2048 lds
    buffer_load_dwordx4 v11, s[4:7], s40 offen offset:3072 lds
    s_add_u32 m0, s42, 61440
    s_nop 0
    buffer_load_dwordx4 v12, s[4:7], s40 offen offset:0 lds
    buffer_load_dwordx4 v13, s[4:7], s40 offen offset:1024 lds
    buffer_load_dwordx4 v14, s[4:7], s40 offen offset:2048 lds
    s_add_u32 s40, s40, 458752
L_p2v:
    s_add_u32 s12, s28, 0x1400000
    s_addc_u32 s13, s29, 0
    s_mov_b32 s14, 0xe00000
    s_mov_b32 s15, 0x00020000
    s_mov_b32 s18, 7340032
    s_mov_b32 s19, 0x00020000
    s_add_u32 s20, s28, 0x2400000
    s_addc_u32 s21, s29, 0
    s_mov_b32 s22, 0x700000
    s_mov_b32 s23, 0x00020000
    s_lshl_b32 s41, s31, 2
    s_add_u32 s41, s41, s3
    s_lshl_b32 s41, s41, 17
    s_add_u32 s50, s41, 122880
    s_lshl_b32 s51, s35, 30
    v_lshrrev_b32 v5, 3, v0
    v_and_b32 v6, 7, v0
    v_lshlrev_b32_e64 v23, 11, v5
    v_lshl_add_u32 v23, v6, 4, v23
    v_bfe_u32 v6, v0, 1, 1
    v_lshlrev_b32_e64 v24, 10, v6
    v_lshl_add_u32 v24, v5, 5, v24
    v_and_b32_e64 v6, 1, v0
    v_lshl_add_u32 v24, v6, 4, v24
    v_bfe_u32 v25, v0, 2, 1
    s_lshl_b32 s48, s2, 1
    s_and_b32 s55, s3, 1
    s_add_u32 s48, s48, s55
    s_mul_i32 s48, s48, 4480
    s_add_u32 s48, s48, 4587520
    s_add_u32 s48, s48, s51
    v_min_u32 v22, 34, v0
    v_lshlrev_b32 v22, 7, v22
    s_lshl_b32 s49, s2, 2
    s_add_u32 s49, s49, s3
    s_lshr_b32 s58, s49, 4
    s_and_b32 s59, s49, 15
    s_mul_i32 s60, s58, 2341
    s_lshr_b32 s60, s60, 16
    s_mul_i32 s61, s60, 28
    s_sub_u32 s61, s58, s61
    s_lshr_b32 s45, s59, 1
    s_mul_i32 s45, s45, 112
    s_add_u32 s45, s45, s58
    s_lshl_b32 s45, s45, 13
    s_and_b32 s58, s59, 1
    s_lshl_b32 s58, s58, 1
    s_sub_u32 s58, s58, s60
    s_add_u32 s58, s58, 3
    v_add_u32 v7, s58, v25
    v_and_b32 v7, 3, v7
    v_lshl_add_u32 v30, v7, 11, v24
    s_mul_i32 s60, s60, 896
    s_sub_u32 s58, s61, 8
    s_mul_i32 s58, s58, 224
    s_add_u32 s58, s58, 96
    s_sub_u32 s44, s61, 4
    s_cmp_lt_u32 s61, 8
    s_cselect_b32 s44, s61, s44
    s_and_b32 s55, s44, 7
    s_mul_i32 s55, s55, 112
    s_lshr_b32 s44, s44, 3
    s_lshl_b32 s44, s44, 5
    s_add_u32 s44, s44, s55
    s_sub_u32 s55, s61, 8
    s_cmp_lt_u32 s55, 4
    s_cselect_b32 s44, s58, s44
    s_cselect_b32 s38, 112, 16
    s_add_u32 s44, s44, s60
    s_add_u32 s38, s38, s44
    s_lshr_b32 s58, s44, 6
    s_mul_i32 s60, s58, 37
    s_lshr_b32 s60, s60, 8
    s_add_u32 s61, s60, 1
    s_min_u32 s61, s61, 7
    s_sub_u32 s61, s58, s61
    s_sub_u32 s55, s61, s62
    s_add_u32 s55, s55, 7
    s_mul_i32 s55, s55, 37
    s_lshr_b32 s55, s55, 8
    s_add_u32 s61, s61, s55
    s_mul_i32 s55, s60, 7
    s_lshl_b32 s60, s60, 3
    s_add_u32 s60, s60, s62
    s_cmp_eq_u32 s55, s58
    s_cselect_b32 s60, s60, s61
    s_cmp_eq_u32 s58, 49
    s_cselect_b32 s60, s61, s60
    s_and_b32 s44, s44, 63
    s_lshl_b32 s60, s60, 6
    s_add_u32 s44, s44, s60
    s_lshr_b32 s58, s38, 6
    s_mul_i32 s60, s58, 37
    s_lshr_b32 s60, s60, 8
    s_add_u32 s61, s60, 1
    s_min_u32 s61, s61, 7
    s_sub_u32 s61, s58, s61
    s_sub_u32 s55, s61, s62
    s_add_u32 s55, s55, 7
    s_mul_i32 s55, s55, 37
    s_lshr_b32 s55, s55, 8
    s_add_u32 s61, s61, s55
    s_mul_i32 s55, s60, 7
    s_lshl_b32 s60, s60, 3
    s_add_u32 s60, s60, s62
    s_cmp_eq_u32 s55, s58
    s_cselect_b32 s60, s60, s61
    s_cmp_eq_u32 s58, 49
    s_cselect_b32 s60, s61, s60
    s_and_b32 s38, s38, 63
    s_lshl_b32 s60, s60, 6
    s_add_u32 s38, s38, s60
    s_sub_u32 s38, s38, s44
    s_sub_u32 s38, s38, 8
    s_lshl_b32 s38, s38, 11
    s_lshl_b32 s44, s44, 11
    s_lshl_b32 s59, s59, 7
    s_add_u32 s44, s44, s59
    s_cmp_lt_u32 s49, 1792
    s_cselect_b32 s55, s51, 0x40000000
    s_add_u32 s44, s44, s55
    s_add_u32 s45, s45, s55
    s_add_u32 s49, s49, 1024
    s_lshr_b32 s58, s49, 4
    s_and_b32 s59, s49, 15
    s_mul_i32 s60, s58, 2341
    s_lshr_b32 s60, s60, 16
    s_mul_i32 s61, s60, 28
    s_sub_u32 s61, s58, s61
    s_lshr_b32 s47, s59, 1
    s_mul_i32 s47, s47, 112
    s_add_u32 s47, s47, s58
    s_lshl_b32 s47, s47, 13
    s_and_b32 s58, s59, 1
    s_lshl_b32 s58, s58, 1
    s_sub_u32 s58, s58, s60
    s_add_u32 s58, s58, 3
    v_add_u32 v7, s58, v25
    v_and_b32 v7, 3, v7
    v_lshl_add_u32 v19, v7, 11, v24
    s_mul_i32 s60, s60, 896
    s_sub_u32 s58, s61, 8
    s_mul_i32 s58, s58, 224
    s_add_u32 s58, s58, 96
    s_sub_u32 s46, s61, 4
    s_cmp_lt_u32 s61, 8
    s_cselect_b32 s46, s61, s46
    s_and_b32 s55, s46, 7
    s_mul_i32 s55, s55, 112
    s_lshr_b32 s46, s46, 3
    s_lshl_b32 s46, s46, 5
    s_add_u32 s46, s46, s55
    s_sub_u32 s55, s61, 8
    s_cmp_lt_u32 s55, 4
    s_cselect_b32 s46, s58, s46
    s_cselect_b32 s39, 112, 16
    s_add_u32 s46, s46, s60
    s_add_u32 s39, s39, s46
    s_lshr_b32 s58, s46, 6
    s_mul_i32 s60, s58, 37
    s_lshr_b32 s60, s60, 8
    s_add_u32 s61, s60, 1
    s_min_u32 s61, s61, 7
    s_sub_u32 s61, s58, s61
    s_sub_u32 s55, s61, s62
    s_add_u32 s55, s55, 7
    s_mul_i32 s55, s55, 37
    s_lshr_b32 s55, s55, 8
    s_add_u32 s61, s61, s55
    s_mul_i32 s55, s60, 7
    s_lshl_b32 s60, s60, 3
    s_add_u32 s60, s60, s62
    s_cmp_eq_u32 s55, s58
    s_cselect_b32 s60, s60, s61
    s_cmp_eq_u32 s58, 49
    s_cselect_b32 s60, s61, s60
    s_and_b32 s46, s46, 63
    s_lshl_b32 s60, s60, 6
    s_add_u32 s46, s46, s60
    s_lshr_b32 s58, s39, 6
    s_mul_i32 s60, s58, 37
    s_lshr_b32 s60, s60, 8
    s_add_u32 s61, s60, 1
    s_min_u32 s61, s61, 7
    s_sub_u32 s61, s58, s61
    s_sub_u32 s55, s61, s62
    s_add_u32 s55, s55, 7
    s_mul_i32 s55, s55, 37
    s_lshr_b32 s55, s55, 8
    s_add_u32 s61, s61, s55
    s_mul_i32 s55, s60, 7
    s_lshl_b32 s60, s60, 3
    s_add_u32 s60, s60, s62
    s_cmp_eq_u32 s55, s58
    s_cselect_b32 s60, s60, s61
    s_cmp_eq_u32 s58, 49
    s_cselect_b32 s60, s61, s60
    s_and_b32 s39, s39, 63
    s_lshl_b32 s60, s60, 6
    s_add_u32 s39, s39, s60
    s_sub_u32 s39, s39, s46
    s_sub_u32 s39, s39, 8
    s_lshl_b32 s39, s39, 11
    s_lshl_b32 s46, s46, 11
    s_lshl_b32 s59, s59, 7
    s_add_u32 s46, s46, s59
    s_cmp_lt_u32 s49, 1792
    s_cselect_b32 s55, s51, 0x40000000
    s_add_u32 s46, s46, s55
    s_add_u32 s47, s47, s55
    s_mov_b32 s49, 6881280
    s_cmp_lg_u32 s3, 1
    s_cbranch_scc1 L_p2x
    s_mov_b32 s56, 0
L_poll_10:
    buffer_load_dword v4, v1, s[24:27], s52 offen sc1
    s_add_u32 s56, s56, 1
    s_waitcnt vmcnt(0)
    v_readfirstlane_b32 s30, v4
    s_cmp_ge_u32 s30, 32
    s_cbranch_scc1 L_polld_11
    s_cmp_lt_u32 s56, 400000
    s_cbranch_scc1 L_poll_10
L_polld_11:
L_p2x:
    s_waitcnt vmcnt(7)
    s_barrier
    buffer_load_dwordx4 a[0:3], v2, s[8:11], s41 offen offset:0 sc1
    buffer_load_dwordx4 a[4:7], v2, s[8:11], s41 offen offset:1024 sc1
    buffer_load_dwordx4 a[8:11], v2, s[8:11], s41 offen offset:2048 sc1
    buffer_load_dwordx4 a[12:15], v2, s[8:11], s41 offen offset:3072 sc1
    s_add_u32 s41, s41, 4096
    buffer_load_dwordx4 a[16:19], v2, s[8:11], s41 offen offset:0 sc1
    buffer_load_dwordx4 a[20:23], v2, s[8:11], s41 offen offset:1024 sc1
    buffer_load_dwordx4 a[24:27], v2, s[8:11], s41 offen offset:2048 sc1
    buffer_load_dwordx4 a[28:31], v2, s[8:11], s41 offen offset:3072 sc1
    s_add_u32 s41, s41, 4096
    ds_read_b64_tr_b16 a[128:129], v15 offset:0
    ds_read_b64_tr_b16 a[130:131], v15 offset:1792
    ds_read_b64_tr_b16 a[132:133], v15 offset:14336
    ds_read_b64_tr_b16 a[134:135], v15 offset:16128
    ds_read_b64_tr_b16 a[136:137], v15 offset:32
    ds_read_b64_tr_b16 a[138:139], v15 offset:1824
    ds_read_b64_tr_b16 a[140:141], v15 offset:14368
    ds_read_b64_tr_b16 a[142:143], v15 offset:16160
    s_waitcnt vmcnt(4)
    s_waitcnt lgkmcnt(6)
    v_mfma_f32_16x16x32_bf16 v[32:35], a[128:131], a[0:3], 0
    ds_read_b64_tr_b16 a[144:145], v15 offset:64
    v_mfma_f32_16x16x32_bf16 v[36:39], a[128:131], a[4:7], 0
    ds_read_b64_tr_b16 a[146:147], v15 offset:1856
    v_mfma_f32_16x16x32_bf16 v[40:43], a[128:131], a[8:11], 0
    buffer_load_dwordx4 a[32:35], v2, s[8:11], s41 offen offset:0 sc1
    v_mfma_f32_16x16x32_bf16 v[44:47], a[128:131], a[12:15], 0
    s_waitcnt lgkmcnt(6)
    v_mfma_f32_16x16x32_bf16 v[48:51], a[132:135], a[0:3], 0
    ds_read_b64_tr_b16 a[148:149], v15 offset:14400
    v_mfma_f32_16x16x32_bf16 v[52:55], a[132:135], a[4:7], 0
    ds_read_b64_tr_b16 a[150:151], v15 offset:16192
    v_mfma_f32_16x16x32_bf16 v[56:59], a[132:135], a[8:11], 0
    v_mfma_f32_16x16x32_bf16 v[60:63], a[132:135], a[12:15], 0
    s_waitcnt lgkmcnt(6)
    v_mfma_f32_16x16x32_bf16 v[64:67], a[136:139], a[0:3], 0
    ds_read_b64_tr_b16 a[152:153], v15 offset:96
    v_mfma_f32_16x16x32_bf16 v[68:71], a[136:139], a[4:7], 0
    ds_read_b64_tr_b16 a[154:155], v15 offset:1888
    v_mfma_f32_16x16x32_bf16 v[72:75], a[136:139], a[8:11], 0
    buffer_load_dwordx4 a[36:39], v2, s[8:11], s41 offen offset:1024 sc1
    v_mfma_f32_16x16x32_bf16 v[76:79], a[136:139], a[12:15], 0
    s_waitcnt lgkmcnt(6)
    v_mfma_f32_16x16x32_bf16 v[80:83], a[140:143], a[0:3], 0
    ds_read_b64_tr_b16 a[156:157], v15 offset:14432
    v_mfma_f32_16x16x32_bf16 v[84:87], a[140:143], a[4:7], 0
    ds_read_b64_tr_b16 a[158:159], v15 offset:16224
    v_mfma_f32_16x16x32_bf16 v[88:91], a[140:143], a[8:11], 0
    v_mfma_f32_16x16x32_bf16 v[92:95], a[140:143], a[12:15], 0
    s_waitcnt lgkmcnt(6)
    v_mfma_f32_16x16x32_bf16 v[96:99], a[144:147], a[0:3], 0
    ds_read_b64_tr_b16 a[128:129], v15 offset:128
    v_mfma_f32_16x16x32_bf16 v[100:103], a[144:147], a[4:7], 0
    ds_read_b64_tr_b16 a[130:131], v15 offset:1920
    v_mfma_f32_16x16x32_bf16 v[104:107], a[144:147], a[8:11], 0
    v_mfma_f32_16x16x32_bf16 v[108:111], a[144:147], a[12:15], 0
    s_waitcnt lgkmcnt(6)
    v_mfma_f32_16x16x32_bf16 v[112:115], a[148:151], a[0:3], 0
    ds_read_b64_tr_b16 a[132:133], v15 offset:14464
    v_mfma_f32_16x16x32_bf16 v[116:119], a[148:151], a[4:7], 0
    ds_read_b64_tr_b16 a[134:135], v15 offset:16256
    v_mfma_f32_16x16x32_bf16 v[120:123], a[148:151], a[8:11], 0
    buffer_load_dwordx4 a[40:43], v2, s[8:11], s41 offen offset:2048 sc1
    v_mfma_f32_16x16x32_bf16 v[124:127], a[148:151], a[12:15], 0
    s_waitcnt lgkmcnt(6)
    v_mfma_f32_16x16x32_bf16 v[128:131], a[152:155], a[0:3], 0
    ds_read_b64_tr_b16 a[136:137], v15 offset:160
    v_mfma_f32_16x16x32_bf16 v[132:135], a[152:155], a[4:7], 0
    ds_read_b64_tr_b16 a[138:139], v15 offset:1952
    v_mfma_f32_16x16x32_bf16 v[136:139], a[152:155], a[8:11], 0
    v_mfma_f32_16x16x32_bf16 v[140:143], a[152:155], a[12:15], 0
    s_waitcnt lgkmcnt(6)
    v_mfma_f32_16x16x32_bf16 v[144:147], a[156:159], a[0:3], 0
    ds_read_b64_tr_b16 a[140:141], v15 offset:14496
    v_mfma_f32_16x16x32_bf16 v[148:151], a[156:159], a[4:7], 0
    ds_read_b64_tr_b16 a[142:143], v15 offset:16288
    v_mfma_f32_16x16x32_bf16 v[152:155], a[156:159], a[8:11], 0
    v_mfma_f32_16x16x32_bf16 v[156:159], a[156:159], a[12:15], 0
    s_waitcnt lgkmcnt(6)
    v_mfma_f32_16x16x32_bf16 v[160:163], a[128:131], a[0:3], 0
    ds_read_b64_tr_b16 a[144:145], v15 offset:192
    v_mfma_f32_16x16x32_bf16 v[164:167], a[128:131], a[4:7], 0
    ds_read_b64_tr_b16 a[146:147], v15 offset:1984
    v_mfma_f32_16x16x32_bf16 v[168:171], a[128:131], a[8:11], 0
    buffer_load_dwordx4 a[44:47], v2, s[8:11], s41 offen offset:3072 sc1
    s_add_u32 s41, s41, 4096
    v_mfma_f32_16x16x32_bf16 v[172:175], a[128:131], a[12:15], 0
    s_waitcnt lgkmcnt(6)
    v_mfma_f32_16x16x32_bf16 v[176:179], a[132:135], a[0:3], 0
    ds_read_b64_tr_b16 a[148:149], v15 offset:14528
    v_mfma_f32_16x16x32_bf16 v[180:183], a[132:135], a[4:7], 0
    ds_read_b64_tr_b16 a[150:151], v15 offset:16320
    v_mfma_f32_16x16x32_bf16 v[184:187], a[132:135], a[8:11], 0
    v_mfma_f32_16x16x32_bf16 v[188:191], a[132:135], a[12:15], 0
    s_waitcnt lgkmcnt(6)
    v_mfma_f32_16x16x32_bf16 v[192:195], a[136:139], a[0:3], 0
    ds_read_b64_tr_b16 a[152:153], v15 offset:7168
    v_mfma_f32_16x16x32_bf16 v[196:199], a[136:139], a[4:7], 0
    ds_read_b64_tr_b16 a[154:155], v15 offset:8960
    v_mfma_f32_16x16x32_bf16 v[200:203], a[136:139], a[8:11], 0
    v_mfma_f32_16x16x32_bf16 v[204:207], a[136:139], a[12:15], 0
    s_waitcnt lgkmcnt(6)
    v_mfma_f32_16x16x32_bf16 v[208:211], a[140:143], a[0:3], 0
    ds_read_b64_tr_b16 a[156:157], v15 offset:21504
    v_mfma_f32_16x16x32_bf16 v[212:215], a[140:143], a[4:7], 0
    ds_read_b64_tr_b16 a[158:159], v15 offset:23296
    v_mfma_f32_16x16x32_bf16 v[216:219], a[140:143], a[8:11], 0
    buffer_load_dwordx4 a[48:51], v2, s[8:11], s41 offen offset:0 sc1
    v_mfma_f32_16x16x32_bf16 v[220:223], a[140:143], a[12:15], 0
    s_waitcnt lgkmcnt(6)
    s_waitcnt vmcnt(20)
    s_barrier
    v_mfma_f32_16x16x32_bf16 v[224:227], a[144:147], a[0:3], 0
    ds_read_b64_tr_b16 a[128:129], v15 offset:7200
    v_mfma_f32_16x16x32_bf16 v[228:231], a[144:147], a[4:7], 0
    ds_read_b64_tr_b16 a[130:131], v15 offset:8992
    s_add_u32 m0, s42, 86016
    v_mfma_f32_16x16x32_bf16 v[232:235], a[144:147], a[8:11], 0
    buffer_load_dwordx4 v8, s[4:7], s40 offen offset:0 lds
    v_mfma_f32_16x16x32_bf16 v[236:239], a[144:147], a[12:15], 0
    s_waitcnt lgkmcnt(6)
    v_mfma_f32_16x16x32_bf16 v[240:243], a[148:151], a[0:3], 0
    ds_read_b64_tr_b16 a[132:133], v15 offset:21536
    v_mfma_f32_16x16x32_bf16 v[244:247], a[148:151], a[4:7], 0
    ds_read_b64_tr_b16 a[134:135], v15 offset:23328
    v_mfma_f32_16x16x32_bf16 v[248:251], a[148:151], a[8:11], 0
    buffer_load_dwordx4 a[52:55], v2, s[8:11], s41 offen offset:1024 sc1
    v_mfma_f32_16x16x32_bf16 v[252:255], a[148:151], a[12:15], 0
    s_waitcnt vmcnt(7)
    s_waitcnt lgkmcnt(6)
    v_mfma_f32_16x16x32_bf16 v[32:35], a[152:155], a[16:19], v[32:35]
    ds_read_b64_tr_b16 a[136:137], v15 offset:7232
    v_mfma_f32_16x16x32_bf16 v[36:39], a[152:155], a[20:23], v[36:39]
    ds_read_b64_tr_b16 a[138:139], v15 offset:9024
    v_mfma_f32_16x16x32_bf16 v[40:43], a[152:155], a[24:27], v[40:43]
    v_mfma_f32_16x16x32_bf16 v[44:47], a[152:155], a[28:31], v[44:47]
    s_waitcnt lgkmcnt(6)
    v_mfma_f32_16x16x32_bf16 v[48:51], a[156:159], a[16:19], v[48:51]
    ds_read_b64_tr_b16 a[140:141], v15 offset:21568
    v_mfma_f32_16x16x32_bf16 v[52:55], a[156:159], a[20:23], v[52:55]
    ds_read_b64_tr_b16 a[142:143], v15 offset:23360
    s_add_u32 m0, s42, 86016
    v_mfma_f32_16x16x32_bf16 v[56:59], a[156:159], a[24:27], v[56:59]
    buffer_load_dwordx4 v9, s[4:7], s40 offen offset:1024 lds
    v_mfma_f32_16x16x32_bf16 v[60:63], a[156:159], a[28:31], v[60:63]
    s_waitcnt lgkmcnt(6)
    v_mfma_f32_16x16x32_bf16 v[64:67], a[128:131], a[16:19], v[64:67]
    ds_read_b64_tr_b16 a[144:145], v15 offset:7264
    v_mfma_f32_16x16x32_bf16 v[68:71], a[128:131], a[20:23], v[68:71]
    ds_read_b64_tr_b16 a[146:147], v15 offset:9056
    v_mfma_f32_16x16x32_bf16 v[72:75], a[128:131], a[24:27], v[72:75]
    buffer_load_dwordx4 a[56:59], v2, s[8:11], s41 offen offset:2048 sc1
    v_mfma_f32_16x16x32_bf16 v[76:79], a[128:131], a[28:31], v[76:79]
    s_waitcnt lgkmcnt(6)
    v_mfma_f32_16x16x32_bf16 v[80:83], a[132:135], a[16:19], v[80:83]
    ds_read_b64_tr_b16 a[148:149], v15 offset:21600
    v_mfma_f32_16x16x32_bf16 v[84:87], a[132:135], a[20:23], v[84:87]
    ds_read_b64_tr_b16 a[150:151], v15 offset:23392
    v_mfma_f32_16x16x32_bf16 v[88:91], a[132:135], a[24:27], v[88:91]
    v_mfma_f32_16x16x32_bf16 v[92:95], a[132:135], a[28:31], v[92:95]
    s_waitcnt lgkmcnt(6)
    v_mfma_f32_16x16x32_bf16 v[96:99], a[136:139], a[16:19], v[96:99]
    ds_read_b64_tr_b16 a[152:153], v15 offset:7296
    v_mfma_f32_16x16x32_bf16 v[100:103], a[136:139], a[20:23], v[100:103]
    ds_read_b64_tr_b16 a[154:155], v15 offset:9088
    s_add_u32 m0, s42, 86016
    v_mfma_f32_16x16x32_bf16 v[104:107], a[136:139], a[24:27], v[104:107]
    buffer_load_dwordx4 v10, s[4:7], s40 offen offset:2048 lds
    v_mfma_f32_16x16x32_bf16 v[108:111], a[136:139], a[28:31], v[108:111]
    s_waitcnt lgkmcnt(6)
    v_mfma_f32_16x16x32_bf16 v[112:115], a[140:143], a[16:19], v[112:115]
    ds_read_b64_tr_b16 a[156:157], v15 offset:21632
    v_mfma_f32_16x16x32_bf16 v[116:119], a[140:143], a[20:23], v[116:119]
    ds_read_b64_tr_b16 a[158:159], v15 offset:23424
    v_mfma_f32_16x16x32_bf16 v[120:123], a[140:143], a[24:27], v[120:123]
    buffer_load_dwordx4 a[60:63], v2, s[8:11], s41 offen offset:3072 sc1
    s_add_u32 s41, s41, 4096
    v_mfma_f32_16x16x32_bf16 v[124:127], a[140:143], a[28:31], v[124:127]
    s_waitcnt lgkmcnt(6)
    v_mfma_f32_16x16x32_bf16 v[128:131], a[144:147], a[16:19], v[128:131]
    ds_read_b64_tr_b16 a[128:129], v15 offset:7328
    v_mfma_f32_16x16x32_bf16 v[132:135], a[144:147], a[20:23], v[132:135]
    ds_read_b64_tr_b16 a[130:131], v15 offset:9120
    s_add_u32 m0, s42, 86016
    v_mfma_f32_16x16x32_bf16 v[136:139], a[144:147], a[24:27], v[136:139]
    buffer_load_dwordx4 v11, s[4:7], s40 offen offset:3072 lds
    v_mfma_f32_16x16x32_bf16 v[140:143], a[144:147], a[28:31], v[140:143]
    s_waitcnt lgkmcnt(6)
    v_mfma_f32_16x16x32_bf16 v[144:147], a[148:151], a[16:19], v[144:147]
    ds_read_b64_tr_b16 a[132:133], v15 offset:21664
    v_mfma_f32_16x16x32_bf16 v[148:151], a[148:151], a[20:23], v[148:151]
    ds_read_b64_tr_b16 a[134:135], v15 offset:23456
    v_mfma_f32_16x16x32_bf16 v[152:155], a[148:151], a[24:27], v[152:155]
    v_mfma_f32_16x16x32_bf16 v[156:159], a[148:151], a[28:31], v[156:159]
    s_waitcnt lgkmcnt(6)
    v_mfma_f32_16x16x32_bf16 v[160:163], a[152:155], a[16:19], v[160:163]
    ds_read_b64_tr_b16 a[136:137], v15 offset:7360
    v_mfma_f32_16x16x32_bf16 v[164:167], a[152:155], a[20:23], v[164:167]
    ds_read_b64_tr_b16 a[138:139], v15 offset:9152
    v_mfma_f32_16x16x32_bf16 v[168:171], a[152:155], a[24:27], v[168:171]
    buffer_load_dwordx4 a[64:67], v2, s[8:11], s41 offen offset:0 sc1
    v_mfma_f32_16x16x32_bf16 v[172:175], a[152:155], a[28:31], v[172:175]
    s_waitcnt lgkmcnt(6)
    v_mfma_f32_16x16x32_bf16 v[176:179], a[156:159], a[16:19], v[176:179]
    ds_read_b64_tr_b16 a[140:141], v15 offset:21696
    v_mfma_f32_16x16x32_bf16 v[180:183], a[156:159], a[20:23], v[180:183]
    ds_read_b64_tr_b16 a[142:143], v15 offset:23488
    s_add_u32 m0, s42, 90112
    v_mfma_f32_16x16x32_bf16 v[184:187], a[156:159], a[24:27], v[184:187]
    buffer_load_dwordx4 v12, s[4:7], s40 offen offset:0 lds
    v_mfma_f32_16x16x32_bf16 v[188:191], a[156:159], a[28:31], v[188:191]
    s_waitcnt lgkmcnt(6)
    v_mfma_f32_16x16x32_bf16 v[192:195], a[128:131], a[16:19], v[192:195]
    ds_read_b64_tr_b16 a[144:145], v15 offset:28672
    v_mfma_f32_16x16x32_bf16 v[196:199], a[128:131], a[20:23], v[196:199]
    ds_read_b64_tr_b16 a[146:147], v15 offset:30464
    v_mfma_f32_16x16x32_bf16 v[200:203], a[128:131], a[24:27], v[200:203]
    buffer_load_dwordx4 a[68:71], v2, s[8:11], s41 offen offset:1024 sc1
    v_mfma_f32_16x16x32_bf16 v[204:207], a[128:131], a[28:31], v[204:207]
    s_waitcnt lgkmcnt(6)
    v_mfma_f32_16x16x32_bf16 v[208:211], a[132:135], a[16:19], v[208:211]
    ds_read_b64_tr_b16 a[148:149], v15 offset:43008
    v_mfma_f32_16x16x32_bf16 v[212:215], a[132:135], a[20:23], v[212:215]
    ds_read_b64_tr_b16 a[150:151], v15 offset:44800
    v_mfma_f32_16x16x32_bf16 v[216:219], a[132:135], a[24:27], v[216:219]
    v_mfma_f32_16x16x32_bf16 v[220:223], a[132:135], a[28:31], v[220:223]
    s_waitcnt lgkmcnt(6)
    v_mfma_f32_16x16x32_bf16 v[224:227], a[136:139], a[16:19], v[224:227]
    ds_read_b64_tr_b16 a[152:153], v15 offset:28704
    v_mfma_f32_16x16x32_bf16 v[228:231], a[136:139], a[20:23], v[228:231]
    ds_read_b64_tr_b16 a[154:155], v15 offset:30496
    s_add_u32 m0, s42, 90112
    v_mfma_f32_16x16x32_bf16 v[232:235], a[136:139], a[24:27], v[232:235]
    buffer_load_dwordx4 v13, s[4:7], s40 offen offset:1024 lds
    v_mfma_f32_16x16x32_bf16 v[236:239], a[136:139], a[28:31], v[236:239]
    s_waitcnt lgkmcnt(6)
    v_mfma_f32_16x16x32_bf16 v[240:243], a[140:143], a[16:19], v[240:243]
    ds_read_b64_tr_b16 a[156:157], v15 offset:43040
    v_mfma_f32_16x16x32_bf16 v[244:247], a[140:143], a[20:23], v[244:247]
    ds_read_b64_tr_b16 a[158:159], v15 offset:44832
    v_mfma_f32_16x16x32_bf16 v[248:251], a[140:143], a[24:27], v[248:251]
    buffer_load_dwordx4 a[72:75], v2, s[8:11], s41 offen offset:2048 sc1
    v_mfma_f32_16x16x32_bf16 v[252:255], a[140:143], a[28:31], v[252:255]
    s_waitcnt vmcnt(13)
    s_waitcnt lgkmcnt(6)
    v_mfma_f32_16x16x32_bf16 v[32:35], a[144:147], a[32:35], v[32:35]
    ds_read_b64_tr_b16 a[128:129], v15 offset:28736
    v_mfma_f32_16x16x32_bf16 v[36:39], a[144:147], a[36:39], v[36:39]
    ds_read_b64_tr_b16 a[130:131], v15 offset:30528
    v_mfma_f32_16x16x32_bf16 v[40:43], a[144:147], a[40:43], v[40:43]
    v_mfma_f32_16x16x32_bf16 v[44:47], a[144:147], a[44:47], v[44:47]
    s_waitcnt lgkmcnt(6)
    v_mfma_f32_16x16x32_bf16 v[48:51], a[148:151], a[32:35], v[48:51]
    ds_read_b64_tr_b16 a[132:133], v15 offset:43072
    v_mfma_f32_16x16x32_bf16 v[52:55], a[148:151], a[36:39], v[52:55]
    ds_read_b64_tr_b16 a[134:135], v15 offset:44864
    s_add_u32 m0, s42, 90112
    v_mfma_f32_16x16x32_bf16 v[56:59], a[148:151], a[40:43], v[56:59]
    buffer_load_dwordx4 v14, s[4:7], s40 offen offset:2048 lds
    s_add_u32 s40, s40, 458752
    v_mfma_f32_16x16x32_bf16 v[60:63], a[148:151], a[44:47], v[60:63]
    s_waitcnt lgkmcnt(6)
    v_mfma_f32_16x16x32_bf16 v[64:67], a[152:155], a[32:35], v[64:67]
    ds_read_b64_tr_b16 a[136:137], v15 offset:28768
    v_mfma_f32_16x16x32_bf16 v[68:71], a[152:155], a[36:39], v[68:71]
    ds_read_b64_tr_b16 a[138:139], v15 offset:30560
    v_mfma_f32_16x16x32_bf16 v[72:75], a[152:155], a[40:43], v[72:75]
    buffer_load_dwordx4 a[76:79], v2, s[8:11], s41 offen offset:3072 sc1
    s_add_u32 s41, s41, 4096
    v_mfma_f32_16x16x32_bf16 v[76:79], a[152:155], a[44:47], v[76:79]
    s_waitcnt lgkmcnt(6)
    v_mfma_f32_16x16x32_bf16 v[80:83], a[156:159], a[32:35], v[80:83]
    ds_read_b64_tr_b16 a[140:141], v15 offset:43104
    v_mfma_f32_16x16x32_bf16 v[84:87], a[156:159], a[36:39], v[84:87]
    ds_read_b64_tr_b16 a[142:143], v15 offset:44896
    v_mfma_f32_16x16x32_bf16 v[88:91], a[156:159], a[40:43], v[88:91]
    v_mfma_f32_16x16x32_bf16 v[92:95], a[156:159], a[44:47], v[92:95]
    s_waitcnt lgkmcnt(6)
    v_mfma_f32_16x16x32_bf16 v[96:99], a[128:131], a[32:35], v[96:99]
    ds_read_b64_tr_b16 a[144:145], v15 offset:28800
    v_mfma_f32_16x16x32_bf16 v[100:103], a[128:131], a[36:39], v[100:103]
    ds_read_b64_tr_b16 a[146:147], v15 offset:30592
    v_mfma_f32_16x16x32_bf16 v[104:107], a[128:131], a[40:43], v[104:107]
    v_mfma_f32_16x16x32_bf16 v[108:111], a[128:131], a[44:47], v[108:111]
    s_waitcnt lgkmcnt(6)
    v_mfma_f32_16x16x32_bf16 v[112:115], a[132:135], a[32:35], v[112:115]
    ds_read_b64_tr_b16 a[148:149], v15 offset:43136
    v_mfma_f32_16x16x32_bf16 v[116:119], a[132:135], a[36:39], v[116:119]
    ds_read_b64_tr_b16 a[150:151], v15 offset:44928
    v_mfma_f32_16x16x32_bf16 v[120:123], a[132:135], a[40:43], v[120:123]
    buffer_load_dwordx4 a[80:83], v2, s[8:11], s41 offen offset:0 sc1
    v_mfma_f32_16x16x32_bf16 v[124:127], a[132:135], a[44:47], v[124:127]
    s_waitcnt lgkmcnt(6)
    v_mfma_f32_16x16x32_bf16 v[128:131], a[136:139], a[32:35], v[128:131]
    ds_read_b64_tr_b16 a[152:153], v15 offset:28832
    v_mfma_f32_16x16x32_bf16 v[132:135], a[136:139], a[36:39], v[132:135]
    ds_read_b64_tr_b16 a[154:155], v15 offset:30624
    v_mfma_f32_16x16x32_bf16 v[136:139], a[136:139], a[40:43], v[136:139]
    v_mfma_f32_16x16x32_bf16 v[140:143], a[136:139], a[44:47], v[140:143]
    s_waitcnt lgkmcnt(6)
    v_mfma_f32_16x16x32_bf16 v[144:147], a[140:143], a[32:35], v[144:147]
    ds_read_b64_tr_b16 a[156:157], v15 offset:43168
    v_mfma_f32_16x16x32_bf16 v[148:151], a[140:143], a[36:39], v[148:151]
    ds_read_b64_tr_b16 a[158:159], v15 offset:44960
    v_mfma_f32_16x16x32_bf16 v[152:155], a[140:143], a[40:43], v[152:155]
    buffer_load_dwordx4 a[84:87], v2, s[8:11], s41 offen offset:1024 sc1
    v_mfma_f32_16x16x32_bf16 v[156:159], a[140:143], a[44:47], v[156:159]
    s_waitcnt lgkmcnt(6)
    v_mfma_f32_16x16x32_bf16 v[160:163], a[144:147], a[32:35], v[160:163]
    ds_read_b64_tr_b16 a[128:129], v15 offset:28864
    v_mfma_f32_16x16x32_bf16 v[164:167], a[144:147], a[36:39], v[164:167]
    ds_read_b64_tr_b16 a[130:131], v15 offset:30656
    v_mfma_f32_16x16x32_bf16 v[168:171], a[144:147], a[40:43], v[168:171]
    v_mfma_f32_16x16x32_bf16 v[172:175], a[144:147], a[44:47], v[172:175]
    s_waitcnt lgkmcnt(6)
    v_mfma_f32_16x16x32_bf16 v[176:179], a[148:151], a[32:35], v[176:179]
    ds_read_b64_tr_b16 a[132:133], v15 offset:43200
    v_mfma_f32_16x16x32_bf16 v[180:183], a[148:151], a[36:39], v[180:183]
    ds_read_b64_tr_b16 a[134:135], v15 offset:44992
    v_mfma_f32_16x16x32_bf16 v[184:187], a[148:151], a[40:43], v[184:187]
    v_mfma_f32_16x16x32_bf16 v[188:191], a[148:151], a[44:47], v[188:191]
    s_waitcnt lgkmcnt(6)
    v_mfma_f32_16x16x32_bf16 v[192:195], a[152:155], a[32:35], v[192:195]
    ds_read_b64_tr_b16 a[136:137], v15 offset:35840
    v_mfma_f32_16x16x32_bf16 v[196:199], a[152:155], a[36:39], v[196:199]
    ds_read_b64_tr_b16 a[138:139], v15 offset:37632
    v_mfma_f32_16x16x32_bf16 v[200:203], a[152:155], a[40:43], v[200:203]
    buffer_load_dwordx4 a[88:91], v2, s[8:11], s41 offen offset:2048 sc1
    v_mfma_f32_16x16x32_bf16 v[204:207], a[152:155], a[44:47], v[204:207]
    s_waitcnt lgkmcnt(6)
    v_mfma_f32_16x16x32_bf16 v[208:211], a[156:159], a[32:35], v[208:211]
    ds_read_b64_tr_b16 a[140:141], v15 offset:50176
    v_mfma_f32_16x16x32_bf16 v[212:215], a[156:159], a[36:39], v[212:215]
    ds_read_b64_tr_b16 a[142:143], v15 offset:51968
    v_mfma_f32_16x16x32_bf16 v[216:219], a[156:159], a[40:43], v[216:219]
    v_mfma_f32_16x16x32_bf16 v[220:223], a[156:159], a[44:47], v[220:223]
    s_waitcnt lgkmcnt(6)
    s_waitcnt vmcnt(30)
    s_barrier
    v_mfma_f32_16x16x32_bf16 v[224:227], a[128:131], a[32:35], v[224:227]
    ds_read_b64_tr_b16 a[144:145], v15 offset:35872
    v_mfma_f32_16x16x32_bf16 v[228:231], a[128:131], a[36:39], v[228:231]
    ds_read_b64_tr_b16 a[146:147], v15 offset:37664
    s_add_u32 m0, s42, 0
    v_mfma_f32_16x16x32_bf16 v[232:235], a[128:131], a[40:43], v[232:235]
    buffer_load_dwordx4 v8, s[4:7], s40 offen offset:0 lds
    v_mfma_f32_16x16x32_bf16 v[236:239], a[128:131], a[44:47], v[236:239]
    s_waitcnt lgkmcnt(6)
    v_mfma_f32_16x16x32_bf16 v[240:243], a[132:135], a[32:35], v[240:243]
    ds_read_b64_tr_b16 a[148:149], v15 offset:50208
    v_mfma_f32_16x16x32_bf16 v[244:247], a[132:135], a[36:39], v[244:247]
    ds_read_b64_tr_b16 a[150:151], v15 offset:52000
    v_mfma_f32_16x16x32_bf16 v[248:251], a[132:135], a[40:43], v[248:251]
    buffer_load_dwordx4 a[92:95], v2, s[8:11], s41 offen offset:3072 sc1
    s_add_u32 s41, s41, 4096
    v_mfma_f32_16x16x32_bf16 v[252:255], a[132:135], a[44:47], v[252:255]
    s_waitcnt vmcnt(13)
    s_waitcnt lgkmcnt(6)
    v_mfma_f32_16x16x32_bf16 v[32:35], a[136:139], a[48:51], v[32:35]
    ds_read_b64_tr_b16 a[152:153], v15 offset:35904
    v_mfma_f32_16x16x32_bf16 v[36:39], a[136:139], a[52:55], v[36:39]
    ds_read_b64_tr_b16 a[154:155], v15 offset:37696
    v_mfma_f32_16x16x32_bf16 v[40:43], a[136:139], a[56:59], v[40:43]
    v_mfma_f32_16x16x32_bf16 v[44:47], a[136:139], a[60:63], v[44:47]
    s_waitcnt lgkmcnt(6)
    v_mfma_f32_16x16x32_bf16 v[48:51], a[140:143], a[48:51], v[48:51]
    ds_read_b64_tr_b16 a[156:157], v15 offset:50240
    v_mfma_f32_16x16x32_bf16 v[52:55], a[140:143], a[52:55], v[52:55]
    ds_read_b64_tr_b16 a[158:159], v15 offset:52032
    s_add_u32 m0, s42, 0
    v_mfma_f32_16x16x32_bf16 v[56:59], a[140:143], a[56:59], v[56:59]
    buffer_load_dwordx4 v9, s[4:7], s40 offen offset:1024 lds
    v_mfma_f32_16x16x32_bf16 v[60:63], a[140:143], a[60:63], v[60:63]
    s_waitcnt lgkmcnt(6)
    v_mfma_f32_16x16x32_bf16 v[64:67], a[144:147], a[48:51], v[64:67]
    ds_read_b64_tr_b16 a[128:129], v15 offset:35936
    v_mfma_f32_16x16x32_bf16 v[68:71], a[144:147], a[52:55], v[68:71]
    ds_read_b64_tr_b16 a[130:131], v15 offset:37728
    v_mfma_f32_16x16x32_bf16 v[72:75], a[144:147], a[56:59], v[72:75]
    buffer_load_dwordx4 a[96:99], v2, s[8:11], s41 offen offset:0 sc1
    v_mfma_f32_16x16x32_bf16 v[76:79], a[144:147], a[60:63], v[76:79]
    s_waitcnt lgkmcnt(6)
    v_mfma_f32_16x16x32_bf16 v[80:83], a[148:151], a[48:51], v[80:83]
    ds_read_b64_tr_b16 a[132:133], v15 offset:50272
    v_mfma_f32_16x16x32_bf16 v[84:87], a[148:151], a[52:55], v[84:87]
    ds_read_b64_tr_b16 a[134:135], v15 offset:52064
    v_mfma_f32_16x16x32_bf16 v[88:91], a[148:151], a[56:59], v[88:91]
    v_mfma_f32_16x16x32_bf16 v[92:95], a[148:151], a[60:63], v[92:95]
    s_waitcnt lgkmcnt(6)
    v_mfma_f32_16x16x32_bf16 v[96:99], a[152:155], a[48:51], v[96:99]
    ds_read_b64_tr_b16 a[136:137], v15 offset:35968
    v_mfma_f32_16x16x32_bf16 v[100:103], a[152:155], a[52:55], v[100:103]
    ds_read_b64_tr_b16 a[138:139], v15 offset:37760
    s_add_u32 m0, s42, 0
    v_mfma_f32_16x16x32_bf16 v[104:107], a[152:155], a[56:59], v[104:107]
    buffer_load_dwordx4 v10, s[4:7], s40 offen offset:2048 lds
    v_mfma_f32_16x16x32_bf16 v[108:111], a[152:155], a[60:63], v[108:111]
    s_waitcnt lgkmcnt(6)
    v_mfma_f32_16x16x32_bf16 v[112:115], a[156:159], a[48:51], v[112:115]
    ds_read_b64_tr_b16 a[140:141], v15 offset:50304
    v_mfma_f32_16x16x32_bf16 v[116:119], a[156:159], a[52:55], v[116:119]
    ds_read_b64_tr_b16 a[142:143], v15 offset:52096
    v_mfma_f32_16x16x32_bf16 v[120:123], a[156:159], a[56:59], v[120:123]
    buffer_load_dwordx4 a[100:103], v2, s[8:11], s41 offen offset:1024 sc1
    v_mfma_f32_16x16x32_bf16 v[124:127], a[156:159], a[60:63], v[124:127]
    s_waitcnt lgkmcnt(6)
    v_mfma_f32_16x16x32_bf16 v[128:131], a[128:131], a[48:51], v[128:131]
    ds_read_b64_tr_b16 a[144:145], v15 offset:36000
    v_mfma_f32_16x16x32_bf16 v[132:135], a[128:131], a[52:55], v[132:135]
    ds_read_b64_tr_b16 a[146:147], v15 offset:37792
    s_add_u32 m0, s42, 0
    v_mfma_f32_16x16x32_bf16 v[136:139], a[128:131], a[56:59], v[136:139]
    buffer_load_dwordx4 v11, s[4:7], s40 offen offset:3072 lds
    v_mfma_f32_16x16x32_bf16 v[140:143], a[128:131], a[60:63], v[140:143]
    s_waitcnt lgkmcnt(6)
    v_mfma_f32_16x16x32_bf16 v[144:147], a[132:135], a[48:51], v[144:147]
    ds_read_b64_tr_b16 a[148:149], v15 offset:50336
    v_mfma_f32_16x16x32_bf16 v[148:151], a[132:135], a[52:55], v[148:151]
    ds_read_b64_tr_b16 a[150:151], v15 offset:52128
    v_mfma_f32_16x16x32_bf16 v[152:155], a[132:135], a[56:59], v[152:155]
    buffer_load_dwordx4 a[104:107], v2, s[8:11], s41 offen offset:2048 sc1
    v_mfma_f32_16x16x32_bf16 v[156:159], a[132:135], a[60:63], v[156:159]
    s_waitcnt lgkmcnt(6)
    v_mfma_f32_16x16x32_bf16 v[160:163], a[136:139], a[48:51], v[160:163]
    ds_read_b64_tr_b16 a[152:153], v15 offset:36032
    v_mfma_f32_16x16x32_bf16 v[164:167], a[136:139], a[52:55], v[164:167]
    ds_read_b64_tr_b16 a[154:155], v15 offset:37824
    v_mfma_f32_16x16x32_bf16 v[168:171], a[136:139], a[56:59], v[168:171]
    v_mfma_f32_16x16x32_bf16 v[172:175], a[136:139], a[60:63], v[172:175]
    s_waitcnt lgkmcnt(6)
    v_mfma_f32_16x16x32_bf16 v[176:179], a[140:143], a[48:51], v[176:179]
    ds_read_b64_tr_b16 a[156:157], v15 offset:50368
    v_mfma_f32_16x16x32_bf16 v[180:183], a[140:143], a[52:55], v[180:183]
    ds_read_b64_tr_b16 a[158:159], v15 offset:52160
    s_add_u32 m0, s42, 4096
    v_mfma_f32_16x16x32_bf16 v[184:187], a[140:143], a[56:59], v[184:187]
    buffer_load_dwordx4 v12, s[4:7], s40 offen offset:0 lds
    v_mfma_f32_16x16x32_bf16 v[188:191], a[140:143], a[60:63], v[188:191]
    s_waitcnt lgkmcnt(6)
    v_mfma_f32_16x16x32_bf16 v[192:195], a[144:147], a[48:51], v[192:195]
    ds_read_b64_tr_b16 a[128:129], v16 offset:0
    v_mfma_f32_16x16x32_bf16 v[196:199], a[144:147], a[52:55], v[196:199]
    ds_read_b64_tr_b16 a[130:131], v16 offset:1792
    v_mfma_f32_16x16x32_bf16 v[200:203], a[144:147], a[56:59], v[200:203]
    buffer_load_dwordx4 a[108:111], v2, s[8:11], s41 offen offset:3072 sc1
    s_add_u32 s41, s41, 4096
    v_mfma_f32_16x16x32_bf16 v[204:207], a[144:147], a[60:63], v[204:207]
    s_waitcnt lgkmcnt(6)
    v_mfma_f32_16x16x32_bf16 v[208:211], a[148:151], a[48:51], v[208:211]
    ds_read_b64_tr_b16 a[132:133], v16 offset:14336
    v_mfma_f32_16x16x32_bf16 v[212:215], a[148:151], a[52:55], v[212:215]
    ds_read_b64_tr_b16 a[134:135], v16 offset:16128
    v_mfma_f32_16x16x32_bf16 v[216:219], a[148:151], a[56:59], v[216:219]
    v_mfma_f32_16x16x32_bf16 v[220:223], a[148:151], a[60:63], v[220:223]
    s_waitcnt lgkmcnt(6)
    v_mfma_f32_16x16x32_bf16 v[224:227], a[152:155], a[48:51], v[224:227]
    ds_read_b64_tr_b16 a[136:137], v16 offset:32
    v_mfma_f32_16x16x32_bf16 v[228:231], a[152:155], a[52:55], v[228:231]
    ds_read_b64_tr_b16 a[138:139], v16 offset:1824
    s_add_u32 m0, s42, 4096
    v_mfma_f32_16x16x32_bf16 v[232:235], a[152:155], a[56:59], v[232:235]
    buffer_load_dwordx4 v13, s[4:7], s40 offen offset:1024 lds
    v_mfma_f32_16x16x32_bf16 v[236:239], a[152:155], a[60:63], v[236:239]
    s_waitcnt lgkmcnt(6)
    v_mfma_f32_16x16x32_bf16 v[240:243], a[156:159], a[48:51], v[240:243]
    ds_read_b64_tr_b16 a[140:141], v16 offset:14368
    v_mfma_f32_16x16x32_bf16 v[244:247], a[156:159], a[52:55], v[244:247]
    ds_read_b64_tr_b16 a[142:143], v16 offset:16160
    v_mfma_f32_16x16x32_bf16 v[248:251], a[156:159], a[56:59], v[248:251]
    buffer_load_dwordx4 a[112:115], v2, s[8:11], s41 offen offset:0 sc1
    v_mfma_f32_16x16x32_bf16 v[252:255], a[156:159], a[60:63], v[252:255]
    s_waitcnt vmcnt(15)
    s_waitcnt lgkmcnt(6)
    v_mfma_f32_16x16x32_bf16 v[32:35], a[128:131], a[64:67], v[32:35]
    ds_read_b64_tr_b16 a[144:145], v16 offset:64
    v_mfma_f32_16x16x32_bf16 v[36:39], a[128:131], a[68:71], v[36:39]
    ds_read_b64_tr_b16 a[146:147], v16 offset:1856
    v_mfma_f32_16x16x32_bf16 v[40:43], a[128:131], a[72:75], v[40:43]
    v_mfma_f32_16x16x32_bf16 v[44:47], a[128:131], a[76:79], v[44:47]
    s_waitcnt lgkmcnt(6)
    v_mfma_f32_16x16x32_bf16 v[48:51], a[132:135], a[64:67], v[48:51]
    ds_read_b64_tr_b16 a[148:149], v16 offset:14400
    v_mfma_f32_16x16x32_bf16 v[52:55], a[132:135], a[68:71], v[52:55]
    ds_read_b64_tr_b16 a[150:151], v16 offset:16192
    s_add_u32 m0, s42, 4096
    v_mfma_f32_16x16x32_bf16 v[56:59], a[132:135], a[72:75], v[56:59]
    buffer_load_dwordx4 v14, s[4:7], s40 offen offset:2048 lds
    s_add_u32 s40, s40, 458752
    v_mfma_f32_16x16x32_bf16 v[60:63], a[132:135], a[76:79], v[60:63]
    s_waitcnt lgkmcnt(6)
    v_mfma_f32_16x16x32_bf16 v[64:67], a[136:139], a[64:67], v[64:67]
    ds_read_b64_tr_b16 a[152:153], v16 offset:96
    v_mfma_f32_16x16x32_bf16 v[68:71], a[136:139], a[68:71], v[68:71]
    ds_read_b64_tr_b16 a[154:155], v16 offset:1888
    v_mfma_f32_16x16x32_bf16 v[72:75], a[136:139], a[72:75], v[72:75]
    buffer_load_dwordx4 a[116:119], v2, s[8:11], s41 offen offset:1024 sc1
    v_mfma_f32_16x16x32_bf16 v[76:79], a[136:139], a[76:79], v[76:79]
    s_waitcnt lgkmcnt(6)
    v_mfma_f32_16x16x32_bf16 v[80:83], a[140:143], a[64:67], v[80:83]
    ds_read_b64_tr_b16 a[156:157], v16 offset:14432
    v_mfma_f32_16x16x32_bf16 v[84:87], a[140:143], a[68:71], v[84:87]
    ds_read_b64_tr_b16 a[158:159], v16 offset:16224
    v_mfma_f32_16x16x32_bf16 v[88:91], a[140:143], a[72:75], v[88:91]
    v_mfma_f32_16x16x32_bf16 v[92:95], a[140:143], a[76:79], v[92:95]
    s_waitcnt lgkmcnt(6)
    v_mfma_f32_16x16x32_bf16 v[96:99], a[144:147], a[64:67], v[96:99]
    ds_read_b64_tr_b16 a[128:129], v16 offset:128
    v_mfma_f32_16x16x32_bf16 v[100:103], a[144:147], a[68:71], v[100:103]
    ds_read_b64_tr_b16 a[130:131], v16 offset:1920
    v_mfma_f32_16x16x32_bf16 v[104:107], a[144:147], a[72:75], v[104:107]
    buffer_load_dwordx4 a[120:123], v2, s[8:11], s41 offen offset:2048 sc1
    v_mfma_f32_16x16x32_bf16 v[108:111], a[144:147], a[76:79], v[108:111]
    s_waitcnt lgkmcnt(6)
    v_mfma_f32_16x16x32_bf16 v[112:115], a[148:151], a[64:67], v[112:115]
    ds_read_b64_tr_b16 a[132:133], v16 offset:14464
    v_mfma_f32_16x16x32_bf16 v[116:119], a[148:151], a[68:71], v[116:119]
    ds_read_b64_tr_b16 a[134:135], v16 offset:16256
    v_mfma_f32_16x16x32_bf16 v[120:123], a[148:151], a[72:75], v[120:123]
    v_mfma_f32_16x16x32_bf16 v[124:127], a[148:151], a[76:79], v[124:127]
    s_waitcnt lgkmcnt(6)
    v_mfma_f32_16x16x32_bf16 v[128:131], a[152:155], a[64:67], v[128:131]
    ds_read_b64_tr_b16 a[136:137], v16 offset:160
    v_mfma_f32_16x16x32_bf16 v[132:135], a[152:155], a[68:71], v[132:135]
    ds_read_b64_tr_b16 a[138:139], v16 offset:1952
    v_mfma_f32_16x16x32_bf16 v[136:139], a[152:155], a[72:75], v[136:139]
    v_mfma_f32_16x16x32_bf16 v[140:143], a[152:155], a[76:79], v[140:143]
    s_waitcnt lgkmcnt(6)
    v_mfma_f32_16x16x32_bf16 v[144:147], a[156:159], a[64:67], v[144:147]
    ds_read_b64_tr_b16 a[140:141], v16 offset:14496
    v_mfma_f32_16x16x32_bf16 v[148:151], a[156:159], a[68:71], v[148:151]
    ds_read_b64_tr_b16 a[142:143], v16 offset:16288
    v_mfma_f32_16x16x32_bf16 v[152:155], a[156:159], a[72:75], v[152:155]
    buffer_load_dwordx4 a[124:127], v2, s[8:11], s41 offen offset:3072 sc1
    s_add_u32 s41, s41, 4096
    v_mfma_f32_16x16x32_bf16 v[156:159], a[156:159], a[76:79], v[156:159]
    s_waitcnt lgkmcnt(6)
    v_mfma_f32_16x16x32_bf16 v[160:163], a[128:131], a[64:67], v[160:163]
    ds_read_b64_tr_b16 a[144:145], v16 offset:192
    v_mfma_f32_16x16x32_bf16 v[164:167], a[128:131], a[68:71], v[164:167]
    ds_read_b64_tr_b16 a[146:147], v16 offset:1984
    v_mfma_f32_16x16x32_bf16 v[168:171], a[128:131], a[72:75], v[168:171]
    v_mfma_f32_16x16x32_bf16 v[172:175], a[128:131], a[76:79], v[172:175]
    s_waitcnt lgkmcnt(6)
    v_mfma_f32_16x16x32_bf16 v[176:179], a[132:135], a[64:67], v[176:179]
    ds_read_b64_tr_b16 a[148:149], v16 offset:14528
    v_mfma_f32_16x16x32_bf16 v[180:183], a[132:135], a[68:71], v[180:183]
    ds_read_b64_tr_b16 a[150:151], v16 offset:16320
    v_mfma_f32_16x16x32_bf16 v[184:187], a[132:135], a[72:75], v[184:187]
    v_mfma_f32_16x16x32_bf16 v[188:191], a[132:135], a[76:79], v[188:191]
    s_waitcnt lgkmcnt(6)
    v_mfma_f32_16x16x32_bf16 v[192:195], a[136:139], a[64:67], v[192:195]
    ds_read_b64_tr_b16 a[152:153], v16 offset:7168
    v_mfma_f32_16x16x32_bf16 v[196:199], a[136:139], a[68:71], v[196:199]
    ds_read_b64_tr_b16 a[154:155], v16 offset:8960
    v_mfma_f32_16x16x32_bf16 v[200:203], a[136:139], a[72:75], v[200:203]
    buffer_load_dwordx4 a[0:3], v2, s[8:11], s41 offen offset:0 sc1
    v_mfma_f32_16x16x32_bf16 v[204:207], a[136:139], a[76:79], v[204:207]
    s_waitcnt lgkmcnt(6)
    v_mfma_f32_16x16x32_bf16 v[208:211], a[140:143], a[64:67], v[208:211]
    ds_read_b64_tr_b16 a[156:157], v16 offset:21504
    v_mfma_f32_16x16x32_bf16 v[212:215], a[140:143], a[68:71], v[212:215]
    ds_read_b64_tr_b16 a[158:159], v16 offset:23296
    v_mfma_f32_16x16x32_bf16 v[216:219], a[140:143], a[72:75], v[216:219]
    v_mfma_f32_16x16x32_bf16 v[220:223], a[140:143], a[76:79], v[220:223]
    s_waitcnt lgkmcnt(6)
    s_waitcnt vmcnt(21)
    s_barrier
    v_mfma_f32_16x16x32_bf16 v[224:227], a[144:147], a[64:67], v[224:227]
    ds_read_b64_tr_b16 a[128:129], v16 offset:7200
    v_mfma_f32_16x16x32_bf16 v[228:231], a[144:147], a[68:71], v[228:231]
    ds_read_b64_tr_b16 a[130:131], v16 offset:8992
    s_add_u32 m0, s42, 28672
    v_mfma_f32_16x16x32_bf16 v[232:235], a[144:147], a[72:75], v[232:235]
    buffer_load_dwordx4 v8, s[4:7], s40 offen offset:0 lds
    v_mfma_f32_16x16x32_bf16 v[236:239], a[144:147], a[76:79], v[236:239]
    s_waitcnt lgkmcnt(6)
    v_mfma_f32_16x16x32_bf16 v[240:243], a[148:151], a[64:67], v[240:243]
    ds_read_b64_tr_b16 a[132:133], v16 offset:21536
    v_mfma_f32_16x16x32_bf16 v[244:247], a[148:151], a[68:71], v[244:247]
    ds_read_b64_tr_b16 a[134:135], v16 offset:23328
    v_mfma_f32_16x16x32_bf16 v[248:251], a[148:151], a[72:75], v[248:251]
    buffer_load_dwordx4 a[4:7], v2, s[8:11], s41 offen offset:1024 sc1
    v_mfma_f32_16x16x32_bf16 v[252:255], a[148:151], a[76:79], v[252:255]
    s_waitcnt vmcnt(17)
    s_waitcnt lgkmcnt(6)
    v_mfma_f32_16x16x32_bf16 v[32:35], a[152:155], a[80:83], v[32:35]
    ds_read_b64_tr_b16 a[136:137], v16 offset:7232
    v_mfma_f32_16x16x32_bf16 v[36:39], a[152:155], a[84:87], v[36:39]
    ds_read_b64_tr_b16 a[138:139], v16 offset:9024
    v_mfma_f32_16x16x32_bf16 v[40:43], a[152:155], a[88:91], v[40:43]
    v_mfma_f32_16x16x32_bf16 v[44:47], a[152:155], a[92:95], v[44:47]
    s_waitcnt lgkmcnt(6)
    v_mfma_f32_16x16x32_bf16 v[48:51], a[156:159], a[80:83], v[48:51]
    ds_read_b64_tr_b16 a[140:141], v16 offset:21568
    v_mfma_f32_16x16x32_bf16 v[52:55], a[156:159], a[84:87], v[52:55]
    ds_read_b64_tr_b16 a[142:143], v16 offset:23360
    s_add_u32 m0, s42, 28672
    v_mfma_f32_16x16x32_bf16 v[56:59], a[156:159], a[88:91], v[56:59]
    buffer_load_dwordx4 v9, s[4:7], s40 offen offset:1024 lds
    v_mfma_f32_16x16x32_bf16 v[60:63], a[156:159], a[92:95], v[60:63]
    s_waitcnt lgkmcnt(6)
    v_mfma_f32_16x16x32_bf16 v[64:67], a[128:131], a[80:83], v[64:67]
    ds_read_b64_tr_b16 a[144:145], v16 offset:7264
    v_mfma_f32_16x16x32_bf16 v[68:71], a[128:131], a[84:87], v[68:71]
    ds_read_b64_tr_b16 a[146:147], v16 offset:9056
    v_mfma_f32_16x16x32_bf16 v[72:75], a[128:131], a[88:91], v[72:75]
    buffer_load_dwordx4 a[8:11], v2, s[8:11], s41 offen offset:2048 sc1
    v_mfma_f32_16x16x32_bf16 v[76:79], a[128:131], a[92:95], v[76:79]
    s_waitcnt lgkmcnt(6)
    v_mfma_f32_16x16x32_bf16 v[80:83], a[132:135], a[80:83], v[80:83]
    ds_read_b64_tr_b16 a[148:149], v16 offset:21600
    v_mfma_f32_16x16x32_bf16 v[84:87], a[132:135], a[84:87], v[84:87]
    ds_read_b64_tr_b16 a[150:151], v16 offset:23392
    v_mfma_f32_16x16x32_bf16 v[88:91], a[132:135], a[88:91], v[88:91]
    v_mfma_f32_16x16x32_bf16 v[92:95], a[132:135], a[92:95], v[92:95]
    s_waitcnt lgkmcnt(6)
    v_mfma_f32_16x16x32_bf16 v[96:99], a[136:139], a[80:83], v[96:99]
    ds_read_b64_tr_b16 a[152:153], v16 offset:7296
    v_mfma_f32_16x16x32_bf16 v[100:103], a[136:139], a[84:87], v[100:103]
    ds_read_b64_tr_b16 a[154:155], v16 offset:9088
    s_add_u32 m0, s42, 28672
    v_mfma_f32_16x16x32_bf16 v[104:107], a[136:139], a[88:91], v[104:107]
    buffer_load_dwordx4 v10, s[4:7], s40 offen offset:2048 lds
    v_mfma_f32_16x16x32_bf16 v[108:111], a[136:139], a[92:95], v[108:111]
    s_waitcnt lgkmcnt(6)
    v_mfma_f32_16x16x32_bf16 v[112:115], a[140:143], a[80:83], v[112:115]
    ds_read_b64_tr_b16 a[156:157], v16 offset:21632
    v_mfma_f32_16x16x32_bf16 v[116:119], a[140:143], a[84:87], v[116:119]
    ds_read_b64_tr_b16 a[158:159], v16 offset:23424
    v_mfma_f32_16x16x32_bf16 v[120:123], a[140:143], a[88:91], v[120:123]
    buffer_load_dwordx4 a[12:15], v2, s[8:11], s41 offen offset:3072 sc1
    s_add_u32 s41, s41, 4096
    v_mfma_f32_16x16x32_bf16 v[124:127], a[140:143], a[92:95], v[124:127]
    s_waitcnt lgkmcnt(6)
    v_mfma_f32_16x16x32_bf16 v[128:131], a[144:147], a[80:83], v[128:131]
    ds_read_b64_tr_b16 a[128:129], v16 offset:7328
    v_mfma_f32_16x16x32_bf16 v[132:135], a[144:147], a[84:87], v[132:135]
    ds_read_b64_tr_b16 a[130:131], v16 offset:9120
    s_add_u32 m0, s42, 28672
    v_mfma_f32_16x16x32_bf16 v[136:139], a[144:147], a[88:91], v[136:139]
    buffer_load_dwordx4 v11, s[4:7], s40 offen offset:3072 lds
    v_mfma_f32_16x16x32_bf16 v[140:143], a[144:147], a[92:95], v[140:143]
    s_waitcnt lgkmcnt(6)
    v_mfma_f32_16x16x32_bf16 v[144:147], a[148:151], a[80:83], v[144:147]
    ds_read_b64_tr_b16 a[132:133], v16 offset:21664
    v_mfma_f32_16x16x32_bf16 v[148:151], a[148:151], a[84:87], v[148:151]
    ds_read_b64_tr_b16 a[134:135], v16 offset:23456
    v_mfma_f32_16x16x32_bf16 v[152:155], a[148:151], a[88:91], v[152:155]
    buffer_load_dwordx4 a[16:19], v2, s[8:11], s41 offen offset:0 sc1
    v_mfma_f32_16x16x32_bf16 v[156:159], a[148:151], a[92:95], v[156:159]
    s_waitcnt lgkmcnt(6)
    v_mfma_f32_16x16x32_bf16 v[160:163], a[152:155], a[80:83], v[160:163]
    ds_read_b64_tr_b16 a[136:137], v16 offset:7360
    v_mfma_f32_16x16x32_bf16 v[164:167], a[152:155], a[84:87], v[164:167]
    ds_read_b64_tr_b16 a[138:139], v16 offset:9152
    v_mfma_f32_16x16x32_bf16 v[168:171], a[152:155], a[88:91], v[168:171]
    v_mfma_f32_16x16x32_bf16 v[172:175], a[152:155], a[92:95], v[172:175]
    s_waitcnt lgkmcnt(6)
    v_mfma_f32_16x16x32_bf16 v[176:179], a[156:159], a[80:83], v[176:179]
    ds_read_b64_tr_b16 a[140:141], v16 offset:21696
    v_mfma_f32_16x16x32_bf16 v[180:183], a[156:159], a[84:87], v[180:183]
    ds_read_b64_tr_b16 a[142:143], v16 offset:23488
    s_add_u32 m0, s42, 32768
    v_mfma_f32_16x16x32_bf16 v[184:187], a[156:159], a[88:91], v[184:187]
    buffer_load_dwordx4 v12, s[4:7], s40 offen offset:0 lds
    v_mfma_f32_16x16x32_bf16 v[188:191], a[156:159], a[92:95], v[188:191]
    s_waitcnt lgkmcnt(6)
    v_mfma_f32_16x16x32_bf16 v[192:195], a[128:131], a[80:83], v[192:195]
    ds_read_b64_tr_b16 a[144:145], v16 offset:28672
    v_mfma_f32_16x16x32_bf16 v[196:199], a[128:131], a[84:87], v[196:199]
    ds_read_b64_tr_b16 a[146:147], v16 offset:30464
    v_mfma_f32_16x16x32_bf16 v[200:203], a[128:131], a[88:91], v[200:203]
    buffer_load_dwordx4 a[20:23], v2, s[8:11], s41 offen offset:1024 sc1
    v_mfma_f32_16x16x32_bf16 v[204:207], a[128:131], a[92:95], v[204:207]
    s_waitcnt lgkmcnt(6)
    v_mfma_f32_16x16x32_bf16 v[208:211], a[132:135], a[80:83], v[208:211]
    ds_read_b64_tr_b16 a[148:149], v16 offset:43008
    v_mfma_f32_16x16x32_bf16 v[212:215], a[132:135], a[84:87], v[212:215]
    ds_read_b64_tr_b16 a[150:151], v16 offset:44800
    v_mfma_f32_16x16x32_bf16 v[216:219], a[132:135], a[88:91], v[216:219]
    v_mfma_f32_16x16x32_bf16 v[220:223], a[132:135], a[92:95], v[220:223]
    s_waitcnt lgkmcnt(6)
    v_mfma_f32_16x16x32_bf16 v[224:227], a[136:139], a[80:83], v[224:227]
    ds_read_b64_tr_b16 a[152:153], v16 offset:28704
    v_mfma_f32_16x16x32_bf16 v[228:231], a[136:139], a[84:87], v[228:231]
    ds_read_b64_tr_b16 a[154:155], v16 offset:30496
    s_add_u32 m0, s42, 32768
    v_mfma_f32_16x16x32_bf16 v[232:235], a[136:139], a[88:91], v[232:235]
    buffer_load_dwordx4 v13, s[4:7], s40 offen offset:1024 lds
    v_mfma_f32_16x16x32_bf16 v[236:239], a[136:139], a[92:95], v[236:239]
    s_waitcnt lgkmcnt(6)
    v_mfma_f32_16x16x32_bf16 v[240:243], a[140:143], a[80:83], v[240:243]
    ds_read_b64_tr_b16 a[156:157], v16 offset:43040
    v_mfma_f32_16x16x32_bf16 v[244:247], a[140:143], a[84:87], v[244:247]
    ds_read_b64_tr_b16 a[158:159], v16 offset:44832
    v_mfma_f32_16x16x32_bf16 v[248:251], a[140:143], a[88:91], v[248:251]
    buffer_load_dwordx4 a[24:27], v2, s[8:11], s41 offen offset:2048 sc1
    v_mfma_f32_16x16x32_bf16 v[252:255], a[140:143], a[92:95], v[252:255]
    s_waitcnt vmcnt(19)
    s_waitcnt lgkmcnt(6)
    v_mfma_f32_16x16x32_bf16 v[32:35], a[144:147], a[96:99], v[32:35]
    ds_read_b64_tr_b16 a[128:129], v16 offset:28736
    v_mfma_f32_16x16x32_bf16 v[36:39], a[144:147], a[100:103], v[36:39]
    ds_read_b64_tr_b16 a[130:131], v16 offset:30528
    v_mfma_f32_16x16x32_bf16 v[40:43], a[144:147], a[104:107], v[40:43]
    buffer_load_dword v31, v22, s[4:7], s48 offen
    v_mfma_f32_16x16x32_bf16 v[44:47], a[144:147], a[108:111], v[44:47]
    s_waitcnt lgkmcnt(6)
    v_mfma_f32_16x16x32_bf16 v[48:51], a[148:151], a[96:99], v[48:51]
    ds_read_b64_tr_b16 a[132:133], v16 offset:43072
    v_mfma_f32_16x16x32_bf16 v[52:55], a[148:151], a[100:103], v[52:55]
    ds_read_b64_tr_b16 a[134:135], v16 offset:44864
    s_add_u32 m0, s42, 32768
    v_mfma_f32_16x16x32_bf16 v[56:59], a[148:151], a[104:107], v[56:59]
    buffer_load_dwordx4 v14, s[4:7], s40 offen offset:2048 lds
    s_add_u32 s40, s40, 458752
    v_mfma_f32_16x16x32_bf16 v[60:63], a[148:151], a[108:111], v[60:63]
    s_waitcnt lgkmcnt(6)
    v_mfma_f32_16x16x32_bf16 v[64:67], a[152:155], a[96:99], v[64:67]
    ds_read_b64_tr_b16 a[136:137], v16 offset:28768
    v_mfma_f32_16x16x32_bf16 v[68:71], a[152:155], a[100:103], v[68:71]
    ds_read_b64_tr_b16 a[138:139], v16 offset:30560
    v_mfma_f32_16x16x32_bf16 v[72:75], a[152:155], a[104:107], v[72:75]
    buffer_load_dwordx4 a[28:31], v2, s[8:11], s41 offen offset:3072 sc1
    s_add_u32 s41, s41, 4096
    v_mfma_f32_16x16x32_bf16 v[76:79], a[152:155], a[108:111], v[76:79]
    s_waitcnt lgkmcnt(6)
    v_mfma_f32_16x16x32_bf16 v[80:83], a[156:159], a[96:99], v[80:83]
    ds_read_b64_tr_b16 a[140:141], v16 offset:43104
    v_mfma_f32_16x16x32_bf16 v[84:87], a[156:159], a[100:103], v[84:87]
    ds_read_b64_tr_b16 a[142:143], v16 offset:44896
    s_add_u32 m0, s42, 114688
    v_mfma_f32_16x16x32_bf16 v[88:91], a[156:159], a[104:107], v[88:91]
    buffer_load_dwordx4 v8, s[4:7], s49 offen offset:0 lds
    v_mfma_f32_16x16x32_bf16 v[92:95], a[156:159], a[108:111], v[92:95]
    s_waitcnt lgkmcnt(6)
    v_mfma_f32_16x16x32_bf16 v[96:99], a[128:131], a[96:99], v[96:99]
    ds_read_b64_tr_b16 a[144:145], v16 offset:28800
    v_mfma_f32_16x16x32_bf16 v[100:103], a[128:131], a[100:103], v[100:103]
    ds_read_b64_tr_b16 a[146:147], v16 offset:30592
    v_mfma_f32_16x16x32_bf16 v[104:107], a[128:131], a[104:107], v[104:107]
    buffer_load_dwordx4 a[32:35], v2, s[8:11], s41 offen offset:0 sc1
    v_mfma_f32_16x16x32_bf16 v[108:111], a[128:131], a[108:111], v[108:111]
    s_waitcnt lgkmcnt(6)
    v_mfma_f32_16x16x32_bf16 v[112:115], a[132:135], a[96:99], v[112:115]
    ds_read_b64_tr_b16 a[148:149], v16 offset:43136
    v_mfma_f32_16x16x32_bf16 v[116:119], a[132:135], a[100:103], v[116:119]
    ds_read_b64_tr_b16 a[150:151], v16 offset:44928
    v_mfma_f32_16x16x32_bf16 v[120:123], a[132:135], a[104:107], v[120:123]
    v_mfma_f32_16x16x32_bf16 v[124:127], a[132:135], a[108:111], v[124:127]
    s_waitcnt lgkmcnt(6)
    v_mfma_f32_16x16x32_bf16 v[128:131], a[136:139], a[96:99], v[128:131]
    ds_read_b64_tr_b16 a[152:153], v16 offset:28832
    v_mfma_f32_16x16x32_bf16 v[132:135], a[136:139], a[100:103], v[132:135]
    ds_read_b64_tr_b16 a[154:155], v16 offset:30624
    v_mfma_f32_16x16x32_bf16 v[136:139], a[136:139], a[104:107], v[136:139]
    buffer_load_dwordx4 a[36:39], v2, s[8:11], s41 offen offset:1024 sc1
    v_mfma_f32_16x16x32_bf16 v[140:143], a[136:139], a[108:111], v[140:143]
    s_waitcnt lgkmcnt(6)
    v_mfma_f32_16x16x32_bf16 v[144:147], a[140:143], a[96:99], v[144:147]
    ds_read_b64_tr_b16 a[156:157], v16 offset:43168
    v_mfma_f32_16x16x32_bf16 v[148:151], a[140:143], a[100:103], v[148:151]
    ds_read_b64_tr_b16 a[158:159], v16 offset:44960
    v_mfma_f32_16x16x32_bf16 v[152:155], a[140:143], a[104:107], v[152:155]
    v_mfma_f32_16x16x32_bf16 v[156:159], a[140:143], a[108:111], v[156:159]
    s_waitcnt lgkmcnt(6)
    v_mfma_f32_16x16x32_bf16 v[160:163], a[144:147], a[96:99], v[160:163]
    ds_read_b64_tr_b16 a[128:129], v16 offset:28864
    v_mfma_f32_16x16x32_bf16 v[164:167], a[144:147], a[100:103], v[164:167]
    ds_read_b64_tr_b16 a[130:131], v16 offset:30656
    v_mfma_f32_16x16x32_bf16 v[168:171], a[144:147], a[104:107], v[168:171]
    v_mfma_f32_16x16x32_bf16 v[172:175], a[144:147], a[108:111], v[172:175]
    s_waitcnt lgkmcnt(6)
    v_mfma_f32_16x16x32_bf16 v[176:179], a[148:151], a[96:99], v[176:179]
    ds_read_b64_tr_b16 a[132:133], v16 offset:43200
    v_mfma_f32_16x16x32_bf16 v[180:183], a[148:151], a[100:103], v[180:183]
    ds_read_b64_tr_b16 a[134:135], v16 offset:44992
    v_mfma_f32_16x16x32_bf16 v[184:187], a[148:151], a[104:107], v[184:187]
    buffer_load_dwordx4 a[40:43], v2, s[8:11], s41 offen offset:2048 sc1
    v_mfma_f32_16x16x32_bf16 v[188:191], a[148:151], a[108:111], v[188:191]
    s_waitcnt lgkmcnt(6)
    v_mfma_f32_16x16x32_bf16 v[192:195], a[152:155], a[96:99], v[192:195]
    ds_read_b64_tr_b16 a[136:137], v16 offset:35840
    v_mfma_f32_16x16x32_bf16 v[196:199], a[152:155], a[100:103], v[196:199]
    ds_read_b64_tr_b16 a[138:139], v16 offset:37632
    v_mfma_f32_16x16x32_bf16 v[200:203], a[152:155], a[104:107], v[200:203]
    v_mfma_f32_16x16x32_bf16 v[204:207], a[152:155], a[108:111], v[204:207]
    s_waitcnt lgkmcnt(6)
    v_mfma_f32_16x16x32_bf16 v[208:211], a[156:159], a[96:99], v[208:211]
    ds_read_b64_tr_b16 a[140:141], v16 offset:50176
    v_mfma_f32_16x16x32_bf16 v[212:215], a[156:159], a[100:103], v[212:215]
    ds_read_b64_tr_b16 a[142:143], v16 offset:51968
    v_mfma_f32_16x16x32_bf16 v[216:219], a[156:159], a[104:107], v[216:219]
    v_mfma_f32_16x16x32_bf16 v[220:223], a[156:159], a[108:111], v[220:223]
    s_waitcnt lgkmcnt(6)
    s_waitcnt vmcnt(23)
    s_barrier
    v_mfma_f32_16x16x32_bf16 v[224:227], a[128:131], a[96:99], v[224:227]
    ds_read_b64_tr_b16 a[144:145], v16 offset:35872
    v_mfma_f32_16x16x32_bf16 v[228:231], a[128:131], a[100:103], v[228:231]
    ds_read_b64_tr_b16 a[146:147], v16 offset:37664
    s_add_u32 m0, s42, 57344
    v_mfma_f32_16x16x32_bf16 v[232:235], a[128:131], a[104:107], v[232:235]
    buffer_load_dwordx4 v8, s[4:7], s40 offen offset:0 lds
    v_mfma_f32_16x16x32_bf16 v[236:239], a[128:131], a[108:111], v[236:239]
    s_waitcnt lgkmcnt(6)
    v_mfma_f32_16x16x32_bf16 v[240:243], a[132:135], a[96:99], v[240:243]
    ds_read_b64_tr_b16 a[148:149], v16 offset:50208
    v_mfma_f32_16x16x32_bf16 v[244:247], a[132:135], a[100:103], v[244:247]
    ds_read_b64_tr_b16 a[150:151], v16 offset:52000
    v_mfma_f32_16x16x32_bf16 v[248:251], a[132:135], a[104:107], v[248:251]
    buffer_load_dwordx4 a[44:47], v2, s[8:11], s41 offen offset:3072 sc1
    s_add_u32 s41, s41, 4096
    v_mfma_f32_16x16x32_bf16 v[252:255], a[132:135], a[108:111], v[252:255]
    s_waitcnt vmcnt(22)
    s_waitcnt lgkmcnt(6)
    v_mfma_f32_16x16x32_bf16 v[32:35], a[136:139], a[112:115], v[32:35]
    ds_read_b64_tr_b16 a[152:153], v16 offset:35904
    v_mfma_f32_16x16x32_bf16 v[36:39], a[136:139], a[116:119], v[36:39]
    ds_read_b64_tr_b16 a[154:155], v16 offset:37696
    v_mfma_f32_16x16x32_bf16 v[40:43], a[136:139], a[120:123], v[40:43]
    v_mfma_f32_16x16x32_bf16 v[44:47], a[136:139], a[124:127], v[44:47]
    s_waitcnt lgkmcnt(6)
    v_mfma_f32_16x16x32_bf16 v[48:51], a[140:143], a[112:115], v[48:51]
    ds_read_b64_tr_b16 a[156:157], v16 offset:50240
    v_mfma_f32_16x16x32_bf16 v[52:55], a[140:143], a[116:119], v[52:55]
    ds_read_b64_tr_b16 a[158:159], v16 offset:52032
    s_add_u32 m0, s42, 57344
    v_mfma_f32_16x16x32_bf16 v[56:59], a[140:143], a[120:123], v[56:59]
    buffer_load_dwordx4 v9, s[4:7], s40 offen offset:1024 lds
    v_mfma_f32_16x16x32_bf16 v[60:63], a[140:143], a[124:127], v[60:63]
    s_waitcnt lgkmcnt(6)
    v_mfma_f32_16x16x32_bf16 v[64:67], a[144:147], a[112:115], v[64:67]
    ds_read_b64_tr_b16 a[128:129], v16 offset:35936
    v_mfma_f32_16x16x32_bf16 v[68:71], a[144:147], a[116:119], v[68:71]
    ds_read_b64_tr_b16 a[130:131], v16 offset:37728
    v_mfma_f32_16x16x32_bf16 v[72:75], a[144:147], a[120:123], v[72:75]
    buffer_load_dwordx4 a[48:51], v2, s[8:11], s41 offen offset:0 sc1
    v_mfma_f32_16x16x32_bf16 v[76:79], a[144:147], a[124:127], v[76:79]
    s_waitcnt lgkmcnt(6)
    v_mfma_f32_16x16x32_bf16 v[80:83], a[148:151], a[112:115], v[80:83]
    ds_read_b64_tr_b16 a[132:133], v16 offset:50272
    v_mfma_f32_16x16x32_bf16 v[84:87], a[148:151], a[116:119], v[84:87]
    ds_read_b64_tr_b16 a[134:135], v16 offset:52064
    v_mfma_f32_16x16x32_bf16 v[88:91], a[148:151], a[120:123], v[88:91]
    buffer_load_dwordx4 a[52:55], v2, s[8:11], s41 offen offset:1024 sc1
    v_mfma_f32_16x16x32_bf16 v[92:95], a[148:151], a[124:127], v[92:95]
    s_waitcnt lgkmcnt(6)
    v_mfma_f32_16x16x32_bf16 v[96:99], a[152:155], a[112:115], v[96:99]
    ds_read_b64_tr_b16 a[136:137], v16 offset:35968
    v_mfma_f32_16x16x32_bf16 v[100:103], a[152:155], a[116:119], v[100:103]
    ds_read_b64_tr_b16 a[138:139], v16 offset:37760
    s_add_u32 m0, s42, 57344
    v_mfma_f32_16x16x32_bf16 v[104:107], a[152:155], a[120:123], v[104:107]
    buffer_load_dwordx4 v10, s[4:7], s40 offen offset:2048 lds
    v_mfma_f32_16x16x32_bf16 v[108:111], a[152:155], a[124:127], v[108:111]
    s_waitcnt lgkmcnt(6)
    v_mfma_f32_16x16x32_bf16 v[112:115], a[156:159], a[112:115], v[112:115]
    ds_read_b64_tr_b16 a[140:141], v16 offset:50304
    v_mfma_f32_16x16x32_bf16 v[116:119], a[156:159], a[116:119], v[116:119]
    ds_read_b64_tr_b16 a[142:143], v16 offset:52096
    v_mfma_f32_16x16x32_bf16 v[120:123], a[156:159], a[120:123], v[120:123]
    v_mfma_f32_16x16x32_bf16 v[124:127], a[156:159], a[124:127], v[124:127]
    s_waitcnt lgkmcnt(6)
    v_mfma_f32_16x16x32_bf16 v[128:131], a[128:131], a[112:115], v[128:131]
    ds_read_b64_tr_b16 a[144:145], v16 offset:36000
    v_mfma_f32_16x16x32_bf16 v[132:135], a[128:131], a[116:119], v[132:135]
    ds_read_b64_tr_b16 a[146:147], v16 offset:37792
    s_add_u32 m0, s42, 57344
    v_mfma_f32_16x16x32_bf16 v[136:139], a[128:131], a[120:123], v[136:139]
    buffer_load_dwordx4 v11, s[4:7], s40 offen offset:3072 lds
    v_mfma_f32_16x16x32_bf16 v[140:143], a[128:131], a[124:127], v[140:143]
    s_waitcnt lgkmcnt(6)
    v_mfma_f32_16x16x32_bf16 v[144:147], a[132:135], a[112:115], v[144:147]
    ds_read_b64_tr_b16 a[148:149], v16 offset:50336
    v_mfma_f32_16x16x32_bf16 v[148:151], a[132:135], a[116:119], v[148:151]
    ds_read_b64_tr_b16 a[150:151], v16 offset:52128
    v_mfma_f32_16x16x32_bf16 v[152:155], a[132:135], a[120:123], v[152:155]
    buffer_load_dwordx4 a[56:59], v2, s[8:11], s41 offen offset:2048 sc1
    v_mfma_f32_16x16x32_bf16 v[156:159], a[132:135], a[124:127], v[156:159]
    s_waitcnt lgkmcnt(6)
    v_mfma_f32_16x16x32_bf16 v[160:163], a[136:139], a[112:115], v[160:163]
    ds_read_b64_tr_b16 a[152:153], v16 offset:36032
    v_mfma_f32_16x16x32_bf16 v[164:167], a[136:139], a[116:119], v[164:167]
    ds_read_b64_tr_b16 a[154:155], v16 offset:37824
    v_mfma_f32_16x16x32_bf16 v[168:171], a[136:139], a[120:123], v[168:171]
    v_mfma_f32_16x16x32_bf16 v[172:175], a[136:139], a[124:127], v[172:175]
    s_waitcnt lgkmcnt(6)
    v_mfma_f32_16x16x32_bf16 v[176:179], a[140:143], a[112:115], v[176:179]
    ds_read_b64_tr_b16 a[156:157], v16 offset:50368
    v_mfma_f32_16x16x32_bf16 v[180:183], a[140:143], a[116:119], v[180:183]
    ds_read_b64_tr_b16 a[158:159], v16 offset:52160
    s_add_u32 m0, s42, 61440
    v_mfma_f32_16x16x32_bf16 v[184:187], a[140:143], a[120:123], v[184:187]
    buffer_load_dwordx4 v12, s[4:7], s40 offen offset:0 lds
    v_mfma_f32_16x16x32_bf16 v[188:191], a[140:143], a[124:127], v[188:191]
    s_waitcnt lgkmcnt(6)
    v_mfma_f32_16x16x32_bf16 v[192:195], a[144:147], a[112:115], v[192:195]
    ds_read_b64_tr_b16 a[128:129], v15 offset:0
    v_mfma_f32_16x16x32_bf16 v[196:199], a[144:147], a[116:119], v[196:199]
    ds_read_b64_tr_b16 a[130:131], v15 offset:1792
    v_mfma_f32_16x16x32_bf16 v[200:203], a[144:147], a[120:123], v[200:203]
    buffer_load_dwordx4 a[60:63], v2, s[8:11], s41 offen offset:3072 sc1
    s_add_u32 s41, s41, 4096
    v_mfma_f32_16x16x32_bf16 v[204:207], a[144:147], a[124:127], v[204:207]
    s_waitcnt lgkmcnt(6)
    v_mfma_f32_16x16x32_bf16 v[208:211], a[148:151], a[112:115], v[208:211]
    ds_read_b64_tr_b16 a[132:133], v15 offset:14336
    v_mfma_f32_16x16x32_bf16 v[212:215], a[148:151], a[116:119], v[212:215]
    ds_read_b64_tr_b16 a[134:135], v15 offset:16128
    v_mfma_f32_16x16x32_bf16 v[216:219], a[148:151], a[120:123], v[216:219]
    v_mfma_f32_16x16x32_bf16 v[220:223], a[148:151], a[124:127], v[220:223]
    s_waitcnt lgkmcnt(6)
    v_mfma_f32_16x16x32_bf16 v[224:227], a[152:155], a[112:115], v[224:227]
    ds_read_b64_tr_b16 a[136:137], v15 offset:32
    v_mfma_f32_16x16x32_bf16 v[228:231], a[152:155], a[116:119], v[228:231]
    ds_read_b64_tr_b16 a[138:139], v15 offset:1824
    s_add_u32 m0, s42, 61440
    v_mfma_f32_16x16x32_bf16 v[232:235], a[152:155], a[120:123], v[232:235]
    buffer_load_dwordx4 v13, s[4:7], s40 offen offset:1024 lds
    v_mfma_f32_16x16x32_bf16 v[236:239], a[152:155], a[124:127], v[236:239]
    s_waitcnt lgkmcnt(6)
    v_mfma_f32_16x16x32_bf16 v[240:243], a[156:159], a[112:115], v[240:243]
    ds_read_b64_tr_b16 a[140:141], v15 offset:14368
    v_mfma_f32_16x16x32_bf16 v[244:247], a[156:159], a[116:119], v[244:247]
    ds_read_b64_tr_b16 a[142:143], v15 offset:16160
    v_mfma_f32_16x16x32_bf16 v[248:251], a[156:159], a[120:123], v[248:251]
    buffer_load_dwordx4 a[64:67], v2, s[8:11], s41 offen offset:0 sc1
    v_mfma_f32_16x16x32_bf16 v[252:255], a[156:159], a[124:127], v[252:255]
    s_waitcnt vmcnt(25)
    s_waitcnt lgkmcnt(6)
    v_mfma_f32_16x16x32_bf16 v[32:35], a[128:131], a[0:3], v[32:35]
    ds_read_b64_tr_b16 a[144:145], v15 offset:64
    v_mfma_f32_16x16x32_bf16 v[36:39], a[128:131], a[4:7], v[36:39]
    ds_read_b64_tr_b16 a[146:147], v15 offset:1856
    v_mfma_f32_16x16x32_bf16 v[40:43], a[128:131], a[8:11], v[40:43]
    buffer_load_dwordx4 a[68:71], v2, s[8:11], s41 offen offset:1024 sc1
    v_mfma_f32_16x16x32_bf16 v[44:47], a[128:131], a[12:15], v[44:47]
    s_waitcnt lgkmcnt(6)
    v_mfma_f32_16x16x32_bf16 v[48:51], a[132:135], a[0:3], v[48:51]
    ds_read_b64_tr_b16 a[148:149], v15 offset:14400
    v_mfma_f32_16x16x32_bf16 v[52:55], a[132:135], a[4:7], v[52:55]
    ds_read_b64_tr_b16 a[150:151], v15 offset:16192
    s_add_u32 m0, s42, 61440
    v_mfma_f32_16x16x32_bf16 v[56:59], a[132:135], a[8:11], v[56:59]
    buffer_load_dwordx4 v14, s[4:7], s40 offen offset:2048 lds
    s_add_u32 s40, s40, 458752
    v_mfma_f32_16x16x32_bf16 v[60:63], a[132:135], a[12:15], v[60:63]
    s_waitcnt lgkmcnt(6)
    v_mfma_f32_16x16x32_bf16 v[64:67], a[136:139], a[0:3], v[64:67]
    ds_read_b64_tr_b16 a[152:153], v15 offset:96
    v_mfma_f32_16x16x32_bf16 v[68:71], a[136:139], a[4:7], v[68:71]
    ds_read_b64_tr_b16 a[154:155], v15 offset:1888
    v_mfma_f32_16x16x32_bf16 v[72:75], a[136:139], a[8:11], v[72:75]
    v_mfma_f32_16x16x32_bf16 v[76:79], a[136:139], a[12:15], v[76:79]
    s_waitcnt lgkmcnt(6)
    v_mfma_f32_16x16x32_bf16 v[80:83], a[140:143], a[0:3], v[80:83]
    ds_read_b64_tr_b16 a[156:157], v15 offset:14432
    v_mfma_f32_16x16x32_bf16 v[84:87], a[140:143], a[4:7], v[84:87]
    ds_read_b64_tr_b16 a[158:159], v15 offset:16224
    s_add_u32 m0, s42, 114688
    v_mfma_f32_16x16x32_bf16 v[88:91], a[140:143], a[8:11], v[88:91]
    buffer_load_dwordx4 v9, s[4:7], s49 offen offset:1024 lds
    v_mfma_f32_16x16x32_bf16 v[92:95], a[140:143], a[12:15], v[92:95]
    s_waitcnt lgkmcnt(6)
    v_mfma_f32_16x16x32_bf16 v[96:99], a[144:147], a[0:3], v[96:99]
    ds_read_b64_tr_b16 a[128:129], v15 offset:128
    v_mfma_f32_16x16x32_bf16 v[100:103], a[144:147], a[4:7], v[100:103]
    ds_read_b64_tr_b16 a[130:131], v15 offset:1920
    v_mfma_f32_16x16x32_bf16 v[104:107], a[144:147], a[8:11], v[104:107]
    buffer_load_dwordx4 a[72:75], v2, s[8:11], s41 offen offset:2048 sc1
    v_mfma_f32_16x16x32_bf16 v[108:111], a[144:147], a[12:15], v[108:111]
    s_waitcnt lgkmcnt(6)
    v_mfma_f32_16x16x32_bf16 v[112:115], a[148:151], a[0:3], v[112:115]
    ds_read_b64_tr_b16 a[132:133], v15 offset:14464
    v_mfma_f32_16x16x32_bf16 v[116:119], a[148:151], a[4:7], v[116:119]
    ds_read_b64_tr_b16 a[134:135], v15 offset:16256
    v_mfma_f32_16x16x32_bf16 v[120:123], a[148:151], a[8:11], v[120:123]
    v_mfma_f32_16x16x32_bf16 v[124:127], a[148:151], a[12:15], v[124:127]
    s_waitcnt lgkmcnt(6)
    v_mfma_f32_16x16x32_bf16 v[128:131], a[152:155], a[0:3], v[128:131]
    ds_read_b64_tr_b16 a[136:137], v15 offset:160
    v_mfma_f32_16x16x32_bf16 v[132:135], a[152:155], a[4:7], v[132:135]
    ds_read_b64_tr_b16 a[138:139], v15 offset:1952
    v_mfma_f32_16x16x32_bf16 v[136:139], a[152:155], a[8:11], v[136:139]
    buffer_load_dwordx4 a[76:79], v2, s[8:11], s41 offen offset:3072 sc1
    s_add_u32 s41, s41, 4096
    v_mfma_f32_16x16x32_bf16 v[140:143], a[152:155], a[12:15], v[140:143]
    s_waitcnt lgkmcnt(6)
    v_mfma_f32_16x16x32_bf16 v[144:147], a[156:159], a[0:3], v[144:147]
    ds_read_b64_tr_b16 a[140:141], v15 offset:14496
    v_mfma_f32_16x16x32_bf16 v[148:151], a[156:159], a[4:7], v[148:151]
    ds_read_b64_tr_b16 a[142:143], v15 offset:16288
    v_mfma_f32_16x16x32_bf16 v[152:155], a[156:159], a[8:11], v[152:155]
    v_mfma_f32_16x16x32_bf16 v[156:159], a[156:159], a[12:15], v[156:159]
    s_waitcnt lgkmcnt(6)
    v_mfma_f32_16x16x32_bf16 v[160:163], a[128:131], a[0:3], v[160:163]
    ds_read_b64_tr_b16 a[144:145], v15 offset:192
    v_mfma_f32_16x16x32_bf16 v[164:167], a[128:131], a[4:7], v[164:167]
    ds_read_b64_tr_b16 a[146:147], v15 offset:1984
    v_mfma_f32_16x16x32_bf16 v[168:171], a[128:131], a[8:11], v[168:171]
    v_mfma_f32_16x16x32_bf16 v[172:175], a[128:131], a[12:15], v[172:175]
    s_waitcnt lgkmcnt(6)
    v_mfma_f32_16x16x32_bf16 v[176:179], a[132:135], a[0:3], v[176:179]
    ds_read_b64_tr_b16 a[148:149], v15 offset:14528
    v_mfma_f32_16x16x32_bf16 v[180:183], a[132:135], a[4:7], v[180:183]
    ds_read_b64_tr_b16 a[150:151], v15 offset:16320
    v_mfma_f32_16x16x32_bf16 v[184:187], a[132:135], a[8:11], v[184:187]
    buffer_load_dwordx4 a[80:83], v2, s[8:11], s41 offen offset:0 sc1
    v_mfma_f32_16x16x32_bf16 v[188:191], a[132:135], a[12:15], v[188:191]
    s_waitcnt lgkmcnt(6)
    v_mfma_f32_16x16x32_bf16 v[192:195], a[136:139], a[0:3], v[192:195]
    ds_read_b64_tr_b16 a[152:153], v15 offset:7168
    v_mfma_f32_16x16x32_bf16 v[196:199], a[136:139], a[4:7], v[196:199]
    ds_read_b64_tr_b16 a[154:155], v15 offset:8960
    v_mfma_f32_16x16x32_bf16 v[200:203], a[136:139], a[8:11], v[200:203]
    v_mfma_f32_16x16x32_bf16 v[204:207], a[136:139], a[12:15], v[204:207]
    s_waitcnt lgkmcnt(6)
    v_mfma_f32_16x16x32_bf16 v[208:211], a[140:143], a[0:3], v[208:211]
    ds_read_b64_tr_b16 a[156:157], v15 offset:21504
    v_mfma_f32_16x16x32_bf16 v[212:215], a[140:143], a[4:7], v[212:215]
    ds_read_b64_tr_b16 a[158:159], v15 offset:23296
    v_mfma_f32_16x16x32_bf16 v[216:219], a[140:143], a[8:11], v[216:219]
    buffer_load_dwordx4 a[84:87], v2, s[8:11], s41 offen offset:1024 sc1
    v_mfma_f32_16x16x32_bf16 v[220:223], a[140:143], a[12:15], v[220:223]
    s_waitcnt lgkmcnt(6)
    s_waitcnt vmcnt(24)
    s_barrier
    v_mfma_f32_16x16x32_bf16 v[224:227], a[144:147], a[0:3], v[224:227]
    ds_read_b64_tr_b16 a[128:129], v15 offset:7200
    v_mfma_f32_16x16x32_bf16 v[228:231], a[144:147], a[4:7], v[228:231]
    ds_read_b64_tr_b16 a[130:131], v15 offset:8992
    s_add_u32 m0, s42, 86016
    v_mfma_f32_16x16x32_bf16 v[232:235], a[144:147], a[8:11], v[232:235]
    buffer_load_dwordx4 v8, s[4:7], s40 offen offset:0 lds
    v_mfma_f32_16x16x32_bf16 v[236:239], a[144:147], a[12:15], v[236:239]
    s_waitcnt lgkmcnt(6)
    v_mfma_f32_16x16x32_bf16 v[240:243], a[148:151], a[0:3], v[240:243]
    ds_read_b64_tr_b16 a[132:133], v15 offset:21536
    v_mfma_f32_16x16x32_bf16 v[244:247], a[148:151], a[4:7], v[244:247]
    ds_read_b64_tr_b16 a[134:135], v15 offset:23328
    v_mfma_f32_16x16x32_bf16 v[248:251], a[148:151], a[8:11], v[248:251]
    v_mfma_f32_16x16x32_bf16 v[252:255], a[148:151], a[12:15], v[252:255]
    s_waitcnt vmcnt(24)
    s_waitcnt lgkmcnt(6)
    v_mfma_f32_16x16x32_bf16 v[32:35], a[152:155], a[16:19], v[32:35]
    ds_read_b64_tr_b16 a[136:137], v15 offset:7232
    v_mfma_f32_16x16x32_bf16 v[36:39], a[152:155], a[20:23], v[36:39]
    ds_read_b64_tr_b16 a[138:139], v15 offset:9024
    v_mfma_f32_16x16x32_bf16 v[40:43], a[152:155], a[24:27], v[40:43]
    buffer_load_dwordx4 a[88:91], v2, s[8:11], s41 offen offset:2048 sc1
    v_mfma_f32_16x16x32_bf16 v[44:47], a[152:155], a[28:31], v[44:47]
    s_waitcnt lgkmcnt(6)
    v_mfma_f32_16x16x32_bf16 v[48:51], a[156:159], a[16:19], v[48:51]
    ds_read_b64_tr_b16 a[140:141], v15 offset:21568
    v_mfma_f32_16x16x32_bf16 v[52:55], a[156:159], a[20:23], v[52:55]
    ds_read_b64_tr_b16 a[142:143], v15 offset:23360
    s_add_u32 m0, s42, 86016
    v_mfma_f32_16x16x32_bf16 v[56:59], a[156:159], a[24:27], v[56:59]
    buffer_load_dwordx4 v9, s[4:7], s40 offen offset:1024 lds
    v_mfma_f32_16x16x32_bf16 v[60:63], a[156:159], a[28:31], v[60:63]
    s_waitcnt lgkmcnt(6)
    v_mfma_f32_16x16x32_bf16 v[64:67], a[128:131], a[16:19], v[64:67]
    ds_read_b64_tr_b16 a[144:145], v15 offset:7264
    v_mfma_f32_16x16x32_bf16 v[68:71], a[128:131], a[20:23], v[68:71]
    ds_read_b64_tr_b16 a[146:147], v15 offset:9056
    v_mfma_f32_16x16x32_bf16 v[72:75], a[128:131], a[24:27], v[72:75]
    v_mfma_f32_16x16x32_bf16 v[76:79], a[128:131], a[28:31], v[76:79]
    s_waitcnt lgkmcnt(6)
    v_mfma_f32_16x16x32_bf16 v[80:83], a[132:135], a[16:19], v[80:83]
    ds_read_b64_tr_b16 a[148:149], v15 offset:21600
    v_mfma_f32_16x16x32_bf16 v[84:87], a[132:135], a[20:23], v[84:87]
    ds_read_b64_tr_b16 a[150:151], v15 offset:23392
    v_mfma_f32_16x16x32_bf16 v[88:91], a[132:135], a[24:27], v[88:91]
    buffer_load_dwordx4 a[92:95], v2, s[8:11], s41 offen offset:3072 sc1
    s_add_u32 s41, s41, 4096
    v_mfma_f32_16x16x32_bf16 v[92:95], a[132:135], a[28:31], v[92:95]
    s_waitcnt lgkmcnt(6)
    v_mfma_f32_16x16x32_bf16 v[96:99], a[136:139], a[16:19], v[96:99]
    ds_read_b64_tr_b16 a[152:153], v15 offset:7296
    v_mfma_f32_16x16x32_bf16 v[100:103], a[136:139], a[20:23], v[100:103]
    ds_read_b64_tr_b16 a[154:155], v15 offset:9088
    s_add_u32 m0, s42, 86016
    v_mfma_f32_16x16x32_bf16 v[104:107], a[136:139], a[24:27], v[104:107]
    buffer_load_dwordx4 v10, s[4:7], s40 offen offset:2048 lds
    v_mfma_f32_16x16x32_bf16 v[108:111], a[136:139], a[28:31], v[108:111]
    s_waitcnt lgkmcnt(6)
    v_mfma_f32_16x16x32_bf16 v[112:115], a[140:143], a[16:19], v[112:115]
    ds_read_b64_tr_b16 a[156:157], v15 offset:21632
    v_mfma_f32_16x16x32_bf16 v[116:119], a[140:143], a[20:23], v[116:119]
    ds_read_b64_tr_b16 a[158:159], v15 offset:23424
    v_mfma_f32_16x16x32_bf16 v[120:123], a[140:143], a[24:27], v[120:123]
    v_mfma_f32_16x16x32_bf16 v[124:127], a[140:143], a[28:31], v[124:127]
    s_waitcnt lgkmcnt(6)
    v_mfma_f32_16x16x32_bf16 v[128:131], a[144:147], a[16:19], v[128:131]
    ds_read_b64_tr_b16 a[128:129], v15 offset:7328
    v_mfma_f32_16x16x32_bf16 v[132:135], a[144:147], a[20:23], v[132:135]
    ds_read_b64_tr_b16 a[130:131], v15 offset:9120
    s_add_u32 m0, s42, 86016
    v_mfma_f32_16x16x32_bf16 v[136:139], a[144:147], a[24:27], v[136:139]
    buffer_load_dwordx4 v11, s[4:7], s40 offen offset:3072 lds
    v_mfma_f32_16x16x32_bf16 v[140:143], a[144:147], a[28:31], v[140:143]
    s_waitcnt lgkmcnt(6)
    v_mfma_f32_16x16x32_bf16 v[144:147], a[148:151], a[16:19], v[144:147]
    ds_read_b64_tr_b16 a[132:133], v15 offset:21664
    v_mfma_f32_16x16x32_bf16 v[148:151], a[148:151], a[20:23], v[148:151]
    ds_read_b64_tr_b16 a[134:135], v15 offset:23456
    v_mfma_f32_16x16x32_bf16 v[152:155], a[148:151], a[24:27], v[152:155]
    buffer_load_dwordx4 a[96:99], v2, s[8:11], s41 offen offset:0 sc1
    v_mfma_f32_16x16x32_bf16 v[156:159], a[148:151], a[28:31], v[156:159]
    s_waitcnt lgkmcnt(6)
    v_mfma_f32_16x16x32_bf16 v[160:163], a[152:155], a[16:19], v[160:163]
    ds_read_b64_tr_b16 a[136:137], v15 offset:7360
    v_mfma_f32_16x16x32_bf16 v[164:167], a[152:155], a[20:23], v[164:167]
    ds_read_b64_tr_b16 a[138:139], v15 offset:9152
    v_mfma_f32_16x16x32_bf16 v[168:171], a[152:155], a[24:27], v[168:171]
    buffer_load_dwordx4 a[100:103], v2, s[8:11], s41 offen offset:1024 sc1
    v_mfma_f32_16x16x32_bf16 v[172:175], a[152:155], a[28:31], v[172:175]
    s_waitcnt lgkmcnt(6)
    v_mfma_f32_16x16x32_bf16 v[176:179], a[156:159], a[16:19], v[176:179]
    ds_read_b64_tr_b16 a[140:141], v15 offset:21696
    v_mfma_f32_16x16x32_bf16 v[180:183], a[156:159], a[20:23], v[180:183]
    ds_read_b64_tr_b16 a[142:143], v15 offset:23488
    s_add_u32 m0, s42, 90112
    v_mfma_f32_16x16x32_bf16 v[184:187], a[156:159], a[24:27], v[184:187]
    buffer_load_dwordx4 v12, s[4:7], s40 offen offset:0 lds
    v_mfma_f32_16x16x32_bf16 v[188:191], a[156:159], a[28:31], v[188:191]
    s_waitcnt lgkmcnt(6)
    v_mfma_f32_16x16x32_bf16 v[192:195], a[128:131], a[16:19], v[192:195]
    ds_read_b64_tr_b16 a[144:145], v15 offset:28672
    v_mfma_f32_16x16x32_bf16 v[196:199], a[128:131], a[20:23], v[196:199]
    ds_read_b64_tr_b16 a[146:147], v15 offset:30464
    v_mfma_f32_16x16x32_bf16 v[200:203], a[128:131], a[24:27], v[200:203]
    v_mfma_f32_16x16x32_bf16 v[204:207], a[128:131], a[28:31], v[204:207]
    s_waitcnt lgkmcnt(6)
    v_mfma_f32_16x16x32_bf16 v[208:211], a[132:135], a[16:19], v[208:211]
    ds_read_b64_tr_b16 a[148:149], v15 offset:43008
    v_mfma_f32_16x16x32_bf16 v[212:215], a[132:135], a[20:23], v[212:215]
    ds_read_b64_tr_b16 a[150:151], v15 offset:44800
    v_mfma_f32_16x16x32_bf16 v[216:219], a[132:135], a[24:27], v[216:219]
    buffer_load_dwordx4 a[104:107], v2, s[8:11], s41 offen offset:2048 sc1
    v_mfma_f32_16x16x32_bf16 v[220:223], a[132:135], a[28:31], v[220:223]
    s_waitcnt lgkmcnt(6)
    v_mfma_f32_16x16x32_bf16 v[224:227], a[136:139], a[16:19], v[224:227]
    ds_read_b64_tr_b16 a[152:153], v15 offset:28704
    v_mfma_f32_16x16x32_bf16 v[228:231], a[136:139], a[20:23], v[228:231]
    ds_read_b64_tr_b16 a[154:155], v15 offset:30496
    s_add_u32 m0, s42, 90112
    v_mfma_f32_16x16x32_bf16 v[232:235], a[136:139], a[24:27], v[232:235]
    buffer_load_dwordx4 v13, s[4:7], s40 offen offset:1024 lds
    v_mfma_f32_16x16x32_bf16 v[236:239], a[136:139], a[28:31], v[236:239]
    s_waitcnt lgkmcnt(6)
    v_mfma_f32_16x16x32_bf16 v[240:243], a[140:143], a[16:19], v[240:243]
    ds_read_b64_tr_b16 a[156:157], v15 offset:43040
    v_mfma_f32_16x16x32_bf16 v[244:247], a[140:143], a[20:23], v[244:247]
    ds_read_b64_tr_b16 a[158:159], v15 offset:44832
    v_mfma_f32_16x16x32_bf16 v[248:251], a[140:143], a[24:27], v[248:251]
    v_mfma_f32_16x16x32_bf16 v[252:255], a[140:143], a[28:31], v[252:255]
    s_waitcnt vmcnt(28)
    s_waitcnt lgkmcnt(6)
    v_mfma_f32_16x16x32_bf16 v[32:35], a[144:147], a[32:35], v[32:35]
    ds_read_b64_tr_b16 a[128:129], v15 offset:28736
    v_mfma_f32_16x16x32_bf16 v[36:39], a[144:147], a[36:39], v[36:39]
    ds_read_b64_tr_b16 a[130:131], v15 offset:30528
    v_mfma_f32_16x16x32_bf16 v[40:43], a[144:147], a[40:43], v[40:43]
    buffer_load_dwordx4 a[108:111], v2, s[8:11], s41 offen offset:3072 sc1
    s_add_u32 s41, s41, 4096
    v_mfma_f32_16x16x32_bf16 v[44:47], a[144:147], a[44:47], v[44:47]
    s_waitcnt lgkmcnt(6)
    v_mfma_f32_16x16x32_bf16 v[48:51], a[148:151], a[32:35], v[48:51]
    ds_read_b64_tr_b16 a[132:133], v15 offset:43072
    v_mfma_f32_16x16x32_bf16 v[52:55], a[148:151], a[36:39], v[52:55]
    ds_read_b64_tr_b16 a[134:135], v15 offset:44864
    s_add_u32 m0, s42, 90112
    v_mfma_f32_16x16x32_bf16 v[56:59], a[148:151], a[40:43], v[56:59]
    buffer_load_dwordx4 v14, s[4:7], s40 offen offset:2048 lds
    s_add_u32 s40, s40, 458752
    v_mfma_f32_16x16x32_bf16 v[60:63], a[148:151], a[44:47], v[60:63]
    s_waitcnt lgkmcnt(6)
    v_mfma_f32_16x16x32_bf16 v[64:67], a[152:155], a[32:35], v[64:67]
    ds_read_b64_tr_b16 a[136:137], v15 offset:28768
    v_mfma_f32_16x16x32_bf16 v[68:71], a[152:155], a[36:39], v[68:71]
    ds_read_b64_tr_b16 a[138:139], v15 offset:30560
    v_mfma_f32_16x16x32_bf16 v[72:75], a[152:155], a[40:43], v[72:75]
    buffer_load_dwordx4 a[192:195], v23, s[16:19], s44 offen nt
    s_add_u32 s44, s44, 16384
    v_mfma_f32_16x16x32_bf16 v[76:79], a[152:155], a[44:47], v[76:79]
    s_waitcnt lgkmcnt(6)
    v_mfma_f32_16x16x32_bf16 v[80:83], a[156:159], a[32:35], v[80:83]
    ds_read_b64_tr_b16 a[140:141], v15 offset:43104
    v_mfma_f32_16x16x32_bf16 v[84:87], a[156:159], a[36:39], v[84:87]
    ds_read_b64_tr_b16 a[142:143], v15 offset:44896
    s_add_u32 m0, s42, 114688
    v_mfma_f32_16x16x32_bf16 v[88:91], a[156:159], a[40:43], v[88:91]
    buffer_load_dwordx4 v10, s[4:7], s49 offen offset:2048 lds
    v_mfma_f32_16x16x32_bf16 v[92:95], a[156:159], a[44:47], v[92:95]
    s_waitcnt lgkmcnt(6)
    v_mfma_f32_16x16x32_bf16 v[96:99], a[128:131], a[32:35], v[96:99]
    ds_read_b64_tr_b16 a[144:145], v15 offset:28800
    v_mfma_f32_16x16x32_bf16 v[100:103], a[128:131], a[36:39], v[100:103]
    ds_read_b64_tr_b16 a[146:147], v15 offset:30592
    v_mfma_f32_16x16x32_bf16 v[104:107], a[128:131], a[40:43], v[104:107]
    buffer_load_dwordx4 a[112:115], v2, s[8:11], s41 offen offset:0 sc1
    v_mfma_f32_16x16x32_bf16 v[108:111], a[128:131], a[44:47], v[108:111]
    s_waitcnt lgkmcnt(6)
    v_mfma_f32_16x16x32_bf16 v[112:115], a[132:135], a[32:35], v[112:115]
    ds_read_b64_tr_b16 a[148:149], v15 offset:43136
    v_mfma_f32_16x16x32_bf16 v[116:119], a[132:135], a[36:39], v[116:119]
    ds_read_b64_tr_b16 a[150:151], v15 offset:44928
    v_mfma_f32_16x16x32_bf16 v[120:123], a[132:135], a[40:43], v[120:123]
    buffer_load_dwordx4 a[116:119], v2, s[8:11], s41 offen offset:1024 sc1
    v_mfma_f32_16x16x32_bf16 v[124:127], a[132:135], a[44:47], v[124:127]
    s_waitcnt lgkmcnt(6)
    v_mfma_f32_16x16x32_bf16 v[128:131], a[136:139], a[32:35], v[128:131]
    ds_read_b64_tr_b16 a[152:153], v15 offset:28832
    v_mfma_f32_16x16x32_bf16 v[132:135], a[136:139], a[36:39], v[132:135]
    ds_read_b64_tr_b16 a[154:155], v15 offset:30624
    v_mfma_f32_16x16x32_bf16 v[136:139], a[136:139], a[40:43], v[136:139]
    buffer_load_dwordx4 a[196:199], v23, s[16:19], s44 offen nt
    s_add_u32 s44, s44, s38
    v_mfma_f32_16x16x32_bf16 v[140:143], a[136:139], a[44:47], v[140:143]
    s_waitcnt lgkmcnt(6)
    v_mfma_f32_16x16x32_bf16 v[144:147], a[140:143], a[32:35], v[144:147]
    ds_read_b64_tr_b16 a[156:157], v15 offset:43168
    v_mfma_f32_16x16x32_bf16 v[148:151], a[140:143], a[36:39], v[148:151]
    ds_read_b64_tr_b16 a[158:159], v15 offset:44960
    v_mfma_f32_16x16x32_bf16 v[152:155], a[140:143], a[40:43], v[152:155]
    buffer_load_dwordx4 a[200:203], v23, s[16:19], s44 offen nt
    s_add_u32 s44, s44, 16384
    v_mfma_f32_16x16x32_bf16 v[156:159], a[140:143], a[44:47], v[156:159]
    s_waitcnt lgkmcnt(6)
    v_mfma_f32_16x16x32_bf16 v[160:163], a[144:147], a[32:35], v[160:163]
    ds_read_b64_tr_b16 a[128:129], v15 offset:28864
    v_mfma_f32_16x16x32_bf16 v[164:167], a[144:147], a[36:39], v[164:167]
    ds_read_b64_tr_b16 a[130:131], v15 offset:30656
    v_mfma_f32_16x16x32_bf16 v[168:171], a[144:147], a[40:43], v[168:171]
    buffer_load_dwordx4 a[120:123], v2, s[8:11], s41 offen offset:2048 sc1
    v_mfma_f32_16x16x32_bf16 v[172:175], a[144:147], a[44:47], v[172:175]
    s_waitcnt lgkmcnt(6)
    v_mfma_f32_16x16x32_bf16 v[176:179], a[148:151], a[32:35], v[176:179]
    ds_read_b64_tr_b16 a[132:133], v15 offset:43200
    v_mfma_f32_16x16x32_bf16 v[180:183], a[148:151], a[36:39], v[180:183]
    ds_read_b64_tr_b16 a[134:135], v15 offset:44992
    v_mfma_f32_16x16x32_bf16 v[184:187], a[148:151], a[40:43], v[184:187]
    buffer_load_dwordx4 a[204:207], v23, s[16:19], s44 offen nt
    v_mfma_f32_16x16x32_bf16 v[188:191], a[148:151], a[44:47], v[188:191]
    s_waitcnt lgkmcnt(6)
    v_mfma_f32_16x16x32_bf16 v[192:195], a[152:155], a[32:35], v[192:195]
    ds_read_b64_tr_b16 a[136:137], v15 offset:35840
    v_mfma_f32_16x16x32_bf16 v[196:199], a[152:155], a[36:39], v[196:199]
    ds_read_b64_tr_b16 a[138:139], v15 offset:37632
    v_mfma_f32_16x16x32_bf16 v[200:203], a[152:155], a[40:43], v[200:203]
    buffer_load_dwordx4 a[208:211], v23, s[16:19], s46 offen nt
    s_add_u32 s46, s46, 16384
    v_mfma_f32_16x16x32_bf16 v[204:207], a[152:155], a[44:47], v[204:207]
    s_waitcnt lgkmcnt(6)
    v_mfma_f32_16x16x32_bf16 v[208:211], a[156:159], a[32:35], v[208:211]
    ds_read_b64_tr_b16 a[140:141], v15 offset:50176
    v_mfma_f32_16x16x32_bf16 v[212:215], a[156:159], a[36:39], v[212:215]
    ds_read_b64_tr_b16 a[142:143], v15 offset:51968
    v_mfma_f32_16x16x32_bf16 v[216:219], a[156:159], a[40:43], v[216:219]
    buffer_load_dwordx4 a[124:127], v2, s[8:11], s41 offen offset:3072 sc1
    s_add_u32 s41, s41, 4096
    v_mfma_f32_16x16x32_bf16 v[220:223], a[156:159], a[44:47], v[220:223]
    s_waitcnt lgkmcnt(6)
    s_waitcnt vmcnt(28)
    s_barrier
    v_mfma_f32_16x16x32_bf16 v[224:227], a[128:131], a[32:35], v[224:227]
    ds_read_b64_tr_b16 a[144:145], v15 offset:35872
    v_mfma_f32_16x16x32_bf16 v[228:231], a[128:131], a[36:39], v[228:231]
    ds_read_b64_tr_b16 a[146:147], v15 offset:37664
    s_add_u32 m0, s42, 0
    v_mfma_f32_16x16x32_bf16 v[232:235], a[128:131], a[40:43], v[232:235]
    buffer_load_dwordx4 v8, s[4:7], s40 offen offset:0 lds
    v_mfma_f32_16x16x32_bf16 v[236:239], a[128:131], a[44:47], v[236:239]
    s_waitcnt lgkmcnt(6)
    v_mfma_f32_16x16x32_bf16 v[240:243], a[132:135], a[32:35], v[240:243]
    ds_read_b64_tr_b16 a[148:149], v15 offset:50208
    v_mfma_f32_16x16x32_bf16 v[244:247], a[132:135], a[36:39], v[244:247]
    ds_read_b64_tr_b16 a[150:151], v15 offset:52000
    v_mfma_f32_16x16x32_bf16 v[248:251], a[132:135], a[40:43], v[248:251]
    buffer_load_dwordx4 a[212:215], v23, s[16:19], s46 offen nt
    s_add_u32 s46, s46, s39
    v_mfma_f32_16x16x32_bf16 v[252:255], a[132:135], a[44:47], v[252:255]
    s_waitcnt vmcnt(34)
    s_waitcnt lgkmcnt(6)
    v_mfma_f32_16x16x32_bf16 v[32:35], a[136:139], a[48:51], v[32:35]
    ds_read_b64_tr_b16 a[152:153], v15 offset:35904
    v_mfma_f32_16x16x32_bf16 v[36:39], a[136:139], a[52:55], v[36:39]
    ds_read_b64_tr_b16 a[154:155], v15 offset:37696
    v_mfma_f32_16x16x32_bf16 v[40:43], a[136:139], a[56:59], v[40:43]
    buffer_load_dwordx4 a[0:3], v2, s[8:11], s41 offen offset:0 sc1
    v_mfma_f32_16x16x32_bf16 v[44:47], a[136:139], a[60:63], v[44:47]
    s_waitcnt lgkmcnt(6)
    v_mfma_f32_16x16x32_bf16 v[48:51], a[140:143], a[48:51], v[48:51]
    ds_read_b64_tr_b16 a[156:157], v15 offset:50240
    v_mfma_f32_16x16x32_bf16 v[52:55], a[140:143], a[52:55], v[52:55]
    ds_read_b64_tr_b16 a[158:159], v15 offset:52032
    s_add_u32 m0, s42, 0
    v_mfma_f32_16x16x32_bf16 v[56:59], a[140:143], a[56:59], v[56:59]
    buffer_load_dwordx4 v9, s[4:7], s40 offen offset:1024 lds
    v_mfma_f32_16x16x32_bf16 v[60:63], a[140:143], a[60:63], v[60:63]
    s_waitcnt lgkmcnt(6)
    v_mfma_f32_16x16x32_bf16 v[64:67], a[144:147], a[48:51], v[64:67]
    ds_read_b64_tr_b16 a[128:129], v15 offset:35936
    v_mfma_f32_16x16x32_bf16 v[68:71], a[144:147], a[52:55], v[68:71]
    ds_read_b64_tr_b16 a[130:131], v15 offset:37728
    v_mfma_f32_16x16x32_bf16 v[72:75], a[144:147], a[56:59], v[72:75]
    buffer_load_dwordx4 a[4:7], v2, s[8:11], s41 offen offset:1024 sc1
    v_mfma_f32_16x16x32_bf16 v[76:79], a[144:147], a[60:63], v[76:79]
    s_waitcnt lgkmcnt(6)
    v_mfma_f32_16x16x32_bf16 v[80:83], a[148:151], a[48:51], v[80:83]
    ds_read_b64_tr_b16 a[132:133], v15 offset:50272
    v_mfma_f32_16x16x32_bf16 v[84:87], a[148:151], a[52:55], v[84:87]
    ds_read_b64_tr_b16 a[134:135], v15 offset:52064
    v_mfma_f32_16x16x32_bf16 v[88:91], a[148:151], a[56:59], v[88:91]
    buffer_load_dwordx4 a[216:219], v23, s[16:19], s46 offen nt
    s_add_u32 s46, s46, 16384
    v_mfma_f32_16x16x32_bf16 v[92:95], a[148:151], a[60:63], v[92:95]
    s_waitcnt lgkmcnt(6)
    v_mfma_f32_16x16x32_bf16 v[96:99], a[152:155], a[48:51], v[96:99]
    ds_read_b64_tr_b16 a[136:137], v15 offset:35968
    v_mfma_f32_16x16x32_bf16 v[100:103], a[152:155], a[52:55], v[100:103]
    ds_read_b64_tr_b16 a[138:139], v15 offset:37760
    s_add_u32 m0, s42, 0
    v_mfma_f32_16x16x32_bf16 v[104:107], a[152:155], a[56:59], v[104:107]
    buffer_load_dwordx4 v10, s[4:7], s40 offen offset:2048 lds
    v_mfma_f32_16x16x32_bf16 v[108:111], a[152:155], a[60:63], v[108:111]
    s_waitcnt lgkmcnt(6)
    v_mfma_f32_16x16x32_bf16 v[112:115], a[156:159], a[48:51], v[112:115]
    ds_read_b64_tr_b16 a[140:141], v15 offset:50304
    v_mfma_f32_16x16x32_bf16 v[116:119], a[156:159], a[52:55], v[116:119]
    ds_read_b64_tr_b16 a[142:143], v15 offset:52096
    v_mfma_f32_16x16x32_bf16 v[120:123], a[156:159], a[56:59], v[120:123]
    buffer_load_dwordx4 a[8:11], v2, s[8:11], s41 offen offset:2048 sc1
    v_mfma_f32_16x16x32_bf16 v[124:127], a[156:159], a[60:63], v[124:127]
    s_waitcnt lgkmcnt(6)
    v_mfma_f32_16x16x32_bf16 v[128:131], a[128:131], a[48:51], v[128:131]
    ds_read_b64_tr_b16 a[144:145], v15 offset:36000
    v_mfma_f32_16x16x32_bf16 v[132:135], a[128:131], a[52:55], v[132:135]
    ds_read_b64_tr_b16 a[146:147], v15 offset:37792
    s_add_u32 m0, s42, 0
    v_mfma_f32_16x16x32_bf16 v[136:139], a[128:131], a[56:59], v[136:139]
    buffer_load_dwordx4 v11, s[4:7], s40 offen offset:3072 lds
    v_mfma_f32_16x16x32_bf16 v[140:143], a[128:131], a[60:63], v[140:143]
    s_waitcnt lgkmcnt(6)
    v_mfma_f32_16x16x32_bf16 v[144:147], a[132:135], a[48:51], v[144:147]
    ds_read_b64_tr_b16 a[148:149], v15 offset:50336
    v_mfma_f32_16x16x32_bf16 v[148:151], a[132:135], a[52:55], v[148:151]
    ds_read_b64_tr_b16 a[150:151], v15 offset:52128
    v_mfma_f32_16x16x32_bf16 v[152:155], a[132:135], a[56:59], v[152:155]
    buffer_load_dwordx4 a[220:223], v23, s[16:19], s46 offen nt
    v_mfma_f32_16x16x32_bf16 v[156:159], a[132:135], a[60:63], v[156:159]
    s_waitcnt lgkmcnt(6)
    v_mfma_f32_16x16x32_bf16 v[160:163], a[136:139], a[48:51], v[160:163]
    ds_read_b64_tr_b16 a[152:153], v15 offset:36032
    v_mfma_f32_16x16x32_bf16 v[164:167], a[136:139], a[52:55], v[164:167]
    ds_read_b64_tr_b16 a[154:155], v15 offset:37824
    v_mfma_f32_16x16x32_bf16 v[168:171], a[136:139], a[56:59], v[168:171]
    buffer_load_dwordx4 a[12:15], v2, s[8:11], s41 offen offset:3072 sc1
    s_add_u32 s41, s41, 4096
    v_mfma_f32_16x16x32_bf16 v[172:175], a[136:139], a[60:63], v[172:175]
    s_waitcnt lgkmcnt(6)
    v_mfma_f32_16x16x32_bf16 v[176:179], a[140:143], a[48:51], v[176:179]
    ds_read_b64_tr_b16 a[156:157], v15 offset:50368
    v_mfma_f32_16x16x32_bf16 v[180:183], a[140:143], a[52:55], v[180:183]
    ds_read_b64_tr_b16 a[158:159], v15 offset:52160
    s_add_u32 m0, s42, 4096
    v_mfma_f32_16x16x32_bf16 v[184:187], a[140:143], a[56:59], v[184:187]
    buffer_load_dwordx4 v12, s[4:7], s40 offen offset:0 lds
    v_mfma_f32_16x16x32_bf16 v[188:191], a[140:143], a[60:63], v[188:191]
    s_waitcnt lgkmcnt(6)
    v_mfma_f32_16x16x32_bf16 v[192:195], a[144:147], a[48:51], v[192:195]
    ds_read_b64_tr_b16 a[128:129], v16 offset:0
    v_mfma_f32_16x16x32_bf16 v[196:199], a[144:147], a[52:55], v[196:199]
    ds_read_b64_tr_b16 a[130:131], v16 offset:1792
    v_mfma_f32_16x16x32_bf16 v[200:203], a[144:147], a[56:59], v[200:203]
    v_mfma_f32_16x16x32_bf16 v[204:207], a[144:147], a[60:63], v[204:207]
    s_waitcnt lgkmcnt(6)
    v_mfma_f32_16x16x32_bf16 v[208:211], a[148:151], a[48:51], v[208:211]
    ds_read_b64_tr_b16 a[132:133], v16 offset:14336
    v_mfma_f32_16x16x32_bf16 v[212:215], a[148:151], a[52:55], v[212:215]
    ds_read_b64_tr_b16 a[134:135], v16 offset:16128
    v_mfma_f32_16x16x32_bf16 v[216:219], a[148:151], a[56:59], v[216:219]
    buffer_load_dwordx4 a[16:19], v2, s[8:11], s41 offen offset:0 sc1
    v_mfma_f32_16x16x32_bf16 v[220:223], a[148:151], a[60:63], v[220:223]
    s_waitcnt lgkmcnt(6)
    v_mfma_f32_16x16x32_bf16 v[224:227], a[152:155], a[48:51], v[224:227]
    ds_read_b64_tr_b16 a[136:137], v16 offset:32
    v_mfma_f32_16x16x32_bf16 v[228:231], a[152:155], a[52:55], v[228:231]
    ds_read_b64_tr_b16 a[138:139], v16 offset:1824
    s_add_u32 m0, s42, 4096
    v_mfma_f32_16x16x32_bf16 v[232:235], a[152:155], a[56:59], v[232:235]
    buffer_load_dwordx4 v13, s[4:7], s40 offen offset:1024 lds
    v_mfma_f32_16x16x32_bf16 v[236:239], a[152:155], a[60:63], v[236:239]
    s_waitcnt lgkmcnt(6)
    v_mfma_f32_16x16x32_bf16 v[240:243], a[156:159], a[48:51], v[240:243]
    ds_read_b64_tr_b16 a[140:141], v16 offset:14368
    v_mfma_f32_16x16x32_bf16 v[244:247], a[156:159], a[52:55], v[244:247]
    ds_read_b64_tr_b16 a[142:143], v16 offset:16160
    v_mfma_f32_16x16x32_bf16 v[248:251], a[156:159], a[56:59], v[248:251]
    buffer_load_dwordx4 a[20:23], v2, s[8:11], s41 offen offset:1024 sc1
    v_mfma_f32_16x16x32_bf16 v[252:255], a[156:159], a[60:63], v[252:255]
    s_waitcnt vmcnt(40)
    s_waitcnt lgkmcnt(6)
    v_mfma_f32_16x16x32_bf16 v[32:35], a[128:131], a[64:67], v[32:35]
    ds_read_b64_tr_b16 a[144:145], v16 offset:64
    v_mfma_f32_16x16x32_bf16 v[36:39], a[128:131], a[68:71], v[36:39]
    ds_read_b64_tr_b16 a[146:147], v16 offset:1856
    v_mfma_f32_16x16x32_bf16 v[40:43], a[128:131], a[72:75], v[40:43]
    v_mfma_f32_16x16x32_bf16 v[44:47], a[128:131], a[76:79], v[44:47]
    s_waitcnt lgkmcnt(6)
    v_mfma_f32_16x16x32_bf16 v[48:51], a[132:135], a[64:67], v[48:51]
    ds_read_b64_tr_b16 a[148:149], v16 offset:14400
    v_mfma_f32_16x16x32_bf16 v[52:55], a[132:135], a[68:71], v[52:55]
    ds_read_b64_tr_b16 a[150:151], v16 offset:16192
    s_add_u32 m0, s42, 4096
    v_mfma_f32_16x16x32_bf16 v[56:59], a[132:135], a[72:75], v[56:59]
    buffer_load_dwordx4 v14, s[4:7], s40 offen offset:2048 lds
    s_add_u32 s40, s40, 458752
    v_mfma_f32_16x16x32_bf16 v[60:63], a[132:135], a[76:79], v[60:63]
    s_waitcnt lgkmcnt(6)
    v_mfma_f32_16x16x32_bf16 v[64:67], a[136:139], a[64:67], v[64:67]
    ds_read_b64_tr_b16 a[152:153], v16 offset:96
    v_mfma_f32_16x16x32_bf16 v[68:71], a[136:139], a[68:71], v[68:71]
    ds_read_b64_tr_b16 a[154:155], v16 offset:1888
    v_mfma_f32_16x16x32_bf16 v[72:75], a[136:139], a[72:75], v[72:75]
    buffer_load_dwordx4 a[24:27], v2, s[8:11], s41 offen offset:2048 sc1
    v_mfma_f32_16x16x32_bf16 v[76:79], a[136:139], a[76:79], v[76:79]
    s_waitcnt lgkmcnt(6)
    v_mfma_f32_16x16x32_bf16 v[80:83], a[140:143], a[64:67], v[80:83]
    ds_read_b64_tr_b16 a[156:157], v16 offset:14432
    v_mfma_f32_16x16x32_bf16 v[84:87], a[140:143], a[68:71], v[84:87]
    ds_read_b64_tr_b16 a[158:159], v16 offset:16224
    s_add_u32 m0, s42, 114688
    v_mfma_f32_16x16x32_bf16 v[88:91], a[140:143], a[72:75], v[88:91]
    buffer_load_dwordx4 v11, s[4:7], s49 offen offset:3072 lds
    v_mfma_f32_16x16x32_bf16 v[92:95], a[140:143], a[76:79], v[92:95]
    s_waitcnt lgkmcnt(6)
    v_mfma_f32_16x16x32_bf16 v[96:99], a[144:147], a[64:67], v[96:99]
    ds_read_b64_tr_b16 a[128:129], v16 offset:128
    v_mfma_f32_16x16x32_bf16 v[100:103], a[144:147], a[68:71], v[100:103]
    ds_read_b64_tr_b16 a[130:131], v16 offset:1920
    v_mfma_f32_16x16x32_bf16 v[104:107], a[144:147], a[72:75], v[104:107]
    v_mfma_f32_16x16x32_bf16 v[108:111], a[144:147], a[76:79], v[108:111]
    s_waitcnt lgkmcnt(6)
    v_mfma_f32_16x16x32_bf16 v[112:115], a[148:151], a[64:67], v[112:115]
    ds_read_b64_tr_b16 a[132:133], v16 offset:14464
    v_mfma_f32_16x16x32_bf16 v[116:119], a[148:151], a[68:71], v[116:119]
    ds_read_b64_tr_b16 a[134:135], v16 offset:16256
    v_mfma_f32_16x16x32_bf16 v[120:123], a[148:151], a[72:75], v[120:123]
    buffer_load_dwordx4 a[28:31], v2, s[8:11], s41 offen offset:3072 sc1
    s_add_u32 s41, s41, 4096
    v_mfma_f32_16x16x32_bf16 v[124:127], a[148:151], a[76:79], v[124:127]
    s_waitcnt lgkmcnt(6)
    v_mfma_f32_16x16x32_bf16 v[128:131], a[152:155], a[64:67], v[128:131]
    ds_read_b64_tr_b16 a[136:137], v16 offset:160
    v_mfma_f32_16x16x32_bf16 v[132:135], a[152:155], a[68:71], v[132:135]
    ds_read_b64_tr_b16 a[138:139], v16 offset:1952
    v_mfma_f32_16x16x32_bf16 v[136:139], a[152:155], a[72:75], v[136:139]
    v_mfma_f32_16x16x32_bf16 v[140:143], a[152:155], a[76:79], v[140:143]
    s_waitcnt lgkmcnt(6)
    v_mfma_f32_16x16x32_bf16 v[144:147], a[156:159], a[64:67], v[144:147]
    ds_read_b64_tr_b16 a[140:141], v16 offset:14496
    v_mfma_f32_16x16x32_bf16 v[148:151], a[156:159], a[68:71], v[148:151]
    ds_read_b64_tr_b16 a[142:143], v16 offset:16288
    v_mfma_f32_16x16x32_bf16 v[152:155], a[156:159], a[72:75], v[152:155]
    v_mfma_f32_16x16x32_bf16 v[156:159], a[156:159], a[76:79], v[156:159]
    s_waitcnt lgkmcnt(6)
    v_mfma_f32_16x16x32_bf16 v[160:163], a[128:131], a[64:67], v[160:163]
    ds_read_b64_tr_b16 a[144:145], v16 offset:192
    v_mfma_f32_16x16x32_bf16 v[164:167], a[128:131], a[68:71], v[164:167]
    ds_read_b64_tr_b16 a[146:147], v16 offset:1984
    v_mfma_f32_16x16x32_bf16 v[168:171], a[128:131], a[72:75], v[168:171]
    buffer_load_dwordx4 a[32:35], v2, s[8:11], s41 offen offset:0 sc1
    v_mfma_f32_16x16x32_bf16 v[172:175], a[128:131], a[76:79], v[172:175]
    s_waitcnt lgkmcnt(6)
    v_mfma_f32_16x16x32_bf16 v[176:179], a[132:135], a[64:67], v[176:179]
    ds_read_b64_tr_b16 a[148:149], v16 offset:14528
    v_mfma_f32_16x16x32_bf16 v[180:183], a[132:135], a[68:71], v[180:183]
    ds_read_b64_tr_b16 a[150:151], v16 offset:16320
    v_mfma_f32_16x16x32_bf16 v[184:187], a[132:135], a[72:75], v[184:187]
    v_mfma_f32_16x16x32_bf16 v[188:191], a[132:135], a[76:79], v[188:191]
    s_waitcnt lgkmcnt(6)
    v_mfma_f32_16x16x32_bf16 v[192:195], a[136:139], a[64:67], v[192:195]
    ds_read_b64_tr_b16 a[152:153], v16 offset:7168
    v_mfma_f32_16x16x32_bf16 v[196:199], a[136:139], a[68:71], v[196:199]
    ds_read_b64_tr_b16 a[154:155], v16 offset:8960
    v_mfma_f32_16x16x32_bf16 v[200:203], a[136:139], a[72:75], v[200:203]
    buffer_load_dwordx4 a[36:39], v2, s[8:11], s41 offen offset:1024 sc1
    v_mfma_f32_16x16x32_bf16 v[204:207], a[136:139], a[76:79], v[204:207]
    s_waitcnt lgkmcnt(6)
    v_mfma_f32_16x16x32_bf16 v[208:211], a[140:143], a[64:67], v[208:211]
    ds_read_b64_tr_b16 a[156:157], v16 offset:21504
    v_mfma_f32_16x16x32_bf16 v[212:215], a[140:143], a[68:71], v[212:215]
    ds_read_b64_tr_b16 a[158:159], v16 offset:23296
    v_mfma_f32_16x16x32_bf16 v[216:219], a[140:143], a[72:75], v[216:219]
    v_mfma_f32_16x16x32_bf16 v[220:223], a[140:143], a[76:79], v[220:223]
    s_waitcnt lgkmcnt(6)
    s_waitcnt vmcnt(31)
    s_barrier
    v_mfma_f32_16x16x32_bf16 v[224:227], a[144:147], a[64:67], v[224:227]
    ds_read_b64_tr_b16 a[128:129], v16 offset:7200
    v_mfma_f32_16x16x32_bf16 v[228:231], a[144:147], a[68:71], v[228:231]
    ds_read_b64_tr_b16 a[130:131], v16 offset:8992
    s_add_u32 m0, s42, 28672
    v_mfma_f32_16x16x32_bf16 v[232:235], a[144:147], a[72:75], v[232:235]
    buffer_load_dwordx4 v8, s[4:7], s40 offen offset:0 lds
    v_mfma_f32_16x16x32_bf16 v[236:239], a[144:147], a[76:79], v[236:239]
    s_waitcnt lgkmcnt(6)
    v_mfma_f32_16x16x32_bf16 v[240:243], a[148:151], a[64:67], v[240:243]
    ds_read_b64_tr_b16 a[132:133], v16 offset:21536
    v_mfma_f32_16x16x32_bf16 v[244:247], a[148:151], a[68:71], v[244:247]
    ds_read_b64_tr_b16 a[134:135], v16 offset:23328
    v_mfma_f32_16x16x32_bf16 v[248:251], a[148:151], a[72:75], v[248:251]
    buffer_load_dwordx4 a[40:43], v2, s[8:11], s41 offen offset:2048 sc1
    v_mfma_f32_16x16x32_bf16 v[252:255], a[148:151], a[76:79], v[252:255]
    s_waitcnt vmcnt(42)
    s_waitcnt lgkmcnt(6)
    v_mfma_f32_16x16x32_bf16 v[32:35], a[152:155], a[80:83], v[32:35]
    ds_read_b64_tr_b16 a[136:137], v16 offset:7232
    v_mfma_f32_16x16x32_bf16 v[36:39], a[152:155], a[84:87], v[36:39]
    ds_read_b64_tr_b16 a[138:139], v16 offset:9024
    v_mfma_f32_16x16x32_bf16 v[40:43], a[152:155], a[88:91], v[40:43]
    v_mfma_f32_16x16x32_bf16 v[44:47], a[152:155], a[92:95], v[44:47]
    s_waitcnt lgkmcnt(6)
    v_mfma_f32_16x16x32_bf16 v[48:51], a[156:159], a[80:83], v[48:51]
    ds_read_b64_tr_b16 a[140:141], v16 offset:21568
    v_mfma_f32_16x16x32_bf16 v[52:55], a[156:159], a[84:87], v[52:55]
    ds_read_b64_tr_b16 a[142:143], v16 offset:23360
    s_add_u32 m0, s42, 28672
    v_mfma_f32_16x16x32_bf16 v[56:59], a[156:159], a[88:91], v[56:59]
    buffer_load_dwordx4 v9, s[4:7], s40 offen offset:1024 lds
    v_mfma_f32_16x16x32_bf16 v[60:63], a[156:159], a[92:95], v[60:63]
    s_waitcnt lgkmcnt(6)
    v_mfma_f32_16x16x32_bf16 v[64:67], a[128:131], a[80:83], v[64:67]
    ds_read_b64_tr_b16 a[144:145], v16 offset:7264
    v_mfma_f32_16x16x32_bf16 v[68:71], a[128:131], a[84:87], v[68:71]
    ds_read_b64_tr_b16 a[146:147], v16 offset:9056
    v_mfma_f32_16x16x32_bf16 v[72:75], a[128:131], a[88:91], v[72:75]
    buffer_load_dwordx4 a[44:47], v2, s[8:11], s41 offen offset:3072 sc1
    s_add_u32 s41, s41, 4096
    v_mfma_f32_16x16x32_bf16 v[76:79], a[128:131], a[92:95], v[76:79]
    s_waitcnt lgkmcnt(6)
    v_mfma_f32_16x16x32_bf16 v[80:83], a[132:135], a[80:83], v[80:83]
    ds_read_b64_tr_b16 a[148:149], v16 offset:21600
    v_mfma_f32_16x16x32_bf16 v[84:87], a[132:135], a[84:87], v[84:87]
    ds_read_b64_tr_b16 a[150:151], v16 offset:23392
    v_mfma_f32_16x16x32_bf16 v[88:91], a[132:135], a[88:91], v[88:91]
    v_mfma_f32_16x16x32_bf16 v[92:95], a[132:135], a[92:95], v[92:95]
    s_waitcnt lgkmcnt(6)
    v_mfma_f32_16x16x32_bf16 v[96:99], a[136:139], a[80:83], v[96:99]
    ds_read_b64_tr_b16 a[152:153], v16 offset:7296
    v_mfma_f32_16x16x32_bf16 v[100:103], a[136:139], a[84:87], v[100:103]
    ds_read_b64_tr_b16 a[154:155], v16 offset:9088
    s_add_u32 m0, s42, 28672
    v_mfma_f32_16x16x32_bf16 v[104:107], a[136:139], a[88:91], v[104:107]
    buffer_load_dwordx4 v10, s[4:7], s40 offen offset:2048 lds
    v_mfma_f32_16x16x32_bf16 v[108:111], a[136:139], a[92:95], v[108:111]
    s_waitcnt lgkmcnt(6)
    v_mfma_f32_16x16x32_bf16 v[112:115], a[140:143], a[80:83], v[112:115]
    ds_read_b64_tr_b16 a[156:157], v16 offset:21632
    v_mfma_f32_16x16x32_bf16 v[116:119], a[140:143], a[84:87], v[116:119]
    ds_read_b64_tr_b16 a[158:159], v16 offset:23424
    v_mfma_f32_16x16x32_bf16 v[120:123], a[140:143], a[88:91], v[120:123]
    buffer_load_dwordx4 a[48:51], v2, s[8:11], s41 offen offset:0 sc1
    v_mfma_f32_16x16x32_bf16 v[124:127], a[140:143], a[92:95], v[124:127]
    s_waitcnt lgkmcnt(6)
    v_mfma_f32_16x16x32_bf16 v[128:131], a[144:147], a[80:83], v[128:131]
    ds_read_b64_tr_b16 a[128:129], v16 offset:7328
    v_mfma_f32_16x16x32_bf16 v[132:135], a[144:147], a[84:87], v[132:135]
    ds_read_b64_tr_b16 a[130:131], v16 offset:9120
    s_add_u32 m0, s42, 28672
    v_mfma_f32_16x16x32_bf16 v[136:139], a[144:147], a[88:91], v[136:139]
    buffer_load_dwordx4 v11, s[4:7], s40 offen offset:3072 lds
    v_mfma_f32_16x16x32_bf16 v[140:143], a[144:147], a[92:95], v[140:143]
    s_waitcnt lgkmcnt(6)
    v_mfma_f32_16x16x32_bf16 v[144:147], a[148:151], a[80:83], v[144:147]
    ds_read_b64_tr_b16 a[132:133], v16 offset:21664
    v_mfma_f32_16x16x32_bf16 v[148:151], a[148:151], a[84:87], v[148:151]
    ds_read_b64_tr_b16 a[134:135], v16 offset:23456
    v_mfma_f32_16x16x32_bf16 v[152:155], a[148:151], a[88:91], v[152:155]
    buffer_load_dwordx4 a[52:55], v2, s[8:11], s41 offen offset:1024 sc1
    v_mfma_f32_16x16x32_bf16 v[156:159], a[148:151], a[92:95], v[156:159]
    s_waitcnt lgkmcnt(6)
    v_mfma_f32_16x16x32_bf16 v[160:163], a[152:155], a[80:83], v[160:163]
    ds_read_b64_tr_b16 a[136:137], v16 offset:7360
    v_mfma_f32_16x16x32_bf16 v[164:167], a[152:155], a[84:87], v[164:167]
    ds_read_b64_tr_b16 a[138:139], v16 offset:9152
    v_mfma_f32_16x16x32_bf16 v[168:171], a[152:155], a[88:91], v[168:171]
    v_mfma_f32_16x16x32_bf16 v[172:175], a[152:155], a[92:95], v[172:175]
    s_waitcnt lgkmcnt(6)
    v_mfma_f32_16x16x32_bf16 v[176:179], a[156:159], a[80:83], v[176:179]
    ds_read_b64_tr_b16 a[140:141], v16 offset:21696
    v_mfma_f32_16x16x32_bf16 v[180:183], a[156:159], a[84:87], v[180:183]
    ds_read_b64_tr_b16 a[142:143], v16 offset:23488
    s_add_u32 m0, s42, 32768
    v_mfma_f32_16x16x32_bf16 v[184:187], a[156:159], a[88:91], v[184:187]
    buffer_load_dwordx4 v12, s[4:7], s40 offen offset:0 lds
    v_mfma_f32_16x16x32_bf16 v[188:191], a[156:159], a[92:95], v[188:191]
    s_waitcnt lgkmcnt(6)
    v_mfma_f32_16x16x32_bf16 v[192:195], a[128:131], a[80:83], v[192:195]
    ds_read_b64_tr_b16 a[144:145], v16 offset:28672
    v_mfma_f32_16x16x32_bf16 v[196:199], a[128:131], a[84:87], v[196:199]
    ds_read_b64_tr_b16 a[146:147], v16 offset:30464
    v_mfma_f32_16x16x32_bf16 v[200:203], a[128:131], a[88:91], v[200:203]
    buffer_load_dwordx4 a[56:59], v2, s[8:11], s41 offen offset:2048 sc1
    v_mfma_f32_16x16x32_bf16 v[204:207], a[128:131], a[92:95], v[204:207]
    s_waitcnt lgkmcnt(6)
    v_mfma_f32_16x16x32_bf16 v[208:211], a[132:135], a[80:83], v[208:211]
    ds_read_b64_tr_b16 a[148:149], v16 offset:43008
    v_mfma_f32_16x16x32_bf16 v[212:215], a[132:135], a[84:87], v[212:215]
    ds_read_b64_tr_b16 a[150:151], v16 offset:44800
    v_mfma_f32_16x16x32_bf16 v[216:219], a[132:135], a[88:91], v[216:219]
    v_mfma_f32_16x16x32_bf16 v[220:223], a[132:135], a[92:95], v[220:223]
    s_waitcnt lgkmcnt(6)
    v_mfma_f32_16x16x32_bf16 v[224:227], a[136:139], a[80:83], v[224:227]
    ds_read_b64_tr_b16 a[152:153], v16 offset:28704
    v_mfma_f32_16x16x32_bf16 v[228:231], a[136:139], a[84:87], v[228:231]
    ds_read_b64_tr_b16 a[154:155], v16 offset:30496
    s_add_u32 m0, s42, 32768
    v_mfma_f32_16x16x32_bf16 v[232:235], a[136:139], a[88:91], v[232:235]
    buffer_load_dwordx4 v13, s[4:7], s40 offen offset:1024 lds
    v_mfma_f32_16x16x32_bf16 v[236:239], a[136:139], a[92:95], v[236:239]
    s_waitcnt lgkmcnt(6)
    v_mfma_f32_16x16x32_bf16 v[240:243], a[140:143], a[80:83], v[240:243]
    ds_read_b64_tr_b16 a[156:157], v16 offset:43040
    v_mfma_f32_16x16x32_bf16 v[244:247], a[140:143], a[84:87], v[244:247]
    ds_read_b64_tr_b16 a[158:159], v16 offset:44832
    v_mfma_f32_16x16x32_bf16 v[248:251], a[140:143], a[88:91], v[248:251]
    buffer_load_dwordx4 a[60:63], v2, s[8:11], s41 offen offset:3072 sc1
    s_add_u32 s41, s41, 4096
    v_mfma_f32_16x16x32_bf16 v[252:255], a[140:143], a[92:95], v[252:255]
    s_waitcnt vmcnt(44)
    s_waitcnt lgkmcnt(6)
    v_mfma_f32_16x16x32_bf16 v[32:35], a[144:147], a[96:99], v[32:35]
    ds_read_b64_tr_b16 a[128:129], v16 offset:28736
    v_mfma_f32_16x16x32_bf16 v[36:39], a[144:147], a[100:103], v[36:39]
    ds_read_b64_tr_b16 a[130:131], v16 offset:30528
    v_mfma_f32_16x16x32_bf16 v[40:43], a[144:147], a[104:107], v[40:43]
    v_mfma_f32_16x16x32_bf16 v[44:47], a[144:147], a[108:111], v[44:47]
    s_waitcnt lgkmcnt(6)
    v_mfma_f32_16x16x32_bf16 v[48:51], a[148:151], a[96:99], v[48:51]
    ds_read_b64_tr_b16 a[132:133], v16 offset:43072
    v_mfma_f32_16x16x32_bf16 v[52:55], a[148:151], a[100:103], v[52:55]
    ds_read_b64_tr_b16 a[134:135], v16 offset:44864
    s_add_u32 m0, s42, 32768
    v_mfma_f32_16x16x32_bf16 v[56:59], a[148:151], a[104:107], v[56:59]
    buffer_load_dwordx4 v14, s[4:7], s40 offen offset:2048 lds
    s_add_u32 s40, s40, 458752
    v_mfma_f32_16x16x32_bf16 v[60:63], a[148:151], a[108:111], v[60:63]
    s_waitcnt lgkmcnt(6)
    v_mfma_f32_16x16x32_bf16 v[64:67], a[152:155], a[96:99], v[64:67]
    ds_read_b64_tr_b16 a[136:137], v16 offset:28768
    v_mfma_f32_16x16x32_bf16 v[68:71], a[152:155], a[100:103], v[68:71]
    ds_read_b64_tr_b16 a[138:139], v16 offset:30560
    v_mfma_f32_16x16x32_bf16 v[72:75], a[152:155], a[104:107], v[72:75]
    buffer_load_dwordx4 a[64:67], v2, s[8:11], s41 offen offset:0 sc1
    v_mfma_f32_16x16x32_bf16 v[76:79], a[152:155], a[108:111], v[76:79]
    s_waitcnt lgkmcnt(6)
    v_mfma_f32_16x16x32_bf16 v[80:83], a[156:159], a[96:99], v[80:83]
    ds_read_b64_tr_b16 a[140:141], v16 offset:43104
    v_mfma_f32_16x16x32_bf16 v[84:87], a[156:159], a[100:103], v[84:87]
    ds_read_b64_tr_b16 a[142:143], v16 offset:44896
    s_add_u32 m0, s42, 118784
    v_mfma_f32_16x16x32_bf16 v[88:91], a[156:159], a[104:107], v[88:91]
    buffer_load_dwordx4 v12, s[4:7], s49 offen offset:0 lds
    v_mfma_f32_16x16x32_bf16 v[92:95], a[156:159], a[108:111], v[92:95]
    s_waitcnt lgkmcnt(6)
    v_mfma_f32_16x16x32_bf16 v[96:99], a[128:131], a[96:99], v[96:99]
    ds_read_b64_tr_b16 a[144:145], v16 offset:28800
    v_mfma_f32_16x16x32_bf16 v[100:103], a[128:131], a[100:103], v[100:103]
    ds_read_b64_tr_b16 a[146:147], v16 offset:30592
    v_mfma_f32_16x16x32_bf16 v[104:107], a[128:131], a[104:107], v[104:107]
    buffer_load_dwordx4 a[68:71], v2, s[8:11], s41 offen offset:1024 sc1
    v_mfma_f32_16x16x32_bf16 v[108:111], a[128:131], a[108:111], v[108:111]
    s_waitcnt lgkmcnt(6)
    v_mfma_f32_16x16x32_bf16 v[112:115], a[132:135], a[96:99], v[112:115]
    ds_read_b64_tr_b16 a[148:149], v16 offset:43136
    v_mfma_f32_16x16x32_bf16 v[116:119], a[132:135], a[100:103], v[116:119]
    ds_read_b64_tr_b16 a[150:151], v16 offset:44928
    v_mfma_f32_16x16x32_bf16 v[120:123], a[132:135], a[104:107], v[120:123]
    v_mfma_f32_16x16x32_bf16 v[124:127], a[132:135], a[108:111], v[124:127]
    s_waitcnt lgkmcnt(6)
    v_mfma_f32_16x16x32_bf16 v[128:131], a[136:139], a[96:99], v[128:131]
    ds_read_b64_tr_b16 a[152:153], v16 offset:28832
    v_mfma_f32_16x16x32_bf16 v[132:135], a[136:139], a[100:103], v[132:135]
    ds_read_b64_tr_b16 a[154:155], v16 offset:30624
    v_mfma_f32_16x16x32_bf16 v[136:139], a[136:139], a[104:107], v[136:139]
    v_mfma_f32_16x16x32_bf16 v[140:143], a[136:139], a[108:111], v[140:143]
    s_waitcnt lgkmcnt(6)
    v_mfma_f32_16x16x32_bf16 v[144:147], a[140:143], a[96:99], v[144:147]
    ds_read_b64_tr_b16 a[156:157], v16 offset:43168
    v_mfma_f32_16x16x32_bf16 v[148:151], a[140:143], a[100:103], v[148:151]
    ds_read_b64_tr_b16 a[158:159], v16 offset:44960
    v_mfma_f32_16x16x32_bf16 v[152:155], a[140:143], a[104:107], v[152:155]
    buffer_load_dwordx4 a[72:75], v2, s[8:11], s41 offen offset:2048 sc1
    v_mfma_f32_16x16x32_bf16 v[156:159], a[140:143], a[108:111], v[156:159]
    s_waitcnt lgkmcnt(6)
    v_mfma_f32_16x16x32_bf16 v[160:163], a[144:147], a[96:99], v[160:163]
    ds_read_b64_tr_b16 a[128:129], v16 offset:28864
    v_mfma_f32_16x16x32_bf16 v[164:167], a[144:147], a[100:103], v[164:167]
    ds_read_b64_tr_b16 a[130:131], v16 offset:30656
    v_mfma_f32_16x16x32_bf16 v[168:171], a[144:147], a[104:107], v[168:171]
    v_mfma_f32_16x16x32_bf16 v[172:175], a[144:147], a[108:111], v[172:175]
    s_waitcnt lgkmcnt(6)
    v_mfma_f32_16x16x32_bf16 v[176:179], a[148:151], a[96:99], v[176:179]
    ds_read_b64_tr_b16 a[132:133], v16 offset:43200
    v_mfma_f32_16x16x32_bf16 v[180:183], a[148:151], a[100:103], v[180:183]
    ds_read_b64_tr_b16 a[134:135], v16 offset:44992
    v_mfma_f32_16x16x32_bf16 v[184:187], a[148:151], a[104:107], v[184:187]
    v_mfma_f32_16x16x32_bf16 v[188:191], a[148:151], a[108:111], v[188:191]
    s_waitcnt lgkmcnt(6)
    v_mfma_f32_16x16x32_bf16 v[192:195], a[152:155], a[96:99], v[192:195]
    ds_read_b64_tr_b16 a[136:137], v16 offset:35840
    v_mfma_f32_16x16x32_bf16 v[196:199], a[152:155], a[100:103], v[196:199]
    ds_read_b64_tr_b16 a[138:139], v16 offset:37632
    v_mfma_f32_16x16x32_bf16 v[200:203], a[152:155], a[104:107], v[200:203]
    buffer_load_dwordx4 a[76:79], v2, s[8:11], s41 offen offset:3072 sc1
    s_add_u32 s41, s41, 4096
    v_mfma_f32_16x16x32_bf16 v[204:207], a[152:155], a[108:111], v[204:207]
    s_waitcnt lgkmcnt(6)
    v_mfma_f32_16x16x32_bf16 v[208:211], a[156:159], a[96:99], v[208:211]
    ds_read_b64_tr_b16 a[140:141], v16 offset:50176
    v_mfma_f32_16x16x32_bf16 v[212:215], a[156:159], a[100:103], v[212:215]
    ds_read_b64_tr_b16 a[142:143], v16 offset:51968
    v_mfma_f32_16x16x32_bf16 v[216:219], a[156:159], a[104:107], v[216:219]
    v_mfma_f32_16x16x32_bf16 v[220:223], a[156:159], a[108:111], v[220:223]
    s_waitcnt lgkmcnt(6)
    s_waitcnt vmcnt(23)
    s_barrier
    v_mfma_f32_16x16x32_bf16 v[224:227], a[128:131], a[96:99], v[224:227]
    ds_read_b64_tr_b16 a[144:145], v16 offset:35872
    v_mfma_f32_16x16x32_bf16 v[228:231], a[128:131], a[100:103], v[228:231]
    ds_read_b64_tr_b16 a[146:147], v16 offset:37664
    s_add_u32 m0, s42, 57344
    v_mfma_f32_16x16x32_bf16 v[232:235], a[128:131], a[104:107], v[232:235]
    buffer_load_dwordx4 v8, s[4:7], s40 offen offset:0 lds
    v_mfma_f32_16x16x32_bf16 v[236:239], a[128:131], a[108:111], v[236:239]
    s_waitcnt lgkmcnt(6)
    v_mfma_f32_16x16x32_bf16 v[240:243], a[132:135], a[96:99], v[240:243]
    ds_read_b64_tr_b16 a[148:149], v16 offset:50208
    v_mfma_f32_16x16x32_bf16 v[244:247], a[132:135], a[100:103], v[244:247]
    ds_read_b64_tr_b16 a[150:151], v16 offset:52000
    v_mfma_f32_16x16x32_bf16 v[248:251], a[132:135], a[104:107], v[248:251]
    buffer_load_dwordx4 a[80:83], v2, s[8:11], s41 offen offset:0 sc1
    v_mfma_f32_16x16x32_bf16 v[252:255], a[132:135], a[108:111], v[252:255]
    s_waitcnt vmcnt(41)
    s_waitcnt lgkmcnt(6)
    v_mfma_f32_16x16x32_bf16 v[32:35], a[136:139], a[112:115], v[32:35]
    ds_read_b64_tr_b16 a[152:153], v16 offset:35904
    v_mfma_f32_16x16x32_bf16 v[36:39], a[136:139], a[116:119], v[36:39]
    ds_read_b64_tr_b16 a[154:155], v16 offset:37696
    v_mfma_f32_16x16x32_bf16 v[40:43], a[136:139], a[120:123], v[40:43]
    v_mfma_f32_16x16x32_bf16 v[44:47], a[136:139], a[124:127], v[44:47]
    s_waitcnt lgkmcnt(6)
    v_mfma_f32_16x16x32_bf16 v[48:51], a[140:143], a[112:115], v[48:51]
    ds_read_b64_tr_b16 a[156:157], v16 offset:50240
    v_mfma_f32_16x16x32_bf16 v[52:55], a[140:143], a[116:119], v[52:55]
    ds_read_b64_tr_b16 a[158:159], v16 offset:52032
    s_add_u32 m0, s42, 57344
    v_mfma_f32_16x16x32_bf16 v[56:59], a[140:143], a[120:123], v[56:59]
    buffer_load_dwordx4 v9, s[4:7], s40 offen offset:1024 lds
    v_mfma_f32_16x16x32_bf16 v[60:63], a[140:143], a[124:127], v[60:63]
    s_waitcnt lgkmcnt(6)
    v_mfma_f32_16x16x32_bf16 v[64:67], a[144:147], a[112:115], v[64:67]
    ds_read_b64_tr_b16 a[128:129], v16 offset:35936
    v_mfma_f32_16x16x32_bf16 v[68:71], a[144:147], a[116:119], v[68:71]
    ds_read_b64_tr_b16 a[130:131], v16 offset:37728
    v_mfma_f32_16x16x32_bf16 v[72:75], a[144:147], a[120:123], v[72:75]
    buffer_load_dwordx4 a[84:87], v2, s[8:11], s41 offen offset:1024 sc1
    v_mfma_f32_16x16x32_bf16 v[76:79], a[144:147], a[124:127], v[76:79]
    s_waitcnt lgkmcnt(6)
    v_mfma_f32_16x16x32_bf16 v[80:83], a[148:151], a[112:115], v[80:83]
    ds_read_b64_tr_b16 a[132:133], v16 offset:50272
    v_mfma_f32_16x16x32_bf16 v[84:87], a[148:151], a[116:119], v[84:87]
    ds_read_b64_tr_b16 a[134:135], v16 offset:52064
    v_mfma_f32_16x16x32_bf16 v[88:91], a[148:151], a[120:123], v[88:91]
    v_mfma_f32_16x16x32_bf16 v[92:95], a[148:151], a[124:127], v[92:95]
    s_waitcnt lgkmcnt(6)
    v_mfma_f32_16x16x32_bf16 v[96:99], a[152:155], a[112:115], v[96:99]
    ds_read_b64_tr_b16 a[136:137], v16 offset:35968
    v_mfma_f32_16x16x32_bf16 v[100:103], a[152:155], a[116:119], v[100:103]
    ds_read_b64_tr_b16 a[138:139], v16 offset:37760
    s_add_u32 m0, s42, 57344
    v_mfma_f32_16x16x32_bf16 v[104:107], a[152:155], a[120:123], v[104:107]
    buffer_load_dwordx4 v10, s[4:7], s40 offen offset:2048 lds
    v_mfma_f32_16x16x32_bf16 v[108:111], a[152:155], a[124:127], v[108:111]
    s_waitcnt lgkmcnt(6)
    v_mfma_f32_16x16x32_bf16 v[112:115], a[156:159], a[112:115], v[112:115]
    ds_read_b64_tr_b16 a[140:141], v16 offset:50304
    v_mfma_f32_16x16x32_bf16 v[116:119], a[156:159], a[116:119], v[116:119]
    ds_read_b64_tr_b16 a[142:143], v16 offset:52096
    v_mfma_f32_16x16x32_bf16 v[120:123], a[156:159], a[120:123], v[120:123]
    buffer_load_dwordx4 a[88:91], v2, s[8:11], s41 offen offset:2048 sc1
    v_mfma_f32_16x16x32_bf16 v[124:127], a[156:159], a[124:127], v[124:127]
    s_waitcnt lgkmcnt(6)
    v_mfma_f32_16x16x32_bf16 v[128:131], a[128:131], a[112:115], v[128:131]
    ds_read_b64_tr_b16 a[144:145], v16 offset:36000
    v_mfma_f32_16x16x32_bf16 v[132:135], a[128:131], a[116:119], v[132:135]
    ds_read_b64_tr_b16 a[146:147], v16 offset:37792
    s_add_u32 m0, s42, 57344
    v_mfma_f32_16x16x32_bf16 v[136:139], a[128:131], a[120:123], v[136:139]
    buffer_load_dwordx4 v11, s[4:7], s40 offen offset:3072 lds
    v_mfma_f32_16x16x32_bf16 v[140:143], a[128:131], a[124:127], v[140:143]
    s_waitcnt lgkmcnt(6)
    v_mfma_f32_16x16x32_bf16 v[144:147], a[132:135], a[112:115], v[144:147]
    ds_read_b64_tr_b16 a[148:149], v16 offset:50336
    v_mfma_f32_16x16x32_bf16 v[148:151], a[132:135], a[116:119], v[148:151]
    ds_read_b64_tr_b16 a[150:151], v16 offset:52128
    v_mfma_f32_16x16x32_bf16 v[152:155], a[132:135], a[120:123], v[152:155]
    buffer_load_dwordx4 a[92:95], v2, s[8:11], s41 offen offset:3072 sc1
    s_add_u32 s41, s41, 4096
    v_mfma_f32_16x16x32_bf16 v[156:159], a[132:135], a[124:127], v[156:159]
    s_waitcnt lgkmcnt(6)
    v_mfma_f32_16x16x32_bf16 v[160:163], a[136:139], a[112:115], v[160:163]
    ds_read_b64_tr_b16 a[152:153], v16 offset:36032
    v_mfma_f32_16x16x32_bf16 v[164:167], a[136:139], a[116:119], v[164:167]
    ds_read_b64_tr_b16 a[154:155], v16 offset:37824
    v_mfma_f32_16x16x32_bf16 v[168:171], a[136:139], a[120:123], v[168:171]
    v_mfma_f32_16x16x32_bf16 v[172:175], a[136:139], a[124:127], v[172:175]
    s_waitcnt lgkmcnt(6)
    v_mfma_f32_16x16x32_bf16 v[176:179], a[140:143], a[112:115], v[176:179]
    ds_read_b64_tr_b16 a[156:157], v16 offset:50368
    v_mfma_f32_16x16x32_bf16 v[180:183], a[140:143], a[116:119], v[180:183]
    ds_read_b64_tr_b16 a[158:159], v16 offset:52160
    s_add_u32 m0, s42, 61440
    v_mfma_f32_16x16x32_bf16 v[184:187], a[140:143], a[120:123], v[184:187]
    buffer_load_dwordx4 v12, s[4:7], s40 offen offset:0 lds
    v_mfma_f32_16x16x32_bf16 v[188:191], a[140:143], a[124:127], v[188:191]
    s_waitcnt lgkmcnt(6)
    v_mfma_f32_16x16x32_bf16 v[192:195], a[144:147], a[112:115], v[192:195]
    ds_read_b64_tr_b16 a[128:129], v15 offset:0
    v_mfma_f32_16x16x32_bf16 v[196:199], a[144:147], a[116:119], v[196:199]
    ds_read_b64_tr_b16 a[130:131], v15 offset:1792
    v_mfma_f32_16x16x32_bf16 v[200:203], a[144:147], a[120:123], v[200:203]
    buffer_load_dwordx4 a[96:99], v2, s[8:11], s41 offen offset:0 sc1
    v_mfma_f32_16x16x32_bf16 v[204:207], a[144:147], a[124:127], v[204:207]
    s_waitcnt lgkmcnt(6)
    v_mfma_f32_16x16x32_bf16 v[208:211], a[148:151], a[112:115], v[208:211]
    ds_read_b64_tr_b16 a[132:133], v15 offset:14336
    v_mfma_f32_16x16x32_bf16 v[212:215], a[148:151], a[116:119], v[212:215]
    ds_read_b64_tr_b16 a[134:135], v15 offset:16128
    v_mfma_f32_16x16x32_bf16 v[216:219], a[148:151], a[120:123], v[216:219]
    v_mfma_f32_16x16x32_bf16 v[220:223], a[148:151], a[124:127], v[220:223]
    s_waitcnt lgkmcnt(6)
    v_mfma_f32_16x16x32_bf16 v[224:227], a[152:155], a[112:115], v[224:227]
    ds_read_b64_tr_b16 a[136:137], v15 offset:32
    v_mfma_f32_16x16x32_bf16 v[228:231], a[152:155], a[116:119], v[228:231]
    ds_read_b64_tr_b16 a[138:139], v15 offset:1824
    s_add_u32 m0, s42, 61440
    v_mfma_f32_16x16x32_bf16 v[232:235], a[152:155], a[120:123], v[232:235]
    buffer_load_dwordx4 v13, s[4:7], s40 offen offset:1024 lds
    v_mfma_f32_16x16x32_bf16 v[236:239], a[152:155], a[124:127], v[236:239]
    s_waitcnt lgkmcnt(6)
    v_mfma_f32_16x16x32_bf16 v[240:243], a[156:159], a[112:115], v[240:243]
    ds_read_b64_tr_b16 a[140:141], v15 offset:14368
    v_mfma_f32_16x16x32_bf16 v[244:247], a[156:159], a[116:119], v[244:247]
    ds_read_b64_tr_b16 a[142:143], v15 offset:16160
    v_mfma_f32_16x16x32_bf16 v[248:251], a[156:159], a[120:123], v[248:251]
    buffer_load_dwordx4 a[100:103], v2, s[8:11], s41 offen offset:1024 sc1
    v_mfma_f32_16x16x32_bf16 v[252:255], a[156:159], a[124:127], v[252:255]
    s_waitcnt vmcnt(40)
    s_waitcnt lgkmcnt(6)
    v_mfma_f32_16x16x32_bf16 v[32:35], a[128:131], a[0:3], v[32:35]
    ds_read_b64_tr_b16 a[144:145], v15 offset:64
    v_mfma_f32_16x16x32_bf16 v[36:39], a[128:131], a[4:7], v[36:39]
    ds_read_b64_tr_b16 a[146:147], v15 offset:1856
    v_mfma_f32_16x16x32_bf16 v[40:43], a[128:131], a[8:11], v[40:43]
    s_waitcnt vmcnt(53)
    buffer_store_dwordx4 a[192:195], v30, s[20:23], s45 offen offset:0 sc1
    v_mfma_f32_16x16x32_bf16 v[44:47], a[128:131], a[12:15], v[44:47]
    s_waitcnt lgkmcnt(6)
    v_mfma_f32_16x16x32_bf16 v[48:51], a[132:135], a[0:3], v[48:51]
    ds_read_b64_tr_b16 a[148:149], v15 offset:14400
    v_mfma_f32_16x16x32_bf16 v[52:55], a[132:135], a[4:7], v[52:55]
    ds_read_b64_tr_b16 a[150:151], v15 offset:16192
    s_add_u32 m0, s42, 61440
    v_mfma_f32_16x16x32_bf16 v[56:59], a[132:135], a[8:11], v[56:59]
    buffer_load_dwordx4 v14, s[4:7], s40 offen offset:2048 lds
    s_add_u32 s40, s40, 458752
    v_mfma_f32_16x16x32_bf16 v[60:63], a[132:135], a[12:15], v[60:63]
    s_waitcnt lgkmcnt(6)
    v_mfma_f32_16x16x32_bf16 v[64:67], a[136:139], a[0:3], v[64:67]
    ds_read_b64_tr_b16 a[152:153], v15 offset:96
    v_mfma_f32_16x16x32_bf16 v[68:71], a[136:139], a[4:7], v[68:71]
    ds_read_b64_tr_b16 a[154:155], v15 offset:1888
    v_mfma_f32_16x16x32_bf16 v[72:75], a[136:139], a[8:11], v[72:75]
    buffer_load_dwordx4 a[104:107], v2, s[8:11], s41 offen offset:2048 sc1
    v_mfma_f32_16x16x32_bf16 v[76:79], a[136:139], a[12:15], v[76:79]
    s_waitcnt lgkmcnt(6)
    v_mfma_f32_16x16x32_bf16 v[80:83], a[140:143], a[0:3], v[80:83]
    ds_read_b64_tr_b16 a[156:157], v15 offset:14432
    v_mfma_f32_16x16x32_bf16 v[84:87], a[140:143], a[4:7], v[84:87]
    ds_read_b64_tr_b16 a[158:159], v15 offset:16224
    s_add_u32 m0, s42, 118784
    v_mfma_f32_16x16x32_bf16 v[88:91], a[140:143], a[8:11], v[88:91]
    buffer_load_dwordx4 v13, s[4:7], s49 offen offset:1024 lds
    v_mfma_f32_16x16x32_bf16 v[92:95], a[140:143], a[12:15], v[92:95]
    s_waitcnt lgkmcnt(6)
    v_mfma_f32_16x16x32_bf16 v[96:99], a[144:147], a[0:3], v[96:99]
    ds_read_b64_tr_b16 a[128:129], v15 offset:128
    v_mfma_f32_16x16x32_bf16 v[100:103], a[144:147], a[4:7], v[100:103]
    ds_read_b64_tr_b16 a[130:131], v15 offset:1920
    v_mfma_f32_16x16x32_bf16 v[104:107], a[144:147], a[8:11], v[104:107]
    buffer_load_dwordx4 a[108:111], v2, s[8:11], s41 offen offset:3072 sc1
    s_add_u32 s41, s41, 4096
    v_mfma_f32_16x16x32_bf16 v[108:111], a[144:147], a[12:15], v[108:111]
    s_waitcnt lgkmcnt(6)
    v_mfma_f32_16x16x32_bf16 v[112:115], a[148:151], a[0:3], v[112:115]
    ds_read_b64_tr_b16 a[132:133], v15 offset:14464
    v_mfma_f32_16x16x32_bf16 v[116:119], a[148:151], a[4:7], v[116:119]
    ds_read_b64_tr_b16 a[134:135], v15 offset:16256
    v_mfma_f32_16x16x32_bf16 v[120:123], a[148:151], a[8:11], v[120:123]
    v_mfma_f32_16x16x32_bf16 v[124:127], a[148:151], a[12:15], v[124:127]
    s_waitcnt lgkmcnt(6)
    v_mfma_f32_16x16x32_bf16 v[128:131], a[152:155], a[0:3], v[128:131]
    ds_read_b64_tr_b16 a[136:137], v15 offset:160
    v_mfma_f32_16x16x32_bf16 v[132:135], a[152:155], a[4:7], v[132:135]
    ds_read_b64_tr_b16 a[138:139], v15 offset:1952
    v_mfma_f32_16x16x32_bf16 v[136:139], a[152:155], a[8:11], v[136:139]
    v_mfma_f32_16x16x32_bf16 v[140:143], a[152:155], a[12:15], v[140:143]
    s_waitcnt lgkmcnt(6)
    v_mfma_f32_16x16x32_bf16 v[144:147], a[156:159], a[0:3], v[144:147]
    ds_read_b64_tr_b16 a[140:141], v15 offset:14496
    v_mfma_f32_16x16x32_bf16 v[148:151], a[156:159], a[4:7], v[148:151]
    ds_read_b64_tr_b16 a[142:143], v15 offset:16288
    v_mfma_f32_16x16x32_bf16 v[152:155], a[156:159], a[8:11], v[152:155]
    buffer_load_dwordx4 a[112:115], v2, s[8:11], s41 offen offset:0 sc1
    v_mfma_f32_16x16x32_bf16 v[156:159], a[156:159], a[12:15], v[156:159]
    s_waitcnt lgkmcnt(6)
    v_mfma_f32_16x16x32_bf16 v[160:163], a[128:131], a[0:3], v[160:163]
    ds_read_b64_tr_b16 a[144:145], v15 offset:192
    v_mfma_f32_16x16x32_bf16 v[164:167], a[128:131], a[4:7], v[164:167]
    ds_read_b64_tr_b16 a[146:147], v15 offset:1984
    v_mfma_f32_16x16x32_bf16 v[168:171], a[128:131], a[8:11], v[168:171]
    v_mfma_f32_16x16x32_bf16 v[172:175], a[128:131], a[12:15], v[172:175]
    s_waitcnt lgkmcnt(6)
    v_mfma_f32_16x16x32_bf16 v[176:179], a[132:135], a[0:3], v[176:179]
    ds_read_b64_tr_b16 a[148:149], v15 offset:14528
    v_mfma_f32_16x16x32_bf16 v[180:183], a[132:135], a[4:7], v[180:183]
    ds_read_b64_tr_b16 a[150:151], v15 offset:16320
    v_mfma_f32_16x16x32_bf16 v[184:187], a[132:135], a[8:11], v[184:187]
    buffer_load_dwordx4 a[116:119], v2, s[8:11], s41 offen offset:1024 sc1
    v_mfma_f32_16x16x32_bf16 v[188:191], a[132:135], a[12:15], v[188:191]
    s_waitcnt lgkmcnt(6)
    v_mfma_f32_16x16x32_bf16 v[192:195], a[136:139], a[0:3], v[192:195]
    ds_read_b64_tr_b16 a[152:153], v15 offset:7168
    v_mfma_f32_16x16x32_bf16 v[196:199], a[136:139], a[4:7], v[196:199]
    ds_read_b64_tr_b16 a[154:155], v15 offset:8960
    v_mfma_f32_16x16x32_bf16 v[200:203], a[136:139], a[8:11], v[200:203]
    buffer_store_dwordx4 a[196:199], v30, s[20:23], s45 offen offset:256 sc1
    v_mfma_f32_16x16x32_bf16 v[204:207], a[136:139], a[12:15], v[204:207]
    s_waitcnt lgkmcnt(6)
    v_mfma_f32_16x16x32_bf16 v[208:211], a[140:143], a[0:3], v[208:211]
    ds_read_b64_tr_b16 a[156:157], v15 offset:21504
    v_mfma_f32_16x16x32_bf16 v[212:215], a[140:143], a[4:7], v[212:215]
    ds_read_b64_tr_b16 a[158:159], v15 offset:23296
    v_mfma_f32_16x16x32_bf16 v[216:219], a[140:143], a[8:11], v[216:219]
    v_mfma_f32_16x16x32_bf16 v[220:223], a[140:143], a[12:15], v[220:223]
    s_waitcnt lgkmcnt(6)
    s_waitcnt vmcnt(25)
    s_barrier
    v_mfma_f32_16x16x32_bf16 v[224:227], a[144:147], a[0:3], v[224:227]
    ds_read_b64_tr_b16 a[128:129], v15 offset:7200
    v_mfma_f32_16x16x32_bf16 v[228:231], a[144:147], a[4:7], v[228:231]
    ds_read_b64_tr_b16 a[130:131], v15 offset:8992
    s_add_u32 m0, s42, 86016
    v_mfma_f32_16x16x32_bf16 v[232:235], a[144:147], a[8:11], v[232:235]
    buffer_load_dwordx4 v8, s[4:7], s40 offen offset:0 lds
    v_mfma_f32_16x16x32_bf16 v[236:239], a[144:147], a[12:15], v[236:239]
    s_waitcnt lgkmcnt(6)
    v_mfma_f32_16x16x32_bf16 v[240:243], a[148:151], a[0:3], v[240:243]
    ds_read_b64_tr_b16 a[132:133], v15 offset:21536
    v_mfma_f32_16x16x32_bf16 v[244:247], a[148:151], a[4:7], v[244:247]
    ds_read_b64_tr_b16 a[134:135], v15 offset:23328
    v_mfma_f32_16x16x32_bf16 v[248:251], a[148:151], a[8:11], v[248:251]
    buffer_load_dwordx4 a[120:123], v2, s[8:11], s41 offen offset:2048 sc1
    v_mfma_f32_16x16x32_bf16 v[252:255], a[148:151], a[12:15], v[252:255]
    s_waitcnt vmcnt(42)
    s_waitcnt lgkmcnt(6)
    v_mfma_f32_16x16x32_bf16 v[32:35], a[152:155], a[16:19], v[32:35]
    ds_read_b64_tr_b16 a[136:137], v15 offset:7232
    v_mfma_f32_16x16x32_bf16 v[36:39], a[152:155], a[20:23], v[36:39]
    ds_read_b64_tr_b16 a[138:139], v15 offset:9024
    v_mfma_f32_16x16x32_bf16 v[40:43], a[152:155], a[24:27], v[40:43]
    v_mfma_f32_16x16x32_bf16 v[44:47], a[152:155], a[28:31], v[44:47]
    s_waitcnt lgkmcnt(6)
    v_mfma_f32_16x16x32_bf16 v[48:51], a[156:159], a[16:19], v[48:51]
    ds_read_b64_tr_b16 a[140:141], v15 offset:21568
    v_mfma_f32_16x16x32_bf16 v[52:55], a[156:159], a[20:23], v[52:55]
    ds_read_b64_tr_b16 a[142:143], v15 offset:23360
    s_add_u32 m0, s42, 86016
    v_mfma_f32_16x16x32_bf16 v[56:59], a[156:159], a[24:27], v[56:59]
    buffer_load_dwordx4 v9, s[4:7], s40 offen offset:1024 lds
    v_mfma_f32_16x16x32_bf16 v[60:63], a[156:159], a[28:31], v[60:63]
    s_waitcnt lgkmcnt(6)
    v_mfma_f32_16x16x32_bf16 v[64:67], a[128:131], a[16:19], v[64:67]
    ds_read_b64_tr_b16 a[144:145], v15 offset:7264
    v_mfma_f32_16x16x32_bf16 v[68:71], a[128:131], a[20:23], v[68:71]
    ds_read_b64_tr_b16 a[146:147], v15 offset:9056
    v_mfma_f32_16x16x32_bf16 v[72:75], a[128:131], a[24:27], v[72:75]
    buffer_load_dwordx4 a[124:127], v2, s[8:11], s41 offen offset:3072 sc1
    s_add_u32 s41, s41, 4096
    v_mfma_f32_16x16x32_bf16 v[76:79], a[128:131], a[28:31], v[76:79]
    s_waitcnt lgkmcnt(6)
    v_mfma_f32_16x16x32_bf16 v[80:83], a[132:135], a[16:19], v[80:83]
    ds_read_b64_tr_b16 a[148:149], v15 offset:21600
    v_mfma_f32_16x16x32_bf16 v[84:87], a[132:135], a[20:23], v[84:87]
    ds_read_b64_tr_b16 a[150:151], v15 offset:23392
    v_mfma_f32_16x16x32_bf16 v[88:91], a[132:135], a[24:27], v[88:91]
    v_mfma_f32_16x16x32_bf16 v[92:95], a[132:135], a[28:31], v[92:95]
    s_waitcnt lgkmcnt(6)
    v_mfma_f32_16x16x32_bf16 v[96:99], a[136:139], a[16:19], v[96:99]
    ds_read_b64_tr_b16 a[152:153], v15 offset:7296
    v_mfma_f32_16x16x32_bf16 v[100:103], a[136:139], a[20:23], v[100:103]
    ds_read_b64_tr_b16 a[154:155], v15 offset:9088
    s_add_u32 m0, s42, 86016
    v_mfma_f32_16x16x32_bf16 v[104:107], a[136:139], a[24:27], v[104:107]
    buffer_load_dwordx4 v10, s[4:7], s40 offen offset:2048 lds
    v_mfma_f32_16x16x32_bf16 v[108:111], a[136:139], a[28:31], v[108:111]
    s_waitcnt lgkmcnt(6)
    v_mfma_f32_16x16x32_bf16 v[112:115], a[140:143], a[16:19], v[112:115]
    ds_read_b64_tr_b16 a[156:157], v15 offset:21632
    v_mfma_f32_16x16x32_bf16 v[116:119], a[140:143], a[20:23], v[116:119]
    ds_read_b64_tr_b16 a[158:159], v15 offset:23424
    v_mfma_f32_16x16x32_bf16 v[120:123], a[140:143], a[24:27], v[120:123]
    buffer_load_dwordx4 a[0:3], v2, s[8:11], s41 offen offset:0 sc1
    v_mfma_f32_16x16x32_bf16 v[124:127], a[140:143], a[28:31], v[124:127]
    s_waitcnt lgkmcnt(6)
    v_mfma_f32_16x16x32_bf16 v[128:131], a[144:147], a[16:19], v[128:131]
    ds_read_b64_tr_b16 a[128:129], v15 offset:7328
    v_mfma_f32_16x16x32_bf16 v[132:135], a[144:147], a[20:23], v[132:135]
    ds_read_b64_tr_b16 a[130:131], v15 offset:9120
    s_add_u32 m0, s42, 86016
    v_mfma_f32_16x16x32_bf16 v[136:139], a[144:147], a[24:27], v[136:139]
    buffer_load_dwordx4 v11, s[4:7], s40 offen offset:3072 lds
    v_mfma_f32_16x16x32_bf16 v[140:143], a[144:147], a[28:31], v[140:143]
    s_waitcnt lgkmcnt(6)
    v_mfma_f32_16x16x32_bf16 v[144:147], a[148:151], a[16:19], v[144:147]
    ds_read_b64_tr_b16 a[132:133], v15 offset:21664
    v_mfma_f32_16x16x32_bf16 v[148:151], a[148:151], a[20:23], v[148:151]
    ds_read_b64_tr_b16 a[134:135], v15 offset:23456
    v_mfma_f32_16x16x32_bf16 v[152:155], a[148:151], a[24:27], v[152:155]
    buffer_load_dwordx4 a[4:7], v2, s[8:11], s41 offen offset:1024 sc1
    v_mfma_f32_16x16x32_bf16 v[156:159], a[148:151], a[28:31], v[156:159]
    s_waitcnt lgkmcnt(6)
    v_mfma_f32_16x16x32_bf16 v[160:163], a[152:155], a[16:19], v[160:163]
    ds_read_b64_tr_b16 a[136:137], v15 offset:7360
    v_mfma_f32_16x16x32_bf16 v[164:167], a[152:155], a[20:23], v[164:167]
    ds_read_b64_tr_b16 a[138:139], v15 offset:9152
    v_mfma_f32_16x16x32_bf16 v[168:171], a[152:155], a[24:27], v[168:171]
    buffer_store_dwordx4 a[200:203], v30, s[20:23], s45 offen offset:512 sc1
    v_mfma_f32_16x16x32_bf16 v[172:175], a[152:155], a[28:31], v[172:175]
    s_waitcnt lgkmcnt(6)
    v_mfma_f32_16x16x32_bf16 v[176:179], a[156:159], a[16:19], v[176:179]
    ds_read_b64_tr_b16 a[140:141], v15 offset:21696
    v_mfma_f32_16x16x32_bf16 v[180:183], a[156:159], a[20:23], v[180:183]
    ds_read_b64_tr_b16 a[142:143], v15 offset:23488
    s_add_u32 m0, s42, 90112
    v_mfma_f32_16x16x32_bf16 v[184:187], a[156:159], a[24:27], v[184:187]
    buffer_load_dwordx4 v12, s[4:7], s40 offen offset:0 lds
    v_mfma_f32_16x16x32_bf16 v[188:191], a[156:159], a[28:31], v[188:191]
    s_waitcnt lgkmcnt(6)
    v_mfma_f32_16x16x32_bf16 v[192:195], a[128:131], a[16:19], v[192:195]
    ds_read_b64_tr_b16 a[144:145], v15 offset:28672
    v_mfma_f32_16x16x32_bf16 v[196:199], a[128:131], a[20:23], v[196:199]
    ds_read_b64_tr_b16 a[146:147], v15 offset:30464
    v_mfma_f32_16x16x32_bf16 v[200:203], a[128:131], a[24:27], v[200:203]
    buffer_load_dwordx4 a[8:11], v2, s[8:11], s41 offen offset:2048 sc1
    v_mfma_f32_16x16x32_bf16 v[204:207], a[128:131], a[28:31], v[204:207]
    s_waitcnt lgkmcnt(6)
    v_mfma_f32_16x16x32_bf16 v[208:211], a[132:135], a[16:19], v[208:211]
    ds_read_b64_tr_b16 a[148:149], v15 offset:43008
    v_mfma_f32_16x16x32_bf16 v[212:215], a[132:135], a[20:23], v[212:215]
    ds_read_b64_tr_b16 a[150:151], v15 offset:44800
    v_mfma_f32_16x16x32_bf16 v[216:219], a[132:135], a[24:27], v[216:219]
    v_mfma_f32_16x16x32_bf16 v[220:223], a[132:135], a[28:31], v[220:223]
    s_waitcnt lgkmcnt(6)
    v_mfma_f32_16x16x32_bf16 v[224:227], a[136:139], a[16:19], v[224:227]
    ds_read_b64_tr_b16 a[152:153], v15 offset:28704
    v_mfma_f32_16x16x32_bf16 v[228:231], a[136:139], a[20:23], v[228:231]
    ds_read_b64_tr_b16 a[154:155], v15 offset:30496
    s_add_u32 m0, s42, 90112
    v_mfma_f32_16x16x32_bf16 v[232:235], a[136:139], a[24:27], v[232:235]
    buffer_load_dwordx4 v13, s[4:7], s40 offen offset:1024 lds
    v_mfma_f32_16x16x32_bf16 v[236:239], a[136:139], a[28:31], v[236:239]
    s_waitcnt lgkmcnt(6)
    v_mfma_f32_16x16x32_bf16 v[240:243], a[140:143], a[16:19], v[240:243]
    ds_read_b64_tr_b16 a[156:157], v15 offset:43040
    v_mfma_f32_16x16x32_bf16 v[244:247], a[140:143], a[20:23], v[244:247]
    ds_read_b64_tr_b16 a[158:159], v15 offset:44832
    v_mfma_f32_16x16x32_bf16 v[248:251], a[140:143], a[24:27], v[248:251]
    buffer_load_dwordx4 a[12:15], v2, s[8:11], s41 offen offset:3072 sc1
    s_add_u32 s41, s41, 4096
    v_mfma_f32_16x16x32_bf16 v[252:255], a[140:143], a[28:31], v[252:255]
    s_waitcnt vmcnt(47)
    s_waitcnt lgkmcnt(6)
    v_mfma_f32_16x16x32_bf16 v[32:35], a[144:147], a[32:35], v[32:35]
    ds_read_b64_tr_b16 a[128:129], v15 offset:28736
    v_mfma_f32_16x16x32_bf16 v[36:39], a[144:147], a[36:39], v[36:39]
    ds_read_b64_tr_b16 a[130:131], v15 offset:30528
    v_mfma_f32_16x16x32_bf16 v[40:43], a[144:147], a[40:43], v[40:43]
    buffer_store_dwordx4 a[204:207], v30, s[20:23], s45 offen offset:768 sc1
    v_mfma_f32_16x16x32_bf16 v[44:47], a[144:147], a[44:47], v[44:47]
    s_waitcnt lgkmcnt(6)
    v_mfma_f32_16x16x32_bf16 v[48:51], a[148:151], a[32:35], v[48:51]
    ds_read_b64_tr_b16 a[132:133], v15 offset:43072
    v_mfma_f32_16x16x32_bf16 v[52:55], a[148:151], a[36:39], v[52:55]
    ds_read_b64_tr_b16 a[134:135], v15 offset:44864
    s_add_u32 m0, s42, 90112
    v_mfma_f32_16x16x32_bf16 v[56:59], a[148:151], a[40:43], v[56:59]
    buffer_load_dwordx4 v14, s[4:7], s40 offen offset:2048 lds
    s_add_u32 s40, s40, 458752
    v_mfma_f32_16x16x32_bf16 v[60:63], a[148:151], a[44:47], v[60:63]
    s_waitcnt lgkmcnt(6)
    v_mfma_f32_16x16x32_bf16 v[64:67], a[152:155], a[32:35], v[64:67]
    ds_read_b64_tr_b16 a[136:137], v15 offset:28768
    v_mfma_f32_16x16x32_bf16 v[68:71], a[152:155], a[36:39], v[68:71]
    ds_read_b64_tr_b16 a[138:139], v15 offset:30560
    v_mfma_f32_16x16x32_bf16 v[72:75], a[152:155], a[40:43], v[72:75]
    buffer_load_dwordx4 a[16:19], v2, s[8:11], s41 offen offset:0 sc1
    v_mfma_f32_16x16x32_bf16 v[76:79], a[152:155], a[44:47], v[76:79]
    s_waitcnt lgkmcnt(6)
    v_mfma_f32_16x16x32_bf16 v[80:83], a[156:159], a[32:35], v[80:83]
    ds_read_b64_tr_b16 a[140:141], v15 offset:43104
    v_mfma_f32_16x16x32_bf16 v[84:87], a[156:159], a[36:39], v[84:87]
    ds_read_b64_tr_b16 a[142:143], v15 offset:44896
    s_add_u32 m0, s42, 118784
    v_mfma_f32_16x16x32_bf16 v[88:91], a[156:159], a[40:43], v[88:91]
    buffer_load_dwordx4 v14, s[4:7], s49 offen offset:2048 lds
    v_mfma_f32_16x16x32_bf16 v[92:95], a[156:159], a[44:47], v[92:95]
    s_waitcnt lgkmcnt(6)
    v_mfma_f32_16x16x32_bf16 v[96:99], a[128:131], a[32:35], v[96:99]
    ds_read_b64_tr_b16 a[144:145], v15 offset:28800
    v_mfma_f32_16x16x32_bf16 v[100:103], a[128:131], a[36:39], v[100:103]
    ds_read_b64_tr_b16 a[146:147], v15 offset:30592
    v_mfma_f32_16x16x32_bf16 v[104:107], a[128:131], a[40:43], v[104:107]
    buffer_load_dwordx4 a[20:23], v2, s[8:11], s41 offen offset:1024 sc1
    v_mfma_f32_16x16x32_bf16 v[108:111], a[128:131], a[44:47], v[108:111]
    s_waitcnt lgkmcnt(6)
    v_mfma_f32_16x16x32_bf16 v[112:115], a[132:135], a[32:35], v[112:115]
    ds_read_b64_tr_b16 a[148:149], v15 offset:43136
    v_mfma_f32_16x16x32_bf16 v[116:119], a[132:135], a[36:39], v[116:119]
    ds_read_b64_tr_b16 a[150:151], v15 offset:44928
    v_mfma_f32_16x16x32_bf16 v[120:123], a[132:135], a[40:43], v[120:123]
    v_mfma_f32_16x16x32_bf16 v[124:127], a[132:135], a[44:47], v[124:127]
    s_waitcnt lgkmcnt(6)
    v_mfma_f32_16x16x32_bf16 v[128:131], a[136:139], a[32:35], v[128:131]
    ds_read_b64_tr_b16 a[152:153], v15 offset:28832
    v_mfma_f32_16x16x32_bf16 v[132:135], a[136:139], a[36:39], v[132:135]
    ds_read_b64_tr_b16 a[154:155], v15 offset:30624
    v_mfma_f32_16x16x32_bf16 v[136:139], a[136:139], a[40:43], v[136:139]
    buffer_load_dwordx4 a[24:27], v2, s[8:11], s41 offen offset:2048 sc1
    v_mfma_f32_16x16x32_bf16 v[140:143], a[136:139], a[44:47], v[140:143]
    s_waitcnt lgkmcnt(6)
    v_mfma_f32_16x16x32_bf16 v[144:147], a[140:143], a[32:35], v[144:147]
    ds_read_b64_tr_b16 a[156:157], v15 offset:43168
    v_mfma_f32_16x16x32_bf16 v[148:151], a[140:143], a[36:39], v[148:151]
    ds_read_b64_tr_b16 a[158:159], v15 offset:44960
    v_mfma_f32_16x16x32_bf16 v[152:155], a[140:143], a[40:43], v[152:155]
    v_mfma_f32_16x16x32_bf16 v[156:159], a[140:143], a[44:47], v[156:159]
    s_waitcnt lgkmcnt(6)
    v_mfma_f32_16x16x32_bf16 v[160:163], a[144:147], a[32:35], v[160:163]
    ds_read_b64_tr_b16 a[128:129], v15 offset:28864
    v_mfma_f32_16x16x32_bf16 v[164:167], a[144:147], a[36:39], v[164:167]
    ds_read_b64_tr_b16 a[130:131], v15 offset:30656
    v_mfma_f32_16x16x32_bf16 v[168:171], a[144:147], a[40:43], v[168:171]
    s_waitcnt vmcnt(63)
    buffer_store_dwordx4 a[208:211], v19, s[20:23], s47 offen offset:0 sc1
    v_mfma_f32_16x16x32_bf16 v[172:175], a[144:147], a[44:47], v[172:175]
    s_waitcnt lgkmcnt(6)
    v_mfma_f32_16x16x32_bf16 v[176:179], a[148:151], a[32:35], v[176:179]
    ds_read_b64_tr_b16 a[132:133], v15 offset:43200
    v_mfma_f32_16x16x32_bf16 v[180:183], a[148:151], a[36:39], v[180:183]
    ds_read_b64_tr_b16 a[134:135], v15 offset:44992
    v_mfma_f32_16x16x32_bf16 v[184:187], a[148:151], a[40:43], v[184:187]
    buffer_load_dwordx4 a[28:31], v2, s[8:11], s41 offen offset:3072 sc1
    s_add_u32 s41, s41, 4096
    v_mfma_f32_16x16x32_bf16 v[188:191], a[148:151], a[44:47], v[188:191]
    s_waitcnt lgkmcnt(6)
    v_mfma_f32_16x16x32_bf16 v[192:195], a[152:155], a[32:35], v[192:195]
    ds_read_b64_tr_b16 a[136:137], v15 offset:35840
    v_mfma_f32_16x16x32_bf16 v[196:199], a[152:155], a[36:39], v[196:199]
    ds_read_b64_tr_b16 a[138:139], v15 offset:37632
    v_mfma_f32_16x16x32_bf16 v[200:203], a[152:155], a[40:43], v[200:203]
    v_mfma_f32_16x16x32_bf16 v[204:207], a[152:155], a[44:47], v[204:207]
    s_waitcnt lgkmcnt(6)
    v_mfma_f32_16x16x32_bf16 v[208:211], a[156:159], a[32:35], v[208:211]
    ds_read_b64_tr_b16 a[140:141], v15 offset:50176
    v_mfma_f32_16x16x32_bf16 v[212:215], a[156:159], a[36:39], v[212:215]
    ds_read_b64_tr_b16 a[142:143], v15 offset:51968
    v_mfma_f32_16x16x32_bf16 v[216:219], a[156:159], a[40:43], v[216:219]
    v_mfma_f32_16x16x32_bf16 v[220:223], a[156:159], a[44:47], v[220:223]
    s_waitcnt lgkmcnt(6)
    s_waitcnt vmcnt(27)
    s_barrier
    v_mfma_f32_16x16x32_bf16 v[224:227], a[128:131], a[32:35], v[224:227]
    ds_read_b64_tr_b16 a[144:145], v15 offset:35872
    v_mfma_f32_16x16x32_bf16 v[228:231], a[128:131], a[36:39], v[228:231]
    ds_read_b64_tr_b16 a[146:147], v15 offset:37664
    s_add_u32 m0, s42, 0
    v_mfma_f32_16x16x32_bf16 v[232:235], a[128:131], a[40:43], v[232:235]
    buffer_load_dwordx4 v8, s[4:7], s40 offen offset:0 lds
    v_mfma_f32_16x16x32_bf16 v[236:239], a[128:131], a[44:47], v[236:239]
    s_waitcnt lgkmcnt(6)
    v_mfma_f32_16x16x32_bf16 v[240:243], a[132:135], a[32:35], v[240:243]
    ds_read_b64_tr_b16 a[148:149], v15 offset:50208
    v_mfma_f32_16x16x32_bf16 v[244:247], a[132:135], a[36:39], v[244:247]
    ds_read_b64_tr_b16 a[150:151], v15 offset:52000
    v_mfma_f32_16x16x32_bf16 v[248:251], a[132:135], a[40:43], v[248:251]
    v_mfma_f32_16x16x32_bf16 v[252:255], a[132:135], a[44:47], v[252:255]
    s_waitcnt vmcnt(48)
    s_waitcnt lgkmcnt(6)
    v_mfma_f32_16x16x32_bf16 v[32:35], a[136:139], a[48:51], v[32:35]
    ds_read_b64_tr_b16 a[152:153], v15 offset:35904
    v_mfma_f32_16x16x32_bf16 v[36:39], a[136:139], a[52:55], v[36:39]
    ds_read_b64_tr_b16 a[154:155], v15 offset:37696
    v_mfma_f32_16x16x32_bf16 v[40:43], a[136:139], a[56:59], v[40:43]
    buffer_load_dwordx4 a[32:35], v2, s[8:11], s41 offen offset:0 sc1
    v_mfma_f32_16x16x32_bf16 v[44:47], a[136:139], a[60:63], v[44:47]
    s_waitcnt lgkmcnt(6)
    v_mfma_f32_16x16x32_bf16 v[48:51], a[140:143], a[48:51], v[48:51]
    ds_read_b64_tr_b16 a[156:157], v15 offset:50240
    v_mfma_f32_16x16x32_bf16 v[52:55], a[140:143], a[52:55], v[52:55]
    ds_read_b64_tr_b16 a[158:159], v15 offset:52032
    s_add_u32 m0, s42, 0
    v_mfma_f32_16x16x32_bf16 v[56:59], a[140:143], a[56:59], v[56:59]
    buffer_load_dwordx4 v9, s[4:7], s40 offen offset:1024 lds
    v_mfma_f32_16x16x32_bf16 v[60:63], a[140:143], a[60:63], v[60:63]
    s_waitcnt lgkmcnt(6)
    v_mfma_f32_16x16x32_bf16 v[64:67], a[144:147], a[48:51], v[64:67]
    ds_read_b64_tr_b16 a[128:129], v15 offset:35936
    v_mfma_f32_16x16x32_bf16 v[68:71], a[144:147], a[52:55], v[68:71]
    ds_read_b64_tr_b16 a[130:131], v15 offset:37728
    v_mfma_f32_16x16x32_bf16 v[72:75], a[144:147], a[56:59], v[72:75]
    buffer_load_dwordx4 a[36:39], v2, s[8:11], s41 offen offset:1024 sc1
    v_mfma_f32_16x16x32_bf16 v[76:79], a[144:147], a[60:63], v[76:79]
    s_waitcnt lgkmcnt(6)
    v_mfma_f32_16x16x32_bf16 v[80:83], a[148:151], a[48:51], v[80:83]
    ds_read_b64_tr_b16 a[132:133], v15 offset:50272
    v_mfma_f32_16x16x32_bf16 v[84:87], a[148:151], a[52:55], v[84:87]
    ds_read_b64_tr_b16 a[134:135], v15 offset:52064
    v_mfma_f32_16x16x32_bf16 v[88:91], a[148:151], a[56:59], v[88:91]
    buffer_load_dwordx4 a[40:43], v2, s[8:11], s41 offen offset:2048 sc1
    v_mfma_f32_16x16x32_bf16 v[92:95], a[148:151], a[60:63], v[92:95]
    s_waitcnt lgkmcnt(6)
    v_mfma_f32_16x16x32_bf16 v[96:99], a[152:155], a[48:51], v[96:99]
    ds_read_b64_tr_b16 a[136:137], v15 offset:35968
    v_mfma_f32_16x16x32_bf16 v[100:103], a[152:155], a[52:55], v[100:103]
    ds_read_b64_tr_b16 a[138:139], v15 offset:37760
    s_add_u32 m0, s42, 0
    v_mfma_f32_16x16x32_bf16 v[104:107], a[152:155], a[56:59], v[104:107]
    buffer_load_dwordx4 v10, s[4:7], s40 offen offset:2048 lds
    v_mfma_f32_16x16x32_bf16 v[108:111], a[152:155], a[60:63], v[108:111]
    s_waitcnt lgkmcnt(6)
    v_mfma_f32_16x16x32_bf16 v[112:115], a[156:159], a[48:51], v[112:115]
    ds_read_b64_tr_b16 a[140:141], v15 offset:50304
    v_mfma_f32_16x16x32_bf16 v[116:119], a[156:159], a[52:55], v[116:119]
    ds_read_b64_tr_b16 a[142:143], v15 offset:52096
    v_mfma_f32_16x16x32_bf16 v[120:123], a[156:159], a[56:59], v[120:123]
    buffer_store_dwordx4 a[212:215], v19, s[20:23], s47 offen offset:256 sc1
    v_mfma_f32_16x16x32_bf16 v[124:127], a[156:159], a[60:63], v[124:127]
    s_waitcnt lgkmcnt(6)
    v_mfma_f32_16x16x32_bf16 v[128:131], a[128:131], a[48:51], v[128:131]
    ds_read_b64_tr_b16 a[144:145], v15 offset:36000
    v_mfma_f32_16x16x32_bf16 v[132:135], a[128:131], a[52:55], v[132:135]
    ds_read_b64_tr_b16 a[146:147], v15 offset:37792
    s_add_u32 m0, s42, 0
    v_mfma_f32_16x16x32_bf16 v[136:139], a[128:131], a[56:59], v[136:139]
    buffer_load_dwordx4 v11, s[4:7], s40 offen offset:3072 lds
    v_mfma_f32_16x16x32_bf16 v[140:143], a[128:131], a[60:63], v[140:143]
    s_waitcnt lgkmcnt(6)
    v_mfma_f32_16x16x32_bf16 v[144:147], a[132:135], a[48:51], v[144:147]
    ds_read_b64_tr_b16 a[148:149], v15 offset:50336
    v_mfma_f32_16x16x32_bf16 v[148:151], a[132:135], a[52:55], v[148:151]
    ds_read_b64_tr_b16 a[150:151], v15 offset:52128
    v_mfma_f32_16x16x32_bf16 v[152:155], a[132:135], a[56:59], v[152:155]
    buffer_load_dwordx4 a[44:47], v2, s[8:11], s41 offen offset:3072 sc1
    s_add_u32 s41, s41, 4096
    v_mfma_f32_16x16x32_bf16 v[156:159], a[132:135], a[60:63], v[156:159]
    s_waitcnt lgkmcnt(6)
    v_mfma_f32_16x16x32_bf16 v[160:163], a[136:139], a[48:51], v[160:163]
    ds_read_b64_tr_b16 a[152:153], v15 offset:36032
    v_mfma_f32_16x16x32_bf16 v[164:167], a[136:139], a[52:55], v[164:167]
    ds_read_b64_tr_b16 a[154:155], v15 offset:37824
    v_mfma_f32_16x16x32_bf16 v[168:171], a[136:139], a[56:59], v[168:171]
    v_mfma_f32_16x16x32_bf16 v[172:175], a[136:139], a[60:63], v[172:175]
    s_waitcnt lgkmcnt(6)
    v_mfma_f32_16x16x32_bf16 v[176:179], a[140:143], a[48:51], v[176:179]
    ds_read_b64_tr_b16 a[156:157], v15 offset:50368
    v_mfma_f32_16x16x32_bf16 v[180:183], a[140:143], a[52:55], v[180:183]
    ds_read_b64_tr_b16 a[158:159], v15 offset:52160
    s_add_u32 m0, s42, 4096
    v_mfma_f32_16x16x32_bf16 v[184:187], a[140:143], a[56:59], v[184:187]
    buffer_load_dwordx4 v12, s[4:7], s40 offen offset:0 lds
    v_mfma_f32_16x16x32_bf16 v[188:191], a[140:143], a[60:63], v[188:191]
    s_waitcnt lgkmcnt(6)
    v_mfma_f32_16x16x32_bf16 v[192:195], a[144:147], a[48:51], v[192:195]
    ds_read_b64_tr_b16 a[128:129], v16 offset:0
    v_mfma_f32_16x16x32_bf16 v[196:199], a[144:147], a[52:55], v[196:199]
    ds_read_b64_tr_b16 a[130:131], v16 offset:1792
    v_mfma_f32_16x16x32_bf16 v[200:203], a[144:147], a[56:59], v[200:203]
    buffer_load_dwordx4 a[176:179], v2, s[8:11], s50 offen offset:0 sc1
    v_mfma_f32_16x16x32_bf16 v[204:207], a[144:147], a[60:63], v[204:207]
    s_waitcnt lgkmcnt(6)
    v_mfma_f32_16x16x32_bf16 v[208:211], a[148:151], a[48:51], v[208:211]
    ds_read_b64_tr_b16 a[132:133], v16 offset:14336
    v_mfma_f32_16x16x32_bf16 v[212:215], a[148:151], a[52:55], v[212:215]
    ds_read_b64_tr_b16 a[134:135], v16 offset:16128
    v_mfma_f32_16x16x32_bf16 v[216:219], a[148:151], a[56:59], v[216:219]
    buffer_load_dwordx4 a[180:183], v2, s[8:11], s50 offen offset:1024 sc1
    v_mfma_f32_16x16x32_bf16 v[220:223], a[148:151], a[60:63], v[220:223]
    s_waitcnt lgkmcnt(6)
    v_mfma_f32_16x16x32_bf16 v[224:227], a[152:155], a[48:51], v[224:227]
    ds_read_b64_tr_b16 a[136:137], v16 offset:32
    v_mfma_f32_16x16x32_bf16 v[228:231], a[152:155], a[52:55], v[228:231]
    ds_read_b64_tr_b16 a[138:139], v16 offset:1824
    s_add_u32 m0, s42, 4096
    v_mfma_f32_16x16x32_bf16 v[232:235], a[152:155], a[56:59], v[232:235]
    buffer_load_dwordx4 v13, s[4:7], s40 offen offset:1024 lds
    v_mfma_f32_16x16x32_bf16 v[236:239], a[152:155], a[60:63], v[236:239]
    s_waitcnt lgkmcnt(6)
    v_mfma_f32_16x16x32_bf16 v[240:243], a[156:159], a[48:51], v[240:243]
    ds_read_b64_tr_b16 a[140:141], v16 offset:14368
    v_mfma_f32_16x16x32_bf16 v[244:247], a[156:159], a[52:55], v[244:247]
    ds_read_b64_tr_b16 a[142:143], v16 offset:16160
    v_mfma_f32_16x16x32_bf16 v[248:251], a[156:159], a[56:59], v[248:251]
    buffer_store_dwordx4 a[216:219], v19, s[20:23], s47 offen offset:512 sc1
    v_mfma_f32_16x16x32_bf16 v[252:255], a[156:159], a[60:63], v[252:255]
    s_waitcnt vmcnt(55)
    s_waitcnt lgkmcnt(6)
    v_mfma_f32_16x16x32_bf16 v[32:35], a[128:131], a[64:67], v[32:35]
    ds_read_b64_tr_b16 a[144:145], v16 offset:64
    v_mfma_f32_16x16x32_bf16 v[36:39], a[128:131], a[68:71], v[36:39]
    ds_read_b64_tr_b16 a[146:147], v16 offset:1856
    v_mfma_f32_16x16x32_bf16 v[40:43], a[128:131], a[72:75], v[40:43]
    buffer_load_dwordx4 a[184:187], v2, s[8:11], s50 offen offset:2048 sc1
    v_mfma_f32_16x16x32_bf16 v[44:47], a[128:131], a[76:79], v[44:47]
    s_waitcnt lgkmcnt(6)
    v_mfma_f32_16x16x32_bf16 v[48:51], a[132:135], a[64:67], v[48:51]
    ds_read_b64_tr_b16 a[148:149], v16 offset:14400
    v_mfma_f32_16x16x32_bf16 v[52:55], a[132:135], a[68:71], v[52:55]
    ds_read_b64_tr_b16 a[150:151], v16 offset:16192
    s_add_u32 m0, s42, 4096
    v_mfma_f32_16x16x32_bf16 v[56:59], a[132:135], a[72:75], v[56:59]
    buffer_load_dwordx4 v14, s[4:7], s40 offen offset:2048 lds
    s_add_u32 s40, s40, 458752
    v_mfma_f32_16x16x32_bf16 v[60:63], a[132:135], a[76:79], v[60:63]
    s_waitcnt lgkmcnt(6)
    v_mfma_f32_16x16x32_bf16 v[64:67], a[136:139], a[64:67], v[64:67]
    ds_read_b64_tr_b16 a[152:153], v16 offset:96
    v_mfma_f32_16x16x32_bf16 v[68:71], a[136:139], a[68:71], v[68:71]
    ds_read_b64_tr_b16 a[154:155], v16 offset:1888
    v_mfma_f32_16x16x32_bf16 v[72:75], a[136:139], a[72:75], v[72:75]
    v_mfma_f32_16x16x32_bf16 v[76:79], a[136:139], a[76:79], v[76:79]
    s_waitcnt lgkmcnt(6)
    v_mfma_f32_16x16x32_bf16 v[80:83], a[140:143], a[64:67], v[80:83]
    ds_read_b64_tr_b16 a[156:157], v16 offset:14432
    v_mfma_f32_16x16x32_bf16 v[84:87], a[140:143], a[68:71], v[84:87]
    ds_read_b64_tr_b16 a[158:159], v16 offset:16224
    v_mfma_f32_16x16x32_bf16 v[88:91], a[140:143], a[72:75], v[88:91]
    buffer_load_dwordx4 a[188:191], v2, s[8:11], s50 offen offset:3072 sc1
    s_add_u32 s50, s50, 4096
    v_mfma_f32_16x16x32_bf16 v[92:95], a[140:143], a[76:79], v[92:95]
    s_waitcnt lgkmcnt(6)
    v_mfma_f32_16x16x32_bf16 v[96:99], a[144:147], a[64:67], v[96:99]
    ds_read_b64_tr_b16 a[128:129], v16 offset:128
    v_mfma_f32_16x16x32_bf16 v[100:103], a[144:147], a[68:71], v[100:103]
    ds_read_b64_tr_b16 a[130:131], v16 offset:1920
    v_mfma_f32_16x16x32_bf16 v[104:107], a[144:147], a[72:75], v[104:107]
    v_mfma_f32_16x16x32_bf16 v[108:111], a[144:147], a[76:79], v[108:111]
    s_waitcnt lgkmcnt(6)
    v_mfma_f32_16x16x32_bf16 v[112:115], a[148:151], a[64:67], v[112:115]
    ds_read_b64_tr_b16 a[132:133], v16 offset:14464
    v_mfma_f32_16x16x32_bf16 v[116:119], a[148:151], a[68:71], v[116:119]
    ds_read_b64_tr_b16 a[134:135], v16 offset:16256
    v_mfma_f32_16x16x32_bf16 v[120:123], a[148:151], a[72:75], v[120:123]
    v_mfma_f32_16x16x32_bf16 v[124:127], a[148:151], a[76:79], v[124:127]
    s_waitcnt lgkmcnt(6)
    v_mfma_f32_16x16x32_bf16 v[128:131], a[152:155], a[64:67], v[128:131]
    ds_read_b64_tr_b16 a[136:137], v16 offset:160
    v_mfma_f32_16x16x32_bf16 v[132:135], a[152:155], a[68:71], v[132:135]
    ds_read_b64_tr_b16 a[138:139], v16 offset:1952
    v_mfma_f32_16x16x32_bf16 v[136:139], a[152:155], a[72:75], v[136:139]
    buffer_load_dwordx4 a[160:163], v2, s[8:11], s50 offen offset:0 sc1
    v_mfma_f32_16x16x32_bf16 v[140:143], a[152:155], a[76:79], v[140:143]
    s_waitcnt lgkmcnt(6)
    v_mfma_f32_16x16x32_bf16 v[144:147], a[156:159], a[64:67], v[144:147]
    ds_read_b64_tr_b16 a[140:141], v16 offset:14496
    v_mfma_f32_16x16x32_bf16 v[148:151], a[156:159], a[68:71], v[148:151]
    ds_read_b64_tr_b16 a[142:143], v16 offset:16288
    v_mfma_f32_16x16x32_bf16 v[152:155], a[156:159], a[72:75], v[152:155]
    buffer_store_dwordx4 a[220:223], v19, s[20:23], s47 offen offset:768 sc1
    v_mfma_f32_16x16x32_bf16 v[156:159], a[156:159], a[76:79], v[156:159]
    s_waitcnt lgkmcnt(6)
    v_mfma_f32_16x16x32_bf16 v[160:163], a[128:131], a[64:67], v[160:163]
    ds_read_b64_tr_b16 a[144:145], v16 offset:192
    v_mfma_f32_16x16x32_bf16 v[164:167], a[128:131], a[68:71], v[164:167]
    ds_read_b64_tr_b16 a[146:147], v16 offset:1984
    v_mfma_f32_16x16x32_bf16 v[168:171], a[128:131], a[72:75], v[168:171]
    buffer_load_dwordx4 a[164:167], v2, s[8:11], s50 offen offset:1024 sc1
    v_mfma_f32_16x16x32_bf16 v[172:175], a[128:131], a[76:79], v[172:175]
    s_waitcnt lgkmcnt(6)
    v_mfma_f32_16x16x32_bf16 v[176:179], a[132:135], a[64:67], v[176:179]
    ds_read_b64_tr_b16 a[148:149], v16 offset:14528
    v_mfma_f32_16x16x32_bf16 v[180:183], a[132:135], a[68:71], v[180:183]
    ds_read_b64_tr_b16 a[150:151], v16 offset:16320
    v_mfma_f32_16x16x32_bf16 v[184:187], a[132:135], a[72:75], v[184:187]
    v_mfma_f32_16x16x32_bf16 v[188:191], a[132:135], a[76:79], v[188:191]
    s_waitcnt lgkmcnt(6)
    v_mfma_f32_16x16x32_bf16 v[192:195], a[136:139], a[64:67], v[192:195]
    ds_read_b64_tr_b16 a[152:153], v16 offset:7168
    v_mfma_f32_16x16x32_bf16 v[196:199], a[136:139], a[68:71], v[196:199]
    ds_read_b64_tr_b16 a[154:155], v16 offset:8960
    v_mfma_f32_16x16x32_bf16 v[200:203], a[136:139], a[72:75], v[200:203]
    v_mfma_f32_16x16x32_bf16 v[204:207], a[136:139], a[76:79], v[204:207]
    s_waitcnt lgkmcnt(6)
    v_mfma_f32_16x16x32_bf16 v[208:211], a[140:143], a[64:67], v[208:211]
    ds_read_b64_tr_b16 a[156:157], v16 offset:21504
    v_mfma_f32_16x16x32_bf16 v[212:215], a[140:143], a[68:71], v[212:215]
    ds_read_b64_tr_b16 a[158:159], v16 offset:23296
    v_mfma_f32_16x16x32_bf16 v[216:219], a[140:143], a[72:75], v[216:219]
    buffer_load_dwordx4 a[168:171], v2, s[8:11], s50 offen offset:2048 sc1
    v_mfma_f32_16x16x32_bf16 v[220:223], a[140:143], a[76:79], v[220:223]
    s_waitcnt lgkmcnt(6)
    s_waitcnt vmcnt(27)
    s_barrier
    v_mfma_f32_16x16x32_bf16 v[224:227], a[144:147], a[64:67], v[224:227]
    ds_read_b64_tr_b16 a[128:129], v16 offset:7200
    v_mfma_f32_16x16x32_bf16 v[228:231], a[144:147], a[68:71], v[228:231]
    ds_read_b64_tr_b16 a[130:131], v16 offset:8992
    s_add_u32 m0, s42, 28672
    v_mfma_f32_16x16x32_bf16 v[232:235], a[144:147], a[72:75], v[232:235]
    buffer_load_dwordx4 v8, s[4:7], s40 offen offset:0 lds
    v_mfma_f32_16x16x32_bf16 v[236:239], a[144:147], a[76:79], v[236:239]
    s_waitcnt lgkmcnt(6)
    v_mfma_f32_16x16x32_bf16 v[240:243], a[148:151], a[64:67], v[240:243]
    ds_read_b64_tr_b16 a[132:133], v16 offset:21536
    v_mfma_f32_16x16x32_bf16 v[244:247], a[148:151], a[68:71], v[244:247]
    ds_read_b64_tr_b16 a[134:135], v16 offset:23328
    v_mfma_f32_16x16x32_bf16 v[248:251], a[148:151], a[72:75], v[248:251]
    v_mfma_f32_16x16x32_bf16 v[252:255], a[148:151], a[76:79], v[252:255]
    s_waitcnt vmcnt(55)
    s_waitcnt lgkmcnt(6)
    v_mfma_f32_16x16x32_bf16 v[32:35], a[152:155], a[80:83], v[32:35]
    ds_read_b64_tr_b16 a[136:137], v16 offset:7232
    v_mfma_f32_16x16x32_bf16 v[36:39], a[152:155], a[84:87], v[36:39]
    ds_read_b64_tr_b16 a[138:139], v16 offset:9024
    s_add_u32 m0, s42, 28672
    v_mfma_f32_16x16x32_bf16 v[40:43], a[152:155], a[88:91], v[40:43]
    buffer_load_dwordx4 v9, s[4:7], s40 offen offset:1024 lds
    v_mfma_f32_16x16x32_bf16 v[44:47], a[152:155], a[92:95], v[44:47]
    s_waitcnt lgkmcnt(6)
    v_mfma_f32_16x16x32_bf16 v[48:51], a[156:159], a[80:83], v[48:51]
    ds_read_b64_tr_b16 a[140:141], v16 offset:21568
    v_mfma_f32_16x16x32_bf16 v[52:55], a[156:159], a[84:87], v[52:55]
    ds_read_b64_tr_b16 a[142:143], v16 offset:23360
    v_mfma_f32_16x16x32_bf16 v[56:59], a[156:159], a[88:91], v[56:59]
    buffer_load_dwordx4 a[172:175], v2, s[8:11], s50 offen offset:3072 sc1
    s_add_u32 s50, s50, 4096
    v_mfma_f32_16x16x32_bf16 v[60:63], a[156:159], a[92:95], v[60:63]
    s_waitcnt lgkmcnt(6)
    v_mfma_f32_16x16x32_bf16 v[64:67], a[128:131], a[80:83], v[64:67]
    ds_read_b64_tr_b16 a[144:145], v16 offset:7264
    v_mfma_f32_16x16x32_bf16 v[68:71], a[128:131], a[84:87], v[68:71]
    ds_read_b64_tr_b16 a[146:147], v16 offset:9056
    s_add_u32 m0, s42, 28672
    v_mfma_f32_16x16x32_bf16 v[72:75], a[128:131], a[88:91], v[72:75]
    buffer_load_dwordx4 v10, s[4:7], s40 offen offset:2048 lds
    v_mfma_f32_16x16x32_bf16 v[76:79], a[128:131], a[92:95], v[76:79]
    s_waitcnt lgkmcnt(6)
    v_mfma_f32_16x16x32_bf16 v[80:83], a[132:135], a[80:83], v[80:83]
    ds_read_b64_tr_b16 a[148:149], v16 offset:21600
    v_mfma_f32_16x16x32_bf16 v[84:87], a[132:135], a[84:87], v[84:87]
    ds_read_b64_tr_b16 a[150:151], v16 offset:23392
    v_mfma_f32_16x16x32_bf16 v[88:91], a[132:135], a[88:91], v[88:91]
    buffer_load_dwordx4 a[48:51], v2, s[8:11], s41 offen offset:0 sc1
    v_mfma_f32_16x16x32_bf16 v[92:95], a[132:135], a[92:95], v[92:95]
    s_waitcnt lgkmcnt(6)
    v_mfma_f32_16x16x32_bf16 v[96:99], a[136:139], a[80:83], v[96:99]
    ds_read_b64_tr_b16 a[152:153], v16 offset:7296
    v_mfma_f32_16x16x32_bf16 v[100:103], a[136:139], a[84:87], v[100:103]
    ds_read_b64_tr_b16 a[154:155], v16 offset:9088
    s_add_u32 m0, s42, 28672
    v_mfma_f32_16x16x32_bf16 v[104:107], a[136:139], a[88:91], v[104:107]
    buffer_load_dwordx4 v11, s[4:7], s40 offen offset:3072 lds
    v_mfma_f32_16x16x32_bf16 v[108:111], a[136:139], a[92:95], v[108:111]
    s_waitcnt lgkmcnt(6)
    v_mfma_f32_16x16x32_bf16 v[112:115], a[140:143], a[80:83], v[112:115]
    ds_read_b64_tr_b16 a[156:157], v16 offset:21632
    v_mfma_f32_16x16x32_bf16 v[116:119], a[140:143], a[84:87], v[116:119]
    ds_read_b64_tr_b16 a[158:159], v16 offset:23424
    v_mfma_f32_16x16x32_bf16 v[120:123], a[140:143], a[88:91], v[120:123]
    buffer_load_dwordx4 a[52:55], v2, s[8:11], s41 offen offset:1024 sc1
    v_mfma_f32_16x16x32_bf16 v[124:127], a[140:143], a[92:95], v[124:127]
    s_waitcnt lgkmcnt(6)
    v_mfma_f32_16x16x32_bf16 v[128:131], a[144:147], a[80:83], v[128:131]
    ds_read_b64_tr_b16 a[128:129], v16 offset:7328
    v_mfma_f32_16x16x32_bf16 v[132:135], a[144:147], a[84:87], v[132:135]
    ds_read_b64_tr_b16 a[130:131], v16 offset:9120
    s_add_u32 m0, s42, 32768
    v_mfma_f32_16x16x32_bf16 v[136:139], a[144:147], a[88:91], v[136:139]
    buffer_load_dwordx4 v12, s[4:7], s40 offen offset:0 lds
    v_mfma_f32_16x16x32_bf16 v[140:143], a[144:147], a[92:95], v[140:143]
    s_waitcnt lgkmcnt(6)
    v_mfma_f32_16x16x32_bf16 v[144:147], a[148:151], a[80:83], v[144:147]
    ds_read_b64_tr_b16 a[132:133], v16 offset:21664
    v_mfma_f32_16x16x32_bf16 v[148:151], a[148:151], a[84:87], v[148:151]
    ds_read_b64_tr_b16 a[134:135], v16 offset:23456
    v_mfma_f32_16x16x32_bf16 v[152:155], a[148:151], a[88:91], v[152:155]
    v_mfma_f32_16x16x32_bf16 v[156:159], a[148:151], a[92:95], v[156:159]
    s_waitcnt lgkmcnt(6)
    v_mfma_f32_16x16x32_bf16 v[160:163], a[152:155], a[80:83], v[160:163]
    ds_read_b64_tr_b16 a[136:137], v16 offset:7360
    v_mfma_f32_16x16x32_bf16 v[164:167], a[152:155], a[84:87], v[164:167]
    ds_read_b64_tr_b16 a[138:139], v16 offset:9152
    s_add_u32 m0, s42, 32768
    v_mfma_f32_16x16x32_bf16 v[168:171], a[152:155], a[88:91], v[168:171]
    buffer_load_dwordx4 v13, s[4:7], s40 offen offset:1024 lds
    v_mfma_f32_16x16x32_bf16 v[172:175], a[152:155], a[92:95], v[172:175]
    s_waitcnt lgkmcnt(6)
    v_mfma_f32_16x16x32_bf16 v[176:179], a[156:159], a[80:83], v[176:179]
    ds_read_b64_tr_b16 a[140:141], v16 offset:21696
    v_mfma_f32_16x16x32_bf16 v[180:183], a[156:159], a[84:87], v[180:183]
    ds_read_b64_tr_b16 a[142:143], v16 offset:23488
    v_mfma_f32_16x16x32_bf16 v[184:187], a[156:159], a[88:91], v[184:187]
    buffer_load_dwordx4 a[56:59], v2, s[8:11], s41 offen offset:2048 sc1
    v_mfma_f32_16x16x32_bf16 v[188:191], a[156:159], a[92:95], v[188:191]
    s_waitcnt lgkmcnt(6)
    v_mfma_f32_16x16x32_bf16 v[192:195], a[128:131], a[80:83], v[192:195]
    ds_read_b64_tr_b16 a[144:145], v16 offset:28672
    v_mfma_f32_16x16x32_bf16 v[196:199], a[128:131], a[84:87], v[196:199]
    ds_read_b64_tr_b16 a[146:147], v16 offset:30464
    s_add_u32 m0, s42, 32768
    v_mfma_f32_16x16x32_bf16 v[200:203], a[128:131], a[88:91], v[200:203]
    buffer_load_dwordx4 v14, s[4:7], s40 offen offset:2048 lds
    s_add_u32 s40, s40, 458752
    v_mfma_f32_16x16x32_bf16 v[204:207], a[128:131], a[92:95], v[204:207]
    s_waitcnt lgkmcnt(6)
    v_mfma_f32_16x16x32_bf16 v[208:211], a[132:135], a[80:83], v[208:211]
    ds_read_b64_tr_b16 a[148:149], v16 offset:43008
    v_mfma_f32_16x16x32_bf16 v[212:215], a[132:135], a[84:87], v[212:215]
    ds_read_b64_tr_b16 a[150:151], v16 offset:44800
    v_mfma_f32_16x16x32_bf16 v[216:219], a[132:135], a[88:91], v[216:219]
    buffer_load_dwordx4 a[60:63], v2, s[8:11], s41 offen offset:3072 sc1
    s_add_u32 s41, s41, 4096
    v_mfma_f32_16x16x32_bf16 v[220:223], a[132:135], a[92:95], v[220:223]
    s_waitcnt lgkmcnt(6)
    v_mfma_f32_16x16x32_bf16 v[224:227], a[136:139], a[80:83], v[224:227]
    ds_read_b64_tr_b16 a[152:153], v16 offset:28704
    v_mfma_f32_16x16x32_bf16 v[228:231], a[136:139], a[84:87], v[228:231]
    ds_read_b64_tr_b16 a[154:155], v16 offset:30496
    v_mfma_f32_16x16x32_bf16 v[232:235], a[136:139], a[88:91], v[232:235]
    v_mfma_f32_16x16x32_bf16 v[236:239], a[136:139], a[92:95], v[236:239]
    s_waitcnt lgkmcnt(6)
    v_mfma_f32_16x16x32_bf16 v[240:243], a[140:143], a[80:83], v[240:243]
    ds_read_b64_tr_b16 a[156:157], v16 offset:43040
    v_mfma_f32_16x16x32_bf16 v[244:247], a[140:143], a[84:87], v[244:247]
    ds_read_b64_tr_b16 a[158:159], v16 offset:44832
    v_mfma_f32_16x16x32_bf16 v[248:251], a[140:143], a[88:91], v[248:251]
    v_mfma_f32_16x16x32_bf16 v[252:255], a[140:143], a[92:95], v[252:255]
    s_waitcnt vmcnt(57)
    s_waitcnt lgkmcnt(6)
    v_mfma_f32_16x16x32_bf16 v[32:35], a[144:147], a[96:99], v[32:35]
    ds_read_b64_tr_b16 a[128:129], v16 offset:28736
    v_mfma_f32_16x16x32_bf16 v[36:39], a[144:147], a[100:103], v[36:39]
    ds_read_b64_tr_b16 a[130:131], v16 offset:30528
    v_mfma_f32_16x16x32_bf16 v[40:43], a[144:147], a[104:107], v[40:43]
    buffer_load_dwordx4 a[64:67], v2, s[8:11], s41 offen offset:0 sc1
    v_mfma_f32_16x16x32_bf16 v[44:47], a[144:147], a[108:111], v[44:47]
    s_waitcnt lgkmcnt(6)
    v_mfma_f32_16x16x32_bf16 v[48:51], a[148:151], a[96:99], v[48:51]
    ds_read_b64_tr_b16 a[132:133], v16 offset:43072
    v_mfma_f32_16x16x32_bf16 v[52:55], a[148:151], a[100:103], v[52:55]
    ds_read_b64_tr_b16 a[134:135], v16 offset:44864
    v_mfma_f32_16x16x32_bf16 v[56:59], a[148:151], a[104:107], v[56:59]
    v_mfma_f32_16x16x32_bf16 v[60:63], a[148:151], a[108:111], v[60:63]
    s_waitcnt lgkmcnt(6)
    v_mfma_f32_16x16x32_bf16 v[64:67], a[152:155], a[96:99], v[64:67]
    ds_read_b64_tr_b16 a[136:137], v16 offset:28768
    v_mfma_f32_16x16x32_bf16 v[68:71], a[152:155], a[100:103], v[68:71]
    ds_read_b64_tr_b16 a[138:139], v16 offset:30560
    v_mfma_f32_16x16x32_bf16 v[72:75], a[152:155], a[104:107], v[72:75]
    buffer_load_dwordx4 a[68:71], v2, s[8:11], s41 offen offset:1024 sc1
    v_mfma_f32_16x16x32_bf16 v[76:79], a[152:155], a[108:111], v[76:79]
    s_waitcnt lgkmcnt(6)
    v_mfma_f32_16x16x32_bf16 v[80:83], a[156:159], a[96:99], v[80:83]
    ds_read_b64_tr_b16 a[140:141], v16 offset:43104
    v_mfma_f32_16x16x32_bf16 v[84:87], a[156:159], a[100:103], v[84:87]
    ds_read_b64_tr_b16 a[142:143], v16 offset:44896
    v_mfma_f32_16x16x32_bf16 v[88:91], a[156:159], a[104:107], v[88:91]
    v_mfma_f32_16x16x32_bf16 v[92:95], a[156:159], a[108:111], v[92:95]
    s_waitcnt lgkmcnt(6)
    v_mfma_f32_16x16x32_bf16 v[96:99], a[128:131], a[96:99], v[96:99]
    ds_read_b64_tr_b16 a[144:145], v16 offset:28800
    v_mfma_f32_16x16x32_bf16 v[100:103], a[128:131], a[100:103], v[100:103]
    ds_read_b64_tr_b16 a[146:147], v16 offset:30592
    v_mfma_f32_16x16x32_bf16 v[104:107], a[128:131], a[104:107], v[104:107]
    v_mfma_f32_16x16x32_bf16 v[108:111], a[128:131], a[108:111], v[108:111]
    s_waitcnt lgkmcnt(6)
    v_mfma_f32_16x16x32_bf16 v[112:115], a[132:135], a[96:99], v[112:115]
    ds_read_b64_tr_b16 a[148:149], v16 offset:43136
    v_mfma_f32_16x16x32_bf16 v[116:119], a[132:135], a[100:103], v[116:119]
    ds_read_b64_tr_b16 a[150:151], v16 offset:44928
    v_mfma_f32_16x16x32_bf16 v[120:123], a[132:135], a[104:107], v[120:123]
    buffer_load_dwordx4 a[72:75], v2, s[8:11], s41 offen offset:2048 sc1
    v_mfma_f32_16x16x32_bf16 v[124:127], a[132:135], a[108:111], v[124:127]
    s_waitcnt lgkmcnt(6)
    v_mfma_f32_16x16x32_bf16 v[128:131], a[136:139], a[96:99], v[128:131]
    ds_read_b64_tr_b16 a[152:153], v16 offset:28832
    v_mfma_f32_16x16x32_bf16 v[132:135], a[136:139], a[100:103], v[132:135]
    ds_read_b64_tr_b16 a[154:155], v16 offset:30624
    v_mfma_f32_16x16x32_bf16 v[136:139], a[136:139], a[104:107], v[136:139]
    v_mfma_f32_16x16x32_bf16 v[140:143], a[136:139], a[108:111], v[140:143]
    s_waitcnt lgkmcnt(6)
    v_mfma_f32_16x16x32_bf16 v[144:147], a[140:143], a[96:99], v[144:147]
    ds_read_b64_tr_b16 a[156:157], v16 offset:43168
    v_mfma_f32_16x16x32_bf16 v[148:151], a[140:143], a[100:103], v[148:151]
    ds_read_b64_tr_b16 a[158:159], v16 offset:44960
    v_mfma_f32_16x16x32_bf16 v[152:155], a[140:143], a[104:107], v[152:155]
    v_mfma_f32_16x16x32_bf16 v[156:159], a[140:143], a[108:111], v[156:159]
    s_waitcnt lgkmcnt(6)
    v_mfma_f32_16x16x32_bf16 v[160:163], a[144:147], a[96:99], v[160:163]
    ds_read_b64_tr_b16 a[128:129], v16 offset:28864
    v_mfma_f32_16x16x32_bf16 v[164:167], a[144:147], a[100:103], v[164:167]
    ds_read_b64_tr_b16 a[130:131], v16 offset:30656
    v_mfma_f32_16x16x32_bf16 v[168:171], a[144:147], a[104:107], v[168:171]
    buffer_load_dwordx4 a[76:79], v2, s[8:11], s41 offen offset:3072 sc1
    s_add_u32 s41, s41, 4096
    v_mfma_f32_16x16x32_bf16 v[172:175], a[144:147], a[108:111], v[172:175]
    s_waitcnt lgkmcnt(6)
    v_mfma_f32_16x16x32_bf16 v[176:179], a[148:151], a[96:99], v[176:179]
    ds_read_b64_tr_b16 a[132:133], v16 offset:43200
    v_mfma_f32_16x16x32_bf16 v[180:183], a[148:151], a[100:103], v[180:183]
    ds_read_b64_tr_b16 a[134:135], v16 offset:44992
    v_mfma_f32_16x16x32_bf16 v[184:187], a[148:151], a[104:107], v[184:187]
    v_mfma_f32_16x16x32_bf16 v[188:191], a[148:151], a[108:111], v[188:191]
    s_waitcnt lgkmcnt(6)
    v_mfma_f32_16x16x32_bf16 v[192:195], a[152:155], a[96:99], v[192:195]
    ds_read_b64_tr_b16 a[136:137], v16 offset:35840
    v_mfma_f32_16x16x32_bf16 v[196:199], a[152:155], a[100:103], v[196:199]
    ds_read_b64_tr_b16 a[138:139], v16 offset:37632
    v_mfma_f32_16x16x32_bf16 v[200:203], a[152:155], a[104:107], v[200:203]
    v_mfma_f32_16x16x32_bf16 v[204:207], a[152:155], a[108:111], v[204:207]
    s_waitcnt lgkmcnt(6)
    v_mfma_f32_16x16x32_bf16 v[208:211], a[156:159], a[96:99], v[208:211]
    ds_read_b64_tr_b16 a[140:141], v16 offset:50176
    v_mfma_f32_16x16x32_bf16 v[212:215], a[156:159], a[100:103], v[212:215]
    ds_read_b64_tr_b16 a[142:143], v16 offset:51968
    v_mfma_f32_16x16x32_bf16 v[216:219], a[156:159], a[104:107], v[216:219]
    buffer_load_dwordx4 a[80:83], v2, s[8:11], s41 offen offset:0 sc1
    v_mfma_f32_16x16x32_bf16 v[220:223], a[156:159], a[108:111], v[220:223]
    s_waitcnt lgkmcnt(6)
    s_waitcnt vmcnt(22)
    s_barrier
    v_mfma_f32_16x16x32_bf16 v[224:227], a[128:131], a[96:99], v[224:227]
    ds_read_b64_tr_b16 a[144:145], v16 offset:35872
    v_mfma_f32_16x16x32_bf16 v[228:231], a[128:131], a[100:103], v[228:231]
    ds_read_b64_tr_b16 a[146:147], v16 offset:37664
    s_add_u32 m0, s42, 57344
    v_mfma_f32_16x16x32_bf16 v[232:235], a[128:131], a[104:107], v[232:235]
    buffer_load_dwordx4 v8, s[4:7], s40 offen offset:0 lds
    v_mfma_f32_16x16x32_bf16 v[236:239], a[128:131], a[108:111], v[236:239]
    s_waitcnt lgkmcnt(6)
    v_mfma_f32_16x16x32_bf16 v[240:243], a[132:135], a[96:99], v[240:243]
    ds_read_b64_tr_b16 a[148:149], v16 offset:50208
    v_mfma_f32_16x16x32_bf16 v[244:247], a[132:135], a[100:103], v[244:247]
    ds_read_b64_tr_b16 a[150:151], v16 offset:52000
    s_add_u32 m0, s42, 57344
    v_mfma_f32_16x16x32_bf16 v[248:251], a[132:135], a[104:107], v[248:251]
    buffer_load_dwordx4 v9, s[4:7], s40 offen offset:1024 lds
    v_mfma_f32_16x16x32_bf16 v[252:255], a[132:135], a[108:111], v[252:255]
    s_waitcnt vmcnt(57)
    s_waitcnt lgkmcnt(6)
    v_mfma_f32_16x16x32_bf16 v[32:35], a[136:139], a[112:115], v[32:35]
    ds_read_b64_tr_b16 a[152:153], v16 offset:35904
    v_mfma_f32_16x16x32_bf16 v[36:39], a[136:139], a[116:119], v[36:39]
    ds_read_b64_tr_b16 a[154:155], v16 offset:37696
    s_add_u32 m0, s42, 57344
    v_mfma_f32_16x16x32_bf16 v[40:43], a[136:139], a[120:123], v[40:43]
    buffer_load_dwordx4 v10, s[4:7], s40 offen offset:2048 lds
    v_mfma_f32_16x16x32_bf16 v[44:47], a[136:139], a[124:127], v[44:47]
    s_waitcnt lgkmcnt(6)
    v_mfma_f32_16x16x32_bf16 v[48:51], a[140:143], a[112:115], v[48:51]
    ds_read_b64_tr_b16 a[156:157], v16 offset:50240
    v_mfma_f32_16x16x32_bf16 v[52:55], a[140:143], a[116:119], v[52:55]
    ds_read_b64_tr_b16 a[158:159], v16 offset:52032
    s_add_u32 m0, s42, 57344
    v_mfma_f32_16x16x32_bf16 v[56:59], a[140:143], a[120:123], v[56:59]
    buffer_load_dwordx4 v11, s[4:7], s40 offen offset:3072 lds
    v_mfma_f32_16x16x32_bf16 v[60:63], a[140:143], a[124:127], v[60:63]
    s_waitcnt lgkmcnt(6)
    v_mfma_f32_16x16x32_bf16 v[64:67], a[144:147], a[112:115], v[64:67]
    ds_read_b64_tr_b16 a[128:129], v16 offset:35936
    v_mfma_f32_16x16x32_bf16 v[68:71], a[144:147], a[116:119], v[68:71]
    ds_read_b64_tr_b16 a[130:131], v16 offset:37728
    s_add_u32 m0, s42, 61440
    v_mfma_f32_16x16x32_bf16 v[72:75], a[144:147], a[120:123], v[72:75]
    buffer_load_dwordx4 v12, s[4:7], s40 offen offset:0 lds
    v_mfma_f32_16x16x32_bf16 v[76:79], a[144:147], a[124:127], v[76:79]
    s_waitcnt lgkmcnt(6)
    v_mfma_f32_16x16x32_bf16 v[80:83], a[148:151], a[112:115], v[80:83]
    ds_read_b64_tr_b16 a[132:133], v16 offset:50272
    v_mfma_f32_16x16x32_bf16 v[84:87], a[148:151], a[116:119], v[84:87]
    ds_read_b64_tr_b16 a[134:135], v16 offset:52064
    s_add_u32 m0, s42, 61440
    v_mfma_f32_16x16x32_bf16 v[88:91], a[148:151], a[120:123], v[88:91]
    buffer_load_dwordx4 v13, s[4:7], s40 offen offset:1024 lds
    v_mfma_f32_16x16x32_bf16 v[92:95], a[148:151], a[124:127], v[92:95]
    s_waitcnt lgkmcnt(6)
    v_mfma_f32_16x16x32_bf16 v[96:99], a[152:155], a[112:115], v[96:99]
    ds_read_b64_tr_b16 a[136:137], v16 offset:35968
    v_mfma_f32_16x16x32_bf16 v[100:103], a[152:155], a[116:119], v[100:103]
    ds_read_b64_tr_b16 a[138:139], v16 offset:37760
    s_add_u32 m0, s42, 61440
    v_mfma_f32_16x16x32_bf16 v[104:107], a[152:155], a[120:123], v[104:107]
    buffer_load_dwordx4 v14, s[4:7], s40 offen offset:2048 lds
    s_add_u32 s40, s40, 458752
    v_mfma_f32_16x16x32_bf16 v[108:111], a[152:155], a[124:127], v[108:111]
    s_waitcnt lgkmcnt(6)
    v_mfma_f32_16x16x32_bf16 v[112:115], a[156:159], a[112:115], v[112:115]
    ds_read_b64_tr_b16 a[140:141], v16 offset:50304
    v_mfma_f32_16x16x32_bf16 v[116:119], a[156:159], a[116:119], v[116:119]
    ds_read_b64_tr_b16 a[142:143], v16 offset:52096
    v_mfma_f32_16x16x32_bf16 v[120:123], a[156:159], a[120:123], v[120:123]
    buffer_load_dwordx4 a[84:87], v2, s[8:11], s41 offen offset:1024 sc1
    v_mfma_f32_16x16x32_bf16 v[124:127], a[156:159], a[124:127], v[124:127]
    s_waitcnt lgkmcnt(6)
    v_mfma_f32_16x16x32_bf16 v[128:131], a[128:131], a[112:115], v[128:131]
    ds_read_b64_tr_b16 a[144:145], v16 offset:36000
    v_mfma_f32_16x16x32_bf16 v[132:135], a[128:131], a[116:119], v[132:135]
    ds_read_b64_tr_b16 a[146:147], v16 offset:37792
    v_mfma_f32_16x16x32_bf16 v[136:139], a[128:131], a[120:123], v[136:139]
    buffer_load_dwordx4 a[88:91], v2, s[8:11], s41 offen offset:2048 sc1
    v_mfma_f32_16x16x32_bf16 v[140:143], a[128:131], a[124:127], v[140:143]
    s_waitcnt lgkmcnt(6)
    v_mfma_f32_16x16x32_bf16 v[144:147], a[132:135], a[112:115], v[144:147]
    ds_read_b64_tr_b16 a[148:149], v16 offset:50336
    v_mfma_f32_16x16x32_bf16 v[148:151], a[132:135], a[116:119], v[148:151]
    ds_read_b64_tr_b16 a[150:151], v16 offset:52128
    v_mfma_f32_16x16x32_bf16 v[152:155], a[132:135], a[120:123], v[152:155]
    buffer_load_dwordx4 a[92:95], v2, s[8:11], s41 offen offset:3072 sc1
    s_add_u32 s41, s41, 4096
    v_mfma_f32_16x16x32_bf16 v[156:159], a[132:135], a[124:127], v[156:159]
    s_waitcnt lgkmcnt(6)
    v_mfma_f32_16x16x32_bf16 v[160:163], a[136:139], a[112:115], v[160:163]
    ds_read_b64_tr_b16 a[152:153], v16 offset:36032
    v_mfma_f32_16x16x32_bf16 v[164:167], a[136:139], a[116:119], v[164:167]
    ds_read_b64_tr_b16 a[154:155], v16 offset:37824
    v_mfma_f32_16x16x32_bf16 v[168:171], a[136:139], a[120:123], v[168:171]
    v_mfma_f32_16x16x32_bf16 v[172:175], a[136:139], a[124:127], v[172:175]
    s_waitcnt lgkmcnt(6)
    v_mfma_f32_16x16x32_bf16 v[176:179], a[140:143], a[112:115], v[176:179]
    ds_read_b64_tr_b16 a[156:157], v16 offset:50368
    v_mfma_f32_16x16x32_bf16 v[180:183], a[140:143], a[116:119], v[180:183]
    ds_read_b64_tr_b16 a[158:159], v16 offset:52160
    v_mfma_f32_16x16x32_bf16 v[184:187], a[140:143], a[120:123], v[184:187]
    v_mfma_f32_16x16x32_bf16 v[188:191], a[140:143], a[124:127], v[188:191]
    s_waitcnt lgkmcnt(6)
    v_mfma_f32_16x16x32_bf16 v[192:195], a[144:147], a[112:115], v[192:195]
    ds_read_b64_tr_b16 a[128:129], v15 offset:0
    v_mfma_f32_16x16x32_bf16 v[196:199], a[144:147], a[116:119], v[196:199]
    ds_read_b64_tr_b16 a[130:131], v15 offset:1792
    v_mfma_f32_16x16x32_bf16 v[200:203], a[144:147], a[120:123], v[200:203]
    v_mfma_f32_16x16x32_bf16 v[204:207], a[144:147], a[124:127], v[204:207]
    s_waitcnt lgkmcnt(6)
    v_mfma_f32_16x16x32_bf16 v[208:211], a[148:151], a[112:115], v[208:211]
    ds_read_b64_tr_b16 a[132:133], v15 offset:14336
    v_mfma_f32_16x16x32_bf16 v[212:215], a[148:151], a[116:119], v[212:215]
    ds_read_b64_tr_b16 a[134:135], v15 offset:16128
    v_mfma_f32_16x16x32_bf16 v[216:219], a[148:151], a[120:123], v[216:219]
    v_mfma_f32_16x16x32_bf16 v[220:223], a[148:151], a[124:127], v[220:223]
    s_waitcnt lgkmcnt(6)
    v_mfma_f32_16x16x32_bf16 v[224:227], a[152:155], a[112:115], v[224:227]
    ds_read_b64_tr_b16 a[136:137], v15 offset:32
    v_mfma_f32_16x16x32_bf16 v[228:231], a[152:155], a[116:119], v[228:231]
    ds_read_b64_tr_b16 a[138:139], v15 offset:1824
    v_mfma_f32_16x16x32_bf16 v[232:235], a[152:155], a[120:123], v[232:235]
    v_mfma_f32_16x16x32_bf16 v[236:239], a[152:155], a[124:127], v[236:239]
    s_waitcnt lgkmcnt(6)
    v_mfma_f32_16x16x32_bf16 v[240:243], a[156:159], a[112:115], v[240:243]
    ds_read_b64_tr_b16 a[140:141], v15 offset:14368
    v_mfma_f32_16x16x32_bf16 v[244:247], a[156:159], a[116:119], v[244:247]
    ds_read_b64_tr_b16 a[142:143], v15 offset:16160
    v_mfma_f32_16x16x32_bf16 v[248:251], a[156:159], a[120:123], v[248:251]
    v_mfma_f32_16x16x32_bf16 v[252:255], a[156:159], a[124:127], v[252:255]
L_fincode:
    s_waitcnt vmcnt(56)
    s_waitcnt lgkmcnt(6)
    v_mfma_f32_16x16x32_bf16 v[32:35], a[128:131], a[0:3], v[32:35]
    ds_read_b64_tr_b16 a[144:145], v15 offset:7168
    v_mfma_f32_16x16x32_bf16 v[36:39], a[128:131], a[4:7], v[36:39]
    ds_read_b64_tr_b16 a[146:147], v15 offset:8960
    s_lshl_b32 s58, s31, 2
    v_mfma_f32_16x16x32_bf16 v[40:43], a[128:131], a[8:11], v[40:43]
    s_add_u32 s58, s58, s3
    v_mfma_f32_16x16x32_bf16 v[44:47], a[128:131], a[12:15], v[44:47]
    s_waitcnt lgkmcnt(6)
    s_lshl_b32 s58, s58, 2
    v_mfma_f32_16x16x32_bf16 v[48:51], a[132:135], a[0:3], v[48:51]
    ds_read_b64_tr_b16 a[148:149], v15 offset:21504
    s_add_u32 s58, s58, s33
    v_mfma_f32_16x16x32_bf16 v[52:55], a[132:135], a[4:7], v[52:55]
    ds_read_b64_tr_b16 a[150:151], v15 offset:23296
    s_mul_i32 s41, s58, 114688
    v_mfma_f32_16x16x32_bf16 v[56:59], a[132:135], a[8:11], v[56:59]
    s_lshr_b32 s44, s34, 1
    v_mfma_f32_16x16x32_bf16 v[60:63], a[132:135], a[12:15], v[60:63]
    s_waitcnt lgkmcnt(6)
    s_add_u32 s44, s44, 8
    v_mfma_f32_16x16x32_bf16 v[64:67], a[136:139], a[0:3], v[64:67]
    ds_read_b64_tr_b16 a[152:153], v17 offset:0
    s_lshl_b32 s44, s44, 12
    v_mfma_f32_16x16x32_bf16 v[68:71], a[136:139], a[4:7], v[68:71]
    ds_read_b64_tr_b16 a[154:155], v17 offset:1792
    s_and_b32 s37, s34, 1
    v_mfma_f32_16x16x32_bf16 v[72:75], a[136:139], a[8:11], v[72:75]
    s_lshl_b32 s37, s37, 3
    v_mfma_f32_16x16x32_bf16 v[76:79], a[136:139], a[12:15], v[76:79]
    s_waitcnt lgkmcnt(6)
    s_add_u32 s44, s44, s37
    v_mfma_f32_16x16x32_bf16 v[80:83], a[140:143], a[0:3], v[80:83]
    ds_read_b64_tr_b16 a[156:157], v17 offset:14336
    s_add_u32 s44, s44, s41
    v_mfma_f32_16x16x32_bf16 v[84:87], a[140:143], a[4:7], v[84:87]
    ds_read_b64_tr_b16 a[158:159], v17 offset:16128
    s_lshl_b32 s37, s34, 12
    v_mfma_f32_16x16x32_bf16 v[88:91], a[140:143], a[8:11], v[88:91]
    s_add_u32 s37, s37, s41
    v_mfma_f32_16x16x32_bf16 v[92:95], a[140:143], a[12:15], v[92:95]
    s_waitcnt vmcnt(48)
    s_waitcnt lgkmcnt(6)
    s_add_u32 s38, s37, 49152
    v_mfma_f32_16x16x32_bf16 v[32:35], a[144:147], a[16:19], v[32:35]
    ds_read_b64_tr_b16 a[128:129], v17 offset:7168
    s_add_u32 s39, s37, 81920
    v_mfma_f32_16x16x32_bf16 v[36:39], a[144:147], a[20:23], v[36:39]
    ds_read_b64_tr_b16 a[130:131], v17 offset:8960
    v_mov_b32 v18, 0x409d30fc
    v_mfma_f32_16x16x32_bf16 v[40:43], a[144:147], a[24:27], v[40:43]
    s_lshl_b32 s60, s33, 8
    v_mfma_f32_16x16x32_bf16 v[44:47], a[144:147], a[28:31], v[44:47]
    s_waitcnt lgkmcnt(6)
    s_add_u32 s60, s60, s53
    v_mfma_f32_16x16x32_bf16 v[48:51], a[148:151], a[16:19], v[48:51]
    ds_read_b64_tr_b16 a[132:133], v17 offset:21504
    s_add_u32 s50, s60, 16
    v_mfma_f32_16x16x32_bf16 v[52:55], a[148:151], a[20:23], v[52:55]
    ds_read_b64_tr_b16 a[134:135], v17 offset:23296
    s_add_u32 s51, s60, 24
    v_mfma_f32_16x16x32_bf16 v[56:59], a[148:151], a[24:27], v[56:59]
    s_add_u32 s59, s60, 40
    v_mfma_f32_16x16x32_bf16 v[60:63], a[148:151], a[28:31], v[60:63]
    s_waitcnt vmcnt(31)
    s_waitcnt lgkmcnt(6)
    s_waitcnt vmcnt(3)
    s_barrier
    s_movk_i32 s49, 4100
    v_mfma_f32_16x16x32_bf16 v[32:35], a[152:155], a[176:179], v[32:35]
    ds_read_b64_tr_b16 a[136:137], v15 offset:28672
    s_and_b32 s43, s2, 7
    v_mfma_f32_16x16x32_bf16 v[36:39], a[152:155], a[180:183], v[36:39]
    ds_read_b64_tr_b16 a[138:139], v15 offset:30464
    s_lshl_b32 s43, s43, 8
    v_mfma_f32_16x16x32_bf16 v[40:43], a[152:155], a[184:187], v[40:43]
    s_add_u32 s43, s43, s49
    v_mfma_f32_16x16x32_bf16 v[44:47], a[152:155], a[188:191], v[44:47]
    s_waitcnt lgkmcnt(6)
    v_and_b32_e64 v29, 7, v0
    v_mfma_f32_16x16x32_bf16 v[48:51], a[156:159], a[176:179], v[48:51]
    ds_read_b64_tr_b16 a[140:141], v15 offset:43008
    v_lshlrev_b32_e64 v29, 8, v29
    v_mfma_f32_16x16x32_bf16 v[52:55], a[156:159], a[180:183], v[52:55]
    ds_read_b64_tr_b16 a[142:143], v15 offset:44800
    v_lshlrev_b32_e64 v28, 3, v0
    v_mfma_f32_16x16x32_bf16 v[56:59], a[156:159], a[184:187], v[56:59]
    v_add_u32 v27, 0x10000, v28
    v_mfma_f32_16x16x32_bf16 v[60:63], a[156:159], a[188:191], v[60:63]
    s_waitcnt vmcnt(24)
    s_waitcnt lgkmcnt(6)
    v_add_u32 v26, 0x20000, v28
    v_mfma_f32_16x16x32_bf16 v[32:35], a[128:131], a[160:163], v[32:35]
    ds_read_b64_tr_b16 a[144:145], v15 offset:35840
    s_lshl_b32 s48, s3, 12
    v_mfma_f32_16x16x32_bf16 v[36:39], a[128:131], a[164:167], v[36:39]
    ds_read_b64_tr_b16 a[146:147], v15 offset:37632
    s_lshl_b32 s40, s34, 2
    v_mfma_f32_16x16x32_bf16 v[40:43], a[128:131], a[168:171], v[40:43]
    s_add_u32 s40, s40, s33
    v_mfma_f32_16x16x32_bf16 v[44:47], a[128:131], a[172:175], v[44:47]
    s_waitcnt lgkmcnt(6)
    s_mul_i32 s40, s40, 229376
    v_mfma_f32_16x16x32_bf16 v[48:51], a[132:135], a[160:163], v[48:51]
    ds_read_b64_tr_b16 a[148:149], v15 offset:50176
    s_add_u32 s40, s40, s48
    v_mfma_f32_16x16x32_bf16 v[52:55], a[132:135], a[164:167], v[52:55]
    ds_read_b64_tr_b16 a[150:151], v15 offset:51968
    v_mfma_f32_16x16x32_bf16 v[56:59], a[132:135], a[168:171], v[56:59]
    v_mfma_f32_16x16x32_bf16 v[60:63], a[132:135], a[172:175], v[60:63]
    s_waitcnt vmcnt(39)
    s_waitcnt lgkmcnt(6)
    v_mfma_f32_16x16x32_bf16 v[32:35], a[136:139], a[32:35], v[32:35]
    ds_read_b64_tr_b16 a[152:153], v16 offset:0
    v_mfma_f32_16x16x32_bf16 v[36:39], a[136:139], a[36:39], v[36:39]
    ds_read_b64_tr_b16 a[154:155], v16 offset:1792
    v_mfma_f32_16x16x32_bf16 v[40:43], a[136:139], a[40:43], v[40:43]
    v_mfma_f32_16x16x32_bf16 v[44:47], a[136:139], a[44:47], v[44:47]
    s_waitcnt lgkmcnt(6)
    v_mfma_f32_16x16x32_bf16 v[48:51], a[140:143], a[32:35], v[48:51]
    ds_read_b64_tr_b16 a[156:157], v16 offset:14336
    v_mfma_f32_16x16x32_bf16 v[52:55], a[140:143], a[36:39], v[52:55]
    ds_read_b64_tr_b16 a[158:159], v16 offset:16128
    v_mfma_f32_16x16x32_bf16 v[56:59], a[140:143], a[40:43], v[56:59]
    v_mfma_f32_16x16x32_bf16 v[60:63], a[140:143], a[44:47], v[60:63]
    s_waitcnt vmcnt(15)
    s_waitcnt lgkmcnt(6)
    v_mfma_f32_16x16x32_bf16 v[32:35], a[144:147], a[48:51], v[32:35]
    ds_read_b64_tr_b16 a[128:129], v16 offset:7168
    v_mfma_f32_16x16x32_bf16 v[36:39], a[144:147], a[52:55], v[36:39]
    ds_read_b64_tr_b16 a[130:131], v16 offset:8960
    v_mfma_f32_16x16x32_bf16 v[40:43], a[144:147], a[56:59], v[40:43]
    v_mfma_f32_16x16x32_bf16 v[44:47], a[144:147], a[60:63], v[44:47]
    s_waitcnt lgkmcnt(6)
    v_mfma_f32_16x16x32_bf16 v[48:51], a[148:151], a[48:51], v[48:51]
    ds_read_b64_tr_b16 a[132:133], v16 offset:21504
    v_mfma_f32_16x16x32_bf16 v[52:55], a[148:151], a[52:55], v[52:55]
    ds_read_b64_tr_b16 a[134:135], v16 offset:23296
    v_mfma_f32_16x16x32_bf16 v[56:59], a[148:151], a[56:59], v[56:59]
    v_mfma_f32_16x16x32_bf16 v[60:63], a[148:151], a[60:63], v[60:63]
    s_waitcnt vmcnt(11)
    s_waitcnt lgkmcnt(6)
    v_mfma_f32_16x16x32_bf16 v[32:35], a[152:155], a[64:67], v[32:35]
    ds_read_b64_tr_b16 a[136:137], v15 offset:7200
    v_mfma_f32_16x16x32_bf16 v[36:39], a[152:155], a[68:71], v[36:39]
    ds_read_b64_tr_b16 a[138:139], v15 offset:8992
    v_mfma_f32_16x16x32_bf16 v[40:43], a[152:155], a[72:75], v[40:43]
    v_mfma_f32_16x16x32_bf16 v[44:47], a[152:155], a[76:79], v[44:47]
    s_waitcnt lgkmcnt(6)
    v_mfma_f32_16x16x32_bf16 v[48:51], a[156:159], a[64:67], v[48:51]
    ds_read_b64_tr_b16 a[140:141], v15 offset:21536
    v_mfma_f32_16x16x32_bf16 v[52:55], a[156:159], a[68:71], v[52:55]
    ds_read_b64_tr_b16 a[142:143], v15 offset:23328
    v_mfma_f32_16x16x32_bf16 v[56:59], a[156:159], a[72:75], v[56:59]
    v_mfma_f32_16x16x32_bf16 v[60:63], a[156:159], a[76:79], v[60:63]
    s_waitcnt vmcnt(0)
    s_waitcnt lgkmcnt(6)
    v_mfma_f32_16x16x32_bf16 v[32:35], a[128:131], a[80:83], v[32:35]
    ds_read_b64_tr_b16 a[144:145], v15 offset:28704
    v_mfma_f32_16x16x32_bf16 v[36:39], a[128:131], a[84:87], v[36:39]
    ds_read_b64_tr_b16 a[146:147], v15 offset:30496
    v_mfma_f32_16x16x32_bf16 v[40:43], a[128:131], a[88:91], v[40:43]
    v_mfma_f32_16x16x32_bf16 v[44:47], a[128:131], a[92:95], v[44:47]
    s_waitcnt lgkmcnt(6)
    v_mfma_f32_16x16x32_bf16 v[48:51], a[132:135], a[80:83], v[48:51]
    ds_read_b64_tr_b16 a[148:149], v15 offset:43040
    v_mfma_f32_16x16x32_bf16 v[52:55], a[132:135], a[84:87], v[52:55]
    ds_read_b64_tr_b16 a[150:151], v15 offset:44832
    v_mfma_f32_16x16x32_bf16 v[56:59], a[132:135], a[88:91], v[56:59]
    v_mfma_f32_16x16x32_bf16 v[60:63], a[132:135], a[92:95], v[60:63]
    s_waitcnt lgkmcnt(6)
    v_mfma_f32_16x16x32_bf16 v[64:67], a[136:139], a[16:19], v[64:67]
    ds_read_b64_tr_b16 a[152:153], v15 offset:35872
    v_mfma_f32_16x16x32_bf16 v[68:71], a[136:139], a[20:23], v[68:71]
    ds_read_b64_tr_b16 a[154:155], v15 offset:37664
    s_cmp_lg_u32 s3, 0
    s_cbranch_scc1 L_wf_14
    s_mov_b64 exec, 1
    v_mov_b32 v3, 0
    v_mov_b32_e64 v4, 1
    buffer_atomic_add v4, v3, s[24:27], s43 offen sc1
    s_mov_b64 exec, -1
L_wf_14:
    v_mfma_f32_16x16x32_bf16 v[72:75], a[136:139], a[24:27], v[72:75]
    v_mfma_f32_16x16x32_bf16 v[76:79], a[136:139], a[28:31], v[76:79]
    s_waitcnt lgkmcnt(6)
    v_pk_fma_f32 v[20:21], v[32:33], v[32:33], v[18:19] op_sel_hi:[1,1,0]
    v_pk_mul_f32 v[48:49], v[32:33], v[48:49]
    v_pk_mul_f32 v[32:33], v[20:21], v[32:33]
    v_pk_fma_f32 v[22:23], v[34:35], v[34:35], v[18:19] op_sel_hi:[1,1,0]
    v_pk_mul_f32 v[50:51], v[34:35], v[50:51]
    v_pk_mul_f32 v[34:35], v[22:23], v[34:35]
    v_pk_fma_f32 v[24:25], v[36:37], v[36:37], v[18:19] op_sel_hi:[1,1,0]
    v_pk_mul_f32 v[52:53], v[36:37], v[52:53]
    v_pk_mul_f32 v[36:37], v[24:25], v[36:37]
    v_pk_fma_f32 v[20:21], v[38:39], v[38:39], v[18:19] op_sel_hi:[1,1,0]
    v_pk_mul_f32 v[54:55], v[38:39], v[54:55]
    v_pk_mul_f32 v[38:39], v[20:21], v[38:39]
    v_pk_fma_f32 v[22:23], v[40:41], v[40:41], v[18:19] op_sel_hi:[1,1,0]
    v_pk_mul_f32 v[56:57], v[40:41], v[56:57]
    v_pk_mul_f32 v[40:41], v[22:23], v[40:41]
    v_pk_fma_f32 v[24:25], v[42:43], v[42:43], v[18:19] op_sel_hi:[1,1,0]
    v_pk_mul_f32 v[58:59], v[42:43], v[58:59]
    v_pk_mul_f32 v[42:43], v[24:25], v[42:43]
    v_pk_fma_f32 v[20:21], v[44:45], v[44:45], v[18:19] op_sel_hi:[1,1,0]
    v_pk_mul_f32 v[60:61], v[44:45], v[60:61]
    v_pk_mul_f32 v[44:45], v[20:21], v[44:45]
    v_pk_fma_f32 v[22:23], v[46:47], v[46:47], v[18:19] op_sel_hi:[1,1,0]
    v_pk_mul_f32 v[62:63], v[46:47], v[62:63]
    v_pk_mul_f32 v[46:47], v[22:23], v[46:47]
    v_exp_f32 v32, -v32
    v_exp_f32 v33, -v33
    v_exp_f32 v34, -v34
    v_exp_f32 v35, -v35
    v_exp_f32 v36, -v36
    v_mfma_f32_16x16x32_bf16 v[80:83], a[140:143], a[16:19], v[80:83]
    ds_read_b64_tr_b16 a[156:157], v15 offset:50208
    v_add_f32_e64 v32, 1.0, v32
    v_mfma_f32_16x16x32_bf16 v[84:87], a[140:143], a[20:23], v[84:87]
    ds_read_b64_tr_b16 a[158:159], v15 offset:52000
    v_add_f32_e64 v33, 1.0, v33
    v_mfma_f32_16x16x32_bf16 v[88:91], a[140:143], a[24:27], v[88:91]
    v_exp_f32 v37, -v37
    v_mfma_f32_16x16x32_bf16 v[92:95], a[140:143], a[28:31], v[92:95]
    s_waitcnt lgkmcnt(6)
    v_exp_f32 v38, -v38
    v_mfma_f32_16x16x32_bf16 v[64:67], a[144:147], a[32:35], v[64:67]
    ds_read_b64_tr_b16 a[128:129], v16 offset:32
    v_add_f32 v34, 1.0, v34
    v_mfma_f32_16x16x32_bf16 v[68:71], a[144:147], a[36:39], v[68:71]
    ds_read_b64_tr_b16 a[130:131], v16 offset:1824
    v_add_f32_e64 v35, 1.0, v35
    v_mfma_f32_16x16x32_bf16 v[72:75], a[144:147], a[40:43], v[72:75]
    v_exp_f32 v39, -v39
    v_mfma_f32_16x16x32_bf16 v[76:79], a[144:147], a[44:47], v[76:79]
    s_waitcnt lgkmcnt(6)
    v_exp_f32 v40, -v40
    v_mfma_f32_16x16x32_bf16 v[80:83], a[148:151], a[32:35], v[80:83]
    ds_read_b64_tr_b16 a[132:133], v16 offset:14368
    v_add_f32 v36, 1.0, v36
    v_mfma_f32_16x16x32_bf16 v[84:87], a[148:151], a[36:39], v[84:87]
    ds_read_b64_tr_b16 a[134:135], v16 offset:16160
    v_add_f32_e64 v37, 1.0, v37
    v_mfma_f32_16x16x32_bf16 v[88:91], a[148:151], a[40:43], v[88:91]
    v_exp_f32 v41, -v41
    v_mfma_f32_16x16x32_bf16 v[92:95], a[148:151], a[44:47], v[92:95]
    s_waitcnt lgkmcnt(6)
    v_exp_f32 v42, -v42
    v_mfma_f32_16x16x32_bf16 v[64:67], a[152:155], a[48:51], v[64:67]
    ds_read_b64_tr_b16 a[136:137], v16 offset:7200
    v_add_f32 v38, 1.0, v38
    v_mfma_f32_16x16x32_bf16 v[68:71], a[152:155], a[52:55], v[68:71]
    ds_read_b64_tr_b16 a[138:139], v16 offset:8992
    v_add_f32_e64 v39, 1.0, v39
    v_mfma_f32_16x16x32_bf16 v[72:75], a[152:155], a[56:59], v[72:75]
    v_exp_f32 v43, -v43
    v_mfma_f32_16x16x32_bf16 v[76:79], a[152:155], a[60:63], v[76:79]
    s_waitcnt lgkmcnt(6)
    v_exp_f32 v44, -v44
    v_mfma_f32_16x16x32_bf16 v[80:83], a[156:159], a[48:51], v[80:83]
    ds_read_b64_tr_b16 a[140:141], v16 offset:21536
    v_add_f32 v40, 1.0, v40
    v_mfma_f32_16x16x32_bf16 v[84:87], a[156:159], a[52:55], v[84:87]
    ds_read_b64_tr_b16 a[142:143], v16 offset:23328
    v_add_f32_e64 v41, 1.0, v41
    v_mfma_f32_16x16x32_bf16 v[88:91], a[156:159], a[56:59], v[88:91]
    v_exp_f32 v45, -v45
    v_mfma_f32_16x16x32_bf16 v[92:95], a[156:159], a[60:63], v[92:95]
    s_waitcnt lgkmcnt(6)
    v_exp_f32 v46, -v46
    v_mfma_f32_16x16x32_bf16 v[64:67], a[128:131], a[64:67], v[64:67]
    ds_read_b64_tr_b16 a[144:145], v17 offset:32
    v_add_f32 v42, 1.0, v42
    v_mfma_f32_16x16x32_bf16 v[68:71], a[128:131], a[68:71], v[68:71]
    ds_read_b64_tr_b16 a[146:147], v17 offset:1824
    v_add_f32_e64 v43, 1.0, v43
    v_mfma_f32_16x16x32_bf16 v[72:75], a[128:131], a[72:75], v[72:75]
    v_exp_f32 v47, -v47
    v_mfma_f32_16x16x32_bf16 v[76:79], a[128:131], a[76:79], v[76:79]
    s_waitcnt lgkmcnt(6)
    v_rcp_f32 v32, v32
    v_mfma_f32_16x16x32_bf16 v[80:83], a[132:135], a[64:67], v[80:83]
    ds_read_b64_tr_b16 a[148:149], v17 offset:14368
    v_add_f32_e64 v44, 1.0, v44
    v_mfma_f32_16x16x32_bf16 v[84:87], a[132:135], a[68:71], v[84:87]
    ds_read_b64_tr_b16 a[150:151], v17 offset:16160
    v_add_f32_e64 v45, 1.0, v45
    v_mfma_f32_16x16x32_bf16 v[88:91], a[132:135], a[72:75], v[88:91]
    v_rcp_f32_e64 v33, v33
    v_mfma_f32_16x16x32_bf16 v[92:95], a[132:135], a[76:79], v[92:95]
    s_waitcnt lgkmcnt(6)
    v_rcp_f32 v34, v34
    v_mfma_f32_16x16x32_bf16 v[64:67], a[136:139], a[80:83], v[64:67]
    ds_read_b64_tr_b16 a[152:153], v17 offset:7200
    v_add_f32_e64 v46, 1.0, v46
    v_mfma_f32_16x16x32_bf16 v[68:71], a[136:139], a[84:87], v[68:71]
    ds_read_b64_tr_b16 a[154:155], v17 offset:8992
    v_add_f32_e64 v47, 1.0, v47
    v_mfma_f32_16x16x32_bf16 v[72:75], a[136:139], a[88:91], v[72:75]
    v_rcp_f32_e64 v35, v35
    v_mfma_f32_16x16x32_bf16 v[76:79], a[136:139], a[92:95], v[76:79]
    s_waitcnt lgkmcnt(6)
    v_rcp_f32 v36, v36
    v_mfma_f32_16x16x32_bf16 v[80:83], a[140:143], a[80:83], v[80:83]
    ds_read_b64_tr_b16 a[156:157], v17 offset:21536
    v_mfma_f32_16x16x32_bf16 v[84:87], a[140:143], a[84:87], v[84:87]
    ds_read_b64_tr_b16 a[158:159], v17 offset:23328
    v_mfma_f32_16x16x32_bf16 v[88:91], a[140:143], a[88:91], v[88:91]
    v_rcp_f32_e64 v37, v37
    v_mfma_f32_16x16x32_bf16 v[92:95], a[140:143], a[92:95], v[92:95]
    s_waitcnt lgkmcnt(6)
    v_rcp_f32 v38, v38
    v_mfma_f32_16x16x32_bf16 v[64:67], a[144:147], a[176:179], v[64:67]
    ds_read_b64_tr_b16 a[128:129], v15 offset:192
    v_mfma_f32_16x16x32_bf16 v[68:71], a[144:147], a[180:183], v[68:71]
    ds_read_b64_tr_b16 a[130:131], v15 offset:1984
    v_mfma_f32_16x16x32_bf16 v[72:75], a[144:147], a[184:187], v[72:75]
    v_rcp_f32_e64 v39, v39
    v_mfma_f32_16x16x32_bf16 v[76:79], a[144:147], a[188:191], v[76:79]
    s_waitcnt lgkmcnt(6)
    v_rcp_f32 v40, v40
    v_mfma_f32_16x16x32_bf16 v[80:83], a[148:151], a[176:179], v[80:83]
    ds_read_b64_tr_b16 a[132:133], v15 offset:14528
    v_mfma_f32_16x16x32_bf16 v[84:87], a[148:151], a[180:183], v[84:87]
    ds_read_b64_tr_b16 a[134:135], v15 offset:16320
    v_mfma_f32_16x16x32_bf16 v[88:91], a[148:151], a[184:187], v[88:91]
    v_rcp_f32_e64 v41, v41
    v_mfma_f32_16x16x32_bf16 v[92:95], a[148:151], a[188:191], v[92:95]
    s_waitcnt lgkmcnt(6)
    v_rcp_f32 v42, v42
    v_mfma_f32_16x16x32_bf16 v[64:67], a[152:155], a[160:163], v[64:67]
    ds_read_b64_tr_b16 a[136:137], v15 offset:7360
    v_mfma_f32_16x16x32_bf16 v[68:71], a[152:155], a[164:167], v[68:71]
    ds_read_b64_tr_b16 a[138:139], v15 offset:9152
    v_mfma_f32_16x16x32_bf16 v[72:75], a[152:155], a[168:171], v[72:75]
    v_rcp_f32_e64 v43, v43
    v_mfma_f32_16x16x32_bf16 v[76:79], a[152:155], a[172:175], v[76:79]
    s_waitcnt lgkmcnt(6)
    v_rcp_f32 v44, v44
    v_mfma_f32_16x16x32_bf16 v[80:83], a[156:159], a[160:163], v[80:83]
    ds_read_b64_tr_b16 a[140:141], v15 offset:21696
    v_mfma_f32_16x16x32_bf16 v[84:87], a[156:159], a[164:167], v[84:87]
    ds_read_b64_tr_b16 a[142:143], v15 offset:23488
    v_mfma_f32_16x16x32_bf16 v[88:91], a[156:159], a[168:171], v[88:91]
    v_rcp_f32_e64 v45, v45
    v_mfma_f32_16x16x32_bf16 v[92:95], a[156:159], a[172:175], v[92:95]
    s_waitcnt lgkmcnt(6)
    v_rcp_f32 v46, v46
    v_mfma_f32_16x16x32_bf16 v[224:227], a[128:131], a[0:3], v[224:227]
    ds_read_b64_tr_b16 a[144:145], v15 offset:28864
    v_mfma_f32_16x16x32_bf16 v[228:231], a[128:131], a[4:7], v[228:231]
    ds_read_b64_tr_b16 a[146:147], v15 offset:30656
    v_mfma_f32_16x16x32_bf16 v[232:235], a[128:131], a[8:11], v[232:235]
    v_rcp_f32_e64 v47, v47
    v_mfma_f32_16x16x32_bf16 v[236:239], a[128:131], a[12:15], v[236:239]
    s_waitcnt lgkmcnt(6)
    v_pk_fma_f32 v[20:21], v[64:65], v[64:65], v[18:19] op_sel_hi:[1,1,0]
    v_pk_mul_f32 v[80:81], v[64:65], v[80:81]
    v_pk_mul_f32 v[64:65], v[20:21], v[64:65]
    v_pk_fma_f32 v[22:23], v[66:67], v[66:67], v[18:19] op_sel_hi:[1,1,0]
    v_pk_mul_f32 v[82:83], v[66:67], v[82:83]
    v_pk_mul_f32 v[66:67], v[22:23], v[66:67]
    v_pk_fma_f32 v[24:25], v[68:69], v[68:69], v[18:19] op_sel_hi:[1,1,0]
    v_pk_mul_f32 v[84:85], v[68:69], v[84:85]
    v_pk_mul_f32 v[68:69], v[24:25], v[68:69]
    v_pk_fma_f32 v[20:21], v[70:71], v[70:71], v[18:19] op_sel_hi:[1,1,0]
    v_pk_mul_f32 v[86:87], v[70:71], v[86:87]
    v_pk_mul_f32 v[70:71], v[20:21], v[70:71]
    v_pk_fma_f32 v[22:23], v[72:73], v[72:73], v[18:19] op_sel_hi:[1,1,0]
    v_pk_mul_f32 v[88:89], v[72:73], v[88:89]
    v_pk_mul_f32 v[72:73], v[22:23], v[72:73]
    v_pk_fma_f32 v[24:25], v[74:75], v[74:75], v[18:19] op_sel_hi:[1,1,0]
    v_pk_mul_f32 v[90:91], v[74:75], v[90:91]
    v_pk_mul_f32 v[74:75], v[24:25], v[74:75]
    v_pk_fma_f32 v[20:21], v[76:77], v[76:77], v[18:19] op_sel_hi:[1,1,0]
    v_pk_mul_f32 v[92:93], v[76:77], v[92:93]
    v_pk_mul_f32 v[76:77], v[20:21], v[76:77]
    v_pk_fma_f32 v[22:23], v[78:79], v[78:79], v[18:19] op_sel_hi:[1,1,0]
    v_pk_mul_f32 v[94:95], v[78:79], v[94:95]
    v_pk_mul_f32 v[78:79], v[22:23], v[78:79]
    v_pk_mul_f32 v[48:49], v[48:49], v[32:33]
    v_pk_mul_f32 v[50:51], v[50:51], v[34:35]
    v_pk_mul_f32 v[52:53], v[52:53], v[36:37]
    v_pk_mul_f32 v[54:55], v[54:55], v[38:39]
    v_pk_mul_f32 v[56:57], v[56:57], v[40:41]
    v_pk_mul_f32 v[58:59], v[58:59], v[42:43]
    v_pk_mul_f32 v[60:61], v[60:61], v[44:45]
    v_pk_mul_f32 v[62:63], v[62:63], v[46:47]
    v_exp_f32 v64, -v64
    v_mfma_f32_16x16x32_bf16 v[240:243], a[132:135], a[0:3], v[240:243]
    ds_read_b64_tr_b16 a[148:149], v15 offset:43200
    v_cvt_pk_bf16_f32 v32, v48, v49
    v_mfma_f32_16x16x32_bf16 v[244:247], a[132:135], a[4:7], v[244:247]
    ds_read_b64_tr_b16 a[150:151], v15 offset:44992
    v_cvt_pk_bf16_f32 v33, v50, v51
    v_mfma_f32_16x16x32_bf16 v[248:251], a[132:135], a[8:11], v[248:251]
    v_exp_f32 v65, -v65
    v_mfma_f32_16x16x32_bf16 v[252:255], a[132:135], a[12:15], v[252:255]
    s_waitcnt lgkmcnt(6)
    v_exp_f32 v66, -v66
    v_mfma_f32_16x16x32_bf16 v[224:227], a[136:139], a[16:19], v[224:227]
    ds_read_b64_tr_b16 a[152:153], v15 offset:36032
    v_cvt_pk_bf16_f32 v36, v52, v53
    v_mfma_f32_16x16x32_bf16 v[228:231], a[136:139], a[20:23], v[228:231]
    ds_read_b64_tr_b16 a[154:155], v15 offset:37824
    v_cvt_pk_bf16_f32 v37, v54, v55
    v_mfma_f32_16x16x32_bf16 v[232:235], a[136:139], a[24:27], v[232:235]
    v_exp_f32 v67, -v67
    v_mfma_f32_16x16x32_bf16 v[236:239], a[136:139], a[28:31], v[236:239]
    s_waitcnt lgkmcnt(6)
    v_exp_f32 v68, -v68
    v_mfma_f32_16x16x32_bf16 v[240:243], a[140:143], a[16:19], v[240:243]
    ds_read_b64_tr_b16 a[156:157], v15 offset:50368
    v_cvt_pk_bf16_f32 v40, v56, v57
    v_mfma_f32_16x16x32_bf16 v[244:247], a[140:143], a[20:23], v[244:247]
    ds_read_b64_tr_b16 a[158:159], v15 offset:52160
    v_cvt_pk_bf16_f32 v41, v58, v59
    v_mfma_f32_16x16x32_bf16 v[248:251], a[140:143], a[24:27], v[248:251]
    v_exp_f32 v69, -v69
    v_mfma_f32_16x16x32_bf16 v[252:255], a[140:143], a[28:31], v[252:255]
    s_waitcnt lgkmcnt(6)
    v_exp_f32 v70, -v70
    v_mfma_f32_16x16x32_bf16 v[224:227], a[144:147], a[32:35], v[224:227]
    ds_read_b64_tr_b16 a[128:129], v16 offset:192
    v_cvt_pk_bf16_f32 v44, v60, v61
    v_mfma_f32_16x16x32_bf16 v[228:231], a[144:147], a[36:39], v[228:231]
    ds_read_b64_tr_b16 a[130:131], v16 offset:1984
    v_cvt_pk_bf16_f32 v45, v62, v63
    v_mfma_f32_16x16x32_bf16 v[232:235], a[144:147], a[40:43], v[232:235]
    v_exp_f32 v71, -v71
    v_mfma_f32_16x16x32_bf16 v[236:239], a[144:147], a[44:47], v[236:239]
    s_waitcnt lgkmcnt(6)
    v_exp_f32 v72, -v72
    v_mfma_f32_16x16x32_bf16 v[240:243], a[148:151], a[32:35], v[240:243]
    ds_read_b64_tr_b16 a[132:133], v16 offset:14528
    v_add_f32 v64, 1.0, v64
    v_mfma_f32_16x16x32_bf16 v[244:247], a[148:151], a[36:39], v[244:247]
    ds_read_b64_tr_b16 a[134:135], v16 offset:16320
    v_add_f32_e64 v65, 1.0, v65
    v_mfma_f32_16x16x32_bf16 v[248:251], a[148:151], a[40:43], v[248:251]
    v_exp_f32 v73, -v73
    v_mfma_f32_16x16x32_bf16 v[252:255], a[148:151], a[44:47], v[252:255]
    s_waitcnt lgkmcnt(6)
    v_exp_f32 v74, -v74
    v_mfma_f32_16x16x32_bf16 v[224:227], a[152:155], a[48:51], v[224:227]
    ds_read_b64_tr_b16 a[136:137], v16 offset:7360
    v_add_f32 v66, 1.0, v66
    v_mfma_f32_16x16x32_bf16 v[228:231], a[152:155], a[52:55], v[228:231]
    ds_read_b64_tr_b16 a[138:139], v16 offset:9152
    v_add_f32_e64 v67, 1.0, v67
    v_mfma_f32_16x16x32_bf16 v[232:235], a[152:155], a[56:59], v[232:235]
    v_exp_f32 v75, -v75
    v_mfma_f32_16x16x32_bf16 v[236:239], a[152:155], a[60:63], v[236:239]
    s_waitcnt lgkmcnt(6)
    v_exp_f32 v76, -v76
    v_mfma_f32_16x16x32_bf16 v[240:243], a[156:159], a[48:51], v[240:243]
    ds_read_b64_tr_b16 a[140:141], v16 offset:21696
    v_add_f32 v68, 1.0, v68
    v_mfma_f32_16x16x32_bf16 v[244:247], a[156:159], a[52:55], v[244:247]
    ds_read_b64_tr_b16 a[142:143], v16 offset:23488
    v_add_f32_e64 v69, 1.0, v69
    v_mfma_f32_16x16x32_bf16 v[248:251], a[156:159], a[56:59], v[248:251]
    v_exp_f32 v77, -v77
    v_mfma_f32_16x16x32_bf16 v[252:255], a[156:159], a[60:63], v[252:255]
    s_waitcnt lgkmcnt(6)
    v_exp_f32 v78, -v78
    v_mfma_f32_16x16x32_bf16 v[224:227], a[128:131], a[64:67], v[224:227]
    ds_read_b64_tr_b16 a[144:145], v17 offset:192
    v_add_f32 v70, 1.0, v70
    v_mfma_f32_16x16x32_bf16 v[228:231], a[128:131], a[68:71], v[228:231]
    ds_read_b64_tr_b16 a[146:147], v17 offset:1984
    v_add_f32_e64 v71, 1.0, v71
    v_mfma_f32_16x16x32_bf16 v[232:235], a[128:131], a[72:75], v[232:235]
    v_exp_f32 v79, -v79
    v_mfma_f32_16x16x32_bf16 v[236:239], a[128:131], a[76:79], v[236:239]
    s_waitcnt lgkmcnt(6)
    v_rcp_f32 v64, v64
    v_mfma_f32_16x16x32_bf16 v[240:243], a[132:135], a[64:67], v[240:243]
    ds_read_b64_tr_b16 a[148:149], v17 offset:14528
    v_add_f32_e64 v72, 1.0, v72
    v_mfma_f32_16x16x32_bf16 v[244:247], a[132:135], a[68:71], v[244:247]
    ds_read_b64_tr_b16 a[150:151], v17 offset:16320
    v_add_f32_e64 v73, 1.0, v73
    v_mfma_f32_16x16x32_bf16 v[248:251], a[132:135], a[72:75], v[248:251]
    v_rcp_f32_e64 v65, v65
    v_mfma_f32_16x16x32_bf16 v[252:255], a[132:135], a[76:79], v[252:255]
    s_waitcnt lgkmcnt(6)
    v_rcp_f32 v66, v66
    v_mfma_f32_16x16x32_bf16 v[224:227], a[136:139], a[80:83], v[224:227]
    ds_read_b64_tr_b16 a[152:153], v17 offset:7360
    v_add_f32_e64 v74, 1.0, v74
    v_mfma_f32_16x16x32_bf16 v[228:231], a[136:139], a[84:87], v[228:231]
    ds_read_b64_tr_b16 a[154:155], v17 offset:9152
    v_add_f32_e64 v75, 1.0, v75
    v_mfma_f32_16x16x32_bf16 v[232:235], a[136:139], a[88:91], v[232:235]
    v_rcp_f32_e64 v67, v67
    v_mfma_f32_16x16x32_bf16 v[236:239], a[136:139], a[92:95], v[236:239]
    s_waitcnt lgkmcnt(6)
    v_rcp_f32 v68, v68
    v_mfma_f32_16x16x32_bf16 v[240:243], a[140:143], a[80:83], v[240:243]
    ds_read_b64_tr_b16 a[156:157], v17 offset:21696
    v_add_f32_e64 v76, 1.0, v76
    v_mfma_f32_16x16x32_bf16 v[244:247], a[140:143], a[84:87], v[244:247]
    ds_read_b64_tr_b16 a[158:159], v17 offset:23488
    v_add_f32_e64 v77, 1.0, v77
    v_mfma_f32_16x16x32_bf16 v[248:251], a[140:143], a[88:91], v[248:251]
    v_rcp_f32_e64 v69, v69
    v_mfma_f32_16x16x32_bf16 v[252:255], a[140:143], a[92:95], v[252:255]
    s_waitcnt lgkmcnt(6)
    v_rcp_f32 v70, v70
    v_mfma_f32_16x16x32_bf16 v[224:227], a[144:147], a[176:179], v[224:227]
    ds_read_b64_tr_b16 a[128:129], v15 offset:64
    v_add_f32_e64 v78, 1.0, v78
    v_mfma_f32_16x16x32_bf16 v[228:231], a[144:147], a[180:183], v[228:231]
    ds_read_b64_tr_b16 a[130:131], v15 offset:1856
    v_add_f32_e64 v79, 1.0, v79
    v_mfma_f32_16x16x32_bf16 v[232:235], a[144:147], a[184:187], v[232:235]
    v_rcp_f32_e64 v71, v71
    v_mfma_f32_16x16x32_bf16 v[236:239], a[144:147], a[188:191], v[236:239]
    s_waitcnt lgkmcnt(6)
    v_rcp_f32 v72, v72
    v_mfma_f32_16x16x32_bf16 v[240:243], a[148:151], a[176:179], v[240:243]
    ds_read_b64_tr_b16 a[132:133], v15 offset:14400
    v_mfma_f32_16x16x32_bf16 v[244:247], a[148:151], a[180:183], v[244:247]
    ds_read_b64_tr_b16 a[134:135], v15 offset:16192
    v_mfma_f32_16x16x32_bf16 v[248:251], a[148:151], a[184:187], v[248:251]
    v_rcp_f32_e64 v73, v73
    v_mfma_f32_16x16x32_bf16 v[252:255], a[148:151], a[188:191], v[252:255]
    s_waitcnt lgkmcnt(6)
    v_rcp_f32 v74, v74
    v_mfma_f32_16x16x32_bf16 v[224:227], a[152:155], a[160:163], v[224:227]
    ds_read_b64_tr_b16 a[136:137], v15 offset:7232
    v_mfma_f32_16x16x32_bf16 v[228:231], a[152:155], a[164:167], v[228:231]
    ds_read_b64_tr_b16 a[138:139], v15 offset:9024
    v_mfma_f32_16x16x32_bf16 v[232:235], a[152:155], a[168:171], v[232:235]
    v_rcp_f32_e64 v75, v75
    v_mfma_f32_16x16x32_bf16 v[236:239], a[152:155], a[172:175], v[236:239]
    s_waitcnt lgkmcnt(6)
    v_rcp_f32 v76, v76
    v_mfma_f32_16x16x32_bf16 v[240:243], a[156:159], a[160:163], v[240:243]
    ds_read_b64_tr_b16 a[140:141], v15 offset:21568
    v_mfma_f32_16x16x32_bf16 v[244:247], a[156:159], a[164:167], v[244:247]
    ds_read_b64_tr_b16 a[142:143], v15 offset:23360
    v_mfma_f32_16x16x32_bf16 v[248:251], a[156:159], a[168:171], v[248:251]
    v_rcp_f32_e64 v77, v77
    v_mfma_f32_16x16x32_bf16 v[252:255], a[156:159], a[172:175], v[252:255]
    s_waitcnt lgkmcnt(6)
    v_rcp_f32 v78, v78
    v_mfma_f32_16x16x32_bf16 v[96:99], a[128:131], a[0:3], v[96:99]
    ds_read_b64_tr_b16 a[144:145], v15 offset:28736
    v_mfma_f32_16x16x32_bf16 v[100:103], a[128:131], a[4:7], v[100:103]
    ds_read_b64_tr_b16 a[146:147], v15 offset:30528
    v_mfma_f32_16x16x32_bf16 v[104:107], a[128:131], a[8:11], v[104:107]
    v_rcp_f32_e64 v79, v79
    v_mfma_f32_16x16x32_bf16 v[108:111], a[128:131], a[12:15], v[108:111]
    s_waitcnt lgkmcnt(6)
    v_pk_fma_f32 v[20:21], v[224:225], v[224:225], v[18:19] op_sel_hi:[1,1,0]
    v_pk_mul_f32 v[240:241], v[224:225], v[240:241]
    v_pk_mul_f32 v[224:225], v[20:21], v[224:225]
    v_pk_fma_f32 v[22:23], v[226:227], v[226:227], v[18:19] op_sel_hi:[1,1,0]
    v_pk_mul_f32 v[242:243], v[226:227], v[242:243]
    v_pk_mul_f32 v[226:227], v[22:23], v[226:227]
    v_pk_fma_f32 v[24:25], v[228:229], v[228:229], v[18:19] op_sel_hi:[1,1,0]
    v_pk_mul_f32 v[244:245], v[228:229], v[244:245]
    v_pk_mul_f32 v[228:229], v[24:25], v[228:229]
    v_pk_fma_f32 v[20:21], v[230:231], v[230:231], v[18:19] op_sel_hi:[1,1,0]
    v_pk_mul_f32 v[246:247], v[230:231], v[246:247]
    v_pk_mul_f32 v[230:231], v[20:21], v[230:231]
    v_pk_fma_f32 v[22:23], v[232:233], v[232:233], v[18:19] op_sel_hi:[1,1,0]
    v_pk_mul_f32 v[248:249], v[232:233], v[248:249]
    v_pk_mul_f32 v[232:233], v[22:23], v[232:233]
    v_pk_fma_f32 v[24:25], v[234:235], v[234:235], v[18:19] op_sel_hi:[1,1,0]
    v_pk_mul_f32 v[250:251], v[234:235], v[250:251]
    v_pk_mul_f32 v[234:235], v[24:25], v[234:235]
    v_pk_fma_f32 v[20:21], v[236:237], v[236:237], v[18:19] op_sel_hi:[1,1,0]
    v_pk_mul_f32 v[252:253], v[236:237], v[252:253]
    v_pk_mul_f32 v[236:237], v[20:21], v[236:237]
    v_pk_fma_f32 v[22:23], v[238:239], v[238:239], v[18:19] op_sel_hi:[1,1,0]
    v_pk_mul_f32 v[254:255], v[238:239], v[254:255]
    v_pk_mul_f32 v[238:239], v[22:23], v[238:239]
    v_pk_mul_f32 v[80:81], v[80:81], v[64:65]
    v_pk_mul_f32 v[82:83], v[82:83], v[66:67]
    v_pk_mul_f32 v[84:85], v[84:85], v[68:69]
    v_pk_mul_f32 v[86:87], v[86:87], v[70:71]
    v_pk_mul_f32 v[88:89], v[88:89], v[72:73]
    v_pk_mul_f32 v[90:91], v[90:91], v[74:75]
    v_pk_mul_f32 v[92:93], v[92:93], v[76:77]
    v_pk_mul_f32 v[94:95], v[94:95], v[78:79]
    v_exp_f32 v224, -v224
    v_mfma_f32_16x16x32_bf16 v[112:115], a[132:135], a[0:3], v[112:115]
    ds_read_b64_tr_b16 a[148:149], v15 offset:43072
    v_cvt_pk_bf16_f32 v34, v80, v81
    v_mfma_f32_16x16x32_bf16 v[116:119], a[132:135], a[4:7], v[116:119]
    ds_read_b64_tr_b16 a[150:151], v15 offset:44864
    v_cvt_pk_bf16_f32 v35, v82, v83
    v_mfma_f32_16x16x32_bf16 v[120:123], a[132:135], a[8:11], v[120:123]
    v_exp_f32 v225, -v225
    v_mfma_f32_16x16x32_bf16 v[124:127], a[132:135], a[12:15], v[124:127]
    s_waitcnt lgkmcnt(6)
    v_exp_f32 v226, -v226
    v_mfma_f32_16x16x32_bf16 v[96:99], a[136:139], a[16:19], v[96:99]
    ds_read_b64_tr_b16 a[152:153], v15 offset:35904
    buffer_store_dwordx4 v[32:35], v2, s[12:15], s37 offen offset:0 sc1
    v_mfma_f32_16x16x32_bf16 v[100:103], a[136:139], a[20:23], v[100:103]
    ds_read_b64_tr_b16 a[154:155], v15 offset:37696
    v_cvt_pk_bf16_f32 v38, v84, v85
    v_mfma_f32_16x16x32_bf16 v[104:107], a[136:139], a[24:27], v[104:107]
    v_exp_f32 v227, -v227
    v_mfma_f32_16x16x32_bf16 v[108:111], a[136:139], a[28:31], v[108:111]
    s_waitcnt lgkmcnt(6)
    v_exp_f32 v228, -v228
    v_mfma_f32_16x16x32_bf16 v[112:115], a[140:143], a[16:19], v[112:115]
    ds_read_b64_tr_b16 a[156:157], v15 offset:50240
    v_cvt_pk_bf16_f32 v39, v86, v87
    v_mfma_f32_16x16x32_bf16 v[116:119], a[140:143], a[20:23], v[116:119]
    ds_read_b64_tr_b16 a[158:159], v15 offset:52032
    buffer_store_dwordx4 v[36:39], v2, s[12:15], s37 offen offset:1024 sc1
    v_mfma_f32_16x16x32_bf16 v[120:123], a[140:143], a[24:27], v[120:123]
    v_exp_f32 v229, -v229
    v_mfma_f32_16x16x32_bf16 v[124:127], a[140:143], a[28:31], v[124:127]
    s_waitcnt lgkmcnt(6)
    v_exp_f32 v230, -v230
    v_mfma_f32_16x16x32_bf16 v[96:99], a[144:147], a[32:35], v[96:99]
    ds_read_b64_tr_b16 a[128:129], v16 offset:64
    v_cvt_pk_bf16_f32 v42, v88, v89
    v_mfma_f32_16x16x32_bf16 v[100:103], a[144:147], a[36:39], v[100:103]
    ds_read_b64_tr_b16 a[130:131], v16 offset:1856
    v_cvt_pk_bf16_f32 v43, v90, v91
    v_mfma_f32_16x16x32_bf16 v[104:107], a[144:147], a[40:43], v[104:107]
    v_exp_f32 v231, -v231
    v_mfma_f32_16x16x32_bf16 v[108:111], a[144:147], a[44:47], v[108:111]
    s_waitcnt lgkmcnt(6)
    v_exp_f32 v232, -v232
    v_mfma_f32_16x16x32_bf16 v[112:115], a[148:151], a[32:35], v[112:115]
    ds_read_b64_tr_b16 a[132:133], v16 offset:14400
    buffer_store_dwordx4 v[40:43], v2, s[12:15], s37 offen offset:2048 sc1
    v_mfma_f32_16x16x32_bf16 v[116:119], a[148:151], a[36:39], v[116:119]
    ds_read_b64_tr_b16 a[134:135], v16 offset:16192
    v_cvt_pk_bf16_f32 v46, v92, v93
    v_mfma_f32_16x16x32_bf16 v[120:123], a[148:151], a[40:43], v[120:123]
    v_exp_f32 v233, -v233
    v_mfma_f32_16x16x32_bf16 v[124:127], a[148:151], a[44:47], v[124:127]
    s_waitcnt lgkmcnt(6)
    v_exp_f32 v234, -v234
    v_mfma_f32_16x16x32_bf16 v[96:99], a[152:155], a[48:51], v[96:99]
    ds_read_b64_tr_b16 a[136:137], v16 offset:7232
    v_cvt_pk_bf16_f32 v47, v94, v95
    v_mfma_f32_16x16x32_bf16 v[100:103], a[152:155], a[52:55], v[100:103]
    ds_read_b64_tr_b16 a[138:139], v16 offset:9024
    buffer_store_dwordx4 v[44:47], v2, s[12:15], s37 offen offset:3072 sc1
    v_mfma_f32_16x16x32_bf16 v[104:107], a[152:155], a[56:59], v[104:107]
    v_exp_f32 v235, -v235
    v_mfma_f32_16x16x32_bf16 v[108:111], a[152:155], a[60:63], v[108:111]
    s_waitcnt lgkmcnt(6)
    v_exp_f32 v236, -v236
    v_mfma_f32_16x16x32_bf16 v[112:115], a[156:159], a[48:51], v[112:115]
    ds_read_b64_tr_b16 a[140:141], v16 offset:21568
    v_add_f32 v224, 1.0, v224
    v_mfma_f32_16x16x32_bf16 v[116:119], a[156:159], a[52:55], v[116:119]
    ds_read_b64_tr_b16 a[142:143], v16 offset:23360
    v_add_f32_e64 v225, 1.0, v225
    v_mfma_f32_16x16x32_bf16 v[120:123], a[156:159], a[56:59], v[120:123]
    v_exp_f32 v237, -v237
    v_mfma_f32_16x16x32_bf16 v[124:127], a[156:159], a[60:63], v[124:127]
    s_waitcnt lgkmcnt(6)
    v_exp_f32 v238, -v238
    v_mfma_f32_16x16x32_bf16 v[96:99], a[128:131], a[64:67], v[96:99]
    ds_read_b64_tr_b16 a[144:145], v17 offset:64
    v_add_f32 v226, 1.0, v226
    v_mfma_f32_16x16x32_bf16 v[100:103], a[128:131], a[68:71], v[100:103]
    ds_read_b64_tr_b16 a[146:147], v17 offset:1856
    v_add_f32_e64 v227, 1.0, v227
    v_mfma_f32_16x16x32_bf16 v[104:107], a[128:131], a[72:75], v[104:107]
    v_exp_f32 v239, -v239
    v_mfma_f32_16x16x32_bf16 v[108:111], a[128:131], a[76:79], v[108:111]
    s_waitcnt lgkmcnt(6)
    v_rcp_f32 v224, v224
    v_mfma_f32_16x16x32_bf16 v[112:115], a[132:135], a[64:67], v[112:115]
    ds_read_b64_tr_b16 a[148:149], v17 offset:14400
    v_add_f32_e64 v228, 1.0, v228
    v_mfma_f32_16x16x32_bf16 v[116:119], a[132:135], a[68:71], v[116:119]
    ds_read_b64_tr_b16 a[150:151], v17 offset:16192
    v_add_f32_e64 v229, 1.0, v229
    v_mfma_f32_16x16x32_bf16 v[120:123], a[132:135], a[72:75], v[120:123]
    v_rcp_f32_e64 v225, v225
    v_mfma_f32_16x16x32_bf16 v[124:127], a[132:135], a[76:79], v[124:127]
    s_waitcnt lgkmcnt(6)
    v_rcp_f32 v226, v226
    v_mfma_f32_16x16x32_bf16 v[96:99], a[136:139], a[80:83], v[96:99]
    ds_read_b64_tr_b16 a[152:153], v17 offset:7232
    v_add_f32_e64 v230, 1.0, v230
    v_mfma_f32_16x16x32_bf16 v[100:103], a[136:139], a[84:87], v[100:103]
    ds_read_b64_tr_b16 a[154:155], v17 offset:9024
    v_add_f32_e64 v231, 1.0, v231
    v_mfma_f32_16x16x32_bf16 v[104:107], a[136:139], a[88:91], v[104:107]
    v_rcp_f32_e64 v227, v227
    v_mfma_f32_16x16x32_bf16 v[108:111], a[136:139], a[92:95], v[108:111]
    s_waitcnt lgkmcnt(6)
    s_cmp_lg_u32 s3, 2
    s_cbranch_scc1 L_pk5
    buffer_load_dword v5, v29, s[24:27], s49 offen sc1
L_pk5:
    v_rcp_f32 v228, v228
    v_mfma_f32_16x16x32_bf16 v[112:115], a[140:143], a[80:83], v[112:115]
    ds_read_b64_tr_b16 a[156:157], v17 offset:21568
    v_add_f32_e64 v232, 1.0, v232
    v_mfma_f32_16x16x32_bf16 v[116:119], a[140:143], a[84:87], v[116:119]
    ds_read_b64_tr_b16 a[158:159], v17 offset:23360
    v_add_f32_e64 v233, 1.0, v233
    v_mfma_f32_16x16x32_bf16 v[120:123], a[140:143], a[88:91], v[120:123]
    v_rcp_f32_e64 v229, v229
    v_mfma_f32_16x16x32_bf16 v[124:127], a[140:143], a[92:95], v[124:127]
    s_waitcnt lgkmcnt(6)
    v_rcp_f32 v230, v230
    v_mfma_f32_16x16x32_bf16 v[96:99], a[144:147], a[176:179], v[96:99]
    ds_read_b64_tr_b16 a[128:129], v15 offset:96
    v_add_f32_e64 v234, 1.0, v234
    v_mfma_f32_16x16x32_bf16 v[100:103], a[144:147], a[180:183], v[100:103]
    ds_read_b64_tr_b16 a[130:131], v15 offset:1888
    v_add_f32_e64 v235, 1.0, v235
    v_mfma_f32_16x16x32_bf16 v[104:107], a[144:147], a[184:187], v[104:107]
    v_rcp_f32_e64 v231, v231
    v_mfma_f32_16x16x32_bf16 v[108:111], a[144:147], a[188:191], v[108:111]
    s_waitcnt lgkmcnt(6)
    v_rcp_f32 v232, v232
    v_mfma_f32_16x16x32_bf16 v[112:115], a[148:151], a[176:179], v[112:115]
    ds_read_b64_tr_b16 a[132:133], v15 offset:14432
    v_add_f32_e64 v236, 1.0, v236
    v_mfma_f32_16x16x32_bf16 v[116:119], a[148:151], a[180:183], v[116:119]
    ds_read_b64_tr_b16 a[134:135], v15 offset:16224
    v_add_f32_e64 v237, 1.0, v237
    v_mfma_f32_16x16x32_bf16 v[120:123], a[148:151], a[184:187], v[120:123]
    v_rcp_f32_e64 v233, v233
    v_mfma_f32_16x16x32_bf16 v[124:127], a[148:151], a[188:191], v[124:127]
    s_waitcnt lgkmcnt(6)
    v_rcp_f32 v234, v234
    v_mfma_f32_16x16x32_bf16 v[96:99], a[152:155], a[160:163], v[96:99]
    ds_read_b64_tr_b16 a[136:137], v15 offset:7264
    v_add_f32_e64 v238, 1.0, v238
    v_mfma_f32_16x16x32_bf16 v[100:103], a[152:155], a[164:167], v[100:103]
    ds_read_b64_tr_b16 a[138:139], v15 offset:9056
    v_add_f32_e64 v239, 1.0, v239
    v_mfma_f32_16x16x32_bf16 v[104:107], a[152:155], a[168:171], v[104:107]
    v_rcp_f32_e64 v235, v235
    v_mfma_f32_16x16x32_bf16 v[108:111], a[152:155], a[172:175], v[108:111]
    s_waitcnt lgkmcnt(6)
    v_rcp_f32 v236, v236
    v_mfma_f32_16x16x32_bf16 v[112:115], a[156:159], a[160:163], v[112:115]
    ds_read_b64_tr_b16 a[140:141], v15 offset:21600
    v_mfma_f32_16x16x32_bf16 v[116:119], a[156:159], a[164:167], v[116:119]
    ds_read_b64_tr_b16 a[142:143], v15 offset:23392
    v_mfma_f32_16x16x32_bf16 v[120:123], a[156:159], a[168:171], v[120:123]
    v_rcp_f32_e64 v237, v237
    v_mfma_f32_16x16x32_bf16 v[124:127], a[156:159], a[172:175], v[124:127]
    s_waitcnt lgkmcnt(6)
    v_rcp_f32 v238, v238
    v_mfma_f32_16x16x32_bf16 v[128:131], a[128:131], a[0:3], v[128:131]
    ds_read_b64_tr_b16 a[144:145], v15 offset:28768
    v_mfma_f32_16x16x32_bf16 v[132:135], a[128:131], a[4:7], v[132:135]
    ds_read_b64_tr_b16 a[146:147], v15 offset:30560
    v_mfma_f32_16x16x32_bf16 v[136:139], a[128:131], a[8:11], v[136:139]
    v_rcp_f32_e64 v239, v239
    v_mfma_f32_16x16x32_bf16 v[140:143], a[128:131], a[12:15], v[140:143]
    s_waitcnt lgkmcnt(6)
    v_pk_fma_f32 v[20:21], v[96:97], v[96:97], v[18:19] op_sel_hi:[1,1,0]
    v_pk_mul_f32 v[112:113], v[96:97], v[112:113]
    v_pk_mul_f32 v[96:97], v[20:21], v[96:97]
    v_pk_fma_f32 v[22:23], v[98:99], v[98:99], v[18:19] op_sel_hi:[1,1,0]
    v_pk_mul_f32 v[114:115], v[98:99], v[114:115]
    v_pk_mul_f32 v[98:99], v[22:23], v[98:99]
    v_pk_fma_f32 v[24:25], v[100:101], v[100:101], v[18:19] op_sel_hi:[1,1,0]
    v_pk_mul_f32 v[116:117], v[100:101], v[116:117]
    v_pk_mul_f32 v[100:101], v[24:25], v[100:101]
    v_pk_fma_f32 v[20:21], v[102:103], v[102:103], v[18:19] op_sel_hi:[1,1,0]
    v_pk_mul_f32 v[118:119], v[102:103], v[118:119]
    v_pk_mul_f32 v[102:103], v[20:21], v[102:103]
    v_pk_fma_f32 v[22:23], v[104:105], v[104:105], v[18:19] op_sel_hi:[1,1,0]
    v_pk_mul_f32 v[120:121], v[104:105], v[120:121]
    v_pk_mul_f32 v[104:105], v[22:23], v[104:105]
    v_pk_fma_f32 v[24:25], v[106:107], v[106:107], v[18:19] op_sel_hi:[1,1,0]
    v_pk_mul_f32 v[122:123], v[106:107], v[122:123]
    v_pk_mul_f32 v[106:107], v[24:25], v[106:107]
    v_pk_fma_f32 v[20:21], v[108:109], v[108:109], v[18:19] op_sel_hi:[1,1,0]
    v_pk_mul_f32 v[124:125], v[108:109], v[124:125]
    v_pk_mul_f32 v[108:109], v[20:21], v[108:109]
    v_pk_fma_f32 v[22:23], v[110:111], v[110:111], v[18:19] op_sel_hi:[1,1,0]
    v_pk_mul_f32 v[126:127], v[110:111], v[126:127]
    v_pk_mul_f32 v[110:111], v[22:23], v[110:111]
    v_pk_mul_f32 v[240:241], v[240:241], v[224:225]
    v_pk_mul_f32 v[242:243], v[242:243], v[226:227]
    v_pk_mul_f32 v[244:245], v[244:245], v[228:229]
    v_pk_mul_f32 v[246:247], v[246:247], v[230:231]
    v_pk_mul_f32 v[248:249], v[248:249], v[232:233]
    v_pk_mul_f32 v[250:251], v[250:251], v[234:235]
    v_pk_mul_f32 v[252:253], v[252:253], v[236:237]
    v_pk_mul_f32 v[254:255], v[254:255], v[238:239]
    v_exp_f32 v96, -v96
    v_mfma_f32_16x16x32_bf16 v[144:147], a[132:135], a[0:3], v[144:147]
    ds_read_b64_tr_b16 a[148:149], v15 offset:43104
    v_cvt_pk_bf16_f32 v224, v240, v241
    v_mfma_f32_16x16x32_bf16 v[148:151], a[132:135], a[4:7], v[148:151]
    ds_read_b64_tr_b16 a[150:151], v15 offset:44896
    v_cvt_pk_bf16_f32 v225, v242, v243
    v_mfma_f32_16x16x32_bf16 v[152:155], a[132:135], a[8:11], v[152:155]
    v_exp_f32 v97, -v97
    v_mfma_f32_16x16x32_bf16 v[156:159], a[132:135], a[12:15], v[156:159]
    s_waitcnt lgkmcnt(6)
    v_exp_f32 v98, -v98
    v_mfma_f32_16x16x32_bf16 v[128:131], a[136:139], a[16:19], v[128:131]
    ds_read_b64_tr_b16 a[152:153], v15 offset:35936
    buffer_store_dwordx2 v[224:225], v2, s[12:15], s44 offen offset:0 sc1
    v_mfma_f32_16x16x32_bf16 v[132:135], a[136:139], a[20:23], v[132:135]
    ds_read_b64_tr_b16 a[154:155], v15 offset:37728
    v_cvt_pk_bf16_f32 v228, v244, v245
    v_mfma_f32_16x16x32_bf16 v[136:139], a[136:139], a[24:27], v[136:139]
    v_exp_f32 v99, -v99
    v_mfma_f32_16x16x32_bf16 v[140:143], a[136:139], a[28:31], v[140:143]
    s_waitcnt lgkmcnt(6)
    v_exp_f32 v100, -v100
    v_mfma_f32_16x16x32_bf16 v[144:147], a[140:143], a[16:19], v[144:147]
    ds_read_b64_tr_b16 a[156:157], v15 offset:50272
    v_cvt_pk_bf16_f32 v229, v246, v247
    v_mfma_f32_16x16x32_bf16 v[148:151], a[140:143], a[20:23], v[148:151]
    ds_read_b64_tr_b16 a[158:159], v15 offset:52064
    buffer_store_dwordx2 v[228:229], v2, s[12:15], s44 offen offset:1024 sc1
    v_mfma_f32_16x16x32_bf16 v[152:155], a[140:143], a[24:27], v[152:155]
    v_exp_f32 v101, -v101
    v_mfma_f32_16x16x32_bf16 v[156:159], a[140:143], a[28:31], v[156:159]
    s_waitcnt lgkmcnt(6)
    v_exp_f32 v102, -v102
    v_mfma_f32_16x16x32_bf16 v[128:131], a[144:147], a[32:35], v[128:131]
    ds_read_b64_tr_b16 a[128:129], v16 offset:96
    v_cvt_pk_bf16_f32 v232, v248, v249
    v_mfma_f32_16x16x32_bf16 v[132:135], a[144:147], a[36:39], v[132:135]
    ds_read_b64_tr_b16 a[130:131], v16 offset:1888
    v_cvt_pk_bf16_f32 v233, v250, v251
    v_mfma_f32_16x16x32_bf16 v[136:139], a[144:147], a[40:43], v[136:139]
    v_exp_f32 v103, -v103
    v_mfma_f32_16x16x32_bf16 v[140:143], a[144:147], a[44:47], v[140:143]
    s_waitcnt lgkmcnt(6)
    v_exp_f32 v104, -v104
    v_mfma_f32_16x16x32_bf16 v[144:147], a[148:151], a[32:35], v[144:147]
    ds_read_b64_tr_b16 a[132:133], v16 offset:14432
    buffer_store_dwordx2 v[232:233], v2, s[12:15], s44 offen offset:2048 sc1
    v_mfma_f32_16x16x32_bf16 v[148:151], a[148:151], a[36:39], v[148:151]
    ds_read_b64_tr_b16 a[134:135], v16 offset:16224
    v_cvt_pk_bf16_f32 v236, v252, v253
    v_mfma_f32_16x16x32_bf16 v[152:155], a[148:151], a[40:43], v[152:155]
    v_exp_f32 v105, -v105
    v_mfma_f32_16x16x32_bf16 v[156:159], a[148:151], a[44:47], v[156:159]
    s_waitcnt lgkmcnt(6)
    v_exp_f32 v106, -v106
    v_mfma_f32_16x16x32_bf16 v[128:131], a[152:155], a[48:51], v[128:131]
    ds_read_b64_tr_b16 a[136:137], v16 offset:7264
    v_cvt_pk_bf16_f32 v237, v254, v255
    v_mfma_f32_16x16x32_bf16 v[132:135], a[152:155], a[52:55], v[132:135]
    ds_read_b64_tr_b16 a[138:139], v16 offset:9056
    buffer_store_dwordx2 v[236:237], v2, s[12:15], s44 offen offset:3072 sc1
    v_mfma_f32_16x16x32_bf16 v[136:139], a[152:155], a[56:59], v[136:139]
    v_exp_f32 v107, -v107
    v_mfma_f32_16x16x32_bf16 v[140:143], a[152:155], a[60:63], v[140:143]
    s_waitcnt lgkmcnt(6)
    v_exp_f32 v108, -v108
    v_mfma_f32_16x16x32_bf16 v[144:147], a[156:159], a[48:51], v[144:147]
    ds_read_b64_tr_b16 a[140:141], v16 offset:21600
    v_add_f32 v96, 1.0, v96
    v_mfma_f32_16x16x32_bf16 v[148:151], a[156:159], a[52:55], v[148:151]
    ds_read_b64_tr_b16 a[142:143], v16 offset:23392
    v_add_f32_e64 v97, 1.0, v97
    v_mfma_f32_16x16x32_bf16 v[152:155], a[156:159], a[56:59], v[152:155]
    v_exp_f32 v109, -v109
    v_mfma_f32_16x16x32_bf16 v[156:159], a[156:159], a[60:63], v[156:159]
    s_waitcnt lgkmcnt(6)
    v_exp_f32 v110, -v110
    v_mfma_f32_16x16x32_bf16 v[128:131], a[128:131], a[64:67], v[128:131]
    ds_read_b64_tr_b16 a[144:145], v17 offset:96
    v_add_f32 v98, 1.0, v98
    v_mfma_f32_16x16x32_bf16 v[132:135], a[128:131], a[68:71], v[132:135]
    ds_read_b64_tr_b16 a[146:147], v17 offset:1888
    v_add_f32_e64 v99, 1.0, v99
    v_mfma_f32_16x16x32_bf16 v[136:139], a[128:131], a[72:75], v[136:139]
    v_exp_f32 v111, -v111
    v_mfma_f32_16x16x32_bf16 v[140:143], a[128:131], a[76:79], v[140:143]
    s_waitcnt lgkmcnt(6)
    v_rcp_f32 v96, v96
    v_mfma_f32_16x16x32_bf16 v[144:147], a[132:135], a[64:67], v[144:147]
    ds_read_b64_tr_b16 a[148:149], v17 offset:14432
    v_add_f32_e64 v100, 1.0, v100
    v_mfma_f32_16x16x32_bf16 v[148:151], a[132:135], a[68:71], v[148:151]
    ds_read_b64_tr_b16 a[150:151], v17 offset:16224
    v_add_f32_e64 v101, 1.0, v101
    v_mfma_f32_16x16x32_bf16 v[152:155], a[132:135], a[72:75], v[152:155]
    v_rcp_f32_e64 v97, v97
    v_mfma_f32_16x16x32_bf16 v[156:159], a[132:135], a[76:79], v[156:159]
    s_waitcnt lgkmcnt(6)
    v_rcp_f32 v98, v98
    v_mfma_f32_16x16x32_bf16 v[128:131], a[136:139], a[80:83], v[128:131]
    ds_read_b64_tr_b16 a[152:153], v17 offset:7264
    v_add_f32_e64 v102, 1.0, v102
    v_mfma_f32_16x16x32_bf16 v[132:135], a[136:139], a[84:87], v[132:135]
    ds_read_b64_tr_b16 a[154:155], v17 offset:9056
    v_add_f32_e64 v103, 1.0, v103
    v_mfma_f32_16x16x32_bf16 v[136:139], a[136:139], a[88:91], v[136:139]
    v_rcp_f32_e64 v99, v99
    v_mfma_f32_16x16x32_bf16 v[140:143], a[136:139], a[92:95], v[140:143]
    s_waitcnt lgkmcnt(6)
    v_rcp_f32 v100, v100
    v_mfma_f32_16x16x32_bf16 v[144:147], a[140:143], a[80:83], v[144:147]
    ds_read_b64_tr_b16 a[156:157], v17 offset:21600
    v_add_f32_e64 v104, 1.0, v104
    v_mfma_f32_16x16x32_bf16 v[148:151], a[140:143], a[84:87], v[148:151]
    ds_read_b64_tr_b16 a[158:159], v17 offset:23392
    v_add_f32_e64 v105, 1.0, v105
    v_mfma_f32_16x16x32_bf16 v[152:155], a[140:143], a[88:91], v[152:155]
    v_rcp_f32_e64 v101, v101
    v_mfma_f32_16x16x32_bf16 v[156:159], a[140:143], a[92:95], v[156:159]
    s_waitcnt lgkmcnt(6)
    v_rcp_f32 v102, v102
    v_mfma_f32_16x16x32_bf16 v[128:131], a[144:147], a[176:179], v[128:131]
    ds_read_b64_tr_b16 a[128:129], v15 offset:128
    v_add_f32_e64 v106, 1.0, v106
    v_mfma_f32_16x16x32_bf16 v[132:135], a[144:147], a[180:183], v[132:135]
    ds_read_b64_tr_b16 a[130:131], v15 offset:1920
    v_add_f32_e64 v107, 1.0, v107
    v_mfma_f32_16x16x32_bf16 v[136:139], a[144:147], a[184:187], v[136:139]
    v_rcp_f32_e64 v103, v103
    v_mfma_f32_16x16x32_bf16 v[140:143], a[144:147], a[188:191], v[140:143]
    s_waitcnt lgkmcnt(6)
    v_rcp_f32 v104, v104
    v_mfma_f32_16x16x32_bf16 v[144:147], a[148:151], a[176:179], v[144:147]
    ds_read_b64_tr_b16 a[132:133], v15 offset:14464
    v_add_f32_e64 v108, 1.0, v108
    v_mfma_f32_16x16x32_bf16 v[148:151], a[148:151], a[180:183], v[148:151]
    ds_read_b64_tr_b16 a[134:135], v15 offset:16256
    v_add_f32_e64 v109, 1.0, v109
    v_mfma_f32_16x16x32_bf16 v[152:155], a[148:151], a[184:187], v[152:155]
    v_rcp_f32_e64 v105, v105
    v_mfma_f32_16x16x32_bf16 v[156:159], a[148:151], a[188:191], v[156:159]
    s_waitcnt lgkmcnt(6)
    v_rcp_f32 v106, v106
    v_mfma_f32_16x16x32_bf16 v[128:131], a[152:155], a[160:163], v[128:131]
    ds_read_b64_tr_b16 a[136:137], v15 offset:7296
    v_add_f32_e64 v110, 1.0, v110
    v_mfma_f32_16x16x32_bf16 v[132:135], a[152:155], a[164:167], v[132:135]
    ds_read_b64_tr_b16 a[138:139], v15 offset:9088
    v_add_f32_e64 v111, 1.0, v111
    v_mfma_f32_16x16x32_bf16 v[136:139], a[152:155], a[168:171], v[136:139]
    v_rcp_f32_e64 v107, v107
    v_mfma_f32_16x16x32_bf16 v[140:143], a[152:155], a[172:175], v[140:143]
    s_waitcnt lgkmcnt(6)
    v_rcp_f32 v108, v108
    v_mfma_f32_16x16x32_bf16 v[144:147], a[156:159], a[160:163], v[144:147]
    ds_read_b64_tr_b16 a[140:141], v15 offset:21632
    v_mfma_f32_16x16x32_bf16 v[148:151], a[156:159], a[164:167], v[148:151]
    ds_read_b64_tr_b16 a[142:143], v15 offset:23424
    v_mfma_f32_16x16x32_bf16 v[152:155], a[156:159], a[168:171], v[152:155]
    v_rcp_f32_e64 v109, v109
    v_mfma_f32_16x16x32_bf16 v[156:159], a[156:159], a[172:175], v[156:159]
    s_waitcnt lgkmcnt(6)
    v_rcp_f32 v110, v110
    v_mfma_f32_16x16x32_bf16 v[160:163], a[128:131], a[0:3], v[160:163]
    ds_read_b64_tr_b16 a[144:145], v15 offset:28800
    v_mfma_f32_16x16x32_bf16 v[164:167], a[128:131], a[4:7], v[164:167]
    ds_read_b64_tr_b16 a[146:147], v15 offset:30592
    s_waitcnt vmcnt(4)
    s_cmp_lg_u32 s3, 2
    s_cbranch_scc1 L_f5ok
    s_mov_b32 s56, 0
    s_waitcnt vmcnt(4)
L_f5:
    v_cmp_gt_u32 vcc, 32, v5
    s_add_u32 s56, s56, 1
    s_cmp_eq_u64 vcc, 0
    s_cbranch_scc1 L_f5ok
    buffer_load_dword v5, v29, s[24:27], s49 offen sc1
    s_waitcnt vmcnt(0)
    s_cmp_lt_u32 s56, 400000
    s_cbranch_scc1 L_f5
L_f5ok:
    s_barrier
    s_cmp_lg_u32 s3, 0
    s_cbranch_scc1 L_wf_15
    s_mov_b64 exec, 1
    v_mov_b32 v3, 0
    v_mov_b32_e64 v4, 1
    buffer_atomic_add v4, v3, s[24:27], s50 offen sc1
    s_mov_b64 exec, -1
L_wf_15:
    v_mfma_f32_16x16x32_bf16 v[168:171], a[128:131], a[8:11], v[168:171]
    v_rcp_f32 v111, v111
    v_mfma_f32_16x16x32_bf16 v[172:175], a[128:131], a[12:15], v[172:175]
    s_waitcnt lgkmcnt(6)
    v_pk_fma_f32 v[20:21], v[128:129], v[128:129], v[18:19] op_sel_hi:[1,1,0]
    v_pk_mul_f32 v[144:145], v[128:129], v[144:145]
    v_pk_mul_f32 v[128:129], v[20:21], v[128:129]
    v_pk_fma_f32 v[22:23], v[130:131], v[130:131], v[18:19] op_sel_hi:[1,1,0]
    v_pk_mul_f32 v[146:147], v[130:131], v[146:147]
    v_pk_mul_f32 v[130:131], v[22:23], v[130:131]
    v_pk_fma_f32 v[24:25], v[132:133], v[132:133], v[18:19] op_sel_hi:[1,1,0]
    v_pk_mul_f32 v[148:149], v[132:133], v[148:149]
    v_pk_mul_f32 v[132:133], v[24:25], v[132:133]
    v_pk_fma_f32 v[20:21], v[134:135], v[134:135], v[18:19] op_sel_hi:[1,1,0]
    v_pk_mul_f32 v[150:151], v[134:135], v[150:151]
    v_pk_mul_f32 v[134:135], v[20:21], v[134:135]
    v_pk_fma_f32 v[22:23], v[136:137], v[136:137], v[18:19] op_sel_hi:[1,1,0]
    v_pk_mul_f32 v[152:153], v[136:137], v[152:153]
    v_pk_mul_f32 v[136:137], v[22:23], v[136:137]
    v_pk_fma_f32 v[24:25], v[138:139], v[138:139], v[18:19] op_sel_hi:[1,1,0]
    v_pk_mul_f32 v[154:155], v[138:139], v[154:155]
    v_pk_mul_f32 v[138:139], v[24:25], v[138:139]
    v_pk_fma_f32 v[20:21], v[140:141], v[140:141], v[18:19] op_sel_hi:[1,1,0]
    v_pk_mul_f32 v[156:157], v[140:141], v[156:157]
    v_pk_mul_f32 v[140:141], v[20:21], v[140:141]
    v_pk_fma_f32 v[22:23], v[142:143], v[142:143], v[18:19] op_sel_hi:[1,1,0]
    v_pk_mul_f32 v[158:159], v[142:143], v[158:159]
    v_pk_mul_f32 v[142:143], v[22:23], v[142:143]
    v_pk_mul_f32 v[112:113], v[112:113], v[96:97]
    v_pk_mul_f32 v[114:115], v[114:115], v[98:99]
    v_pk_mul_f32 v[116:117], v[116:117], v[100:101]
    v_pk_mul_f32 v[118:119], v[118:119], v[102:103]
    v_pk_mul_f32 v[120:121], v[120:121], v[104:105]
    v_pk_mul_f32 v[122:123], v[122:123], v[106:107]
    v_pk_mul_f32 v[124:125], v[124:125], v[108:109]
    v_pk_mul_f32 v[126:127], v[126:127], v[110:111]
    v_exp_f32 v128, -v128
    v_mfma_f32_16x16x32_bf16 v[176:179], a[132:135], a[0:3], v[176:179]
    ds_read_b64_tr_b16 a[148:149], v15 offset:43136
    v_cvt_pk_bf16_f32 v96, v112, v113
    v_mfma_f32_16x16x32_bf16 v[180:183], a[132:135], a[4:7], v[180:183]
    ds_read_b64_tr_b16 a[150:151], v15 offset:44928
    v_cvt_pk_bf16_f32 v97, v114, v115
    v_mfma_f32_16x16x32_bf16 v[184:187], a[132:135], a[8:11], v[184:187]
    v_exp_f32 v129, -v129
    v_mfma_f32_16x16x32_bf16 v[188:191], a[132:135], a[12:15], v[188:191]
    s_waitcnt lgkmcnt(6)
    v_exp_f32 v130, -v130
    v_mfma_f32_16x16x32_bf16 v[160:163], a[136:139], a[16:19], v[160:163]
    ds_read_b64_tr_b16 a[152:153], v15 offset:35968
    v_cvt_pk_bf16_f32 v100, v116, v117
    v_mfma_f32_16x16x32_bf16 v[164:167], a[136:139], a[20:23], v[164:167]
    ds_read_b64_tr_b16 a[154:155], v15 offset:37760
    v_cvt_pk_bf16_f32 v101, v118, v119
    v_mfma_f32_16x16x32_bf16 v[168:171], a[136:139], a[24:27], v[168:171]
    v_exp_f32 v131, -v131
    v_mfma_f32_16x16x32_bf16 v[172:175], a[136:139], a[28:31], v[172:175]
    s_waitcnt lgkmcnt(6)
    v_exp_f32 v132, -v132
    s_add_u32 m0, s48, 147456
    v_mfma_f32_16x16x32_bf16 v[176:179], a[140:143], a[16:19], v[176:179]
    ds_read_b64_tr_b16 a[156:157], v15 offset:50304
    v_cvt_pk_bf16_f32 v104, v120, v121
    v_mfma_f32_16x16x32_bf16 v[180:183], a[140:143], a[20:23], v[180:183]
    ds_read_b64_tr_b16 a[158:159], v15 offset:52096
    v_cvt_pk_bf16_f32 v105, v122, v123
    v_mfma_f32_16x16x32_bf16 v[184:187], a[140:143], a[24:27], v[184:187]
    v_exp_f32 v133, -v133
    buffer_load_dwordx4 v2, s[20:23], s40 offen offset:0 sc1 lds
    v_mfma_f32_16x16x32_bf16 v[188:191], a[140:143], a[28:31], v[188:191]
    s_waitcnt lgkmcnt(6)
    v_exp_f32 v134, -v134
    v_mfma_f32_16x16x32_bf16 v[160:163], a[144:147], a[32:35], v[160:163]
    ds_read_b64_tr_b16 a[128:129], v16 offset:128
    v_cvt_pk_bf16_f32 v108, v124, v125
    v_mfma_f32_16x16x32_bf16 v[164:167], a[144:147], a[36:39], v[164:167]
    ds_read_b64_tr_b16 a[130:131], v16 offset:1920
    v_cvt_pk_bf16_f32 v109, v126, v127
    v_mfma_f32_16x16x32_bf16 v[168:171], a[144:147], a[40:43], v[168:171]
    v_exp_f32 v135, -v135
    v_mfma_f32_16x16x32_bf16 v[172:175], a[144:147], a[44:47], v[172:175]
    s_waitcnt lgkmcnt(6)
    v_exp_f32 v136, -v136
    v_mfma_f32_16x16x32_bf16 v[176:179], a[148:151], a[32:35], v[176:179]
    ds_read_b64_tr_b16 a[132:133], v16 offset:14464
    v_add_f32 v128, 1.0, v128
    v_mfma_f32_16x16x32_bf16 v[180:183], a[148:151], a[36:39], v[180:183]
    ds_read_b64_tr_b16 a[134:135], v16 offset:16256
    v_add_f32_e64 v129, 1.0, v129
    v_mfma_f32_16x16x32_bf16 v[184:187], a[148:151], a[40:43], v[184:187]
    v_exp_f32 v137, -v137
    buffer_load_dwordx4 v2, s[20:23], s40 offen offset:1024 sc1 lds
    v_mfma_f32_16x16x32_bf16 v[188:191], a[148:151], a[44:47], v[188:191]
    s_waitcnt lgkmcnt(6)
    v_exp_f32 v138, -v138
    v_mfma_f32_16x16x32_bf16 v[160:163], a[152:155], a[48:51], v[160:163]
    ds_read_b64_tr_b16 a[136:137], v16 offset:7296
    v_add_f32 v130, 1.0, v130
    v_mfma_f32_16x16x32_bf16 v[164:167], a[152:155], a[52:55], v[164:167]
    ds_read_b64_tr_b16 a[138:139], v16 offset:9088
    v_add_f32_e64 v131, 1.0, v131
    v_mfma_f32_16x16x32_bf16 v[168:171], a[152:155], a[56:59], v[168:171]
    v_exp_f32 v139, -v139
    v_mfma_f32_16x16x32_bf16 v[172:175], a[152:155], a[60:63], v[172:175]
    s_waitcnt lgkmcnt(6)
    v_exp_f32 v140, -v140
    v_mfma_f32_16x16x32_bf16 v[176:179], a[156:159], a[48:51], v[176:179]
    ds_read_b64_tr_b16 a[140:141], v16 offset:21632
    v_add_f32 v132, 1.0, v132
    v_mfma_f32_16x16x32_bf16 v[180:183], a[156:159], a[52:55], v[180:183]
    ds_read_b64_tr_b16 a[142:143], v16 offset:23424
    v_add_f32_e64 v133, 1.0, v133
    v_mfma_f32_16x16x32_bf16 v[184:187], a[156:159], a[56:59], v[184:187]
    v_exp_f32 v141, -v141
    buffer_load_dwordx4 v2, s[20:23], s40 offen offset:2048 sc1 lds
    v_mfma_f32_16x16x32_bf16 v[188:191], a[156:159], a[60:63], v[188:191]
    s_waitcnt lgkmcnt(6)
    v_exp_f32 v142, -v142
    v_mfma_f32_16x16x32_bf16 v[160:163], a[128:131], a[64:67], v[160:163]
    ds_read_b64_tr_b16 a[144:145], v17 offset:128
    v_add_f32 v134, 1.0, v134
    v_mfma_f32_16x16x32_bf16 v[164:167], a[128:131], a[68:71], v[164:167]
    ds_read_b64_tr_b16 a[146:147], v17 offset:1920
    v_add_f32_e64 v135, 1.0, v135
    v_mfma_f32_16x16x32_bf16 v[168:171], a[128:131], a[72:75], v[168:171]
    v_exp_f32 v143, -v143
    v_mfma_f32_16x16x32_bf16 v[172:175], a[128:131], a[76:79], v[172:175]
    s_waitcnt lgkmcnt(6)
    v_rcp_f32 v128, v128
    v_mfma_f32_16x16x32_bf16 v[176:179], a[132:135], a[64:67], v[176:179]
    ds_read_b64_tr_b16 a[148:149], v17 offset:14464
    v_add_f32_e64 v136, 1.0, v136
    v_mfma_f32_16x16x32_bf16 v[180:183], a[132:135], a[68:71], v[180:183]
    ds_read_b64_tr_b16 a[150:151], v17 offset:16256
    v_add_f32_e64 v137, 1.0, v137
    v_mfma_f32_16x16x32_bf16 v[184:187], a[132:135], a[72:75], v[184:187]
    v_rcp_f32_e64 v129, v129
    buffer_load_dwordx4 v2, s[20:23], s40 offen offset:3072 sc1 lds
    v_mfma_f32_16x16x32_bf16 v[188:191], a[132:135], a[76:79], v[188:191]
    s_waitcnt lgkmcnt(6)
    v_rcp_f32 v130, v130
    v_mfma_f32_16x16x32_bf16 v[160:163], a[136:139], a[80:83], v[160:163]
    ds_read_b64_tr_b16 a[152:153], v17 offset:7296
    v_add_f32_e64 v138, 1.0, v138
    s_add_u32 s40, s40, 16384
    v_mfma_f32_16x16x32_bf16 v[164:167], a[136:139], a[84:87], v[164:167]
    ds_read_b64_tr_b16 a[154:155], v17 offset:9088
    v_add_f32_e64 v139, 1.0, v139
    v_mfma_f32_16x16x32_bf16 v[168:171], a[136:139], a[88:91], v[168:171]
    v_rcp_f32_e64 v131, v131
    v_mfma_f32_16x16x32_bf16 v[172:175], a[136:139], a[92:95], v[172:175]
    s_waitcnt lgkmcnt(6)
    v_rcp_f32 v132, v132
    v_mfma_f32_16x16x32_bf16 v[176:179], a[140:143], a[80:83], v[176:179]
    ds_read_b64_tr_b16 a[156:157], v17 offset:21632
    v_add_f32_e64 v140, 1.0, v140
    v_mfma_f32_16x16x32_bf16 v[180:183], a[140:143], a[84:87], v[180:183]
    ds_read_b64_tr_b16 a[158:159], v17 offset:23424
    v_add_f32_e64 v141, 1.0, v141
    v_mfma_f32_16x16x32_bf16 v[184:187], a[140:143], a[88:91], v[184:187]
    v_rcp_f32_e64 v133, v133
    v_mfma_f32_16x16x32_bf16 v[188:191], a[140:143], a[92:95], v[188:191]
    s_waitcnt lgkmcnt(6)
    v_rcp_f32 v134, v134
    v_mfma_f32_16x16x32_bf16 v[160:163], a[144:147], a[176:179], v[160:163]
    ds_read_b64_tr_b16 a[128:129], v15 offset:160
    v_add_f32_e64 v142, 1.0, v142
    v_mfma_f32_16x16x32_bf16 v[164:167], a[144:147], a[180:183], v[164:167]
    ds_read_b64_tr_b16 a[130:131], v15 offset:1952
    v_add_f32_e64 v143, 1.0, v143
    v_mfma_f32_16x16x32_bf16 v[168:171], a[144:147], a[184:187], v[168:171]
    v_rcp_f32_e64 v135, v135
    v_mfma_f32_16x16x32_bf16 v[172:175], a[144:147], a[188:191], v[172:175]
    s_waitcnt lgkmcnt(6)
    v_rcp_f32 v136, v136
    v_mfma_f32_16x16x32_bf16 v[176:179], a[148:151], a[176:179], v[176:179]
    ds_read_b64_tr_b16 a[132:133], v15 offset:14496
    v_mfma_f32_16x16x32_bf16 v[180:183], a[148:151], a[180:183], v[180:183]
    ds_read_b64_tr_b16 a[134:135], v15 offset:16288
    v_mfma_f32_16x16x32_bf16 v[184:187], a[148:151], a[184:187], v[184:187]
    v_rcp_f32_e64 v137, v137
    v_mfma_f32_16x16x32_bf16 v[188:191], a[148:151], a[188:191], v[188:191]
    s_waitcnt lgkmcnt(6)
    v_rcp_f32 v138, v138
    v_mfma_f32_16x16x32_bf16 v[160:163], a[152:155], a[160:163], v[160:163]
    ds_read_b64_tr_b16 a[136:137], v15 offset:7328
    v_mfma_f32_16x16x32_bf16 v[164:167], a[152:155], a[164:167], v[164:167]
    ds_read_b64_tr_b16 a[138:139], v15 offset:9120
    v_mfma_f32_16x16x32_bf16 v[168:171], a[152:155], a[168:171], v[168:171]
    v_rcp_f32_e64 v139, v139
    v_mfma_f32_16x16x32_bf16 v[172:175], a[152:155], a[172:175], v[172:175]
    s_waitcnt lgkmcnt(6)
    v_rcp_f32 v140, v140
    v_mfma_f32_16x16x32_bf16 v[176:179], a[156:159], a[160:163], v[176:179]
    ds_read_b64_tr_b16 a[140:141], v15 offset:21664
    v_mfma_f32_16x16x32_bf16 v[180:183], a[156:159], a[164:167], v[180:183]
    ds_read_b64_tr_b16 a[142:143], v15 offset:23456
    v_mfma_f32_16x16x32_bf16 v[184:187], a[156:159], a[168:171], v[184:187]
    v_rcp_f32_e64 v141, v141
    v_mfma_f32_16x16x32_bf16 v[188:191], a[156:159], a[172:175], v[188:191]
    s_waitcnt lgkmcnt(6)
    v_rcp_f32 v142, v142
    v_mfma_f32_16x16x32_bf16 v[192:195], a[128:131], a[0:3], v[192:195]
    ds_read_b64_tr_b16 a[144:145], v15 offset:28832
    v_mfma_f32_16x16x32_bf16 v[196:199], a[128:131], a[4:7], v[196:199]
    ds_read_b64_tr_b16 a[146:147], v15 offset:30624
    v_mfma_f32_16x16x32_bf16 v[200:203], a[128:131], a[8:11], v[200:203]
    v_rcp_f32_e64 v143, v143
    v_mfma_f32_16x16x32_bf16 v[204:207], a[128:131], a[12:15], v[204:207]
    s_waitcnt lgkmcnt(6)
    v_pk_fma_f32 v[20:21], v[160:161], v[160:161], v[18:19] op_sel_hi:[1,1,0]
    v_pk_mul_f32 v[176:177], v[160:161], v[176:177]
    v_pk_mul_f32 v[160:161], v[20:21], v[160:161]
    v_pk_fma_f32 v[22:23], v[162:163], v[162:163], v[18:19] op_sel_hi:[1,1,0]
    v_pk_mul_f32 v[178:179], v[162:163], v[178:179]
    v_pk_mul_f32 v[162:163], v[22:23], v[162:163]
    v_pk_fma_f32 v[24:25], v[164:165], v[164:165], v[18:19] op_sel_hi:[1,1,0]
    v_pk_mul_f32 v[180:181], v[164:165], v[180:181]
    v_pk_mul_f32 v[164:165], v[24:25], v[164:165]
    v_pk_fma_f32 v[20:21], v[166:167], v[166:167], v[18:19] op_sel_hi:[1,1,0]
    v_pk_mul_f32 v[182:183], v[166:167], v[182:183]
    v_pk_mul_f32 v[166:167], v[20:21], v[166:167]
    v_pk_fma_f32 v[22:23], v[168:169], v[168:169], v[18:19] op_sel_hi:[1,1,0]
    v_pk_mul_f32 v[184:185], v[168:169], v[184:185]
    v_pk_mul_f32 v[168:169], v[22:23], v[168:169]
    v_pk_fma_f32 v[24:25], v[170:171], v[170:171], v[18:19] op_sel_hi:[1,1,0]
    v_pk_mul_f32 v[186:187], v[170:171], v[186:187]
    v_pk_mul_f32 v[170:171], v[24:25], v[170:171]
    v_pk_fma_f32 v[20:21], v[172:173], v[172:173], v[18:19] op_sel_hi:[1,1,0]
    v_pk_mul_f32 v[188:189], v[172:173], v[188:189]
    v_pk_mul_f32 v[172:173], v[20:21], v[172:173]
    v_pk_fma_f32 v[22:23], v[174:175], v[174:175], v[18:19] op_sel_hi:[1,1,0]
    v_pk_mul_f32 v[190:191], v[174:175], v[190:191]
    v_pk_mul_f32 v[174:175], v[22:23], v[174:175]
    v_pk_mul_f32 v[144:145], v[144:145], v[128:129]
    v_pk_mul_f32 v[146:147], v[146:147], v[130:131]
    v_pk_mul_f32 v[148:149], v[148:149], v[132:133]
    v_pk_mul_f32 v[150:151], v[150:151], v[134:135]
    v_pk_mul_f32 v[152:153], v[152:153], v[136:137]
    v_pk_mul_f32 v[154:155], v[154:155], v[138:139]
    v_pk_mul_f32 v[156:157], v[156:157], v[140:141]
    v_pk_mul_f32 v[158:159], v[158:159], v[142:143]
    v_exp_f32 v160, -v160
    v_mfma_f32_16x16x32_bf16 v[208:211], a[132:135], a[0:3], v[208:211]
    ds_read_b64_tr_b16 a[148:149], v15 offset:43168
    v_cvt_pk_bf16_f32 v98, v144, v145
    v_mfma_f32_16x16x32_bf16 v[212:215], a[132:135], a[4:7], v[212:215]
    ds_read_b64_tr_b16 a[150:151], v15 offset:44960
    v_cvt_pk_bf16_f32 v99, v146, v147
    v_mfma_f32_16x16x32_bf16 v[216:219], a[132:135], a[8:11], v[216:219]
    v_exp_f32 v161, -v161
    v_mfma_f32_16x16x32_bf16 v[220:223], a[132:135], a[12:15], v[220:223]
    s_waitcnt lgkmcnt(6)
    v_exp_f32 v162, -v162
    v_mfma_f32_16x16x32_bf16 v[192:195], a[136:139], a[16:19], v[192:195]
    ds_read_b64_tr_b16 a[152:153], v15 offset:36000
    buffer_store_dwordx4 v[96:99], v2, s[12:15], s38 offen offset:0 sc1
    v_mfma_f32_16x16x32_bf16 v[196:199], a[136:139], a[20:23], v[196:199]
    ds_read_b64_tr_b16 a[154:155], v15 offset:37792
    v_cvt_pk_bf16_f32 v102, v148, v149
    buffer_load_dword v30, v1, s[24:27], s50 offen sc1
    v_mfma_f32_16x16x32_bf16 v[200:203], a[136:139], a[24:27], v[200:203]
    v_exp_f32 v163, -v163
    v_mfma_f32_16x16x32_bf16 v[204:207], a[136:139], a[28:31], v[204:207]
    s_waitcnt lgkmcnt(6)
    v_exp_f32 v164, -v164
    v_mfma_f32_16x16x32_bf16 v[208:211], a[140:143], a[16:19], v[208:211]
    ds_read_b64_tr_b16 a[156:157], v15 offset:50336
    v_cvt_pk_bf16_f32 v103, v150, v151
    v_mfma_f32_16x16x32_bf16 v[212:215], a[140:143], a[20:23], v[212:215]
    ds_read_b64_tr_b16 a[158:159], v15 offset:52128
    buffer_store_dwordx4 v[100:103], v2, s[12:15], s38 offen offset:1024 sc1
    v_mfma_f32_16x16x32_bf16 v[216:219], a[140:143], a[24:27], v[216:219]
    v_exp_f32 v165, -v165
    v_mfma_f32_16x16x32_bf16 v[220:223], a[140:143], a[28:31], v[220:223]
    s_waitcnt lgkmcnt(6)
    v_exp_f32 v166, -v166
    v_mfma_f32_16x16x32_bf16 v[192:195], a[144:147], a[32:35], v[192:195]
    ds_read_b64_tr_b16 a[128:129], v16 offset:160
    v_cvt_pk_bf16_f32 v106, v152, v153
    v_mfma_f32_16x16x32_bf16 v[196:199], a[144:147], a[36:39], v[196:199]
    ds_read_b64_tr_b16 a[130:131], v16 offset:1952
    v_cvt_pk_bf16_f32 v107, v154, v155
    v_mfma_f32_16x16x32_bf16 v[200:203], a[144:147], a[40:43], v[200:203]
    v_exp_f32 v167, -v167
    v_mfma_f32_16x16x32_bf16 v[204:207], a[144:147], a[44:47], v[204:207]
    s_waitcnt lgkmcnt(6)
    v_exp_f32 v168, -v168
    v_mfma_f32_16x16x32_bf16 v[208:211], a[148:151], a[32:35], v[208:211]
    ds_read_b64_tr_b16 a[132:133], v16 offset:14496
    buffer_store_dwordx4 v[104:107], v2, s[12:15], s38 offen offset:2048 sc1
    v_mfma_f32_16x16x32_bf16 v[212:215], a[148:151], a[36:39], v[212:215]
    ds_read_b64_tr_b16 a[134:135], v16 offset:16288
    v_cvt_pk_bf16_f32 v110, v156, v157
    v_mfma_f32_16x16x32_bf16 v[216:219], a[148:151], a[40:43], v[216:219]
    v_exp_f32 v169, -v169
    v_mfma_f32_16x16x32_bf16 v[220:223], a[148:151], a[44:47], v[220:223]
    s_waitcnt lgkmcnt(6)
    v_exp_f32 v170, -v170
    v_mfma_f32_16x16x32_bf16 v[192:195], a[152:155], a[48:51], v[192:195]
    ds_read_b64_tr_b16 a[136:137], v16 offset:7328
    v_cvt_pk_bf16_f32 v111, v158, v159
    v_mfma_f32_16x16x32_bf16 v[196:199], a[152:155], a[52:55], v[196:199]
    ds_read_b64_tr_b16 a[138:139], v16 offset:9120
    buffer_store_dwordx4 v[108:111], v2, s[12:15], s38 offen offset:3072 sc1
    v_mfma_f32_16x16x32_bf16 v[200:203], a[152:155], a[56:59], v[200:203]
    v_exp_f32 v171, -v171
    v_mfma_f32_16x16x32_bf16 v[204:207], a[152:155], a[60:63], v[204:207]
    s_waitcnt lgkmcnt(6)
    v_exp_f32 v172, -v172
    v_mfma_f32_16x16x32_bf16 v[208:211], a[156:159], a[48:51], v[208:211]
    ds_read_b64_tr_b16 a[140:141], v16 offset:21664
    v_add_f32 v160, 1.0, v160
    v_mfma_f32_16x16x32_bf16 v[212:215], a[156:159], a[52:55], v[212:215]
    ds_read_b64_tr_b16 a[142:143], v16 offset:23456
    v_add_f32 v161, 1.0, v161
    s_waitcnt vmcnt(3)
    v_readfirstlane_b32 s30, v30
    s_mov_b32 s56, 0
    s_cmp_ge_u32 s30, 8
    s_cbranch_scc1 L_f3aok
L_poll_16:
    buffer_load_dword v4, v1, s[24:27], s50 offen sc1
    s_add_u32 s56, s56, 1
    s_waitcnt vmcnt(0)
    v_readfirstlane_b32 s30, v4
    s_cmp_ge_u32 s30, 8
    s_cbranch_scc1 L_f3aok
    s_cmp_lt_u32 s56, 400000
    s_cbranch_scc1 L_poll_16
L_f3aok:
    v_mfma_f32_16x16x32_bf16 v[216:219], a[156:159], a[56:59], v[216:219]
    v_exp_f32 v173, -v173
    v_mfma_f32_16x16x32_bf16 v[220:223], a[156:159], a[60:63], v[220:223]
    s_waitcnt lgkmcnt(6)
    v_exp_f32 v174, -v174
    v_mfma_f32_16x16x32_bf16 v[192:195], a[128:131], a[64:67], v[192:195]
    ds_read_b64_tr_b16 a[144:145], v17 offset:160
    v_add_f32 v162, 1.0, v162
    buffer_load_dwordx4 a[192:195], v2, s[12:15], s41 offen offset:0 sc1
    v_mfma_f32_16x16x32_bf16 v[196:199], a[128:131], a[68:71], v[196:199]
    ds_read_b64_tr_b16 a[146:147], v17 offset:1952
    v_add_f32_e64 v163, 1.0, v163
    v_mfma_f32_16x16x32_bf16 v[200:203], a[128:131], a[72:75], v[200:203]
    v_exp_f32 v175, -v175
    v_mfma_f32_16x16x32_bf16 v[204:207], a[128:131], a[76:79], v[204:207]
    s_waitcnt lgkmcnt(6)
    v_rcp_f32 v160, v160
    buffer_load_dwordx4 a[196:199], v2, s[12:15], s41 offen offset:1024 sc1
    v_mfma_f32_16x16x32_bf16 v[208:211], a[132:135], a[64:67], v[208:211]
    ds_read_b64_tr_b16 a[148:149], v17 offset:14496
    v_add_f32_e64 v164, 1.0, v164
    v_mfma_f32_16x16x32_bf16 v[212:215], a[132:135], a[68:71], v[212:215]
    ds_read_b64_tr_b16 a[150:151], v17 offset:16288
    v_add_f32_e64 v165, 1.0, v165
    v_mfma_f32_16x16x32_bf16 v[216:219], a[132:135], a[72:75], v[216:219]
    v_rcp_f32_e64 v161, v161
    buffer_load_dwordx4 a[200:203], v2, s[12:15], s41 offen offset:2048 sc1
    v_mfma_f32_16x16x32_bf16 v[220:223], a[132:135], a[76:79], v[220:223]
    s_waitcnt lgkmcnt(6)
    v_rcp_f32 v162, v162
    v_mfma_f32_16x16x32_bf16 v[192:195], a[136:139], a[80:83], v[192:195]
    ds_read_b64_tr_b16 a[152:153], v17 offset:7328
    v_add_f32_e64 v166, 1.0, v166
    v_mfma_f32_16x16x32_bf16 v[196:199], a[136:139], a[84:87], v[196:199]
    ds_read_b64_tr_b16 a[154:155], v17 offset:9120
    v_add_f32_e64 v167, 1.0, v167
    buffer_load_dwordx4 a[204:207], v2, s[12:15], s41 offen offset:3072 sc1
    v_mfma_f32_16x16x32_bf16 v[200:203], a[136:139], a[88:91], v[200:203]
    v_rcp_f32_e64 v163, v163
    v_mfma_f32_16x16x32_bf16 v[204:207], a[136:139], a[92:95], v[204:207]
    s_waitcnt lgkmcnt(6)
    v_rcp_f32 v164, v164
    s_add_u32 s41, s41, 4096
    v_mfma_f32_16x16x32_bf16 v[208:211], a[140:143], a[80:83], v[208:211]
    ds_read_b64_tr_b16 a[156:157], v17 offset:21664
    v_add_f32_e64 v168, 1.0, v168
    v_mfma_f32_16x16x32_bf16 v[212:215], a[140:143], a[84:87], v[212:215]
    ds_read_b64_tr_b16 a[158:159], v17 offset:23456
    v_add_f32_e64 v169, 1.0, v169
    v_mfma_f32_16x16x32_bf16 v[216:219], a[140:143], a[88:91], v[216:219]
    v_rcp_f32_e64 v165, v165
    buffer_load_dwordx4 a[208:211], v2, s[12:15], s41 offen offset:0 sc1
    v_mfma_f32_16x16x32_bf16 v[220:223], a[140:143], a[92:95], v[220:223]
    s_waitcnt lgkmcnt(6)
    s_waitcnt vmcnt(10)
    s_waitcnt lgkmcnt(0)
    s_barrier
    v_rcp_f32_e64 v166, v166
    v_mfma_f32_16x16x32_bf16 v[192:195], a[144:147], a[176:179], v[192:195]
    ds_read_b64_tr_b16 a[128:129], v26 offset:16384
    v_add_f32_e64 v170, 1.0, v170
    v_mfma_f32_16x16x32_bf16 v[196:199], a[144:147], a[180:183], v[196:199]
    ds_read_b64_tr_b16 a[130:131], v26 offset:16896
    v_add_f32_e64 v171, 1.0, v171
    buffer_load_dwordx4 a[212:215], v2, s[12:15], s41 offen offset:1024 sc1
    v_mfma_f32_16x16x32_bf16 v[200:203], a[144:147], a[184:187], v[200:203]
    v_rcp_f32_e64 v167, v167
    s_add_u32 m0, s48, 16384
    v_mfma_f32_16x16x32_bf16 v[204:207], a[144:147], a[188:191], v[204:207]
    s_waitcnt lgkmcnt(6)
    v_rcp_f32 v168, v168
    v_mfma_f32_16x16x32_bf16 v[208:211], a[148:151], a[176:179], v[208:211]
    ds_read_b64_tr_b16 a[132:133], v26 offset:17408
    v_add_f32_e64 v172, 1.0, v172
    buffer_load_dwordx4 a[216:219], v2, s[12:15], s41 offen offset:2048 sc1
    v_mfma_f32_16x16x32_bf16 v[212:215], a[148:151], a[180:183], v[212:215]
    ds_read_b64_tr_b16 a[134:135], v26 offset:17920
    v_add_f32_e64 v173, 1.0, v173
    buffer_load_dwordx4 v2, s[20:23], s40 offen offset:0 sc1 lds
    v_mfma_f32_16x16x32_bf16 v[216:219], a[148:151], a[184:187], v[216:219]
    v_rcp_f32_e64 v169, v169
    v_mfma_f32_16x16x32_bf16 v[220:223], a[148:151], a[188:191], v[220:223]
    s_waitcnt lgkmcnt(6)
    v_rcp_f32 v170, v170
    buffer_load_dwordx4 a[220:223], v2, s[12:15], s41 offen offset:3072 sc1
    v_mfma_f32_16x16x32_bf16 v[192:195], a[152:155], a[160:163], v[192:195]
    ds_read_b64_tr_b16 a[136:137], v26 offset:18432
    v_add_f32_e64 v174, 1.0, v174
    buffer_load_dwordx4 v2, s[20:23], s40 offen offset:1024 sc1 lds
    v_mfma_f32_16x16x32_bf16 v[196:199], a[152:155], a[164:167], v[196:199]
    ds_read_b64_tr_b16 a[138:139], v26 offset:18944
    v_add_f32_e64 v175, 1.0, v175
    s_add_u32 s41, s41, 4096
    v_mfma_f32_16x16x32_bf16 v[200:203], a[152:155], a[168:171], v[200:203]
    v_rcp_f32_e64 v171, v171
    v_mfma_f32_16x16x32_bf16 v[204:207], a[152:155], a[172:175], v[204:207]
    s_waitcnt lgkmcnt(6)
    v_rcp_f32 v172, v172
    buffer_load_dwordx4 v2, s[20:23], s40 offen offset:2048 sc1 lds
    v_mfma_f32_16x16x32_bf16 v[208:211], a[156:159], a[160:163], v[208:211]
    ds_read_b64_tr_b16 a[140:141], v26 offset:19456
    buffer_load_dwordx4 v[224:227], v2, s[12:15], s41 offen offset:0 sc1
    v_mfma_f32_16x16x32_bf16 v[212:215], a[156:159], a[164:167], v[212:215]
    ds_read_b64_tr_b16 a[142:143], v26 offset:19968
    buffer_load_dwordx4 v[228:231], v2, s[12:15], s41 offen offset:1024 sc1
    v_mfma_f32_16x16x32_bf16 v[216:219], a[156:159], a[168:171], v[216:219]
    v_rcp_f32_e64 v173, v173
    buffer_load_dwordx4 v2, s[20:23], s40 offen offset:3072 sc1 lds
    v_mfma_f32_16x16x32_bf16 v[220:223], a[156:159], a[172:175], v[220:223]
    s_waitcnt vmcnt(10)
    s_waitcnt lgkmcnt(6)
    v_rcp_f32_e64 v174, v174
    v_mfma_f32_16x16x32_bf16 v[32:35], a[128:131], a[192:195], 0
    ds_read_b64_tr_b16 a[144:145], v26 offset:20480
    buffer_load_dwordx4 v[232:235], v2, s[12:15], s41 offen offset:2048 sc1
    s_add_u32 s40, s40, 16384
    v_mfma_f32_16x16x32_bf16 v[36:39], a[128:131], a[196:199], 0
    ds_read_b64_tr_b16 a[146:147], v26 offset:20992
    buffer_load_dwordx4 v[236:239], v2, s[12:15], s41 offen offset:3072 sc1
    v_mfma_f32_16x16x32_bf16 v[40:43], a[128:131], a[200:203], 0
    v_rcp_f32_e64 v175, v175
    v_mfma_f32_16x16x32_bf16 v[44:47], a[128:131], a[204:207], 0
    s_waitcnt lgkmcnt(6)
    v_pk_fma_f32 v[20:21], v[192:193], v[192:193], v[18:19] op_sel_hi:[1,1,0]
    v_pk_mul_f32 v[208:209], v[192:193], v[208:209]
    v_pk_mul_f32 v[192:193], v[20:21], v[192:193]
    v_pk_fma_f32 v[22:23], v[194:195], v[194:195], v[18:19] op_sel_hi:[1,1,0]
    v_pk_mul_f32 v[210:211], v[194:195], v[210:211]
    v_pk_mul_f32 v[194:195], v[22:23], v[194:195]
    v_pk_fma_f32 v[24:25], v[196:197], v[196:197], v[18:19] op_sel_hi:[1,1,0]
    v_pk_mul_f32 v[212:213], v[196:197], v[212:213]
    v_pk_mul_f32 v[196:197], v[24:25], v[196:197]
    v_pk_fma_f32 v[20:21], v[198:199], v[198:199], v[18:19] op_sel_hi:[1,1,0]
    v_pk_mul_f32 v[214:215], v[198:199], v[214:215]
    v_pk_mul_f32 v[198:199], v[20:21], v[198:199]
    v_pk_fma_f32 v[22:23], v[200:201], v[200:201], v[18:19] op_sel_hi:[1,1,0]
    v_pk_mul_f32 v[216:217], v[200:201], v[216:217]
    v_pk_mul_f32 v[200:201], v[22:23], v[200:201]
    v_pk_fma_f32 v[24:25], v[202:203], v[202:203], v[18:19] op_sel_hi:[1,1,0]
    v_pk_mul_f32 v[218:219], v[202:203], v[218:219]
    v_pk_mul_f32 v[202:203], v[24:25], v[202:203]
    v_pk_fma_f32 v[20:21], v[204:205], v[204:205], v[18:19] op_sel_hi:[1,1,0]
    v_pk_mul_f32 v[220:221], v[204:205], v[220:221]
    v_pk_mul_f32 v[204:205], v[20:21], v[204:205]
    v_pk_fma_f32 v[22:23], v[206:207], v[206:207], v[18:19] op_sel_hi:[1,1,0]
    v_pk_mul_f32 v[222:223], v[206:207], v[222:223]
    v_pk_mul_f32 v[206:207], v[22:23], v[206:207]
    v_pk_mul_f32 v[176:177], v[176:177], v[160:161]
    v_pk_mul_f32 v[178:179], v[178:179], v[162:163]
    v_pk_mul_f32 v[180:181], v[180:181], v[164:165]
    v_pk_mul_f32 v[182:183], v[182:183], v[166:167]
    v_pk_mul_f32 v[184:185], v[184:185], v[168:169]
    v_pk_mul_f32 v[186:187], v[186:187], v[170:171]
    v_pk_mul_f32 v[188:189], v[188:189], v[172:173]
    v_pk_mul_f32 v[190:191], v[190:191], v[174:175]
    v_exp_f32 v192, -v192
    s_add_u32 s41, s41, 4096
    s_add_u32 m0, s48, 32768
    v_mfma_f32_16x16x32_bf16 v[48:51], a[132:135], a[192:195], 0
    ds_read_b64_tr_b16 a[148:149], v26 offset:21504
    v_cvt_pk_bf16_f32 v160, v176, v177
    v_mfma_f32_16x16x32_bf16 v[52:55], a[132:135], a[196:199], 0
    ds_read_b64_tr_b16 a[150:151], v26 offset:22016
    v_cvt_pk_bf16_f32 v161, v178, v179
    v_mfma_f32_16x16x32_bf16 v[56:59], a[132:135], a[200:203], 0
    v_exp_f32 v193, -v193
    buffer_load_dwordx4 v[240:243], v2, s[12:15], s41 offen offset:0 sc1
    buffer_load_dwordx4 v2, s[20:23], s40 offen offset:0 sc1 lds
    v_mfma_f32_16x16x32_bf16 v[60:63], a[132:135], a[204:207], 0
    s_waitcnt lgkmcnt(6)
    v_exp_f32 v194, -v194
    v_mfma_f32_16x16x32_bf16 v[64:67], a[136:139], a[192:195], 0
    ds_read_b64_tr_b16 a[152:153], v26 offset:22528
    v_cvt_pk_bf16_f32 v164, v180, v181
    v_mfma_f32_16x16x32_bf16 v[68:71], a[136:139], a[196:199], 0
    ds_read_b64_tr_b16 a[154:155], v26 offset:23040
    v_cvt_pk_bf16_f32 v165, v182, v183
    buffer_load_dwordx4 v[244:247], v2, s[12:15], s41 offen offset:1024 sc1
    v_mfma_f32_16x16x32_bf16 v[72:75], a[136:139], a[200:203], 0
    v_exp_f32 v195, -v195
    v_mfma_f32_16x16x32_bf16 v[76:79], a[136:139], a[204:207], 0
    s_waitcnt lgkmcnt(6)
    v_exp_f32 v196, -v196
    v_mfma_f32_16x16x32_bf16 v[80:83], a[140:143], a[192:195], 0
    ds_read_b64_tr_b16 a[156:157], v26 offset:23552
    v_cvt_pk_bf16_f32 v168, v184, v185
    buffer_load_dwordx4 v[248:251], v2, s[12:15], s41 offen offset:2048 sc1
    v_mfma_f32_16x16x32_bf16 v[84:87], a[140:143], a[196:199], 0
    ds_read_b64_tr_b16 a[158:159], v26 offset:24064
    v_cvt_pk_bf16_f32 v169, v186, v187
    v_mfma_f32_16x16x32_bf16 v[88:91], a[140:143], a[200:203], 0
    v_exp_f32 v197, -v197
    v_mfma_f32_16x16x32_bf16 v[92:95], a[140:143], a[204:207], 0
    s_waitcnt lgkmcnt(6)
    v_exp_f32 v198, -v198
    buffer_load_dwordx4 v[252:255], v2, s[12:15], s41 offen offset:3072 sc1
    v_mfma_f32_16x16x32_bf16 v[96:99], a[144:147], a[192:195], 0
    ds_read_b64_tr_b16 a[128:129], v26 offset:24576
    v_cvt_pk_bf16_f32 v172, v188, v189
    v_mfma_f32_16x16x32_bf16 v[100:103], a[144:147], a[196:199], 0
    ds_read_b64_tr_b16 a[130:131], v26 offset:25088
    v_cvt_pk_bf16_f32 v173, v190, v191
    s_add_u32 s41, s41, 4096
    buffer_load_dwordx4 v2, s[20:23], s40 offen offset:1024 sc1 lds
    v_mfma_f32_16x16x32_bf16 v[104:107], a[144:147], a[200:203], 0
    v_exp_f32 v199, -v199
    v_mfma_f32_16x16x32_bf16 v[108:111], a[144:147], a[204:207], 0
    s_waitcnt lgkmcnt(6)
    v_exp_f32 v200, -v200
    v_mfma_f32_16x16x32_bf16 v[112:115], a[148:151], a[192:195], 0
    ds_read_b64_tr_b16 a[132:133], v26 offset:25600
    v_add_f32 v192, 1.0, v192
    buffer_load_dwordx4 a[64:67], v2, s[12:15], s41 offen offset:0 sc1
    v_mfma_f32_16x16x32_bf16 v[116:119], a[148:151], a[196:199], 0
    ds_read_b64_tr_b16 a[134:135], v26 offset:26112
    v_add_f32_e64 v193, 1.0, v193
    v_mfma_f32_16x16x32_bf16 v[120:123], a[148:151], a[200:203], 0
    v_exp_f32 v201, -v201
    v_mfma_f32_16x16x32_bf16 v[124:127], a[148:151], a[204:207], 0
    s_waitcnt lgkmcnt(6)
    v_exp_f32 v202, -v202
    buffer_load_dwordx4 a[68:71], v2, s[12:15], s41 offen offset:1024 sc1
    v_mfma_f32_16x16x32_bf16 v[128:131], a[152:155], a[192:195], 0
    ds_read_b64_tr_b16 a[136:137], v26 offset:26624
    v_add_f32 v194, 1.0, v194
    v_mfma_f32_16x16x32_bf16 v[132:135], a[152:155], a[196:199], 0
    ds_read_b64_tr_b16 a[138:139], v26 offset:27136
    v_add_f32_e64 v195, 1.0, v195
    v_mfma_f32_16x16x32_bf16 v[136:139], a[152:155], a[200:203], 0
    v_exp_f32 v203, -v203
    buffer_load_dwordx4 a[72:75], v2, s[12:15], s41 offen offset:2048 sc1
    v_mfma_f32_16x16x32_bf16 v[140:143], a[152:155], a[204:207], 0
    s_waitcnt lgkmcnt(6)
    v_exp_f32 v204, -v204
    v_mfma_f32_16x16x32_bf16 v[144:147], a[156:159], a[192:195], 0
    ds_read_b64_tr_b16 a[140:141], v26 offset:27648
    v_add_f32 v196, 1.0, v196
    v_mfma_f32_16x16x32_bf16 v[148:151], a[156:159], a[196:199], 0
    ds_read_b64_tr_b16 a[142:143], v26 offset:28160
    v_add_f32_e64 v197, 1.0, v197
    buffer_load_dwordx4 a[76:79], v2, s[12:15], s41 offen offset:3072 sc1
    v_mfma_f32_16x16x32_bf16 v[152:155], a[156:159], a[200:203], 0
    v_exp_f32 v205, -v205
    v_mfma_f32_16x16x32_bf16 v[156:159], a[156:159], a[204:207], 0
    s_waitcnt vmcnt(17)
    s_waitcnt lgkmcnt(6)
    v_exp_f32 v206, -v206
    s_add_u32 s41, s41, 4096
    v_mfma_f32_16x16x32_bf16 v[32:35], a[128:131], a[208:211], v[32:35]
    ds_read_b64_tr_b16 a[144:145], v26 offset:28672
    v_add_f32_e64 v198, 1.0, v198
    buffer_load_dwordx4 v2, s[20:23], s40 offen offset:2048 sc1 lds
    v_mfma_f32_16x16x32_bf16 v[36:39], a[128:131], a[212:215], v[36:39]
    ds_read_b64_tr_b16 a[146:147], v26 offset:29184
    v_add_f32_e64 v199, 1.0, v199
    v_mfma_f32_16x16x32_bf16 v[40:43], a[128:131], a[216:219], v[40:43]
    v_exp_f32 v207, -v207
    buffer_load_dwordx4 a[80:83], v2, s[12:15], s41 offen offset:0 sc1
    v_mfma_f32_16x16x32_bf16 v[44:47], a[128:131], a[220:223], v[44:47]
    s_waitcnt lgkmcnt(6)
    v_rcp_f32 v192, v192
    v_mfma_f32_16x16x32_bf16 v[48:51], a[132:135], a[208:211], v[48:51]
    ds_read_b64_tr_b16 a[148:149], v26 offset:29696
    v_add_f32_e64 v200, 1.0, v200
    v_mfma_f32_16x16x32_bf16 v[52:55], a[132:135], a[212:215], v[52:55]
    ds_read_b64_tr_b16 a[150:151], v26 offset:30208
    v_add_f32_e64 v201, 1.0, v201
    v_mfma_f32_16x16x32_bf16 v[56:59], a[132:135], a[216:219], v[56:59]
    v_rcp_f32_e64 v193, v193
    v_mfma_f32_16x16x32_bf16 v[60:63], a[132:135], a[220:223], v[60:63]
    s_waitcnt lgkmcnt(6)
    v_rcp_f32 v194, v194
    buffer_load_dwordx4 a[84:87], v2, s[12:15], s41 offen offset:1024 sc1
    v_mfma_f32_16x16x32_bf16 v[64:67], a[136:139], a[208:211], v[64:67]
    ds_read_b64_tr_b16 a[152:153], v26 offset:30720
    v_add_f32_e64 v202, 1.0, v202
    v_mfma_f32_16x16x32_bf16 v[68:71], a[136:139], a[212:215], v[68:71]
    ds_read_b64_tr_b16 a[154:155], v26 offset:31232
    v_add_f32_e64 v203, 1.0, v203
    v_mfma_f32_16x16x32_bf16 v[72:75], a[136:139], a[216:219], v[72:75]
    v_rcp_f32_e64 v195, v195
    v_mfma_f32_16x16x32_bf16 v[76:79], a[136:139], a[220:223], v[76:79]
    s_waitcnt lgkmcnt(6)
    v_rcp_f32 v196, v196
    v_mfma_f32_16x16x32_bf16 v[80:83], a[140:143], a[208:211], v[80:83]
    ds_read_b64_tr_b16 a[156:157], v26 offset:31744
    v_add_f32_e64 v204, 1.0, v204
    v_mfma_f32_16x16x32_bf16 v[84:87], a[140:143], a[212:215], v[84:87]
    ds_read_b64_tr_b16 a[158:159], v26 offset:32256
    v_add_f32_e64 v205, 1.0, v205
    v_mfma_f32_16x16x32_bf16 v[88:91], a[140:143], a[216:219], v[88:91]
    v_rcp_f32_e64 v197, v197
    buffer_load_dwordx4 v2, s[20:23], s40 offen offset:3072 sc1 lds
    v_mfma_f32_16x16x32_bf16 v[92:95], a[140:143], a[220:223], v[92:95]
    s_waitcnt lgkmcnt(6)
    s_waitcnt vmcnt(16)
    s_barrier
    s_cmp_lg_u32 s3, 0
    s_cbranch_scc1 L_wf_12
    s_mov_b64 exec, 1
    v_mov_b32 v3, 0
    v_mov_b32 v4, 1
    buffer_atomic_add v4, v3, s[24:27], s51 offen sc1
    s_mov_b64 exec, -1
L_wf_12:
    v_rcp_f32 v198, v198
    buffer_load_dwordx4 a[88:91], v2, s[12:15], s41 offen offset:2048 sc1
    v_mfma_f32_16x16x32_bf16 v[96:99], a[144:147], a[208:211], v[96:99]
    ds_read_b64_tr_b16 a[128:129], v28 offset:16384
    v_add_f32_e64 v206, 1.0, v206
    s_add_u32 s40, s40, 16384
    v_mfma_f32_16x16x32_bf16 v[100:103], a[144:147], a[212:215], v[100:103]
    ds_read_b64_tr_b16 a[130:131], v28 offset:16896
    v_add_f32_e64 v207, 1.0, v207
    v_mfma_f32_16x16x32_bf16 v[104:107], a[144:147], a[216:219], v[104:107]
    v_rcp_f32_e64 v199, v199
    v_mfma_f32_16x16x32_bf16 v[108:111], a[144:147], a[220:223], v[108:111]
    s_waitcnt lgkmcnt(6)
    v_rcp_f32 v200, v200
    v_mfma_f32_16x16x32_bf16 v[112:115], a[148:151], a[208:211], v[112:115]
    ds_read_b64_tr_b16 a[132:133], v28 offset:17408
    buffer_load_dwordx4 a[92:95], v2, s[12:15], s41 offen offset:3072 sc1
    v_mfma_f32_16x16x32_bf16 v[116:119], a[148:151], a[212:215], v[116:119]
    ds_read_b64_tr_b16 a[134:135], v28 offset:17920
    s_add_u32 s41, s41, 4096
    v_mfma_f32_16x16x32_bf16 v[120:123], a[148:151], a[216:219], v[120:123]
    v_rcp_f32_e64 v201, v201
    v_mfma_f32_16x16x32_bf16 v[124:127], a[148:151], a[220:223], v[124:127]
    s_waitcnt lgkmcnt(6)
    v_rcp_f32 v202, v202
    v_mfma_f32_16x16x32_bf16 v[128:131], a[152:155], a[208:211], v[128:131]
    ds_read_b64_tr_b16 a[136:137], v28 offset:18432
    v_mfma_f32_16x16x32_bf16 v[132:135], a[152:155], a[212:215], v[132:135]
    ds_read_b64_tr_b16 a[138:139], v28 offset:18944
    v_mfma_f32_16x16x32_bf16 v[136:139], a[152:155], a[216:219], v[136:139]
    v_rcp_f32_e64 v203, v203
    v_mfma_f32_16x16x32_bf16 v[140:143], a[152:155], a[220:223], v[140:143]
    s_waitcnt lgkmcnt(6)
    v_rcp_f32 v204, v204
    v_mfma_f32_16x16x32_bf16 v[144:147], a[156:159], a[208:211], v[144:147]
    ds_read_b64_tr_b16 a[140:141], v28 offset:19456
    s_add_u32 m0, s48, 49152
    v_mfma_f32_16x16x32_bf16 v[148:151], a[156:159], a[212:215], v[148:151]
    ds_read_b64_tr_b16 a[142:143], v28 offset:19968
    buffer_load_dwordx4 v2, s[20:23], s40 offen offset:0 sc1 lds
    v_mfma_f32_16x16x32_bf16 v[152:155], a[156:159], a[216:219], v[152:155]
    v_rcp_f32_e64 v205, v205
    buffer_load_dwordx4 a[96:99], v2, s[12:15], s41 offen offset:0 sc1
    v_mfma_f32_16x16x32_bf16 v[156:159], a[156:159], a[220:223], v[156:159]
    s_waitcnt vmcnt(18)
    s_waitcnt lgkmcnt(6)
    v_rcp_f32_e64 v206, v206
    v_mfma_f32_16x16x32_bf16 v[32:35], a[128:131], v[224:227], v[32:35]
    ds_read_b64_tr_b16 a[144:145], v28 offset:20480
    v_mfma_f32_16x16x32_bf16 v[36:39], a[128:131], v[228:231], v[36:39]
    ds_read_b64_tr_b16 a[146:147], v28 offset:20992
    v_mfma_f32_16x16x32_bf16 v[40:43], a[128:131], v[232:235], v[40:43]
    v_rcp_f32_e64 v207, v207
    v_mfma_f32_16x16x32_bf16 v[44:47], a[128:131], v[236:239], v[44:47]
    s_waitcnt lgkmcnt(6)
    v_pk_mul_f32 v[208:209], v[208:209], v[192:193]
    v_pk_mul_f32 v[210:211], v[210:211], v[194:195]
    v_pk_mul_f32 v[212:213], v[212:213], v[196:197]
    v_pk_mul_f32 v[214:215], v[214:215], v[198:199]
    v_pk_mul_f32 v[216:217], v[216:217], v[200:201]
    v_pk_mul_f32 v[218:219], v[218:219], v[202:203]
    v_pk_mul_f32 v[220:221], v[220:221], v[204:205]
    v_pk_mul_f32 v[222:223], v[222:223], v[206:207]
    v_mfma_f32_16x16x32_bf16 v[48:51], a[132:135], v[224:227], v[48:51]
    ds_read_b64_tr_b16 a[148:149], v28 offset:21504
    v_cvt_pk_bf16_f32 v162, v208, v209
    v_mfma_f32_16x16x32_bf16 v[52:55], a[132:135], v[228:231], v[52:55]
    ds_read_b64_tr_b16 a[150:151], v28 offset:22016
    v_cvt_pk_bf16_f32 v163, v210, v211
    v_mfma_f32_16x16x32_bf16 v[56:59], a[132:135], v[232:235], v[56:59]
    buffer_store_dwordx4 v[160:163], v2, s[12:15], s39 offen offset:0 sc1
    buffer_load_dwordx4 a[100:103], v2, s[12:15], s41 offen offset:1024 sc1
    v_mfma_f32_16x16x32_bf16 v[60:63], a[132:135], v[236:239], v[60:63]
    s_waitcnt lgkmcnt(6)
    v_cvt_pk_bf16_f32 v166, v212, v213
    v_mfma_f32_16x16x32_bf16 v[64:67], a[136:139], v[224:227], v[64:67]
    ds_read_b64_tr_b16 a[152:153], v28 offset:22528
    v_cvt_pk_bf16_f32 v167, v214, v215
    v_mfma_f32_16x16x32_bf16 v[68:71], a[136:139], v[228:231], v[68:71]
    ds_read_b64_tr_b16 a[154:155], v28 offset:23040
    buffer_store_dwordx4 v[164:167], v2, s[12:15], s39 offen offset:1024 sc1
    v_mfma_f32_16x16x32_bf16 v[72:75], a[136:139], v[232:235], v[72:75]
    v_cvt_pk_bf16_f32 v170, v216, v217
    buffer_load_dwordx4 v2, s[20:23], s40 offen offset:1024 sc1 lds
    v_mfma_f32_16x16x32_bf16 v[76:79], a[136:139], v[236:239], v[76:79]
    s_waitcnt lgkmcnt(6)
    v_cvt_pk_bf16_f32 v171, v218, v219
    v_mfma_f32_16x16x32_bf16 v[80:83], a[140:143], v[224:227], v[80:83]
    ds_read_b64_tr_b16 a[156:157], v28 offset:23552
    buffer_store_dwordx4 v[168:171], v2, s[12:15], s39 offen offset:2048 sc1
    v_mfma_f32_16x16x32_bf16 v[84:87], a[140:143], v[228:231], v[84:87]
    ds_read_b64_tr_b16 a[158:159], v28 offset:24064
    v_cvt_pk_bf16_f32 v174, v220, v221
    v_mfma_f32_16x16x32_bf16 v[88:91], a[140:143], v[232:235], v[88:91]
    v_cvt_pk_bf16_f32 v175, v222, v223
    buffer_load_dwordx4 a[104:107], v2, s[12:15], s41 offen offset:2048 sc1
    v_mfma_f32_16x16x32_bf16 v[92:95], a[140:143], v[236:239], v[92:95]
    s_waitcnt lgkmcnt(6)
    buffer_store_dwordx4 v[172:175], v2, s[12:15], s39 offen offset:3072 sc1
    v_mfma_f32_16x16x32_bf16 v[96:99], a[144:147], v[224:227], v[96:99]
    ds_read_b64_tr_b16 a[128:129], v28 offset:24576
    v_mfma_f32_16x16x32_bf16 v[100:103], a[144:147], v[228:231], v[100:103]
    ds_read_b64_tr_b16 a[130:131], v28 offset:25088
    v_mfma_f32_16x16x32_bf16 v[104:107], a[144:147], v[232:235], v[104:107]
    v_mfma_f32_16x16x32_bf16 v[108:111], a[144:147], v[236:239], v[108:111]
    s_waitcnt lgkmcnt(6)
    buffer_load_dwordx4 a[108:111], v2, s[12:15], s41 offen offset:3072 sc1
    s_add_u32 s41, s41, 4096
    v_mfma_f32_16x16x32_bf16 v[112:115], a[148:151], v[224:227], v[112:115]
    ds_read_b64_tr_b16 a[132:133], v28 offset:25600
    v_mfma_f32_16x16x32_bf16 v[116:119], a[148:151], v[228:231], v[116:119]
    ds_read_b64_tr_b16 a[134:135], v28 offset:26112
    v_mfma_f32_16x16x32_bf16 v[120:123], a[148:151], v[232:235], v[120:123]
    v_mfma_f32_16x16x32_bf16 v[124:127], a[148:151], v[236:239], v[124:127]
    s_waitcnt lgkmcnt(6)
    v_mfma_f32_16x16x32_bf16 v[128:131], a[152:155], v[224:227], v[128:131]
    ds_read_b64_tr_b16 a[136:137], v28 offset:26624
    buffer_load_dwordx4 v2, s[20:23], s40 offen offset:2048 sc1 lds
    v_mfma_f32_16x16x32_bf16 v[132:135], a[152:155], v[228:231], v[132:135]
    ds_read_b64_tr_b16 a[138:139], v28 offset:27136
    v_mfma_f32_16x16x32_bf16 v[136:139], a[152:155], v[232:235], v[136:139]
    v_mfma_f32_16x16x32_bf16 v[140:143], a[152:155], v[236:239], v[140:143]
    s_waitcnt lgkmcnt(6)
    buffer_load_dwordx4 a[112:115], v2, s[12:15], s41 offen offset:0 sc1
    buffer_load_dword v30, v1, s[24:27], s51 offen sc1
    v_mfma_f32_16x16x32_bf16 v[144:147], a[156:159], v[224:227], v[144:147]
    ds_read_b64_tr_b16 a[140:141], v28 offset:27648
    v_mfma_f32_16x16x32_bf16 v[148:151], a[156:159], v[228:231], v[148:151]
    ds_read_b64_tr_b16 a[142:143], v28 offset:28160
    v_mfma_f32_16x16x32_bf16 v[152:155], a[156:159], v[232:235], v[152:155]
    v_mfma_f32_16x16x32_bf16 v[156:159], a[156:159], v[236:239], v[156:159]
    s_waitcnt vmcnt(24)
    s_waitcnt lgkmcnt(6)
    v_mfma_f32_16x16x32_bf16 v[32:35], a[128:131], v[240:243], v[32:35]
    ds_read_b64_tr_b16 a[144:145], v28 offset:28672
    v_mfma_f32_16x16x32_bf16 v[36:39], a[128:131], v[244:247], v[36:39]
    ds_read_b64_tr_b16 a[146:147], v28 offset:29184
    v_mfma_f32_16x16x32_bf16 v[40:43], a[128:131], v[248:251], v[40:43]
    v_mfma_f32_16x16x32_bf16 v[44:47], a[128:131], v[252:255], v[44:47]
    s_waitcnt lgkmcnt(6)
    buffer_load_dwordx4 a[116:119], v2, s[12:15], s41 offen offset:1024 sc1
    v_mfma_f32_16x16x32_bf16 v[48:51], a[132:135], v[240:243], v[48:51]
    ds_read_b64_tr_b16 a[148:149], v28 offset:29696
    v_mfma_f32_16x16x32_bf16 v[52:55], a[132:135], v[244:247], v[52:55]
    ds_read_b64_tr_b16 a[150:151], v28 offset:30208
    v_mfma_f32_16x16x32_bf16 v[56:59], a[132:135], v[248:251], v[56:59]
    buffer_load_dwordx4 v2, s[20:23], s40 offen offset:3072 sc1 lds
    s_add_u32 s40, s40, 16384
    v_mfma_f32_16x16x32_bf16 v[60:63], a[132:135], v[252:255], v[60:63]
    s_waitcnt lgkmcnt(6)
    v_mfma_f32_16x16x32_bf16 v[64:67], a[136:139], v[240:243], v[64:67]
    ds_read_b64_tr_b16 a[152:153], v28 offset:30720
    v_mfma_f32_16x16x32_bf16 v[68:71], a[136:139], v[244:247], v[68:71]
    ds_read_b64_tr_b16 a[154:155], v28 offset:31232
    v_mfma_f32_16x16x32_bf16 v[72:75], a[136:139], v[248:251], v[72:75]
    buffer_load_dwordx4 a[120:123], v2, s[12:15], s41 offen offset:2048 sc1
    v_mfma_f32_16x16x32_bf16 v[76:79], a[136:139], v[252:255], v[76:79]
    s_waitcnt lgkmcnt(6)
    v_mfma_f32_16x16x32_bf16 v[80:83], a[140:143], v[240:243], v[80:83]
    ds_read_b64_tr_b16 a[156:157], v28 offset:31744
    v_mfma_f32_16x16x32_bf16 v[84:87], a[140:143], v[244:247], v[84:87]
    ds_read_b64_tr_b16 a[158:159], v28 offset:32256
    v_mfma_f32_16x16x32_bf16 v[88:91], a[140:143], v[248:251], v[88:91]
    v_mfma_f32_16x16x32_bf16 v[92:95], a[140:143], v[252:255], v[92:95]
    s_waitcnt lgkmcnt(6)
    s_waitcnt vmcnt(18)
    s_barrier
    v_mfma_f32_16x16x32_bf16 v[96:99], a[144:147], v[240:243], v[96:99]
    ds_read_b64_tr_b16 a[128:129], v28 offset:32768
    v_mfma_f32_16x16x32_bf16 v[100:103], a[144:147], v[244:247], v[100:103]
    ds_read_b64_tr_b16 a[130:131], v28 offset:33280
    v_mfma_f32_16x16x32_bf16 v[104:107], a[144:147], v[248:251], v[104:107]
    buffer_load_dwordx4 a[124:127], v2, s[12:15], s41 offen offset:3072 sc1
    s_add_u32 s41, s41, 4096
    v_mfma_f32_16x16x32_bf16 v[108:111], a[144:147], v[252:255], v[108:111]
    s_waitcnt lgkmcnt(6)
    v_mfma_f32_16x16x32_bf16 v[112:115], a[148:151], v[240:243], v[112:115]
    ds_read_b64_tr_b16 a[132:133], v28 offset:33792
    v_mfma_f32_16x16x32_bf16 v[116:119], a[148:151], v[244:247], v[116:119]
    ds_read_b64_tr_b16 a[134:135], v28 offset:34304
    s_add_u32 m0, s48, 65536
    v_mfma_f32_16x16x32_bf16 v[120:123], a[148:151], v[248:251], v[120:123]
    buffer_load_dwordx4 v2, s[20:23], s40 offen offset:0 sc1 lds
    v_mfma_f32_16x16x32_bf16 v[124:127], a[148:151], v[252:255], v[124:127]
    s_waitcnt lgkmcnt(6)
    v_mfma_f32_16x16x32_bf16 v[128:131], a[152:155], v[240:243], v[128:131]
    ds_read_b64_tr_b16 a[136:137], v28 offset:34816
    v_mfma_f32_16x16x32_bf16 v[132:135], a[152:155], v[244:247], v[132:135]
    ds_read_b64_tr_b16 a[138:139], v28 offset:35328
    v_mfma_f32_16x16x32_bf16 v[136:139], a[152:155], v[248:251], v[136:139]
    v_mfma_f32_16x16x32_bf16 v[140:143], a[152:155], v[252:255], v[140:143]
    s_waitcnt lgkmcnt(6)
    v_mfma_f32_16x16x32_bf16 v[144:147], a[156:159], v[240:243], v[144:147]
    ds_read_b64_tr_b16 a[140:141], v28 offset:35840
    v_mfma_f32_16x16x32_bf16 v[148:151], a[156:159], v[244:247], v[148:151]
    ds_read_b64_tr_b16 a[142:143], v28 offset:36352
    v_mfma_f32_16x16x32_bf16 v[152:155], a[156:159], v[248:251], v[152:155]
    v_mfma_f32_16x16x32_bf16 v[156:159], a[156:159], v[252:255], v[156:159]
    s_waitcnt vmcnt(24)
    s_waitcnt lgkmcnt(6)
    v_mfma_f32_16x16x32_bf16 v[32:35], a[128:131], a[64:67], v[32:35]
    ds_read_b64_tr_b16 a[144:145], v28 offset:36864
    v_mfma_f32_16x16x32_bf16 v[36:39], a[128:131], a[68:71], v[36:39]
    ds_read_b64_tr_b16 a[146:147], v28 offset:37376
    v_mfma_f32_16x16x32_bf16 v[40:43], a[128:131], a[72:75], v[40:43]
    v_mfma_f32_16x16x32_bf16 v[44:47], a[128:131], a[76:79], v[44:47]
    s_waitcnt lgkmcnt(6)
    buffer_load_dwordx4 v2, s[20:23], s40 offen offset:1024 sc1 lds
    v_mfma_f32_16x16x32_bf16 v[48:51], a[132:135], a[64:67], v[48:51]
    ds_read_b64_tr_b16 a[148:149], v28 offset:37888
    v_mfma_f32_16x16x32_bf16 v[52:55], a[132:135], a[68:71], v[52:55]
    ds_read_b64_tr_b16 a[150:151], v28 offset:38400
    v_mfma_f32_16x16x32_bf16 v[56:59], a[132:135], a[72:75], v[56:59]
    v_mfma_f32_16x16x32_bf16 v[60:63], a[132:135], a[76:79], v[60:63]
    s_waitcnt lgkmcnt(6)
    v_mfma_f32_16x16x32_bf16 v[64:67], a[136:139], a[64:67], v[64:67]
    ds_read_b64_tr_b16 a[152:153], v28 offset:38912
    v_mfma_f32_16x16x32_bf16 v[68:71], a[136:139], a[68:71], v[68:71]
    ds_read_b64_tr_b16 a[154:155], v28 offset:39424
    v_mfma_f32_16x16x32_bf16 v[72:75], a[136:139], a[72:75], v[72:75]
    v_mfma_f32_16x16x32_bf16 v[76:79], a[136:139], a[76:79], v[76:79]
    s_waitcnt lgkmcnt(6)
    s_waitcnt vmcnt(6)
    v_readfirstlane_b32 s30, v30
    s_mov_b32 s56, 0
    s_cmp_ge_u32 s30, 8
    s_cbranch_scc1 L_f3bok
L_poll_17:
    buffer_load_dword v4, v1, s[24:27], s51 offen sc1
    s_add_u32 s56, s56, 1
    s_waitcnt vmcnt(0)
    v_readfirstlane_b32 s30, v4
    s_cmp_ge_u32 s30, 8
    s_cbranch_scc1 L_f3bok
    s_cmp_lt_u32 s56, 400000
    s_cbranch_scc1 L_poll_17
L_f3bok:
    buffer_load_dwordx4 a[0:3], v2, s[12:15], s41 offen offset:0 sc1
    v_mfma_f32_16x16x32_bf16 v[80:83], a[140:143], a[64:67], v[80:83]
    ds_read_b64_tr_b16 a[156:157], v28 offset:39936
    buffer_load_dwordx4 a[4:7], v2, s[12:15], s41 offen offset:1024 sc1
    v_mfma_f32_16x16x32_bf16 v[84:87], a[140:143], a[68:71], v[84:87]
    ds_read_b64_tr_b16 a[158:159], v28 offset:40448
    buffer_load_dwordx4 a[8:11], v2, s[12:15], s41 offen offset:2048 sc1
    v_mfma_f32_16x16x32_bf16 v[88:91], a[140:143], a[72:75], v[88:91]
    v_mfma_f32_16x16x32_bf16 v[92:95], a[140:143], a[76:79], v[92:95]
    s_waitcnt lgkmcnt(6)
    v_mfma_f32_16x16x32_bf16 v[96:99], a[144:147], a[64:67], v[96:99]
    ds_read_b64_tr_b16 a[128:129], v28 offset:40960
    v_mfma_f32_16x16x32_bf16 v[100:103], a[144:147], a[68:71], v[100:103]
    ds_read_b64_tr_b16 a[130:131], v28 offset:41472
    buffer_load_dwordx4 a[12:15], v2, s[12:15], s41 offen offset:3072 sc1
    v_mfma_f32_16x16x32_bf16 v[104:107], a[144:147], a[72:75], v[104:107]
    s_add_u32 s41, s41, 4096
    buffer_load_dwordx4 v2, s[20:23], s40 offen offset:2048 sc1 lds
    v_mfma_f32_16x16x32_bf16 v[108:111], a[144:147], a[76:79], v[108:111]
    s_waitcnt lgkmcnt(6)
    v_mfma_f32_16x16x32_bf16 v[112:115], a[148:151], a[64:67], v[112:115]
    ds_read_b64_tr_b16 a[132:133], v28 offset:41984
    v_mfma_f32_16x16x32_bf16 v[116:119], a[148:151], a[68:71], v[116:119]
    ds_read_b64_tr_b16 a[134:135], v28 offset:42496
    v_mfma_f32_16x16x32_bf16 v[120:123], a[148:151], a[72:75], v[120:123]
    v_mfma_f32_16x16x32_bf16 v[124:127], a[148:151], a[76:79], v[124:127]
    s_waitcnt lgkmcnt(6)
    v_mfma_f32_16x16x32_bf16 v[128:131], a[152:155], a[64:67], v[128:131]
    ds_read_b64_tr_b16 a[136:137], v28 offset:43008
    v_mfma_f32_16x16x32_bf16 v[132:135], a[152:155], a[68:71], v[132:135]
    ds_read_b64_tr_b16 a[138:139], v28 offset:43520
    buffer_load_dwordx4 a[16:19], v2, s[12:15], s41 offen offset:0 sc1
    v_mfma_f32_16x16x32_bf16 v[136:139], a[152:155], a[72:75], v[136:139]
    v_mfma_f32_16x16x32_bf16 v[140:143], a[152:155], a[76:79], v[140:143]
    s_waitcnt lgkmcnt(6)
    v_mfma_f32_16x16x32_bf16 v[144:147], a[156:159], a[64:67], v[144:147]
    ds_read_b64_tr_b16 a[140:141], v28 offset:44032
    v_mfma_f32_16x16x32_bf16 v[148:151], a[156:159], a[68:71], v[148:151]
    ds_read_b64_tr_b16 a[142:143], v28 offset:44544
    v_mfma_f32_16x16x32_bf16 v[152:155], a[156:159], a[72:75], v[152:155]
    v_mfma_f32_16x16x32_bf16 v[156:159], a[156:159], a[76:79], v[156:159]
    s_waitcnt vmcnt(25)
    s_waitcnt lgkmcnt(6)
    v_mfma_f32_16x16x32_bf16 v[32:35], a[128:131], a[80:83], v[32:35]
    ds_read_b64_tr_b16 a[144:145], v28 offset:45056
    buffer_load_dwordx4 v2, s[20:23], s40 offen offset:3072 sc1 lds
    v_mfma_f32_16x16x32_bf16 v[36:39], a[128:131], a[84:87], v[36:39]
    ds_read_b64_tr_b16 a[146:147], v28 offset:45568
    s_add_u32 s40, s40, 16384
    v_mfma_f32_16x16x32_bf16 v[40:43], a[128:131], a[88:91], v[40:43]
    buffer_load_dwordx4 a[20:23], v2, s[12:15], s41 offen offset:1024 sc1
    v_mfma_f32_16x16x32_bf16 v[44:47], a[128:131], a[92:95], v[44:47]
    s_waitcnt lgkmcnt(6)
    v_mfma_f32_16x16x32_bf16 v[48:51], a[132:135], a[80:83], v[48:51]
    ds_read_b64_tr_b16 a[148:149], v28 offset:46080
    v_mfma_f32_16x16x32_bf16 v[52:55], a[132:135], a[84:87], v[52:55]
    ds_read_b64_tr_b16 a[150:151], v28 offset:46592
    v_mfma_f32_16x16x32_bf16 v[56:59], a[132:135], a[88:91], v[56:59]
    v_mfma_f32_16x16x32_bf16 v[60:63], a[132:135], a[92:95], v[60:63]
    s_waitcnt lgkmcnt(6)
    v_mfma_f32_16x16x32_bf16 v[64:67], a[136:139], a[80:83], v[64:67]
    ds_read_b64_tr_b16 a[152:153], v28 offset:47104
    buffer_load_dwordx4 a[24:27], v2, s[12:15], s41 offen offset:2048 sc1
    v_mfma_f32_16x16x32_bf16 v[68:71], a[136:139], a[84:87], v[68:71]
    ds_read_b64_tr_b16 a[154:155], v28 offset:47616
    v_mfma_f32_16x16x32_bf16 v[72:75], a[136:139], a[88:91], v[72:75]
    v_mfma_f32_16x16x32_bf16 v[76:79], a[136:139], a[92:95], v[76:79]
    s_waitcnt lgkmcnt(6)
    v_mfma_f32_16x16x32_bf16 v[80:83], a[140:143], a[80:83], v[80:83]
    ds_read_b64_tr_b16 a[156:157], v28 offset:48128
    v_mfma_f32_16x16x32_bf16 v[84:87], a[140:143], a[84:87], v[84:87]
    ds_read_b64_tr_b16 a[158:159], v28 offset:48640
    v_mfma_f32_16x16x32_bf16 v[88:91], a[140:143], a[88:91], v[88:91]
    v_mfma_f32_16x16x32_bf16 v[92:95], a[140:143], a[92:95], v[92:95]
    s_waitcnt lgkmcnt(6)
    s_waitcnt vmcnt(13)
    s_barrier
    s_cmp_lg_u32 s3, 0
    s_cbranch_scc1 L_wf_13
    s_mov_b64 exec, 1
    v_mov_b32 v3, 0
    v_mov_b32_e64 v4, 1
    buffer_atomic_add v4, v3, s[24:27], s59 offen sc1
    s_mov_b64 exec, -1
L_wf_13:
    s_add_u32 m0, s48, 81920
    v_mfma_f32_16x16x32_bf16 v[96:99], a[144:147], a[80:83], v[96:99]
    ds_read_b64_tr_b16 a[128:129], v28 offset:49152
    buffer_load_dwordx4 v2, s[20:23], s40 offen offset:0 sc1 lds
    v_mfma_f32_16x16x32_bf16 v[100:103], a[144:147], a[84:87], v[100:103]
    ds_read_b64_tr_b16 a[130:131], v28 offset:49664
    buffer_load_dwordx4 a[28:31], v2, s[12:15], s41 offen offset:3072 sc1
    v_mfma_f32_16x16x32_bf16 v[104:107], a[144:147], a[88:91], v[104:107]
    s_add_u32 s41, s41, 4096
    v_mfma_f32_16x16x32_bf16 v[108:111], a[144:147], a[92:95], v[108:111]
    s_waitcnt lgkmcnt(6)
    v_mfma_f32_16x16x32_bf16 v[112:115], a[148:151], a[80:83], v[112:115]
    ds_read_b64_tr_b16 a[132:133], v28 offset:50176
    v_mfma_f32_16x16x32_bf16 v[116:119], a[148:151], a[84:87], v[116:119]
    ds_read_b64_tr_b16 a[134:135], v28 offset:50688
    v_mfma_f32_16x16x32_bf16 v[120:123], a[148:151], a[88:91], v[120:123]
    v_mfma_f32_16x16x32_bf16 v[124:127], a[148:151], a[92:95], v[124:127]
    s_waitcnt lgkmcnt(6)
    buffer_load_dwordx4 a[32:35], v2, s[12:15], s41 offen offset:0 sc1
    v_mfma_f32_16x16x32_bf16 v[128:131], a[152:155], a[80:83], v[128:131]
    ds_read_b64_tr_b16 a[136:137], v28 offset:51200
    v_mfma_f32_16x16x32_bf16 v[132:135], a[152:155], a[84:87], v[132:135]
    ds_read_b64_tr_b16 a[138:139], v28 offset:51712
    v_mfma_f32_16x16x32_bf16 v[136:139], a[152:155], a[88:91], v[136:139]
    v_mfma_f32_16x16x32_bf16 v[140:143], a[152:155], a[92:95], v[140:143]
    s_waitcnt lgkmcnt(6)
    v_mfma_f32_16x16x32_bf16 v[144:147], a[156:159], a[80:83], v[144:147]
    ds_read_b64_tr_b16 a[140:141], v28 offset:52224
    v_mfma_f32_16x16x32_bf16 v[148:151], a[156:159], a[84:87], v[148:151]
    ds_read_b64_tr_b16 a[142:143], v28 offset:52736
    buffer_load_dwordx4 v2, s[20:23], s40 offen offset:1024 sc1 lds
    v_mfma_f32_16x16x32_bf16 v[152:155], a[156:159], a[88:91], v[152:155]
    v_mfma_f32_16x16x32_bf16 v[156:159], a[156:159], a[92:95], v[156:159]
    s_waitcnt vmcnt(22)
    s_waitcnt lgkmcnt(6)
    buffer_load_dwordx4 a[36:39], v2, s[12:15], s41 offen offset:1024 sc1
    v_mfma_f32_16x16x32_bf16 v[32:35], a[128:131], a[96:99], v[32:35]
    ds_read_b64_tr_b16 a[144:145], v28 offset:53248
    v_mfma_f32_16x16x32_bf16 v[36:39], a[128:131], a[100:103], v[36:39]
    ds_read_b64_tr_b16 a[146:147], v28 offset:53760
    v_mfma_f32_16x16x32_bf16 v[40:43], a[128:131], a[104:107], v[40:43]
    v_mfma_f32_16x16x32_bf16 v[44:47], a[128:131], a[108:111], v[44:47]
    s_waitcnt lgkmcnt(6)
    v_mfma_f32_16x16x32_bf16 v[48:51], a[132:135], a[96:99], v[48:51]
    ds_read_b64_tr_b16 a[148:149], v28 offset:54272
    v_mfma_f32_16x16x32_bf16 v[52:55], a[132:135], a[100:103], v[52:55]
    ds_read_b64_tr_b16 a[150:151], v28 offset:54784
    v_mfma_f32_16x16x32_bf16 v[56:59], a[132:135], a[104:107], v[56:59]
    v_mfma_f32_16x16x32_bf16 v[60:63], a[132:135], a[108:111], v[60:63]
    s_waitcnt lgkmcnt(6)
    buffer_load_dwordx4 a[40:43], v2, s[12:15], s41 offen offset:2048 sc1
    v_mfma_f32_16x16x32_bf16 v[64:67], a[136:139], a[96:99], v[64:67]
    ds_read_b64_tr_b16 a[152:153], v28 offset:55296
    v_mfma_f32_16x16x32_bf16 v[68:71], a[136:139], a[100:103], v[68:71]
    ds_read_b64_tr_b16 a[154:155], v28 offset:55808
    v_mfma_f32_16x16x32_bf16 v[72:75], a[136:139], a[104:107], v[72:75]
    v_mfma_f32_16x16x32_bf16 v[76:79], a[136:139], a[108:111], v[76:79]
    s_waitcnt lgkmcnt(6)
    v_mfma_f32_16x16x32_bf16 v[80:83], a[140:143], a[96:99], v[80:83]
    ds_read_b64_tr_b16 a[156:157], v28 offset:56320
    buffer_load_dwordx4 v2, s[20:23], s40 offen offset:2048 sc1 lds
    v_mfma_f32_16x16x32_bf16 v[84:87], a[140:143], a[100:103], v[84:87]
    ds_read_b64_tr_b16 a[158:159], v28 offset:56832
    v_mfma_f32_16x16x32_bf16 v[88:91], a[140:143], a[104:107], v[88:91]
    buffer_load_dwordx4 a[44:47], v2, s[12:15], s41 offen offset:3072 sc1
    s_add_u32 s41, s41, 4096
    v_mfma_f32_16x16x32_bf16 v[92:95], a[140:143], a[108:111], v[92:95]
    s_waitcnt lgkmcnt(6)
    v_mfma_f32_16x16x32_bf16 v[96:99], a[144:147], a[96:99], v[96:99]
    ds_read_b64_tr_b16 a[128:129], v28 offset:57344
    v_mfma_f32_16x16x32_bf16 v[100:103], a[144:147], a[100:103], v[100:103]
    ds_read_b64_tr_b16 a[130:131], v28 offset:57856
    v_mfma_f32_16x16x32_bf16 v[104:107], a[144:147], a[104:107], v[104:107]
    v_mfma_f32_16x16x32_bf16 v[108:111], a[144:147], a[108:111], v[108:111]
    s_waitcnt lgkmcnt(6)
    v_mfma_f32_16x16x32_bf16 v[112:115], a[148:151], a[96:99], v[112:115]
    ds_read_b64_tr_b16 a[132:133], v28 offset:58368
    v_mfma_f32_16x16x32_bf16 v[116:119], a[148:151], a[100:103], v[116:119]
    ds_read_b64_tr_b16 a[134:135], v28 offset:58880
    v_mfma_f32_16x16x32_bf16 v[120:123], a[148:151], a[104:107], v[120:123]
    buffer_load_dwordx4 a[48:51], v2, s[12:15], s41 offen offset:0 sc1
    v_mfma_f32_16x16x32_bf16 v[124:127], a[148:151], a[108:111], v[124:127]
    s_waitcnt lgkmcnt(6)
    v_mfma_f32_16x16x32_bf16 v[128:131], a[152:155], a[96:99], v[128:131]
    ds_read_b64_tr_b16 a[136:137], v28 offset:59392
    v_mfma_f32_16x16x32_bf16 v[132:135], a[152:155], a[100:103], v[132:135]
    ds_read_b64_tr_b16 a[138:139], v28 offset:59904
    v_mfma_f32_16x16x32_bf16 v[136:139], a[152:155], a[104:107], v[136:139]
    buffer_load_dwordx4 v2, s[20:23], s40 offen offset:3072 sc1 lds
    s_add_u32 s40, s40, 16384
    v_mfma_f32_16x16x32_bf16 v[140:143], a[152:155], a[108:111], v[140:143]
    s_waitcnt lgkmcnt(6)
    v_mfma_f32_16x16x32_bf16 v[144:147], a[156:159], a[96:99], v[144:147]
    ds_read_b64_tr_b16 a[140:141], v28 offset:60416
    v_mfma_f32_16x16x32_bf16 v[148:151], a[156:159], a[100:103], v[148:151]
    ds_read_b64_tr_b16 a[142:143], v28 offset:60928
    v_mfma_f32_16x16x32_bf16 v[152:155], a[156:159], a[104:107], v[152:155]
    buffer_load_dwordx4 a[52:55], v2, s[12:15], s41 offen offset:1024 sc1
    v_mfma_f32_16x16x32_bf16 v[156:159], a[156:159], a[108:111], v[156:159]
    s_waitcnt vmcnt(22)
    s_waitcnt lgkmcnt(6)
    v_mfma_f32_16x16x32_bf16 v[32:35], a[128:131], a[112:115], v[32:35]
    ds_read_b64_tr_b16 a[144:145], v28 offset:61440
    v_mfma_f32_16x16x32_bf16 v[36:39], a[128:131], a[116:119], v[36:39]
    ds_read_b64_tr_b16 a[146:147], v28 offset:61952
    v_mfma_f32_16x16x32_bf16 v[40:43], a[128:131], a[120:123], v[40:43]
    v_mfma_f32_16x16x32_bf16 v[44:47], a[128:131], a[124:127], v[44:47]
    s_waitcnt lgkmcnt(6)
    v_mfma_f32_16x16x32_bf16 v[48:51], a[132:135], a[112:115], v[48:51]
    ds_read_b64_tr_b16 a[148:149], v28 offset:62464
    v_mfma_f32_16x16x32_bf16 v[52:55], a[132:135], a[116:119], v[52:55]
    ds_read_b64_tr_b16 a[150:151], v28 offset:62976
    v_mfma_f32_16x16x32_bf16 v[56:59], a[132:135], a[120:123], v[56:59]
    buffer_load_dwordx4 a[56:59], v2, s[12:15], s41 offen offset:2048 sc1
    v_mfma_f32_16x16x32_bf16 v[60:63], a[132:135], a[124:127], v[60:63]
    s_waitcnt lgkmcnt(6)
    v_mfma_f32_16x16x32_bf16 v[64:67], a[136:139], a[112:115], v[64:67]
    ds_read_b64_tr_b16 a[152:153], v28 offset:63488
    v_mfma_f32_16x16x32_bf16 v[68:71], a[136:139], a[116:119], v[68:71]
    ds_read_b64_tr_b16 a[154:155], v28 offset:64000
    s_add_u32 m0, s48, 98304
    v_mfma_f32_16x16x32_bf16 v[72:75], a[136:139], a[120:123], v[72:75]
    buffer_load_dwordx4 v2, s[20:23], s40 offen offset:0 sc1 lds
    v_mfma_f32_16x16x32_bf16 v[76:79], a[136:139], a[124:127], v[76:79]
    s_waitcnt lgkmcnt(6)
    v_mfma_f32_16x16x32_bf16 v[80:83], a[140:143], a[112:115], v[80:83]
    ds_read_b64_tr_b16 a[156:157], v28 offset:64512
    v_mfma_f32_16x16x32_bf16 v[84:87], a[140:143], a[116:119], v[84:87]
    ds_read_b64_tr_b16 a[158:159], v28 offset:65024
    buffer_load_dwordx4 a[60:63], v2, s[12:15], s41 offen offset:3072 sc1
    v_mfma_f32_16x16x32_bf16 v[88:91], a[140:143], a[120:123], v[88:91]
    s_add_u32 s41, s41, 4096
    v_mfma_f32_16x16x32_bf16 v[92:95], a[140:143], a[124:127], v[92:95]
    s_waitcnt lgkmcnt(6)
    s_waitcnt vmcnt(16)
    s_barrier
    v_mfma_f32_16x16x32_bf16 v[96:99], a[144:147], a[112:115], v[96:99]
    ds_read_b64_tr_b16 a[128:129], v27 offset:0
    v_mfma_f32_16x16x32_bf16 v[100:103], a[144:147], a[116:119], v[100:103]
    ds_read_b64_tr_b16 a[130:131], v27 offset:512
    v_mfma_f32_16x16x32_bf16 v[104:107], a[144:147], a[120:123], v[104:107]
    v_mfma_f32_16x16x32_bf16 v[108:111], a[144:147], a[124:127], v[108:111]
    s_waitcnt lgkmcnt(6)
    v_mfma_f32_16x16x32_bf16 v[112:115], a[148:151], a[112:115], v[112:115]
    ds_read_b64_tr_b16 a[132:133], v27 offset:1024
    v_mfma_f32_16x16x32_bf16 v[116:119], a[148:151], a[116:119], v[116:119]
    ds_read_b64_tr_b16 a[134:135], v27 offset:1536
    buffer_load_dwordx4 a[64:67], v2, s[12:15], s41 offen offset:0 sc1
    v_mfma_f32_16x16x32_bf16 v[120:123], a[148:151], a[120:123], v[120:123]
    v_mfma_f32_16x16x32_bf16 v[124:127], a[148:151], a[124:127], v[124:127]
    s_waitcnt lgkmcnt(6)
    buffer_load_dwordx4 v2, s[20:23], s40 offen offset:1024 sc1 lds
    v_mfma_f32_16x16x32_bf16 v[128:131], a[152:155], a[112:115], v[128:131]
    ds_read_b64_tr_b16 a[136:137], v27 offset:2048
    v_mfma_f32_16x16x32_bf16 v[132:135], a[152:155], a[116:119], v[132:135]
    ds_read_b64_tr_b16 a[138:139], v27 offset:2560
    v_mfma_f32_16x16x32_bf16 v[136:139], a[152:155], a[120:123], v[136:139]
    v_mfma_f32_16x16x32_bf16 v[140:143], a[152:155], a[124:127], v[140:143]
    s_waitcnt lgkmcnt(6)
    v_mfma_f32_16x16x32_bf16 v[144:147], a[156:159], a[112:115], v[144:147]
    ds_read_b64_tr_b16 a[140:141], v27 offset:3072
    v_mfma_f32_16x16x32_bf16 v[148:151], a[156:159], a[116:119], v[148:151]
    ds_read_b64_tr_b16 a[142:143], v27 offset:3584
    buffer_load_dwordx4 a[68:71], v2, s[12:15], s41 offen offset:1024 sc1
    v_mfma_f32_16x16x32_bf16 v[152:155], a[156:159], a[120:123], v[152:155]
    v_mfma_f32_16x16x32_bf16 v[156:159], a[156:159], a[124:127], v[156:159]
    s_waitcnt vmcnt(22)
    s_waitcnt lgkmcnt(6)
    v_mfma_f32_16x16x32_bf16 v[32:35], a[128:131], a[0:3], v[32:35]
    ds_read_b64_tr_b16 a[144:145], v27 offset:4096
    v_mfma_f32_16x16x32_bf16 v[36:39], a[128:131], a[4:7], v[36:39]
    ds_read_b64_tr_b16 a[146:147], v27 offset:4608
    v_mfma_f32_16x16x32_bf16 v[40:43], a[128:131], a[8:11], v[40:43]
    v_mfma_f32_16x16x32_bf16 v[44:47], a[128:131], a[12:15], v[44:47]
    s_waitcnt lgkmcnt(6)
    v_mfma_f32_16x16x32_bf16 v[48:51], a[132:135], a[0:3], v[48:51]
    ds_read_b64_tr_b16 a[148:149], v27 offset:5120
    buffer_load_dwordx4 a[72:75], v2, s[12:15], s41 offen offset:2048 sc1
    v_mfma_f32_16x16x32_bf16 v[52:55], a[132:135], a[4:7], v[52:55]
    ds_read_b64_tr_b16 a[150:151], v27 offset:5632
    v_mfma_f32_16x16x32_bf16 v[56:59], a[132:135], a[8:11], v[56:59]
    buffer_load_dwordx4 v2, s[20:23], s40 offen offset:2048 sc1 lds
    v_mfma_f32_16x16x32_bf16 v[60:63], a[132:135], a[12:15], v[60:63]
    s_waitcnt lgkmcnt(6)
    v_mfma_f32_16x16x32_bf16 v[64:67], a[136:139], a[0:3], v[64:67]
    ds_read_b64_tr_b16 a[152:153], v27 offset:6144
    v_mfma_f32_16x16x32_bf16 v[68:71], a[136:139], a[4:7], v[68:71]
    ds_read_b64_tr_b16 a[154:155], v27 offset:6656
    v_mfma_f32_16x16x32_bf16 v[72:75], a[136:139], a[8:11], v[72:75]
    v_mfma_f32_16x16x32_bf16 v[76:79], a[136:139], a[12:15], v[76:79]
    s_waitcnt lgkmcnt(6)
    v_mfma_f32_16x16x32_bf16 v[80:83], a[140:143], a[0:3], v[80:83]
    ds_read_b64_tr_b16 a[156:157], v27 offset:7168
    buffer_load_dwordx4 a[76:79], v2, s[12:15], s41 offen offset:3072 sc1
    v_mfma_f32_16x16x32_bf16 v[84:87], a[140:143], a[4:7], v[84:87]
    ds_read_b64_tr_b16 a[158:159], v27 offset:7680
    s_add_u32 s41, s41, 4096
    v_mfma_f32_16x16x32_bf16 v[88:91], a[140:143], a[8:11], v[88:91]
    v_mfma_f32_16x16x32_bf16 v[92:95], a[140:143], a[12:15], v[92:95]
    s_waitcnt lgkmcnt(6)
    v_mfma_f32_16x16x32_bf16 v[96:99], a[144:147], a[0:3], v[96:99]
    ds_read_b64_tr_b16 a[128:129], v27 offset:8192
    v_mfma_f32_16x16x32_bf16 v[100:103], a[144:147], a[4:7], v[100:103]
    ds_read_b64_tr_b16 a[130:131], v27 offset:8704
    v_mfma_f32_16x16x32_bf16 v[104:107], a[144:147], a[8:11], v[104:107]
    v_mfma_f32_16x16x32_bf16 v[108:111], a[144:147], a[12:15], v[108:111]
    s_waitcnt lgkmcnt(6)
    v_mfma_f32_16x16x32_bf16 v[112:115], a[148:151], a[0:3], v[112:115]
    ds_read_b64_tr_b16 a[132:133], v27 offset:9216
    buffer_load_dwordx4 a[80:83], v2, s[12:15], s41 offen offset:0 sc1
    v_mfma_f32_16x16x32_bf16 v[116:119], a[148:151], a[4:7], v[116:119]
    ds_read_b64_tr_b16 a[134:135], v27 offset:9728
    buffer_load_dwordx4 v2, s[20:23], s40 offen offset:3072 sc1 lds
    v_mfma_f32_16x16x32_bf16 v[120:123], a[148:151], a[8:11], v[120:123]
    s_add_u32 s40, s40, 16384
    v_mfma_f32_16x16x32_bf16 v[124:127], a[148:151], a[12:15], v[124:127]
    s_waitcnt lgkmcnt(6)
    v_mfma_f32_16x16x32_bf16 v[128:131], a[152:155], a[0:3], v[128:131]
    ds_read_b64_tr_b16 a[136:137], v27 offset:10240
    v_mfma_f32_16x16x32_bf16 v[132:135], a[152:155], a[4:7], v[132:135]
    ds_read_b64_tr_b16 a[138:139], v27 offset:10752
    v_mfma_f32_16x16x32_bf16 v[136:139], a[152:155], a[8:11], v[136:139]
    v_mfma_f32_16x16x32_bf16 v[140:143], a[152:155], a[12:15], v[140:143]
    s_waitcnt lgkmcnt(6)
    buffer_load_dwordx4 a[84:87], v2, s[12:15], s41 offen offset:1024 sc1
    v_mfma_f32_16x16x32_bf16 v[144:147], a[156:159], a[0:3], v[144:147]
    ds_read_b64_tr_b16 a[140:141], v27 offset:11264
    v_mfma_f32_16x16x32_bf16 v[148:151], a[156:159], a[4:7], v[148:151]
    ds_read_b64_tr_b16 a[142:143], v27 offset:11776
    v_mfma_f32_16x16x32_bf16 v[152:155], a[156:159], a[8:11], v[152:155]
    v_mfma_f32_16x16x32_bf16 v[156:159], a[156:159], a[12:15], v[156:159]
    s_waitcnt vmcnt(21)
    s_waitcnt lgkmcnt(6)
    v_mfma_f32_16x16x32_bf16 v[32:35], a[128:131], a[16:19], v[32:35]
    ds_read_b64_tr_b16 a[144:145], v27 offset:12288
    v_mfma_f32_16x16x32_bf16 v[36:39], a[128:131], a[20:23], v[36:39]
    ds_read_b64_tr_b16 a[146:147], v27 offset:12800
    v_mfma_f32_16x16x32_bf16 v[40:43], a[128:131], a[24:27], v[40:43]
    v_mfma_f32_16x16x32_bf16 v[44:47], a[128:131], a[28:31], v[44:47]
    s_waitcnt lgkmcnt(6)
    s_add_u32 m0, s48, 114688
    buffer_load_dwordx4 a[88:91], v2, s[12:15], s41 offen offset:2048 sc1
    v_mfma_f32_16x16x32_bf16 v[48:51], a[132:135], a[16:19], v[48:51]
    ds_read_b64_tr_b16 a[148:149], v27 offset:13312
    buffer_load_dwordx4 v2, s[20:23], s40 offen offset:0 sc1 lds
    v_mfma_f32_16x16x32_bf16 v[52:55], a[132:135], a[20:23], v[52:55]
    ds_read_b64_tr_b16 a[150:151], v27 offset:13824
    v_mfma_f32_16x16x32_bf16 v[56:59], a[132:135], a[24:27], v[56:59]
    v_mfma_f32_16x16x32_bf16 v[60:63], a[132:135], a[28:31], v[60:63]
    s_waitcnt lgkmcnt(6)
    v_mfma_f32_16x16x32_bf16 v[64:67], a[136:139], a[16:19], v[64:67]
    ds_read_b64_tr_b16 a[152:153], v27 offset:14336
    v_mfma_f32_16x16x32_bf16 v[68:71], a[136:139], a[20:23], v[68:71]
    ds_read_b64_tr_b16 a[154:155], v27 offset:14848
    v_mfma_f32_16x16x32_bf16 v[72:75], a[136:139], a[24:27], v[72:75]
    v_mfma_f32_16x16x32_bf16 v[76:79], a[136:139], a[28:31], v[76:79]
    s_waitcnt lgkmcnt(6)
    buffer_load_dwordx4 a[92:95], v2, s[12:15], s41 offen offset:3072 sc1
    s_add_u32 s41, s41, 4096
    v_mfma_f32_16x16x32_bf16 v[80:83], a[140:143], a[16:19], v[80:83]
    ds_read_b64_tr_b16 a[156:157], v27 offset:15360
    v_mfma_f32_16x16x32_bf16 v[84:87], a[140:143], a[20:23], v[84:87]
    ds_read_b64_tr_b16 a[158:159], v27 offset:15872
    v_mfma_f32_16x16x32_bf16 v[88:91], a[140:143], a[24:27], v[88:91]
    v_mfma_f32_16x16x32_bf16 v[92:95], a[140:143], a[28:31], v[92:95]
    s_waitcnt lgkmcnt(6)
    s_waitcnt vmcnt(16)
    s_barrier
    v_mfma_f32_16x16x32_bf16 v[96:99], a[144:147], a[16:19], v[96:99]
    ds_read_b64_tr_b16 a[128:129], v27 offset:16384
    v_mfma_f32_16x16x32_bf16 v[100:103], a[144:147], a[20:23], v[100:103]
    ds_read_b64_tr_b16 a[130:131], v27 offset:16896
    buffer_load_dwordx4 v2, s[20:23], s40 offen offset:1024 sc1 lds
    v_mfma_f32_16x16x32_bf16 v[104:107], a[144:147], a[24:27], v[104:107]
    v_mfma_f32_16x16x32_bf16 v[108:111], a[144:147], a[28:31], v[108:111]
    s_waitcnt lgkmcnt(6)
    buffer_load_dwordx4 a[96:99], v2, s[12:15], s41 offen offset:0 sc1
    v_mfma_f32_16x16x32_bf16 v[112:115], a[148:151], a[16:19], v[112:115]
    ds_read_b64_tr_b16 a[132:133], v27 offset:17408
    v_mfma_f32_16x16x32_bf16 v[116:119], a[148:151], a[20:23], v[116:119]
    ds_read_b64_tr_b16 a[134:135], v27 offset:17920
    v_mfma_f32_16x16x32_bf16 v[120:123], a[148:151], a[24:27], v[120:123]
    v_mfma_f32_16x16x32_bf16 v[124:127], a[148:151], a[28:31], v[124:127]
    s_waitcnt lgkmcnt(6)
    v_mfma_f32_16x16x32_bf16 v[128:131], a[152:155], a[16:19], v[128:131]
    ds_read_b64_tr_b16 a[136:137], v27 offset:18432
    v_mfma_f32_16x16x32_bf16 v[132:135], a[152:155], a[20:23], v[132:135]
    ds_read_b64_tr_b16 a[138:139], v27 offset:18944
    v_mfma_f32_16x16x32_bf16 v[136:139], a[152:155], a[24:27], v[136:139]
    buffer_load_dwordx4 a[100:103], v2, s[12:15], s41 offen offset:1024 sc1
    v_mfma_f32_16x16x32_bf16 v[140:143], a[152:155], a[28:31], v[140:143]
    s_waitcnt lgkmcnt(6)
    v_mfma_f32_16x16x32_bf16 v[144:147], a[156:159], a[16:19], v[144:147]
    ds_read_b64_tr_b16 a[140:141], v27 offset:19456
    v_mfma_f32_16x16x32_bf16 v[148:151], a[156:159], a[20:23], v[148:151]
    ds_read_b64_tr_b16 a[142:143], v27 offset:19968
    v_mfma_f32_16x16x32_bf16 v[152:155], a[156:159], a[24:27], v[152:155]
    v_mfma_f32_16x16x32_bf16 v[156:159], a[156:159], a[28:31], v[156:159]
    s_waitcnt vmcnt(21)
    s_waitcnt lgkmcnt(6)
    v_mfma_f32_16x16x32_bf16 v[32:35], a[128:131], a[32:35], v[32:35]
    ds_read_b64_tr_b16 a[144:145], v27 offset:20480
    buffer_load_dwordx4 v2, s[20:23], s40 offen offset:2048 sc1 lds
    v_mfma_f32_16x16x32_bf16 v[36:39], a[128:131], a[36:39], v[36:39]
    ds_read_b64_tr_b16 a[146:147], v27 offset:20992
    s_mov_b32 s8, s28
    v_mfma_f32_16x16x32_bf16 v[40:43], a[128:131], a[40:43], v[40:43]
    buffer_load_dwordx4 a[104:107], v2, s[12:15], s41 offen offset:2048 sc1
    s_mov_b32 s9, s29
    v_mfma_f32_16x16x32_bf16 v[44:47], a[128:131], a[44:47], v[44:47]
    s_waitcnt lgkmcnt(6)
    s_mov_b32 s10, 0x1000000
    v_mfma_f32_16x16x32_bf16 v[48:51], a[132:135], a[32:35], v[48:51]
    ds_read_b64_tr_b16 a[148:149], v27 offset:21504
    s_mov_b32 s11, 0x00020000
    v_mfma_f32_16x16x32_bf16 v[52:55], a[132:135], a[36:39], v[52:55]
    ds_read_b64_tr_b16 a[150:151], v27 offset:22016
    s_lshl_b32 s44, s31, 2
    v_mfma_f32_16x16x32_bf16 v[56:59], a[132:135], a[40:43], v[56:59]
    s_add_u32 s44, s44, s3
    v_mfma_f32_16x16x32_bf16 v[60:63], a[132:135], a[44:47], v[60:63]
    s_waitcnt lgkmcnt(6)
    s_lshl_b32 s44, s44, 17
    v_mfma_f32_16x16x32_bf16 v[64:67], a[136:139], a[32:35], v[64:67]
    ds_read_b64_tr_b16 a[152:153], v27 offset:22528
    s_lshl_b32 s37, s33, 22
    v_mfma_f32_16x16x32_bf16 v[68:71], a[136:139], a[36:39], v[68:71]
    ds_read_b64_tr_b16 a[154:155], v27 offset:23040
    s_add_u32 s44, s44, s37
    v_mfma_f32_16x16x32_bf16 v[72:75], a[136:139], a[40:43], v[72:75]
    buffer_load_dwordx4 a[108:111], v2, s[12:15], s41 offen offset:3072 sc1
    s_add_u32 s41, s41, 4096
    v_mfma_f32_16x16x32_bf16 v[76:79], a[136:139], a[44:47], v[76:79]
    s_waitcnt lgkmcnt(6)
    s_lshl_b32 s37, s34, 12
    v_mfma_f32_16x16x32_bf16 v[80:83], a[140:143], a[32:35], v[80:83]
    ds_read_b64_tr_b16 a[156:157], v27 offset:23552
    s_add_u32 s44, s44, s37
    v_mfma_f32_16x16x32_bf16 v[84:87], a[140:143], a[36:39], v[84:87]
    ds_read_b64_tr_b16 a[158:159], v27 offset:24064
    s_add_u32 s37, s44, 0x8000
    v_mfma_f32_16x16x32_bf16 v[88:91], a[140:143], a[40:43], v[88:91]
    buffer_load_dwordx4 v2, s[20:23], s40 offen offset:3072 sc1 lds
    s_add_u32 s40, s40, 16384
    v_mfma_f32_16x16x32_bf16 v[92:95], a[140:143], a[44:47], v[92:95]
    s_waitcnt lgkmcnt(6)
    s_add_u32 s38, s44, 0x10000
    v_mfma_f32_16x16x32_bf16 v[96:99], a[144:147], a[32:35], v[96:99]
    ds_read_b64_tr_b16 a[128:129], v27 offset:24576
    s_add_u32 s39, s44, 0x18000
    v_mfma_f32_16x16x32_bf16 v[100:103], a[144:147], a[36:39], v[100:103]
    ds_read_b64_tr_b16 a[130:131], v27 offset:25088
    buffer_load_dwordx4 a[112:115], v2, s[12:15], s41 offen offset:0 sc1
    v_mfma_f32_16x16x32_bf16 v[104:107], a[144:147], a[40:43], v[104:107]
    v_lshrrev_b32 v6, 4, v0
    v_mfma_f32_16x16x32_bf16 v[108:111], a[144:147], a[44:47], v[108:111]
    s_waitcnt lgkmcnt(6)
    v_and_b32 v5, 1, v6
    v_mfma_f32_16x16x32_bf16 v[112:115], a[148:151], a[32:35], v[112:115]
    ds_read_b64_tr_b16 a[132:133], v27 offset:25600
    v_lshlrev_b32_e64 v5, 1, v5
    v_mfma_f32_16x16x32_bf16 v[116:119], a[148:151], a[36:39], v[116:119]
    ds_read_b64_tr_b16 a[134:135], v27 offset:26112
    v_lshrrev_b32_e64 v6, 1, v6
    v_mfma_f32_16x16x32_bf16 v[120:123], a[148:151], a[40:43], v[120:123]
    v_or_b32_e64 v6, v6, v5
    v_mfma_f32_16x16x32_bf16 v[124:127], a[148:151], a[44:47], v[124:127]
    s_waitcnt lgkmcnt(6)
    v_and_b32 v5, 15, v0
    v_mfma_f32_16x16x32_bf16 v[128:131], a[152:155], a[32:35], v[128:131]
    ds_read_b64_tr_b16 a[136:137], v27 offset:26624
    v_lshlrev_b32_e64 v5, 4, v5
    v_mfma_f32_16x16x32_bf16 v[132:135], a[152:155], a[36:39], v[132:135]
    ds_read_b64_tr_b16 a[138:139], v27 offset:27136
    buffer_load_dwordx4 a[116:119], v2, s[12:15], s41 offen offset:1024 sc1
    v_mfma_f32_16x16x32_bf16 v[136:139], a[152:155], a[40:43], v[136:139]
    v_lshl_add_u32 v7, v6, 8, v5
    v_mfma_f32_16x16x32_bf16 v[140:143], a[152:155], a[44:47], v[140:143]
    s_waitcnt lgkmcnt(6)
    s_add_u32 s43, s33, 1
    v_mfma_f32_16x16x32_bf16 v[144:147], a[156:159], a[32:35], v[144:147]
    ds_read_b64_tr_b16 a[140:141], v27 offset:27648
    s_and_b32 s43, s43, 3
    v_mfma_f32_16x16x32_bf16 v[148:151], a[156:159], a[36:39], v[148:151]
    ds_read_b64_tr_b16 a[142:143], v27 offset:28160
    s_add_u32 m0, s48, 0
    v_mfma_f32_16x16x32_bf16 v[152:155], a[156:159], a[40:43], v[152:155]
    buffer_load_dwordx4 v2, s[20:23], s40 offen offset:0 sc1 lds
    s_lshl_b32 s43, s43, 10
    v_mfma_f32_16x16x32_bf16 v[156:159], a[156:159], a[44:47], v[156:159]
    s_waitcnt vmcnt(22)
    s_waitcnt lgkmcnt(6)
    v_add_u32 v18, s43, v7
    v_mfma_f32_16x16x32_bf16 v[32:35], a[128:131], a[48:51], v[32:35]
    ds_read_b64_tr_b16 a[144:145], v27 offset:28672
    s_add_u32 s43, s33, 2
    v_mfma_f32_16x16x32_bf16 v[36:39], a[128:131], a[52:55], v[36:39]
    ds_read_b64_tr_b16 a[146:147], v27 offset:29184
    buffer_load_dwordx4 a[120:123], v2, s[12:15], s41 offen offset:2048 sc1
    v_mfma_f32_16x16x32_bf16 v[40:43], a[128:131], a[56:59], v[40:43]
    s_and_b32 s43, s43, 3
    v_mfma_f32_16x16x32_bf16 v[44:47], a[128:131], a[60:63], v[44:47]
    s_waitcnt lgkmcnt(6)
    s_lshl_b32 s43, s43, 10
    v_mfma_f32_16x16x32_bf16 v[48:51], a[132:135], a[48:51], v[48:51]
    ds_read_b64_tr_b16 a[148:149], v27 offset:29696
    v_add_u32_e64 v19, s43, v7
    v_mfma_f32_16x16x32_bf16 v[52:55], a[132:135], a[52:55], v[52:55]
    ds_read_b64_tr_b16 a[150:151], v27 offset:30208
    s_add_u32 s43, s33, 3
    v_mfma_f32_16x16x32_bf16 v[56:59], a[132:135], a[56:59], v[56:59]
    s_and_b32 s43, s43, 3
    v_mfma_f32_16x16x32_bf16 v[60:63], a[132:135], a[60:63], v[60:63]
    s_waitcnt lgkmcnt(6)
    s_lshl_b32 s43, s43, 10
    v_mfma_f32_16x16x32_bf16 v[64:67], a[136:139], a[48:51], v[64:67]
    ds_read_b64_tr_b16 a[152:153], v27 offset:30720
    buffer_load_dwordx4 a[124:127], v2, s[12:15], s41 offen offset:3072 sc1
    v_mfma_f32_16x16x32_bf16 v[68:71], a[136:139], a[52:55], v[68:71]
    ds_read_b64_tr_b16 a[154:155], v27 offset:31232
    s_add_u32 s41, s41, 4096
    v_mfma_f32_16x16x32_bf16 v[72:75], a[136:139], a[56:59], v[72:75]
    v_add_u32_e64 v20, s43, v7
    v_mfma_f32_16x16x32_bf16 v[76:79], a[136:139], a[60:63], v[76:79]
    s_waitcnt lgkmcnt(6)
    buffer_load_dwordx4 v2, s[20:23], s40 offen offset:1024 sc1 lds
    s_lshl_b32 s43, s33, 10
    v_mfma_f32_16x16x32_bf16 v[80:83], a[140:143], a[48:51], v[80:83]
    ds_read_b64_tr_b16 a[156:157], v27 offset:31744
    v_add_u32_e64 v21, s43, v7
    v_mfma_f32_16x16x32_bf16 v[84:87], a[140:143], a[52:55], v[84:87]
    ds_read_b64_tr_b16 a[158:159], v27 offset:32256
    s_sub_u32 s43, 1, s35
    v_mfma_f32_16x16x32_bf16 v[88:91], a[140:143], a[56:59], v[88:91]
    s_lshl_b32 s43, s43, 30
    v_mfma_f32_16x16x32_bf16 v[92:95], a[140:143], a[60:63], v[92:95]
    s_waitcnt lgkmcnt(6)
    s_waitcnt vmcnt(17)
    s_barrier
    v_add_u32 v22, s43, v21
    v_mfma_f32_16x16x32_bf16 v[96:99], a[144:147], a[48:51], v[96:99]
    ds_read_b64_tr_b16 a[128:129], v27 offset:32768
    buffer_load_dwordx4 a[0:3], v2, s[12:15], s41 offen offset:0 sc1
    v_mfma_f32_16x16x32_bf16 v[100:103], a[144:147], a[52:55], v[100:103]
    ds_read_b64_tr_b16 a[130:131], v27 offset:33280
    buffer_load_dwordx4 v[208:211], v22, s[8:11], s44 offen sc1
    v_mfma_f32_16x16x32_bf16 v[104:107], a[144:147], a[56:59], v[104:107]
    buffer_load_dwordx4 v[212:215], v22, s[8:11], s37 offen sc1
    v_mfma_f32_16x16x32_bf16 v[108:111], a[144:147], a[60:63], v[108:111]
    s_waitcnt lgkmcnt(6)
    buffer_load_dwordx4 v[216:219], v22, s[8:11], s38 offen sc1
    v_mfma_f32_16x16x32_bf16 v[112:115], a[148:151], a[48:51], v[112:115]
    ds_read_b64_tr_b16 a[132:133], v27 offset:33792
    buffer_load_dwordx4 v[220:223], v22, s[8:11], s39 offen sc1
    v_mfma_f32_16x16x32_bf16 v[116:119], a[148:151], a[52:55], v[116:119]
    ds_read_b64_tr_b16 a[134:135], v27 offset:34304
    v_mfma_f32_16x16x32_bf16 v[120:123], a[148:151], a[56:59], v[120:123]
    v_mfma_f32_16x16x32_bf16 v[124:127], a[148:151], a[60:63], v[124:127]
    s_waitcnt lgkmcnt(6)
    v_mfma_f32_16x16x32_bf16 v[128:131], a[152:155], a[48:51], v[128:131]
    ds_read_b64_tr_b16 a[136:137], v27 offset:34816
    buffer_load_dwordx4 a[4:7], v2, s[12:15], s41 offen offset:1024 sc1
    v_mfma_f32_16x16x32_bf16 v[132:135], a[152:155], a[52:55], v[132:135]
    ds_read_b64_tr_b16 a[138:139], v27 offset:35328
    v_mfma_f32_16x16x32_bf16 v[136:139], a[152:155], a[56:59], v[136:139]
    buffer_load_dwordx4 v2, s[20:23], s40 offen offset:2048 sc1 lds
    v_mfma_f32_16x16x32_bf16 v[140:143], a[152:155], a[60:63], v[140:143]
    s_waitcnt lgkmcnt(6)
    v_mfma_f32_16x16x32_bf16 v[144:147], a[156:159], a[48:51], v[144:147]
    ds_read_b64_tr_b16 a[140:141], v27 offset:35840
    v_mfma_f32_16x16x32_bf16 v[148:151], a[156:159], a[52:55], v[148:151]
    ds_read_b64_tr_b16 a[142:143], v27 offset:36352
    v_mfma_f32_16x16x32_bf16 v[152:155], a[156:159], a[56:59], v[152:155]
    v_mfma_f32_16x16x32_bf16 v[156:159], a[156:159], a[60:63], v[156:159]
    s_waitcnt vmcnt(26)
    s_waitcnt lgkmcnt(6)
    v_mfma_f32_16x16x32_bf16 v[32:35], a[128:131], a[64:67], v[32:35]
    ds_read_b64_tr_b16 a[144:145], v27 offset:36864
    buffer_load_dwordx4 a[8:11], v2, s[12:15], s41 offen offset:2048 sc1
    v_mfma_f32_16x16x32_bf16 v[36:39], a[128:131], a[68:71], v[36:39]
    ds_read_b64_tr_b16 a[146:147], v27 offset:37376
    v_mfma_f32_16x16x32_bf16 v[40:43], a[128:131], a[72:75], v[40:43]
    v_mfma_f32_16x16x32_bf16 v[44:47], a[128:131], a[76:79], v[44:47]
    s_waitcnt lgkmcnt(6)
    v_mfma_f32_16x16x32_bf16 v[48:51], a[132:135], a[64:67], v[48:51]
    ds_read_b64_tr_b16 a[148:149], v27 offset:37888
    v_mfma_f32_16x16x32_bf16 v[52:55], a[132:135], a[68:71], v[52:55]
    ds_read_b64_tr_b16 a[150:151], v27 offset:38400
    v_mfma_f32_16x16x32_bf16 v[56:59], a[132:135], a[72:75], v[56:59]
    v_mfma_f32_16x16x32_bf16 v[60:63], a[132:135], a[76:79], v[60:63]
    s_waitcnt lgkmcnt(6)
    buffer_load_dwordx4 a[12:15], v2, s[12:15], s41 offen offset:3072 sc1
    s_add_u32 s41, s41, 4096
    v_mfma_f32_16x16x32_bf16 v[64:67], a[136:139], a[64:67], v[64:67]
    ds_read_b64_tr_b16 a[152:153], v27 offset:38912
    buffer_load_dwordx4 v2, s[20:23], s40 offen offset:3072 sc1 lds
    v_mfma_f32_16x16x32_bf16 v[68:71], a[136:139], a[68:71], v[68:71]
    ds_read_b64_tr_b16 a[154:155], v27 offset:39424
    s_add_u32 s40, s40, 16384
    v_mfma_f32_16x16x32_bf16 v[72:75], a[136:139], a[72:75], v[72:75]
    v_mfma_f32_16x16x32_bf16 v[76:79], a[136:139], a[76:79], v[76:79]
    s_waitcnt lgkmcnt(6)
    v_mfma_f32_16x16x32_bf16 v[80:83], a[140:143], a[64:67], v[80:83]
    ds_read_b64_tr_b16 a[156:157], v27 offset:39936
    v_mfma_f32_16x16x32_bf16 v[84:87], a[140:143], a[68:71], v[84:87]
    ds_read_b64_tr_b16 a[158:159], v27 offset:40448
    v_mfma_f32_16x16x32_bf16 v[88:91], a[140:143], a[72:75], v[88:91]
    v_mfma_f32_16x16x32_bf16 v[92:95], a[140:143], a[76:79], v[92:95]
    s_waitcnt lgkmcnt(6)
    buffer_load_dwordx4 a[16:19], v2, s[12:15], s41 offen offset:0 sc1
    v_mfma_f32_16x16x32_bf16 v[96:99], a[144:147], a[64:67], v[96:99]
    ds_read_b64_tr_b16 a[128:129], v27 offset:40960
    v_mfma_f32_16x16x32_bf16 v[100:103], a[144:147], a[68:71], v[100:103]
    ds_read_b64_tr_b16 a[130:131], v27 offset:41472
    v_mfma_f32_16x16x32_bf16 v[104:107], a[144:147], a[72:75], v[104:107]
    v_mfma_f32_16x16x32_bf16 v[108:111], a[144:147], a[76:79], v[108:111]
    s_waitcnt lgkmcnt(6)
    v_mfma_f32_16x16x32_bf16 v[112:115], a[148:151], a[64:67], v[112:115]
    ds_read_b64_tr_b16 a[132:133], v27 offset:41984
    v_mfma_f32_16x16x32_bf16 v[116:119], a[148:151], a[68:71], v[116:119]
    ds_read_b64_tr_b16 a[134:135], v27 offset:42496
    v_mfma_f32_16x16x32_bf16 v[120:123], a[148:151], a[72:75], v[120:123]
    v_mfma_f32_16x16x32_bf16 v[124:127], a[148:151], a[76:79], v[124:127]
    s_waitcnt lgkmcnt(6)
    s_add_u32 m0, s48, 16384
    buffer_load_dwordx4 a[20:23], v2, s[12:15], s41 offen offset:1024 sc1
    v_mfma_f32_16x16x32_bf16 v[128:131], a[152:155], a[64:67], v[128:131]
    ds_read_b64_tr_b16 a[136:137], v27 offset:43008
    buffer_load_dwordx4 v2, s[20:23], s40 offen offset:0 sc1 lds
    v_mfma_f32_16x16x32_bf16 v[132:135], a[152:155], a[68:71], v[132:135]
    ds_read_b64_tr_b16 a[138:139], v27 offset:43520
    v_mfma_f32_16x16x32_bf16 v[136:139], a[152:155], a[72:75], v[136:139]
    v_mfma_f32_16x16x32_bf16 v[140:143], a[152:155], a[76:79], v[140:143]
    s_waitcnt lgkmcnt(6)
    v_mfma_f32_16x16x32_bf16 v[144:147], a[156:159], a[64:67], v[144:147]
    ds_read_b64_tr_b16 a[140:141], v27 offset:44032
    v_mfma_f32_16x16x32_bf16 v[148:151], a[156:159], a[68:71], v[148:151]
    ds_read_b64_tr_b16 a[142:143], v27 offset:44544
    v_mfma_f32_16x16x32_bf16 v[152:155], a[156:159], a[72:75], v[152:155]
    buffer_load_dwordx4 a[24:27], v2, s[12:15], s41 offen offset:2048 sc1
    v_mfma_f32_16x16x32_bf16 v[156:159], a[156:159], a[76:79], v[156:159]
    s_waitcnt vmcnt(27)
    s_waitcnt lgkmcnt(6)
    v_mfma_f32_16x16x32_bf16 v[32:35], a[128:131], a[80:83], v[32:35]
    ds_read_b64_tr_b16 a[144:145], v27 offset:45056
    v_mfma_f32_16x16x32_bf16 v[36:39], a[128:131], a[84:87], v[36:39]
    ds_read_b64_tr_b16 a[146:147], v27 offset:45568
    v_mfma_f32_16x16x32_bf16 v[40:43], a[128:131], a[88:91], v[40:43]
    v_mfma_f32_16x16x32_bf16 v[44:47], a[128:131], a[92:95], v[44:47]
    s_waitcnt lgkmcnt(6)
    v_mfma_f32_16x16x32_bf16 v[48:51], a[132:135], a[80:83], v[48:51]
    ds_read_b64_tr_b16 a[148:149], v27 offset:46080
    v_mfma_f32_16x16x32_bf16 v[52:55], a[132:135], a[84:87], v[52:55]
    ds_read_b64_tr_b16 a[150:151], v27 offset:46592
    buffer_load_dwordx4 v2, s[20:23], s40 offen offset:1024 sc1 lds
    v_mfma_f32_16x16x32_bf16 v[56:59], a[132:135], a[88:91], v[56:59]
    buffer_load_dwordx4 a[28:31], v2, s[12:15], s41 offen offset:3072 sc1
    s_add_u32 s41, s41, 4096
    v_mfma_f32_16x16x32_bf16 v[60:63], a[132:135], a[92:95], v[60:63]
    s_waitcnt lgkmcnt(6)
    v_mfma_f32_16x16x32_bf16 v[64:67], a[136:139], a[80:83], v[64:67]
    ds_read_b64_tr_b16 a[152:153], v27 offset:47104
    v_mfma_f32_16x16x32_bf16 v[68:71], a[136:139], a[84:87], v[68:71]
    ds_read_b64_tr_b16 a[154:155], v27 offset:47616
    v_mfma_f32_16x16x32_bf16 v[72:75], a[136:139], a[88:91], v[72:75]
    v_mfma_f32_16x16x32_bf16 v[76:79], a[136:139], a[92:95], v[76:79]
    s_waitcnt lgkmcnt(6)
    v_mfma_f32_16x16x32_bf16 v[80:83], a[140:143], a[80:83], v[80:83]
    ds_read_b64_tr_b16 a[156:157], v27 offset:48128
    v_mfma_f32_16x16x32_bf16 v[84:87], a[140:143], a[84:87], v[84:87]
    ds_read_b64_tr_b16 a[158:159], v27 offset:48640
    v_mfma_f32_16x16x32_bf16 v[88:91], a[140:143], a[88:91], v[88:91]
    buffer_load_dwordx4 a[32:35], v2, s[12:15], s41 offen offset:0 sc1
    v_mfma_f32_16x16x32_bf16 v[92:95], a[140:143], a[92:95], v[92:95]
    s_waitcnt lgkmcnt(6)
    s_waitcnt vmcnt(23)
    s_barrier
    v_mfma_f32_16x16x32_bf16 v[96:99], a[144:147], a[80:83], v[96:99]
    ds_read_b64_tr_b16 a[128:129], v27 offset:49152
    v_mfma_f32_16x16x32_bf16 v[100:103], a[144:147], a[84:87], v[100:103]
    ds_read_b64_tr_b16 a[130:131], v27 offset:49664
    v_mfma_f32_16x16x32_bf16 v[104:107], a[144:147], a[88:91], v[104:107]
    v_mfma_f32_16x16x32_bf16 v[108:111], a[144:147], a[92:95], v[108:111]
    s_waitcnt lgkmcnt(6)
    v_mfma_f32_16x16x32_bf16 v[112:115], a[148:151], a[80:83], v[112:115]
    ds_read_b64_tr_b16 a[132:133], v27 offset:50176
    buffer_load_dwordx4 v2, s[20:23], s40 offen offset:2048 sc1 lds
    v_mfma_f32_16x16x32_bf16 v[116:119], a[148:151], a[84:87], v[116:119]
    ds_read_b64_tr_b16 a[134:135], v27 offset:50688
    buffer_load_dwordx4 a[36:39], v2, s[12:15], s41 offen offset:1024 sc1
    v_mfma_f32_16x16x32_bf16 v[120:123], a[148:151], a[88:91], v[120:123]
    v_mfma_f32_16x16x32_bf16 v[124:127], a[148:151], a[92:95], v[124:127]
    s_waitcnt lgkmcnt(6)
    v_mfma_f32_16x16x32_bf16 v[128:131], a[152:155], a[80:83], v[128:131]
    ds_read_b64_tr_b16 a[136:137], v27 offset:51200
    v_mfma_f32_16x16x32_bf16 v[132:135], a[152:155], a[84:87], v[132:135]
    ds_read_b64_tr_b16 a[138:139], v27 offset:51712
    v_mfma_f32_16x16x32_bf16 v[136:139], a[152:155], a[88:91], v[136:139]
    v_mfma_f32_16x16x32_bf16 v[140:143], a[152:155], a[92:95], v[140:143]
    s_waitcnt lgkmcnt(6)
    buffer_load_dword v30, v1, s[24:27], s59 offen sc1
    v_mfma_f32_16x16x32_bf16 v[144:147], a[156:159], a[80:83], v[144:147]
    ds_read_b64_tr_b16 a[140:141], v27 offset:52224
    v_mfma_f32_16x16x32_bf16 v[148:151], a[156:159], a[84:87], v[148:151]
    ds_read_b64_tr_b16 a[142:143], v27 offset:52736
    buffer_load_dwordx4 a[40:43], v2, s[12:15], s41 offen offset:2048 sc1
    v_mfma_f32_16x16x32_bf16 v[152:155], a[156:159], a[88:91], v[152:155]
    v_mfma_f32_16x16x32_bf16 v[156:159], a[156:159], a[92:95], v[156:159]
    s_waitcnt vmcnt(28)
    s_waitcnt lgkmcnt(6)
    v_mfma_f32_16x16x32_bf16 v[32:35], a[128:131], a[96:99], v[32:35]
    ds_read_b64_tr_b16 a[144:145], v27 offset:53248
    v_mfma_f32_16x16x32_bf16 v[36:39], a[128:131], a[100:103], v[36:39]
    ds_read_b64_tr_b16 a[146:147], v27 offset:53760
    v_mfma_f32_16x16x32_bf16 v[40:43], a[128:131], a[104:107], v[40:43]
    buffer_load_dwordx4 v2, s[20:23], s40 offen offset:3072 sc1 lds
    s_add_u32 s40, s40, 16384
    v_mfma_f32_16x16x32_bf16 v[44:47], a[128:131], a[108:111], v[44:47]
    s_waitcnt lgkmcnt(6)
    v_mfma_f32_16x16x32_bf16 v[48:51], a[132:135], a[96:99], v[48:51]
    ds_read_b64_tr_b16 a[148:149], v27 offset:54272
    v_mfma_f32_16x16x32_bf16 v[52:55], a[132:135], a[100:103], v[52:55]
    ds_read_b64_tr_b16 a[150:151], v27 offset:54784
    buffer_load_dwordx4 a[44:47], v2, s[12:15], s41 offen offset:3072 sc1
    v_mfma_f32_16x16x32_bf16 v[56:59], a[132:135], a[104:107], v[56:59]
    s_add_u32 s41, s41, 4096
    v_mfma_f32_16x16x32_bf16 v[60:63], a[132:135], a[108:111], v[60:63]
    s_waitcnt lgkmcnt(6)
    v_mfma_f32_16x16x32_bf16 v[64:67], a[136:139], a[96:99], v[64:67]
    ds_read_b64_tr_b16 a[152:153], v27 offset:55296
    v_mfma_f32_16x16x32_bf16 v[68:71], a[136:139], a[100:103], v[68:71]
    ds_read_b64_tr_b16 a[154:155], v27 offset:55808
    v_mfma_f32_16x16x32_bf16 v[72:75], a[136:139], a[104:107], v[72:75]
    v_mfma_f32_16x16x32_bf16 v[76:79], a[136:139], a[108:111], v[76:79]
    s_waitcnt lgkmcnt(6)
    v_mfma_f32_16x16x32_bf16 v[80:83], a[140:143], a[96:99], v[80:83]
    ds_read_b64_tr_b16 a[156:157], v27 offset:56320
    v_mfma_f32_16x16x32_bf16 v[84:87], a[140:143], a[100:103], v[84:87]
    ds_read_b64_tr_b16 a[158:159], v27 offset:56832
    buffer_load_dwordx4 a[48:51], v2, s[12:15], s41 offen offset:0 sc1
    v_mfma_f32_16x16x32_bf16 v[88:91], a[140:143], a[104:107], v[88:91]
    v_mfma_f32_16x16x32_bf16 v[92:95], a[140:143], a[108:111], v[92:95]
    s_waitcnt lgkmcnt(6)
    v_mfma_f32_16x16x32_bf16 v[96:99], a[144:147], a[96:99], v[96:99]
    ds_read_b64_tr_b16 a[128:129], v27 offset:57344
    v_mfma_f32_16x16x32_bf16 v[100:103], a[144:147], a[100:103], v[100:103]
    ds_read_b64_tr_b16 a[130:131], v27 offset:57856
    s_add_u32 m0, s48, 32768
    v_mfma_f32_16x16x32_bf16 v[104:107], a[144:147], a[104:107], v[104:107]
    buffer_load_dwordx4 v2, s[20:23], s40 offen offset:0 sc1 lds
    v_mfma_f32_16x16x32_bf16 v[108:111], a[144:147], a[108:111], v[108:111]
    s_waitcnt lgkmcnt(6)
    v_mfma_f32_16x16x32_bf16 v[112:115], a[148:151], a[96:99], v[112:115]
    ds_read_b64_tr_b16 a[132:133], v27 offset:58368
    buffer_load_dwordx4 a[52:55], v2, s[12:15], s41 offen offset:1024 sc1
    v_mfma_f32_16x16x32_bf16 v[116:119], a[148:151], a[100:103], v[116:119]
    ds_read_b64_tr_b16 a[134:135], v27 offset:58880
    v_mfma_f32_16x16x32_bf16 v[120:123], a[148:151], a[104:107], v[120:123]
    v_mfma_f32_16x16x32_bf16 v[124:127], a[148:151], a[108:111], v[124:127]
    s_waitcnt lgkmcnt(6)
    v_mfma_f32_16x16x32_bf16 v[128:131], a[152:155], a[96:99], v[128:131]
    ds_read_b64_tr_b16 a[136:137], v27 offset:59392
    v_mfma_f32_16x16x32_bf16 v[132:135], a[152:155], a[100:103], v[132:135]
    ds_read_b64_tr_b16 a[138:139], v27 offset:59904
    v_mfma_f32_16x16x32_bf16 v[136:139], a[152:155], a[104:107], v[136:139]
    v_mfma_f32_16x16x32_bf16 v[140:143], a[152:155], a[108:111], v[140:143]
    s_waitcnt lgkmcnt(6)
    v_mfma_f32_16x16x32_bf16 v[144:147], a[156:159], a[96:99], v[144:147]
    ds_read_b64_tr_b16 a[140:141], v27 offset:60416
    buffer_load_dwordx4 a[56:59], v2, s[12:15], s41 offen offset:2048 sc1
    v_mfma_f32_16x16x32_bf16 v[148:151], a[156:159], a[100:103], v[148:151]
    ds_read_b64_tr_b16 a[142:143], v27 offset:60928
    v_mfma_f32_16x16x32_bf16 v[152:155], a[156:159], a[104:107], v[152:155]
    v_mfma_f32_16x16x32_bf16 v[156:159], a[156:159], a[108:111], v[156:159]
    s_waitcnt vmcnt(28)
    s_waitcnt lgkmcnt(6)
    buffer_load_dwordx4 v2, s[20:23], s40 offen offset:1024 sc1 lds
    v_mfma_f32_16x16x32_bf16 v[32:35], a[128:131], a[112:115], v[32:35]
    ds_read_b64_tr_b16 a[144:145], v27 offset:61440
    v_mfma_f32_16x16x32_bf16 v[36:39], a[128:131], a[116:119], v[36:39]
    ds_read_b64_tr_b16 a[146:147], v27 offset:61952
    v_mfma_f32_16x16x32_bf16 v[40:43], a[128:131], a[120:123], v[40:43]
    v_mfma_f32_16x16x32_bf16 v[44:47], a[128:131], a[124:127], v[44:47]
    s_waitcnt lgkmcnt(6)
    v_mfma_f32_16x16x32_bf16 v[48:51], a[132:135], a[112:115], v[48:51]
    ds_read_b64_tr_b16 a[148:149], v27 offset:62464
    buffer_load_dwordx4 a[60:63], v2, s[12:15], s41 offen offset:3072 sc1
    v_mfma_f32_16x16x32_bf16 v[52:55], a[132:135], a[116:119], v[52:55]
    ds_read_b64_tr_b16 a[150:151], v27 offset:62976
    s_add_u32 s41, s41, 4096
    v_mfma_f32_16x16x32_bf16 v[56:59], a[132:135], a[120:123], v[56:59]
    v_mfma_f32_16x16x32_bf16 v[60:63], a[132:135], a[124:127], v[60:63]
    s_waitcnt lgkmcnt(6)
    v_mfma_f32_16x16x32_bf16 v[64:67], a[136:139], a[112:115], v[64:67]
    ds_read_b64_tr_b16 a[152:153], v27 offset:63488
    v_mfma_f32_16x16x32_bf16 v[68:71], a[136:139], a[116:119], v[68:71]
    ds_read_b64_tr_b16 a[154:155], v27 offset:64000
    v_mfma_f32_16x16x32_bf16 v[72:75], a[136:139], a[120:123], v[72:75]
    v_mfma_f32_16x16x32_bf16 v[76:79], a[136:139], a[124:127], v[76:79]
    s_waitcnt lgkmcnt(6)
    s_waitcnt vmcnt(9)
    v_readfirstlane_b32 s30, v30
    s_mov_b32 s56, 0
    s_cmp_ge_u32 s30, 8
    s_cbranch_scc1 L_f3cok
L_poll_18:
    buffer_load_dword v4, v1, s[24:27], s59 offen sc1
    s_add_u32 s56, s56, 1
    s_waitcnt vmcnt(0)
    v_readfirstlane_b32 s30, v4
    s_cmp_ge_u32 s30, 8
    s_cbranch_scc1 L_f3cok
    s_cmp_lt_u32 s56, 400000
    s_cbranch_scc1 L_poll_18
L_f3cok:
    buffer_load_dwordx4 a[64:67], v2, s[12:15], s41 offen offset:0 sc1
    v_mfma_f32_16x16x32_bf16 v[80:83], a[140:143], a[112:115], v[80:83]
    ds_read_b64_tr_b16 a[156:157], v27 offset:64512
    v_mfma_f32_16x16x32_bf16 v[84:87], a[140:143], a[116:119], v[84:87]
    ds_read_b64_tr_b16 a[158:159], v27 offset:65024
    v_mfma_f32_16x16x32_bf16 v[88:91], a[140:143], a[120:123], v[88:91]
    buffer_load_dwordx4 v2, s[20:23], s40 offen offset:2048 sc1 lds
    v_mfma_f32_16x16x32_bf16 v[92:95], a[140:143], a[124:127], v[92:95]
    s_waitcnt lgkmcnt(6)
    s_waitcnt vmcnt(21)
    s_barrier
    v_mfma_f32_16x16x32_bf16 v[96:99], a[144:147], a[112:115], v[96:99]
    ds_read_b64_tr_b16 a[128:129], v28 offset:0
    v_mfma_f32_16x16x32_bf16 v[100:103], a[144:147], a[116:119], v[100:103]
    ds_read_b64_tr_b16 a[130:131], v28 offset:512
    v_mfma_f32_16x16x32_bf16 v[104:107], a[144:147], a[120:123], v[104:107]
    v_mfma_f32_16x16x32_bf16 v[108:111], a[144:147], a[124:127], v[108:111]
    s_waitcnt lgkmcnt(6)
    buffer_load_dwordx4 a[68:71], v2, s[12:15], s41 offen offset:1024 sc1
    v_mfma_f32_16x16x32_bf16 v[112:115], a[148:151], a[112:115], v[112:115]
    ds_read_b64_tr_b16 a[132:133], v28 offset:1024
    v_mfma_f32_16x16x32_bf16 v[116:119], a[148:151], a[116:119], v[116:119]
    ds_read_b64_tr_b16 a[134:135], v28 offset:1536
    v_mfma_f32_16x16x32_bf16 v[120:123], a[148:151], a[120:123], v[120:123]
    v_mfma_f32_16x16x32_bf16 v[124:127], a[148:151], a[124:127], v[124:127]
    s_waitcnt lgkmcnt(6)
    v_mfma_f32_16x16x32_bf16 v[128:131], a[152:155], a[112:115], v[128:131]
    ds_read_b64_tr_b16 a[136:137], v28 offset:2048
    v_mfma_f32_16x16x32_bf16 v[132:135], a[152:155], a[116:119], v[132:135]
    ds_read_b64_tr_b16 a[138:139], v28 offset:2560
    v_mfma_f32_16x16x32_bf16 v[136:139], a[152:155], a[120:123], v[136:139]
    v_mfma_f32_16x16x32_bf16 v[140:143], a[152:155], a[124:127], v[140:143]
    s_waitcnt lgkmcnt(6)
    buffer_load_dwordx4 a[72:75], v2, s[12:15], s41 offen offset:2048 sc1
    v_mfma_f32_16x16x32_bf16 v[144:147], a[156:159], a[112:115], v[144:147]
    ds_read_b64_tr_b16 a[140:141], v28 offset:3072
    buffer_load_dwordx4 v2, s[20:23], s40 offen offset:3072 sc1 lds
    v_mfma_f32_16x16x32_bf16 v[148:151], a[156:159], a[116:119], v[148:151]
    ds_read_b64_tr_b16 a[142:143], v28 offset:3584
    s_add_u32 s40, s40, 16384
    v_mfma_f32_16x16x32_bf16 v[152:155], a[156:159], a[120:123], v[152:155]
    v_mfma_f32_16x16x32_bf16 v[156:159], a[156:159], a[124:127], v[156:159]
    s_waitcnt vmcnt(25)
    s_waitcnt lgkmcnt(6)
    v_mfma_f32_16x16x32_bf16 v[32:35], a[128:131], a[0:3], v[32:35]
    ds_read_b64_tr_b16 a[144:145], v28 offset:4096
    v_mfma_f32_16x16x32_bf16 v[36:39], a[128:131], a[4:7], v[36:39]
    ds_read_b64_tr_b16 a[146:147], v28 offset:4608
    v_mfma_f32_16x16x32_bf16 v[40:43], a[128:131], a[8:11], v[40:43]
    buffer_load_dwordx4 a[76:79], v2, s[12:15], s41 offen offset:3072 sc1
    s_add_u32 s41, s41, 4096
    v_mfma_f32_16x16x32_bf16 v[44:47], a[128:131], a[12:15], v[44:47]
    s_waitcnt lgkmcnt(6)
    v_mfma_f32_16x16x32_bf16 v[48:51], a[132:135], a[0:3], v[48:51]
    ds_read_b64_tr_b16 a[148:149], v28 offset:5120
    v_mfma_f32_16x16x32_bf16 v[52:55], a[132:135], a[4:7], v[52:55]
    ds_read_b64_tr_b16 a[150:151], v28 offset:5632
    v_mfma_f32_16x16x32_bf16 v[56:59], a[132:135], a[8:11], v[56:59]
    v_mfma_f32_16x16x32_bf16 v[60:63], a[132:135], a[12:15], v[60:63]
    s_waitcnt lgkmcnt(6)
    v_mfma_f32_16x16x32_bf16 v[64:67], a[136:139], a[0:3], v[64:67]
    ds_read_b64_tr_b16 a[152:153], v28 offset:6144
    v_mfma_f32_16x16x32_bf16 v[68:71], a[136:139], a[4:7], v[68:71]
    ds_read_b64_tr_b16 a[154:155], v28 offset:6656
    v_mfma_f32_16x16x32_bf16 v[72:75], a[136:139], a[8:11], v[72:75]
    buffer_load_dwordx4 a[80:83], v2, s[12:15], s41 offen offset:0 sc1
    v_mfma_f32_16x16x32_bf16 v[76:79], a[136:139], a[12:15], v[76:79]
    s_waitcnt lgkmcnt(6)
    s_add_u32 m0, s48, 49152
    v_mfma_f32_16x16x32_bf16 v[80:83], a[140:143], a[0:3], v[80:83]
    ds_read_b64_tr_b16 a[156:157], v28 offset:7168
    buffer_load_dwordx4 v2, s[20:23], s40 offen offset:0 sc1 lds
    v_mfma_f32_16x16x32_bf16 v[84:87], a[140:143], a[4:7], v[84:87]
    ds_read_b64_tr_b16 a[158:159], v28 offset:7680
    v_mfma_f32_16x16x32_bf16 v[88:91], a[140:143], a[8:11], v[88:91]
    v_mfma_f32_16x16x32_bf16 v[92:95], a[140:143], a[12:15], v[92:95]
    s_waitcnt lgkmcnt(6)
    v_mfma_f32_16x16x32_bf16 v[96:99], a[144:147], a[0:3], v[96:99]
    ds_read_b64_tr_b16 a[128:129], v28 offset:8192
    v_mfma_f32_16x16x32_bf16 v[100:103], a[144:147], a[4:7], v[100:103]
    ds_read_b64_tr_b16 a[130:131], v28 offset:8704
    v_mfma_f32_16x16x32_bf16 v[104:107], a[144:147], a[8:11], v[104:107]
    buffer_load_dwordx4 a[84:87], v2, s[12:15], s41 offen offset:1024 sc1
    v_mfma_f32_16x16x32_bf16 v[108:111], a[144:147], a[12:15], v[108:111]
    s_waitcnt lgkmcnt(6)
    v_mfma_f32_16x16x32_bf16 v[112:115], a[148:151], a[0:3], v[112:115]
    ds_read_b64_tr_b16 a[132:133], v28 offset:9216
    v_mfma_f32_16x16x32_bf16 v[116:119], a[148:151], a[4:7], v[116:119]
    ds_read_b64_tr_b16 a[134:135], v28 offset:9728
    v_mfma_f32_16x16x32_bf16 v[120:123], a[148:151], a[8:11], v[120:123]
    v_mfma_f32_16x16x32_bf16 v[124:127], a[148:151], a[12:15], v[124:127]
    s_waitcnt lgkmcnt(6)
    v_mfma_f32_16x16x32_bf16 v[128:131], a[152:155], a[0:3], v[128:131]
    ds_read_b64_tr_b16 a[136:137], v28 offset:10240
    v_mfma_f32_16x16x32_bf16 v[132:135], a[152:155], a[4:7], v[132:135]
    ds_read_b64_tr_b16 a[138:139], v28 offset:10752
    buffer_load_dwordx4 v2, s[20:23], s40 offen offset:1024 sc1 lds
    v_mfma_f32_16x16x32_bf16 v[136:139], a[152:155], a[8:11], v[136:139]
    buffer_load_dwordx4 a[88:91], v2, s[12:15], s41 offen offset:2048 sc1
    v_mfma_f32_16x16x32_bf16 v[140:143], a[152:155], a[12:15], v[140:143]
    s_waitcnt lgkmcnt(6)
    v_mfma_f32_16x16x32_bf16 v[144:147], a[156:159], a[0:3], v[144:147]
    ds_read_b64_tr_b16 a[140:141], v28 offset:11264
    v_mfma_f32_16x16x32_bf16 v[148:151], a[156:159], a[4:7], v[148:151]
    ds_read_b64_tr_b16 a[142:143], v28 offset:11776
    v_mfma_f32_16x16x32_bf16 v[152:155], a[156:159], a[8:11], v[152:155]
    v_mfma_f32_16x16x32_bf16 v[156:159], a[156:159], a[12:15], v[156:159]
    s_waitcnt vmcnt(24)
    s_waitcnt lgkmcnt(6)
    v_mfma_f32_16x16x32_bf16 v[32:35], a[128:131], a[16:19], v[32:35]
    ds_read_b64_tr_b16 a[144:145], v28 offset:12288
    v_mfma_f32_16x16x32_bf16 v[36:39], a[128:131], a[20:23], v[36:39]
    ds_read_b64_tr_b16 a[146:147], v28 offset:12800
    buffer_load_dwordx4 a[92:95], v2, s[12:15], s41 offen offset:3072 sc1
    v_mfma_f32_16x16x32_bf16 v[40:43], a[128:131], a[24:27], v[40:43]
    s_add_u32 s41, s41, 4096
    v_mfma_f32_16x16x32_bf16 v[44:47], a[128:131], a[28:31], v[44:47]
    s_waitcnt lgkmcnt(6)
    v_mfma_f32_16x16x32_bf16 v[48:51], a[132:135], a[16:19], v[48:51]
    ds_read_b64_tr_b16 a[148:149], v28 offset:13312
    v_mfma_f32_16x16x32_bf16 v[52:55], a[132:135], a[20:23], v[52:55]
    ds_read_b64_tr_b16 a[150:151], v28 offset:13824
    v_mfma_f32_16x16x32_bf16 v[56:59], a[132:135], a[24:27], v[56:59]
    v_mfma_f32_16x16x32_bf16 v[60:63], a[132:135], a[28:31], v[60:63]
    s_waitcnt lgkmcnt(6)
    v_mfma_f32_16x16x32_bf16 v[64:67], a[136:139], a[16:19], v[64:67]
    ds_read_b64_tr_b16 a[152:153], v28 offset:14336
    buffer_load_dwordx4 v2, s[20:23], s40 offen offset:2048 sc1 lds
    v_mfma_f32_16x16x32_bf16 v[68:71], a[136:139], a[20:23], v[68:71]
    ds_read_b64_tr_b16 a[154:155], v28 offset:14848
    buffer_load_dwordx4 a[96:99], v2, s[12:15], s41 offen offset:0 sc1
    v_mfma_f32_16x16x32_bf16 v[72:75], a[136:139], a[24:27], v[72:75]
    v_mfma_f32_16x16x32_bf16 v[76:79], a[136:139], a[28:31], v[76:79]
    s_waitcnt lgkmcnt(6)
    v_mfma_f32_16x16x32_bf16 v[80:83], a[140:143], a[16:19], v[80:83]
    ds_read_b64_tr_b16 a[156:157], v28 offset:15360
    v_mfma_f32_16x16x32_bf16 v[84:87], a[140:143], a[20:23], v[84:87]
    ds_read_b64_tr_b16 a[158:159], v28 offset:15872
    v_mfma_f32_16x16x32_bf16 v[88:91], a[140:143], a[24:27], v[88:91]
    v_mfma_f32_16x16x32_bf16 v[92:95], a[140:143], a[28:31], v[92:95]
    s_waitcnt lgkmcnt(6)
    s_waitcnt vmcnt(21)
    s_barrier
    v_mfma_f32_16x16x32_bf16 v[96:99], a[144:147], a[16:19], v[96:99]
    ds_read_b64_tr_b16 a[128:129], v28 offset:16384
    v_mfma_f32_16x16x32_bf16 v[100:103], a[144:147], a[20:23], v[100:103]
    ds_read_b64_tr_b16 a[130:131], v28 offset:16896
    buffer_load_dwordx4 a[100:103], v2, s[12:15], s41 offen offset:1024 sc1
    v_mfma_f32_16x16x32_bf16 v[104:107], a[144:147], a[24:27], v[104:107]
    v_mfma_f32_16x16x32_bf16 v[108:111], a[144:147], a[28:31], v[108:111]
    s_waitcnt lgkmcnt(6)
    v_mfma_f32_16x16x32_bf16 v[112:115], a[148:151], a[16:19], v[112:115]
    ds_read_b64_tr_b16 a[132:133], v28 offset:17408
    v_mfma_f32_16x16x32_bf16 v[116:119], a[148:151], a[20:23], v[116:119]
    ds_read_b64_tr_b16 a[134:135], v28 offset:17920
    v_mfma_f32_16x16x32_bf16 v[120:123], a[148:151], a[24:27], v[120:123]
    buffer_load_dwordx4 v2, s[20:23], s40 offen offset:3072 sc1 lds
    s_add_u32 s40, s40, 16384
    v_mfma_f32_16x16x32_bf16 v[124:127], a[148:151], a[28:31], v[124:127]
    s_waitcnt lgkmcnt(6)
    v_mfma_f32_16x16x32_bf16 v[128:131], a[152:155], a[16:19], v[128:131]
    ds_read_b64_tr_b16 a[136:137], v28 offset:18432
    buffer_load_dwordx4 a[104:107], v2, s[12:15], s41 offen offset:2048 sc1
    v_mfma_f32_16x16x32_bf16 v[132:135], a[152:155], a[20:23], v[132:135]
    ds_read_b64_tr_b16 a[138:139], v28 offset:18944
    v_mfma_f32_16x16x32_bf16 v[136:139], a[152:155], a[24:27], v[136:139]
    v_mfma_f32_16x16x32_bf16 v[140:143], a[152:155], a[28:31], v[140:143]
    s_waitcnt lgkmcnt(6)
    v_mfma_f32_16x16x32_bf16 v[144:147], a[156:159], a[16:19], v[144:147]
    ds_read_b64_tr_b16 a[140:141], v28 offset:19456
    v_mfma_f32_16x16x32_bf16 v[148:151], a[156:159], a[20:23], v[148:151]
    ds_read_b64_tr_b16 a[142:143], v28 offset:19968
    v_mfma_f32_16x16x32_bf16 v[152:155], a[156:159], a[24:27], v[152:155]
    v_mfma_f32_16x16x32_bf16 v[156:159], a[156:159], a[28:31], v[156:159]
    s_waitcnt vmcnt(23)
    s_waitcnt lgkmcnt(6)
    v_mfma_f32_16x16x32_bf16 v[32:35], a[128:131], a[32:35], v[32:35]
    ds_read_b64_tr_b16 a[144:145], v28 offset:20480
    buffer_load_dwordx4 a[108:111], v2, s[12:15], s41 offen offset:3072 sc1
    v_mfma_f32_16x16x32_bf16 v[36:39], a[128:131], a[36:39], v[36:39]
    ds_read_b64_tr_b16 a[146:147], v28 offset:20992
    s_add_u32 s41, s41, 4096
    v_mfma_f32_16x16x32_bf16 v[40:43], a[128:131], a[40:43], v[40:43]
    v_mfma_f32_16x16x32_bf16 v[44:47], a[128:131], a[44:47], v[44:47]
    s_waitcnt lgkmcnt(6)
    v_mfma_f32_16x16x32_bf16 v[48:51], a[132:135], a[32:35], v[48:51]
    ds_read_b64_tr_b16 a[148:149], v28 offset:21504
    v_mfma_f32_16x16x32_bf16 v[52:55], a[132:135], a[36:39], v[52:55]
    ds_read_b64_tr_b16 a[150:151], v28 offset:22016
    s_add_u32 m0, s48, 65536
    v_mfma_f32_16x16x32_bf16 v[56:59], a[132:135], a[40:43], v[56:59]
    buffer_load_dwordx4 v2, s[20:23], s40 offen offset:0 sc1 lds
    v_mfma_f32_16x16x32_bf16 v[60:63], a[132:135], a[44:47], v[60:63]
    s_waitcnt lgkmcnt(6)
    v_mfma_f32_16x16x32_bf16 v[64:67], a[136:139], a[32:35], v[64:67]
    ds_read_b64_tr_b16 a[152:153], v28 offset:22528
    buffer_load_dwordx4 a[112:115], v2, s[12:15], s41 offen offset:0 sc1
    v_mfma_f32_16x16x32_bf16 v[68:71], a[136:139], a[36:39], v[68:71]
    ds_read_b64_tr_b16 a[154:155], v28 offset:23040
    v_mfma_f32_16x16x32_bf16 v[72:75], a[136:139], a[40:43], v[72:75]
    v_mfma_f32_16x16x32_bf16 v[76:79], a[136:139], a[44:47], v[76:79]
    s_waitcnt lgkmcnt(6)
    v_mfma_f32_16x16x32_bf16 v[80:83], a[140:143], a[32:35], v[80:83]
    ds_read_b64_tr_b16 a[156:157], v28 offset:23552
    v_mfma_f32_16x16x32_bf16 v[84:87], a[140:143], a[36:39], v[84:87]
    ds_read_b64_tr_b16 a[158:159], v28 offset:24064
    v_mfma_f32_16x16x32_bf16 v[88:91], a[140:143], a[40:43], v[88:91]
    v_mfma_f32_16x16x32_bf16 v[92:95], a[140:143], a[44:47], v[92:95]
    s_waitcnt lgkmcnt(6)
    buffer_load_dwordx4 a[116:119], v2, s[12:15], s41 offen offset:1024 sc1
    v_mfma_f32_16x16x32_bf16 v[96:99], a[144:147], a[32:35], v[96:99]
    ds_read_b64_tr_b16 a[128:129], v28 offset:24576
    v_mfma_f32_16x16x32_bf16 v[100:103], a[144:147], a[36:39], v[100:103]
    ds_read_b64_tr_b16 a[130:131], v28 offset:25088
    v_mfma_f32_16x16x32_bf16 v[104:107], a[144:147], a[40:43], v[104:107]
    v_mfma_f32_16x16x32_bf16 v[108:111], a[144:147], a[44:47], v[108:111]
    s_waitcnt lgkmcnt(6)
    buffer_load_dwordx4 v2, s[20:23], s40 offen offset:1024 sc1 lds
    v_mfma_f32_16x16x32_bf16 v[112:115], a[148:151], a[32:35], v[112:115]
    ds_read_b64_tr_b16 a[132:133], v28 offset:25600
    v_mfma_f32_16x16x32_bf16 v[116:119], a[148:151], a[36:39], v[116:119]
    ds_read_b64_tr_b16 a[134:135], v28 offset:26112
    v_mfma_f32_16x16x32_bf16 v[120:123], a[148:151], a[40:43], v[120:123]
    v_mfma_f32_16x16x32_bf16 v[124:127], a[148:151], a[44:47], v[124:127]
    s_waitcnt lgkmcnt(6)
    buffer_load_dwordx4 a[120:123], v2, s[12:15], s41 offen offset:2048 sc1
    v_mfma_f32_16x16x32_bf16 v[128:131], a[152:155], a[32:35], v[128:131]
    ds_read_b64_tr_b16 a[136:137], v28 offset:26624
    v_mfma_f32_16x16x32_bf16 v[132:135], a[152:155], a[36:39], v[132:135]
    ds_read_b64_tr_b16 a[138:139], v28 offset:27136
    v_mfma_f32_16x16x32_bf16 v[136:139], a[152:155], a[40:43], v[136:139]
    v_mfma_f32_16x16x32_bf16 v[140:143], a[152:155], a[44:47], v[140:143]
    s_waitcnt lgkmcnt(6)
    v_mfma_f32_16x16x32_bf16 v[144:147], a[156:159], a[32:35], v[144:147]
    ds_read_b64_tr_b16 a[140:141], v28 offset:27648
    v_mfma_f32_16x16x32_bf16 v[148:151], a[156:159], a[36:39], v[148:151]
    ds_read_b64_tr_b16 a[142:143], v28 offset:28160
    v_mfma_f32_16x16x32_bf16 v[152:155], a[156:159], a[40:43], v[152:155]
    v_mfma_f32_16x16x32_bf16 v[156:159], a[156:159], a[44:47], v[156:159]
    s_waitcnt vmcnt(23)
    s_waitcnt lgkmcnt(6)
    buffer_load_dwordx4 a[124:127], v2, s[12:15], s41 offen offset:3072 sc1
    s_add_u32 s41, s41, 4096
    v_mfma_f32_16x16x32_bf16 v[32:35], a[128:131], a[48:51], v[32:35]
    ds_read_b64_tr_b16 a[144:145], v28 offset:28672
    v_mfma_f32_16x16x32_bf16 v[36:39], a[128:131], a[52:55], v[36:39]
    ds_read_b64_tr_b16 a[146:147], v28 offset:29184
    v_mfma_f32_16x16x32_bf16 v[40:43], a[128:131], a[56:59], v[40:43]
    buffer_load_dwordx4 v2, s[20:23], s40 offen offset:2048 sc1 lds
    v_mfma_f32_16x16x32_bf16 v[44:47], a[128:131], a[60:63], v[44:47]
    s_waitcnt lgkmcnt(6)
    v_mfma_f32_16x16x32_bf16 v[48:51], a[132:135], a[48:51], v[48:51]
    ds_read_b64_tr_b16 a[148:149], v28 offset:29696
    v_mfma_f32_16x16x32_bf16 v[52:55], a[132:135], a[52:55], v[52:55]
    ds_read_b64_tr_b16 a[150:151], v28 offset:30208
    v_mfma_f32_16x16x32_bf16 v[56:59], a[132:135], a[56:59], v[56:59]
    v_mfma_f32_16x16x32_bf16 v[60:63], a[132:135], a[60:63], v[60:63]
    s_waitcnt lgkmcnt(6)
    buffer_load_dwordx4 a[0:3], v2, s[12:15], s41 offen offset:0 sc1
    v_mfma_f32_16x16x32_bf16 v[64:67], a[136:139], a[48:51], v[64:67]
    ds_read_b64_tr_b16 a[152:153], v28 offset:30720
    v_mfma_f32_16x16x32_bf16 v[68:71], a[136:139], a[52:55], v[68:71]
    ds_read_b64_tr_b16 a[154:155], v28 offset:31232
    v_mfma_f32_16x16x32_bf16 v[72:75], a[136:139], a[56:59], v[72:75]
    v_mfma_f32_16x16x32_bf16 v[76:79], a[136:139], a[60:63], v[76:79]
    s_waitcnt lgkmcnt(6)
    v_mfma_f32_16x16x32_bf16 v[80:83], a[140:143], a[48:51], v[80:83]
    ds_read_b64_tr_b16 a[156:157], v28 offset:31744
    v_mfma_f32_16x16x32_bf16 v[84:87], a[140:143], a[52:55], v[84:87]
    ds_read_b64_tr_b16 a[158:159], v28 offset:32256
    v_mfma_f32_16x16x32_bf16 v[88:91], a[140:143], a[56:59], v[88:91]
    buffer_load_dwordx4 a[4:7], v2, s[12:15], s41 offen offset:1024 sc1
    v_mfma_f32_16x16x32_bf16 v[92:95], a[140:143], a[60:63], v[92:95]
    s_waitcnt lgkmcnt(6)
    s_waitcnt vmcnt(22)
    s_barrier
    v_mfma_f32_16x16x32_bf16 v[96:99], a[144:147], a[48:51], v[96:99]
    ds_read_b64_tr_b16 a[128:129], v28 offset:32768
    buffer_load_dwordx4 v2, s[20:23], s40 offen offset:3072 sc1 lds
    v_mfma_f32_16x16x32_bf16 v[100:103], a[144:147], a[52:55], v[100:103]
    ds_read_b64_tr_b16 a[130:131], v28 offset:33280
    s_add_u32 s40, s40, 16384
    v_mfma_f32_16x16x32_bf16 v[104:107], a[144:147], a[56:59], v[104:107]
    v_mfma_f32_16x16x32_bf16 v[108:111], a[144:147], a[60:63], v[108:111]
    s_waitcnt lgkmcnt(6)
    v_mfma_f32_16x16x32_bf16 v[112:115], a[148:151], a[48:51], v[112:115]
    ds_read_b64_tr_b16 a[132:133], v28 offset:33792
    v_mfma_f32_16x16x32_bf16 v[116:119], a[148:151], a[52:55], v[116:119]
    ds_read_b64_tr_b16 a[134:135], v28 offset:34304
    v_mfma_f32_16x16x32_bf16 v[120:123], a[148:151], a[56:59], v[120:123]
    buffer_load_dwordx4 a[8:11], v2, s[12:15], s41 offen offset:2048 sc1
    v_mfma_f32_16x16x32_bf16 v[124:127], a[148:151], a[60:63], v[124:127]
    s_waitcnt lgkmcnt(6)
    v_mfma_f32_16x16x32_bf16 v[128:131], a[152:155], a[48:51], v[128:131]
    ds_read_b64_tr_b16 a[136:137], v28 offset:34816
    v_mfma_f32_16x16x32_bf16 v[132:135], a[152:155], a[52:55], v[132:135]
    ds_read_b64_tr_b16 a[138:139], v28 offset:35328
    v_mfma_f32_16x16x32_bf16 v[136:139], a[152:155], a[56:59], v[136:139]
    v_mfma_f32_16x16x32_bf16 v[140:143], a[152:155], a[60:63], v[140:143]
    s_waitcnt lgkmcnt(6)
    v_mfma_f32_16x16x32_bf16 v[144:147], a[156:159], a[48:51], v[144:147]
    ds_read_b64_tr_b16 a[140:141], v28 offset:35840
    v_mfma_f32_16x16x32_bf16 v[148:151], a[156:159], a[52:55], v[148:151]
    ds_read_b64_tr_b16 a[142:143], v28 offset:36352
    v_mfma_f32_16x16x32_bf16 v[152:155], a[156:159], a[56:59], v[152:155]
    buffer_load_dwordx4 a[12:15], v2, s[12:15], s41 offen offset:3072 sc1
    s_add_u32 s41, s41, 4096
    v_mfma_f32_16x16x32_bf16 v[156:159], a[156:159], a[60:63], v[156:159]
    s_waitcnt vmcnt(24)
    s_waitcnt lgkmcnt(6)
    s_add_u32 m0, s48, 81920
    v_mfma_f32_16x16x32_bf16 v[32:35], a[128:131], a[64:67], v[32:35]
    ds_read_b64_tr_b16 a[144:145], v28 offset:36864
    buffer_load_dwordx4 v2, s[20:23], s40 offen offset:0 sc1 lds
    v_mfma_f32_16x16x32_bf16 v[36:39], a[128:131], a[68:71], v[36:39]
    ds_read_b64_tr_b16 a[146:147], v28 offset:37376
    v_mfma_f32_16x16x32_bf16 v[40:43], a[128:131], a[72:75], v[40:43]
    v_mfma_f32_16x16x32_bf16 v[44:47], a[128:131], a[76:79], v[44:47]
    s_waitcnt lgkmcnt(6)
    v_mfma_f32_16x16x32_bf16 v[48:51], a[132:135], a[64:67], v[48:51]
    ds_read_b64_tr_b16 a[148:149], v28 offset:37888
    v_mfma_f32_16x16x32_bf16 v[52:55], a[132:135], a[68:71], v[52:55]
    ds_read_b64_tr_b16 a[150:151], v28 offset:38400
    buffer_load_dwordx4 a[16:19], v2, s[12:15], s41 offen offset:0 sc1
    v_mfma_f32_16x16x32_bf16 v[56:59], a[132:135], a[72:75], v[56:59]
    v_mfma_f32_16x16x32_bf16 v[60:63], a[132:135], a[76:79], v[60:63]
    s_waitcnt lgkmcnt(6)
    v_mfma_f32_16x16x32_bf16 v[64:67], a[136:139], a[64:67], v[64:67]
    ds_read_b64_tr_b16 a[152:153], v28 offset:38912
    v_mfma_f32_16x16x32_bf16 v[68:71], a[136:139], a[68:71], v[68:71]
    ds_read_b64_tr_b16 a[154:155], v28 offset:39424
    v_mfma_f32_16x16x32_bf16 v[72:75], a[136:139], a[72:75], v[72:75]
    v_mfma_f32_16x16x32_bf16 v[76:79], a[136:139], a[76:79], v[76:79]
    s_waitcnt lgkmcnt(6)
    v_mfma_f32_16x16x32_bf16 v[80:83], a[140:143], a[64:67], v[80:83]
    ds_read_b64_tr_b16 a[156:157], v28 offset:39936
    v_mfma_f32_16x16x32_bf16 v[84:87], a[140:143], a[68:71], v[84:87]
    ds_read_b64_tr_b16 a[158:159], v28 offset:40448
    buffer_load_dwordx4 a[20:23], v2, s[12:15], s41 offen offset:1024 sc1
    v_mfma_f32_16x16x32_bf16 v[88:91], a[140:143], a[72:75], v[88:91]
    buffer_load_dwordx4 v2, s[20:23], s40 offen offset:1024 sc1 lds
    v_mfma_f32_16x16x32_bf16 v[92:95], a[140:143], a[76:79], v[92:95]
    s_waitcnt lgkmcnt(6)
    v_mfma_f32_16x16x32_bf16 v[96:99], a[144:147], a[64:67], v[96:99]
    ds_read_b64_tr_b16 a[128:129], v28 offset:40960
    v_mfma_f32_16x16x32_bf16 v[100:103], a[144:147], a[68:71], v[100:103]
    ds_read_b64_tr_b16 a[130:131], v28 offset:41472
    v_mfma_f32_16x16x32_bf16 v[104:107], a[144:147], a[72:75], v[104:107]
    v_mfma_f32_16x16x32_bf16 v[108:111], a[144:147], a[76:79], v[108:111]
    s_waitcnt lgkmcnt(6)
    v_mfma_f32_16x16x32_bf16 v[112:115], a[148:151], a[64:67], v[112:115]
    ds_read_b64_tr_b16 a[132:133], v28 offset:41984
    v_mfma_f32_16x16x32_bf16 v[116:119], a[148:151], a[68:71], v[116:119]
    ds_read_b64_tr_b16 a[134:135], v28 offset:42496
    buffer_load_dwordx4 a[24:27], v2, s[12:15], s41 offen offset:2048 sc1
    v_mfma_f32_16x16x32_bf16 v[120:123], a[148:151], a[72:75], v[120:123]
    v_mfma_f32_16x16x32_bf16 v[124:127], a[148:151], a[76:79], v[124:127]
    s_waitcnt lgkmcnt(6)
    v_mfma_f32_16x16x32_bf16 v[128:131], a[152:155], a[64:67], v[128:131]
    ds_read_b64_tr_b16 a[136:137], v28 offset:43008
    v_mfma_f32_16x16x32_bf16 v[132:135], a[152:155], a[68:71], v[132:135]
    ds_read_b64_tr_b16 a[138:139], v28 offset:43520
    v_mfma_f32_16x16x32_bf16 v[136:139], a[152:155], a[72:75], v[136:139]
    v_mfma_f32_16x16x32_bf16 v[140:143], a[152:155], a[76:79], v[140:143]
    s_waitcnt lgkmcnt(6)
    v_mfma_f32_16x16x32_bf16 v[144:147], a[156:159], a[64:67], v[144:147]
    ds_read_b64_tr_b16 a[140:141], v28 offset:44032
    buffer_load_dwordx4 v2, s[20:23], s40 offen offset:2048 sc1 lds
    v_mfma_f32_16x16x32_bf16 v[148:151], a[156:159], a[68:71], v[148:151]
    ds_read_b64_tr_b16 a[142:143], v28 offset:44544
    buffer_load_dwordx4 a[28:31], v2, s[12:15], s41 offen offset:3072 sc1
    v_mfma_f32_16x16x32_bf16 v[152:155], a[156:159], a[72:75], v[152:155]
    s_add_u32 s41, s41, 4096
    v_mfma_f32_16x16x32_bf16 v[156:159], a[156:159], a[76:79], v[156:159]
    s_waitcnt vmcnt(25)
    s_waitcnt lgkmcnt(6)
    v_mfma_f32_16x16x32_bf16 v[32:35], a[128:131], a[80:83], v[32:35]
    ds_read_b64_tr_b16 a[144:145], v28 offset:45056
    v_mfma_f32_16x16x32_bf16 v[36:39], a[128:131], a[84:87], v[36:39]
    ds_read_b64_tr_b16 a[146:147], v28 offset:45568
    v_mfma_f32_16x16x32_bf16 v[40:43], a[128:131], a[88:91], v[40:43]
    v_mfma_f32_16x16x32_bf16 v[44:47], a[128:131], a[92:95], v[44:47]
    s_waitcnt lgkmcnt(6)
    v_mfma_f32_16x16x32_bf16 v[48:51], a[132:135], a[80:83], v[48:51]
    ds_read_b64_tr_b16 a[148:149], v28 offset:46080
    buffer_load_dwordx4 a[32:35], v2, s[12:15], s41 offen offset:0 sc1
    v_mfma_f32_16x16x32_bf16 v[52:55], a[132:135], a[84:87], v[52:55]
    ds_read_b64_tr_b16 a[150:151], v28 offset:46592
    v_mfma_f32_16x16x32_bf16 v[56:59], a[132:135], a[88:91], v[56:59]
    v_mfma_f32_16x16x32_bf16 v[60:63], a[132:135], a[92:95], v[60:63]
    s_waitcnt lgkmcnt(6)
    v_mfma_f32_16x16x32_bf16 v[64:67], a[136:139], a[80:83], v[64:67]
    ds_read_b64_tr_b16 a[152:153], v28 offset:47104
    v_mfma_f32_16x16x32_bf16 v[68:71], a[136:139], a[84:87], v[68:71]
    ds_read_b64_tr_b16 a[154:155], v28 offset:47616
    v_mfma_f32_16x16x32_bf16 v[72:75], a[136:139], a[88:91], v[72:75]
    buffer_load_dwordx4 v2, s[20:23], s40 offen offset:3072 sc1 lds
    s_add_u32 s40, s40, 16384
    v_mfma_f32_16x16x32_bf16 v[76:79], a[136:139], a[92:95], v[76:79]
    s_waitcnt lgkmcnt(6)
    v_mfma_f32_16x16x32_bf16 v[80:83], a[140:143], a[80:83], v[80:83]
    ds_read_b64_tr_b16 a[156:157], v28 offset:48128
    buffer_load_dwordx4 a[36:39], v2, s[12:15], s41 offen offset:1024 sc1
    v_mfma_f32_16x16x32_bf16 v[84:87], a[140:143], a[84:87], v[84:87]
    ds_read_b64_tr_b16 a[158:159], v28 offset:48640
    v_mfma_f32_16x16x32_bf16 v[88:91], a[140:143], a[88:91], v[88:91]
    v_mfma_f32_16x16x32_bf16 v[92:95], a[140:143], a[92:95], v[92:95]
    s_waitcnt lgkmcnt(6)
    s_waitcnt vmcnt(24)
    s_barrier
    v_mfma_f32_16x16x32_bf16 v[96:99], a[144:147], a[80:83], v[96:99]
    ds_read_b64_tr_b16 a[128:129], v28 offset:49152
    v_mfma_f32_16x16x32_bf16 v[100:103], a[144:147], a[84:87], v[100:103]
    ds_read_b64_tr_b16 a[130:131], v28 offset:49664
    v_mfma_f32_16x16x32_bf16 v[104:107], a[144:147], a[88:91], v[104:107]
    v_mfma_f32_16x16x32_bf16 v[108:111], a[144:147], a[92:95], v[108:111]
    s_waitcnt lgkmcnt(6)
    v_mfma_f32_16x16x32_bf16 v[112:115], a[148:151], a[80:83], v[112:115]
    ds_read_b64_tr_b16 a[132:133], v28 offset:50176
    buffer_load_dwordx4 a[40:43], v2, s[12:15], s41 offen offset:2048 sc1
    v_mfma_f32_16x16x32_bf16 v[116:119], a[148:151], a[84:87], v[116:119]
    ds_read_b64_tr_b16 a[134:135], v28 offset:50688
    v_mfma_f32_16x16x32_bf16 v[120:123], a[148:151], a[88:91], v[120:123]
    v_mfma_f32_16x16x32_bf16 v[124:127], a[148:151], a[92:95], v[124:127]
    s_waitcnt lgkmcnt(6)
    v_mfma_f32_16x16x32_bf16 v[128:131], a[152:155], a[80:83], v[128:131]
    ds_read_b64_tr_b16 a[136:137], v28 offset:51200
    v_mfma_f32_16x16x32_bf16 v[132:135], a[152:155], a[84:87], v[132:135]
    ds_read_b64_tr_b16 a[138:139], v28 offset:51712
    v_mfma_f32_16x16x32_bf16 v[136:139], a[152:155], a[88:91], v[136:139]
    v_mfma_f32_16x16x32_bf16 v[140:143], a[152:155], a[92:95], v[140:143]
    s_waitcnt lgkmcnt(6)
    buffer_load_dwordx4 a[44:47], v2, s[12:15], s41 offen offset:3072 sc1
    s_add_u32 s41, s41, 4096
    v_mfma_f32_16x16x32_bf16 v[144:147], a[156:159], a[80:83], v[144:147]
    ds_read_b64_tr_b16 a[140:141], v28 offset:52224
    v_mfma_f32_16x16x32_bf16 v[148:151], a[156:159], a[84:87], v[148:151]
    ds_read_b64_tr_b16 a[142:143], v28 offset:52736
    v_mfma_f32_16x16x32_bf16 v[152:155], a[156:159], a[88:91], v[152:155]
    v_mfma_f32_16x16x32_bf16 v[156:159], a[156:159], a[92:95], v[156:159]
    s_waitcnt vmcnt(24)
    s_waitcnt lgkmcnt(6)
    v_mfma_f32_16x16x32_bf16 v[32:35], a[128:131], a[96:99], v[32:35]
    ds_read_b64_tr_b16 a[144:145], v28 offset:53248
    v_mfma_f32_16x16x32_bf16 v[36:39], a[128:131], a[100:103], v[36:39]
    ds_read_b64_tr_b16 a[146:147], v28 offset:53760
    v_mfma_f32_16x16x32_bf16 v[40:43], a[128:131], a[104:107], v[40:43]
    v_mfma_f32_16x16x32_bf16 v[44:47], a[128:131], a[108:111], v[44:47]
    s_waitcnt lgkmcnt(6)
    buffer_load_dwordx4 a[48:51], v2, s[12:15], s41 offen offset:0 sc1
    v_mfma_f32_16x16x32_bf16 v[48:51], a[132:135], a[96:99], v[48:51]
    ds_read_b64_tr_b16 a[148:149], v28 offset:54272
    v_mfma_f32_16x16x32_bf16 v[52:55], a[132:135], a[100:103], v[52:55]
    ds_read_b64_tr_b16 a[150:151], v28 offset:54784
    v_mfma_f32_16x16x32_bf16 v[56:59], a[132:135], a[104:107], v[56:59]
    v_mfma_f32_16x16x32_bf16 v[60:63], a[132:135], a[108:111], v[60:63]
    s_waitcnt lgkmcnt(6)
    v_mfma_f32_16x16x32_bf16 v[64:67], a[136:139], a[96:99], v[64:67]
    ds_read_b64_tr_b16 a[152:153], v28 offset:55296
    v_mfma_f32_16x16x32_bf16 v[68:71], a[136:139], a[100:103], v[68:71]
    ds_read_b64_tr_b16 a[154:155], v28 offset:55808
    v_mfma_f32_16x16x32_bf16 v[72:75], a[136:139], a[104:107], v[72:75]
    v_mfma_f32_16x16x32_bf16 v[76:79], a[136:139], a[108:111], v[76:79]
    s_waitcnt lgkmcnt(6)
    buffer_load_dwordx4 a[52:55], v2, s[12:15], s41 offen offset:1024 sc1
    v_mfma_f32_16x16x32_bf16 v[80:83], a[140:143], a[96:99], v[80:83]
    ds_read_b64_tr_b16 a[156:157], v28 offset:56320
    v_mfma_f32_16x16x32_bf16 v[84:87], a[140:143], a[100:103], v[84:87]
    ds_read_b64_tr_b16 a[158:159], v28 offset:56832
    v_mfma_f32_16x16x32_bf16 v[88:91], a[140:143], a[104:107], v[88:91]
    v_mfma_f32_16x16x32_bf16 v[92:95], a[140:143], a[108:111], v[92:95]
    s_waitcnt lgkmcnt(6)
    v_mfma_f32_16x16x32_bf16 v[96:99], a[144:147], a[96:99], v[96:99]
    ds_read_b64_tr_b16 a[128:129], v28 offset:57344
    v_mfma_f32_16x16x32_bf16 v[100:103], a[144:147], a[100:103], v[100:103]
    ds_read_b64_tr_b16 a[130:131], v28 offset:57856
    v_mfma_f32_16x16x32_bf16 v[104:107], a[144:147], a[104:107], v[104:107]
    buffer_load_dwordx4 a[56:59], v2, s[12:15], s41 offen offset:2048 sc1
    v_mfma_f32_16x16x32_bf16 v[108:111], a[144:147], a[108:111], v[108:111]
    s_waitcnt lgkmcnt(6)
    v_mfma_f32_16x16x32_bf16 v[112:115], a[148:151], a[96:99], v[112:115]
    ds_read_b64_tr_b16 a[132:133], v28 offset:58368
    v_mfma_f32_16x16x32_bf16 v[116:119], a[148:151], a[100:103], v[116:119]
    ds_read_b64_tr_b16 a[134:135], v28 offset:58880
    v_mfma_f32_16x16x32_bf16 v[120:123], a[148:151], a[104:107], v[120:123]
    v_mfma_f32_16x16x32_bf16 v[124:127], a[148:151], a[108:111], v[124:127]
    s_waitcnt lgkmcnt(6)
    v_mfma_f32_16x16x32_bf16 v[128:131], a[152:155], a[96:99], v[128:131]
    ds_read_b64_tr_b16 a[136:137], v28 offset:59392
    v_mfma_f32_16x16x32_bf16 v[132:135], a[152:155], a[100:103], v[132:135]
    ds_read_b64_tr_b16 a[138:139], v28 offset:59904
    v_mfma_f32_16x16x32_bf16 v[136:139], a[152:155], a[104:107], v[136:139]
    buffer_load_dwordx4 a[60:63], v2, s[12:15], s41 offen offset:3072 sc1
    s_add_u32 s41, s41, 4096
    v_mfma_f32_16x16x32_bf16 v[140:143], a[152:155], a[108:111], v[140:143]
    s_waitcnt lgkmcnt(6)
    v_mfma_f32_16x16x32_bf16 v[144:147], a[156:159], a[96:99], v[144:147]
    ds_read_b64_tr_b16 a[140:141], v28 offset:60416
    v_mfma_f32_16x16x32_bf16 v[148:151], a[156:159], a[100:103], v[148:151]
    ds_read_b64_tr_b16 a[142:143], v28 offset:60928
    v_mfma_f32_16x16x32_bf16 v[152:155], a[156:159], a[104:107], v[152:155]
    v_mfma_f32_16x16x32_bf16 v[156:159], a[156:159], a[108:111], v[156:159]
    s_waitcnt vmcnt(22)
    s_waitcnt lgkmcnt(6)
    v_mfma_f32_16x16x32_bf16 v[32:35], a[128:131], a[112:115], v[32:35]
    ds_read_b64_tr_b16 a[144:145], v28 offset:61440
    v_mfma_f32_16x16x32_bf16 v[36:39], a[128:131], a[116:119], v[36:39]
    ds_read_b64_tr_b16 a[146:147], v28 offset:61952
    v_mfma_f32_16x16x32_bf16 v[40:43], a[128:131], a[120:123], v[40:43]
    v_mfma_f32_16x16x32_bf16 v[44:47], a[128:131], a[124:127], v[44:47]
    s_waitcnt lgkmcnt(6)
    v_mfma_f32_16x16x32_bf16 v[48:51], a[132:135], a[112:115], v[48:51]
    ds_read_b64_tr_b16 a[148:149], v28 offset:62464
    v_mfma_f32_16x16x32_bf16 v[52:55], a[132:135], a[116:119], v[52:55]
    ds_read_b64_tr_b16 a[150:151], v28 offset:62976
    v_mfma_f32_16x16x32_bf16 v[56:59], a[132:135], a[120:123], v[56:59]
    v_mfma_f32_16x16x32_bf16 v[60:63], a[132:135], a[124:127], v[60:63]
    s_waitcnt lgkmcnt(6)
    v_mfma_f32_16x16x32_bf16 v[64:67], a[136:139], a[112:115], v[64:67]
    ds_read_b64_tr_b16 a[152:153], v28 offset:63488
    v_mfma_f32_16x16x32_bf16 v[68:71], a[136:139], a[116:119], v[68:71]
    ds_read_b64_tr_b16 a[154:155], v28 offset:64000
    v_mfma_f32_16x16x32_bf16 v[72:75], a[136:139], a[120:123], v[72:75]
    v_mfma_f32_16x16x32_bf16 v[76:79], a[136:139], a[124:127], v[76:79]
    s_waitcnt lgkmcnt(6)
    v_mfma_f32_16x16x32_bf16 v[80:83], a[140:143], a[112:115], v[80:83]
    ds_read_b64_tr_b16 a[156:157], v28 offset:64512
    v_mfma_f32_16x16x32_bf16 v[84:87], a[140:143], a[116:119], v[84:87]
    ds_read_b64_tr_b16 a[158:159], v28 offset:65024
    v_mfma_f32_16x16x32_bf16 v[88:91], a[140:143], a[120:123], v[88:91]
    v_mfma_f32_16x16x32_bf16 v[92:95], a[140:143], a[124:127], v[92:95]
    s_waitcnt lgkmcnt(6)
    s_waitcnt vmcnt(18)
    s_barrier
    v_mfma_f32_16x16x32_bf16 v[96:99], a[144:147], a[112:115], v[96:99]
    ds_read_b64_tr_b16 a[128:129], v27 offset:0
    v_mfma_f32_16x16x32_bf16 v[100:103], a[144:147], a[116:119], v[100:103]
    ds_read_b64_tr_b16 a[130:131], v27 offset:512
    v_mfma_f32_16x16x32_bf16 v[104:107], a[144:147], a[120:123], v[104:107]
    v_mfma_f32_16x16x32_bf16 v[108:111], a[144:147], a[124:127], v[108:111]
    s_waitcnt lgkmcnt(6)
    v_mfma_f32_16x16x32_bf16 v[112:115], a[148:151], a[112:115], v[112:115]
    ds_read_b64_tr_b16 a[132:133], v27 offset:1024
    v_mfma_f32_16x16x32_bf16 v[116:119], a[148:151], a[116:119], v[116:119]
    ds_read_b64_tr_b16 a[134:135], v27 offset:1536
    v_mfma_f32_16x16x32_bf16 v[120:123], a[148:151], a[120:123], v[120:123]
    v_mfma_f32_16x16x32_bf16 v[124:127], a[148:151], a[124:127], v[124:127]
    s_waitcnt lgkmcnt(6)
    v_mfma_f32_16x16x32_bf16 v[128:131], a[152:155], a[112:115], v[128:131]
    ds_read_b64_tr_b16 a[136:137], v27 offset:8192
    v_mfma_f32_16x16x32_bf16 v[132:135], a[152:155], a[116:119], v[132:135]
    ds_read_b64_tr_b16 a[138:139], v27 offset:8704
    v_mfma_f32_16x16x32_bf16 v[136:139], a[152:155], a[120:123], v[136:139]
    v_mfma_f32_16x16x32_bf16 v[140:143], a[152:155], a[124:127], v[140:143]
    s_waitcnt lgkmcnt(6)
    v_mfma_f32_16x16x32_bf16 v[144:147], a[156:159], a[112:115], v[144:147]
    ds_read_b64_tr_b16 a[140:141], v27 offset:9216
    v_mfma_f32_16x16x32_bf16 v[148:151], a[156:159], a[116:119], v[148:151]
    ds_read_b64_tr_b16 a[142:143], v27 offset:9728
    v_mfma_f32_16x16x32_bf16 v[152:155], a[156:159], a[120:123], v[152:155]
    v_mfma_f32_16x16x32_bf16 v[156:159], a[156:159], a[124:127], v[156:159]
    s_waitcnt vmcnt(16)
    s_waitcnt lgkmcnt(6)
    s_waitcnt vmcnt(7)
    s_barrier
    v_mfma_f32_16x16x32_bf16 v[32:35], a[128:131], a[0:3], v[32:35]
    ds_read_b64_tr_b16 a[144:145], v27 offset:16384
    v_mfma_f32_16x16x32_bf16 v[36:39], a[128:131], a[4:7], v[36:39]
    ds_read_b64_tr_b16 a[146:147], v27 offset:16896
    v_mfma_f32_16x16x32_bf16 v[40:43], a[128:131], a[8:11], v[40:43]
    v_mfma_f32_16x16x32_bf16 v[44:47], a[128:131], a[12:15], v[44:47]
    s_waitcnt lgkmcnt(6)
    v_mfma_f32_16x16x32_bf16 v[48:51], a[132:135], a[0:3], v[48:51]
    ds_read_b64_tr_b16 a[148:149], v27 offset:17408
    v_mfma_f32_16x16x32_bf16 v[52:55], a[132:135], a[4:7], v[52:55]
    ds_read_b64_tr_b16 a[150:151], v27 offset:17920
    v_mfma_f32_16x16x32_bf16 v[56:59], a[132:135], a[8:11], v[56:59]
    v_mfma_f32_16x16x32_bf16 v[60:63], a[132:135], a[12:15], v[60:63]
    s_waitcnt vmcnt(9)
    s_waitcnt lgkmcnt(6)
    v_mfma_f32_16x16x32_bf16 v[32:35], a[136:139], a[16:19], v[32:35]
    ds_read_b64_tr_b16 a[152:153], v27 offset:24576
    v_mfma_f32_16x16x32_bf16 v[36:39], a[136:139], a[20:23], v[36:39]
    ds_read_b64_tr_b16 a[154:155], v27 offset:25088
    v_mfma_f32_16x16x32_bf16 v[40:43], a[136:139], a[24:27], v[40:43]
    v_mfma_f32_16x16x32_bf16 v[44:47], a[136:139], a[28:31], v[44:47]
    s_waitcnt lgkmcnt(6)
    v_mfma_f32_16x16x32_bf16 v[48:51], a[140:143], a[16:19], v[48:51]
    ds_read_b64_tr_b16 a[156:157], v27 offset:25600
    v_mfma_f32_16x16x32_bf16 v[52:55], a[140:143], a[20:23], v[52:55]
    ds_read_b64_tr_b16 a[158:159], v27 offset:26112
    v_mfma_f32_16x16x32_bf16 v[56:59], a[140:143], a[24:27], v[56:59]
    v_mfma_f32_16x16x32_bf16 v[60:63], a[140:143], a[28:31], v[60:63]
    s_waitcnt vmcnt(4)
    s_waitcnt lgkmcnt(6)
    v_mfma_f32_16x16x32_bf16 v[32:35], a[144:147], a[32:35], v[32:35]
    ds_read_b64_tr_b16 a[128:129], v27 offset:2048
    v_mfma_f32_16x16x32_bf16 v[36:39], a[144:147], a[36:39], v[36:39]
    ds_read_b64_tr_b16 a[130:131], v27 offset:2560
    v_mfma_f32_16x16x32_bf16 v[40:43], a[144:147], a[40:43], v[40:43]
    v_mfma_f32_16x16x32_bf16 v[44:47], a[144:147], a[44:47], v[44:47]
    s_waitcnt lgkmcnt(6)
    v_mfma_f32_16x16x32_bf16 v[48:51], a[148:151], a[32:35], v[48:51]
    ds_read_b64_tr_b16 a[132:133], v27 offset:3072
    v_mfma_f32_16x16x32_bf16 v[52:55], a[148:151], a[36:39], v[52:55]
    ds_read_b64_tr_b16 a[134:135], v27 offset:3584
    v_mfma_f32_16x16x32_bf16 v[56:59], a[148:151], a[40:43], v[56:59]
    v_mfma_f32_16x16x32_bf16 v[60:63], a[148:151], a[44:47], v[60:63]
    s_waitcnt vmcnt(0)
    s_waitcnt lgkmcnt(6)
    v_mfma_f32_16x16x32_bf16 v[32:35], a[152:155], a[48:51], v[32:35]
    ds_read_b64_tr_b16 a[136:137], v27 offset:10240
    v_mfma_f32_16x16x32_bf16 v[36:39], a[152:155], a[52:55], v[36:39]
    ds_read_b64_tr_b16 a[138:139], v27 offset:10752
    v_mfma_f32_16x16x32_bf16 v[40:43], a[152:155], a[56:59], v[40:43]
    v_mfma_f32_16x16x32_bf16 v[44:47], a[152:155], a[60:63], v[44:47]
    s_waitcnt lgkmcnt(6)
    v_mfma_f32_16x16x32_bf16 v[48:51], a[156:159], a[48:51], v[48:51]
    ds_read_b64_tr_b16 a[140:141], v27 offset:11264
    v_mfma_f32_16x16x32_bf16 v[52:55], a[156:159], a[52:55], v[52:55]
    ds_read_b64_tr_b16 a[142:143], v27 offset:11776
    v_mfma_f32_16x16x32_bf16 v[56:59], a[156:159], a[56:59], v[56:59]
    v_mfma_f32_16x16x32_bf16 v[60:63], a[156:159], a[60:63], v[60:63]
    s_waitcnt lgkmcnt(6)
    v_mfma_f32_16x16x32_bf16 v[64:67], a[128:131], a[0:3], v[64:67]
    ds_read_b64_tr_b16 a[144:145], v27 offset:18432
    v_mfma_f32_16x16x32_bf16 v[68:71], a[128:131], a[4:7], v[68:71]
    ds_read_b64_tr_b16 a[146:147], v27 offset:18944
    v_mfma_f32_16x16x32_bf16 v[72:75], a[128:131], a[8:11], v[72:75]
    v_mfma_f32_16x16x32_bf16 v[76:79], a[128:131], a[12:15], v[76:79]
    s_waitcnt lgkmcnt(6)
    v_cvt_pk_bf16_f32 v160, v32, v33
    v_cvt_pk_bf16_f32 v161, v34, v35
    v_mfma_f32_16x16x32_bf16 v[80:83], a[132:135], a[0:3], v[80:83]
    ds_read_b64_tr_b16 a[148:149], v27 offset:19456
    v_cvt_pk_bf16_f32 v162, v48, v49
    v_mfma_f32_16x16x32_bf16 v[84:87], a[132:135], a[4:7], v[84:87]
    ds_read_b64_tr_b16 a[150:151], v27 offset:19968
    v_cvt_pk_bf16_f32 v163, v50, v51
    v_mfma_f32_16x16x32_bf16 v[88:91], a[132:135], a[8:11], v[88:91]
    v_cvt_pk_bf16_f32 v164, v36, v37
    v_mfma_f32_16x16x32_bf16 v[92:95], a[132:135], a[12:15], v[92:95]
    s_waitcnt lgkmcnt(6)
    v_cvt_pk_bf16_f32 v165, v38, v39
    v_mfma_f32_16x16x32_bf16 v[64:67], a[136:139], a[16:19], v[64:67]
    ds_read_b64_tr_b16 a[152:153], v27 offset:26624
    v_permlane16_swap_b32 v160, v162
    v_mfma_f32_16x16x32_bf16 v[68:71], a[136:139], a[20:23], v[68:71]
    ds_read_b64_tr_b16 a[154:155], v27 offset:27136
    v_permlane16_swap_b32 v161, v163
    v_mfma_f32_16x16x32_bf16 v[72:75], a[136:139], a[24:27], v[72:75]
    buffer_store_dwordx4 v[160:163], v18, s[8:11], s44 offen sc1
    v_mfma_f32_16x16x32_bf16 v[76:79], a[136:139], a[28:31], v[76:79]
    s_waitcnt lgkmcnt(6)
    v_cvt_pk_bf16_f32 v166, v52, v53
    v_mfma_f32_16x16x32_bf16 v[80:83], a[140:143], a[16:19], v[80:83]
    ds_read_b64_tr_b16 a[156:157], v27 offset:27648
    v_cvt_pk_bf16_f32 v167, v54, v55
    v_mfma_f32_16x16x32_bf16 v[84:87], a[140:143], a[20:23], v[84:87]
    ds_read_b64_tr_b16 a[158:159], v27 offset:28160
    v_cvt_pk_bf16_f32 v168, v40, v41
    v_mfma_f32_16x16x32_bf16 v[88:91], a[140:143], a[24:27], v[88:91]
    v_cvt_pk_bf16_f32 v169, v42, v43
    v_mfma_f32_16x16x32_bf16 v[92:95], a[140:143], a[28:31], v[92:95]
    s_waitcnt lgkmcnt(6)
    v_permlane16_swap_b32 v164, v166
    v_mfma_f32_16x16x32_bf16 v[64:67], a[144:147], a[32:35], v[64:67]
    ds_read_b64_tr_b16 a[128:129], v27 offset:4096
    v_permlane16_swap_b32 v165, v167
    v_mfma_f32_16x16x32_bf16 v[68:71], a[144:147], a[36:39], v[68:71]
    ds_read_b64_tr_b16 a[130:131], v27 offset:4608
    buffer_store_dwordx4 v[164:167], v18, s[8:11], s37 offen sc1
    v_mfma_f32_16x16x32_bf16 v[72:75], a[144:147], a[40:43], v[72:75]
    v_cvt_pk_bf16_f32 v170, v56, v57
    v_cvt_pk_bf16_f32 v171, v58, v59
    v_mfma_f32_16x16x32_bf16 v[76:79], a[144:147], a[44:47], v[76:79]
    s_waitcnt lgkmcnt(6)
    v_cvt_pk_bf16_f32 v172, v44, v45
    v_mfma_f32_16x16x32_bf16 v[80:83], a[148:151], a[32:35], v[80:83]
    ds_read_b64_tr_b16 a[132:133], v27 offset:5120
    v_cvt_pk_bf16_f32 v173, v46, v47
    v_mfma_f32_16x16x32_bf16 v[84:87], a[148:151], a[36:39], v[84:87]
    ds_read_b64_tr_b16 a[134:135], v27 offset:5632
    v_permlane16_swap_b32 v168, v170
    v_mfma_f32_16x16x32_bf16 v[88:91], a[148:151], a[40:43], v[88:91]
    v_permlane16_swap_b32 v169, v171
    v_mfma_f32_16x16x32_bf16 v[92:95], a[148:151], a[44:47], v[92:95]
    s_waitcnt lgkmcnt(6)
    buffer_store_dwordx4 v[168:171], v18, s[8:11], s38 offen sc1
    v_mfma_f32_16x16x32_bf16 v[64:67], a[152:155], a[48:51], v[64:67]
    ds_read_b64_tr_b16 a[136:137], v27 offset:12288
    v_cvt_pk_bf16_f32 v174, v60, v61
    v_mfma_f32_16x16x32_bf16 v[68:71], a[152:155], a[52:55], v[68:71]
    ds_read_b64_tr_b16 a[138:139], v27 offset:12800
    v_cvt_pk_bf16_f32 v175, v62, v63
    v_mfma_f32_16x16x32_bf16 v[72:75], a[152:155], a[56:59], v[72:75]
    s_nop 0
    v_mfma_f32_16x16x32_bf16 v[76:79], a[152:155], a[60:63], v[76:79]
    s_waitcnt lgkmcnt(6)
    v_permlane16_swap_b32 v172, v174
    v_mfma_f32_16x16x32_bf16 v[80:83], a[156:159], a[48:51], v[80:83]
    ds_read_b64_tr_b16 a[140:141], v27 offset:13312
    v_permlane16_swap_b32 v173, v175
    v_mfma_f32_16x16x32_bf16 v[84:87], a[156:159], a[52:55], v[84:87]
    ds_read_b64_tr_b16 a[142:143], v27 offset:13824
    buffer_store_dwordx4 v[172:175], v18, s[8:11], s39 offen sc1
    v_mfma_f32_16x16x32_bf16 v[88:91], a[156:159], a[56:59], v[88:91]
    v_mfma_f32_16x16x32_bf16 v[92:95], a[156:159], a[60:63], v[92:95]
    s_waitcnt lgkmcnt(6)
    v_mfma_f32_16x16x32_bf16 v[96:99], a[128:131], a[0:3], v[96:99]
    ds_read_b64_tr_b16 a[144:145], v27 offset:20480
    v_mfma_f32_16x16x32_bf16 v[100:103], a[128:131], a[4:7], v[100:103]
    ds_read_b64_tr_b16 a[146:147], v27 offset:20992
    v_mfma_f32_16x16x32_bf16 v[104:107], a[128:131], a[8:11], v[104:107]
    v_mfma_f32_16x16x32_bf16 v[108:111], a[128:131], a[12:15], v[108:111]
    s_waitcnt lgkmcnt(6)
    v_cvt_pk_bf16_f32 v176, v64, v65
    v_cvt_pk_bf16_f32 v177, v66, v67
    v_mfma_f32_16x16x32_bf16 v[112:115], a[132:135], a[0:3], v[112:115]
    ds_read_b64_tr_b16 a[148:149], v27 offset:21504
    v_cvt_pk_bf16_f32 v178, v80, v81
    v_mfma_f32_16x16x32_bf16 v[116:119], a[132:135], a[4:7], v[116:119]
    ds_read_b64_tr_b16 a[150:151], v27 offset:22016
    v_cvt_pk_bf16_f32 v179, v82, v83
    v_mfma_f32_16x16x32_bf16 v[120:123], a[132:135], a[8:11], v[120:123]
    v_cvt_pk_bf16_f32 v180, v68, v69
    v_mfma_f32_16x16x32_bf16 v[124:127], a[132:135], a[12:15], v[124:127]
    s_waitcnt lgkmcnt(6)
    v_cvt_pk_bf16_f32 v181, v70, v71
    v_mfma_f32_16x16x32_bf16 v[96:99], a[136:139], a[16:19], v[96:99]
    ds_read_b64_tr_b16 a[152:153], v27 offset:28672
    v_permlane16_swap_b32 v176, v178
    v_mfma_f32_16x16x32_bf16 v[100:103], a[136:139], a[20:23], v[100:103]
    ds_read_b64_tr_b16 a[154:155], v27 offset:29184
    v_permlane16_swap_b32 v177, v179
    v_mfma_f32_16x16x32_bf16 v[104:107], a[136:139], a[24:27], v[104:107]
    buffer_store_dwordx4 v[176:179], v19, s[8:11], s44 offen sc1
    v_mfma_f32_16x16x32_bf16 v[108:111], a[136:139], a[28:31], v[108:111]
    s_waitcnt lgkmcnt(6)
    v_cvt_pk_bf16_f32 v182, v84, v85
    v_mfma_f32_16x16x32_bf16 v[112:115], a[140:143], a[16:19], v[112:115]
    ds_read_b64_tr_b16 a[156:157], v27 offset:29696
    v_cvt_pk_bf16_f32 v183, v86, v87
    v_mfma_f32_16x16x32_bf16 v[116:119], a[140:143], a[20:23], v[116:119]
    ds_read_b64_tr_b16 a[158:159], v27 offset:30208
    v_cvt_pk_bf16_f32 v184, v72, v73
    v_mfma_f32_16x16x32_bf16 v[120:123], a[140:143], a[24:27], v[120:123]
    v_cvt_pk_bf16_f32 v185, v74, v75
    v_mfma_f32_16x16x32_bf16 v[124:127], a[140:143], a[28:31], v[124:127]
    s_waitcnt lgkmcnt(6)
    v_permlane16_swap_b32 v180, v182
    v_mfma_f32_16x16x32_bf16 v[96:99], a[144:147], a[32:35], v[96:99]
    ds_read_b64_tr_b16 a[128:129], v27 offset:6144
    v_permlane16_swap_b32 v181, v183
    v_mfma_f32_16x16x32_bf16 v[100:103], a[144:147], a[36:39], v[100:103]
    ds_read_b64_tr_b16 a[130:131], v27 offset:6656
    buffer_store_dwordx4 v[180:183], v19, s[8:11], s37 offen sc1
    v_mfma_f32_16x16x32_bf16 v[104:107], a[144:147], a[40:43], v[104:107]
    v_cvt_pk_bf16_f32 v186, v88, v89
    v_cvt_pk_bf16_f32 v187, v90, v91
    v_mfma_f32_16x16x32_bf16 v[108:111], a[144:147], a[44:47], v[108:111]
    s_waitcnt lgkmcnt(6)
    v_cvt_pk_bf16_f32 v188, v76, v77
    v_mfma_f32_16x16x32_bf16 v[112:115], a[148:151], a[32:35], v[112:115]
    ds_read_b64_tr_b16 a[132:133], v27 offset:7168
    v_cvt_pk_bf16_f32 v189, v78, v79
    v_mfma_f32_16x16x32_bf16 v[116:119], a[148:151], a[36:39], v[116:119]
    ds_read_b64_tr_b16 a[134:135], v27 offset:7680
    v_permlane16_swap_b32 v184, v186
    v_mfma_f32_16x16x32_bf16 v[120:123], a[148:151], a[40:43], v[120:123]
    v_permlane16_swap_b32 v185, v187
    v_mfma_f32_16x16x32_bf16 v[124:127], a[148:151], a[44:47], v[124:127]
    s_waitcnt lgkmcnt(6)
    buffer_store_dwordx4 v[184:187], v19, s[8:11], s38 offen sc1
    v_mfma_f32_16x16x32_bf16 v[96:99], a[152:155], a[48:51], v[96:99]
    ds_read_b64_tr_b16 a[136:137], v27 offset:14336
    v_cvt_pk_bf16_f32 v190, v92, v93
    v_mfma_f32_16x16x32_bf16 v[100:103], a[152:155], a[52:55], v[100:103]
    ds_read_b64_tr_b16 a[138:139], v27 offset:14848
    v_cvt_pk_bf16_f32 v191, v94, v95
    v_mfma_f32_16x16x32_bf16 v[104:107], a[152:155], a[56:59], v[104:107]
    s_nop 0
    v_mfma_f32_16x16x32_bf16 v[108:111], a[152:155], a[60:63], v[108:111]
    s_waitcnt lgkmcnt(6)
    v_permlane16_swap_b32 v188, v190
    v_mfma_f32_16x16x32_bf16 v[112:115], a[156:159], a[48:51], v[112:115]
    ds_read_b64_tr_b16 a[140:141], v27 offset:15360
    v_permlane16_swap_b32 v189, v191
    v_mfma_f32_16x16x32_bf16 v[116:119], a[156:159], a[52:55], v[116:119]
    ds_read_b64_tr_b16 a[142:143], v27 offset:15872
    buffer_store_dwordx4 v[188:191], v19, s[8:11], s39 offen sc1
    v_mfma_f32_16x16x32_bf16 v[120:123], a[156:159], a[56:59], v[120:123]
    v_mfma_f32_16x16x32_bf16 v[124:127], a[156:159], a[60:63], v[124:127]
    s_waitcnt lgkmcnt(6)
    v_mfma_f32_16x16x32_bf16 v[128:131], a[128:131], a[0:3], v[128:131]
    ds_read_b64_tr_b16 a[144:145], v27 offset:22528
    v_mfma_f32_16x16x32_bf16 v[132:135], a[128:131], a[4:7], v[132:135]
    ds_read_b64_tr_b16 a[146:147], v27 offset:23040
    v_mfma_f32_16x16x32_bf16 v[136:139], a[128:131], a[8:11], v[136:139]
    v_mfma_f32_16x16x32_bf16 v[140:143], a[128:131], a[12:15], v[140:143]
    s_waitcnt lgkmcnt(6)
    v_cvt_pk_bf16_f32 v192, v96, v97
    v_cvt_pk_bf16_f32 v193, v98, v99
    v_mfma_f32_16x16x32_bf16 v[144:147], a[132:135], a[0:3], v[144:147]
    ds_read_b64_tr_b16 a[148:149], v27 offset:23552
    v_cvt_pk_bf16_f32 v194, v112, v113
    v_mfma_f32_16x16x32_bf16 v[148:151], a[132:135], a[4:7], v[148:151]
    ds_read_b64_tr_b16 a[150:151], v27 offset:24064
    v_cvt_pk_bf16_f32 v195, v114, v115
    v_mfma_f32_16x16x32_bf16 v[152:155], a[132:135], a[8:11], v[152:155]
    v_cvt_pk_bf16_f32 v196, v100, v101
    v_mfma_f32_16x16x32_bf16 v[156:159], a[132:135], a[12:15], v[156:159]
    s_waitcnt lgkmcnt(6)
    v_cvt_pk_bf16_f32 v197, v102, v103
    v_mfma_f32_16x16x32_bf16 v[128:131], a[136:139], a[16:19], v[128:131]
    ds_read_b64_tr_b16 a[152:153], v27 offset:30720
    v_permlane16_swap_b32 v192, v194
    v_mfma_f32_16x16x32_bf16 v[132:135], a[136:139], a[20:23], v[132:135]
    ds_read_b64_tr_b16 a[154:155], v27 offset:31232
    v_permlane16_swap_b32 v193, v195
    v_mfma_f32_16x16x32_bf16 v[136:139], a[136:139], a[24:27], v[136:139]
    buffer_store_dwordx4 v[192:195], v20, s[8:11], s44 offen sc1
    v_mfma_f32_16x16x32_bf16 v[140:143], a[136:139], a[28:31], v[140:143]
    s_waitcnt lgkmcnt(6)
    v_cvt_pk_bf16_f32 v198, v116, v117
    v_mfma_f32_16x16x32_bf16 v[144:147], a[140:143], a[16:19], v[144:147]
    ds_read_b64_tr_b16 a[156:157], v27 offset:31744
    v_cvt_pk_bf16_f32 v199, v118, v119
    v_mfma_f32_16x16x32_bf16 v[148:151], a[140:143], a[20:23], v[148:151]
    ds_read_b64_tr_b16 a[158:159], v27 offset:32256
    v_cvt_pk_bf16_f32 v200, v104, v105
    v_mfma_f32_16x16x32_bf16 v[152:155], a[140:143], a[24:27], v[152:155]
    v_cvt_pk_bf16_f32 v201, v106, v107
    v_mfma_f32_16x16x32_bf16 v[156:159], a[140:143], a[28:31], v[156:159]
    s_waitcnt lgkmcnt(6)
    v_permlane16_swap_b32 v196, v198
    v_mfma_f32_16x16x32_bf16 v[128:131], a[144:147], a[32:35], v[128:131]
    v_permlane16_swap_b32 v197, v199
    buffer_store_dwordx4 v[196:199], v20, s[8:11], s37 offen sc1
    v_mfma_f32_16x16x32_bf16 v[132:135], a[144:147], a[36:39], v[132:135]
    v_cvt_pk_bf16_f32 v202, v120, v121
    v_mfma_f32_16x16x32_bf16 v[136:139], a[144:147], a[40:43], v[136:139]
    v_cvt_pk_bf16_f32 v203, v122, v123
    v_mfma_f32_16x16x32_bf16 v[140:143], a[144:147], a[44:47], v[140:143]
    s_waitcnt lgkmcnt(4)
    v_cvt_pk_bf16_f32 v204, v108, v109
    v_mfma_f32_16x16x32_bf16 v[144:147], a[148:151], a[32:35], v[144:147]
    v_cvt_pk_bf16_f32 v205, v110, v111
    v_mfma_f32_16x16x32_bf16 v[148:151], a[148:151], a[36:39], v[148:151]
    v_permlane16_swap_b32 v200, v202
    v_mfma_f32_16x16x32_bf16 v[152:155], a[148:151], a[40:43], v[152:155]
    v_permlane16_swap_b32 v201, v203
    v_mfma_f32_16x16x32_bf16 v[156:159], a[148:151], a[44:47], v[156:159]
    s_waitcnt lgkmcnt(2)
    buffer_store_dwordx4 v[200:203], v20, s[8:11], s38 offen sc1
    v_mfma_f32_16x16x32_bf16 v[128:131], a[152:155], a[48:51], v[128:131]
    v_cvt_pk_bf16_f32 v206, v124, v125
    v_mfma_f32_16x16x32_bf16 v[132:135], a[152:155], a[52:55], v[132:135]
    v_cvt_pk_bf16_f32 v207, v126, v127
    v_mfma_f32_16x16x32_bf16 v[136:139], a[152:155], a[56:59], v[136:139]
    s_nop 0
    v_mfma_f32_16x16x32_bf16 v[140:143], a[152:155], a[60:63], v[140:143]
    s_waitcnt lgkmcnt(0)
    v_permlane16_swap_b32 v204, v206
    v_mfma_f32_16x16x32_bf16 v[144:147], a[156:159], a[48:51], v[144:147]
    v_permlane16_swap_b32 v205, v207
    v_mfma_f32_16x16x32_bf16 v[148:151], a[156:159], a[52:55], v[148:151]
    buffer_store_dwordx4 v[204:207], v20, s[8:11], s39 offen sc1
    v_mfma_f32_16x16x32_bf16 v[152:155], a[156:159], a[56:59], v[152:155]
    v_mfma_f32_16x16x32_bf16 v[156:159], a[156:159], a[60:63], v[156:159]
    s_waitcnt vmcnt(63)
    s_cmp_lg_u32 s35, 0
    s_cbranch_scc1 L_last
    s_waitcnt vmcnt(4)
    s_add_u32 s59, s53, 520
    s_add_u32 s60, s53, 264
    s_barrier
    s_cmp_lg_u32 s3, 2
    s_cbranch_scc1 L_wf_19
    s_mov_b64 exec, 1
    v_mov_b32 v3, 0
    v_mov_b32_e64 v4, 1
    buffer_atomic_add v4, v3, s[24:27], s59 offen sc1
    s_mov_b64 exec, -1
L_wf_19:
    s_nop 1
    v_cvt_pk_bf16_f32 v208, v128, v129
    v_cvt_pk_bf16_f32 v209, v130, v131
    v_cvt_pk_bf16_f32 v210, v144, v145
    v_cvt_pk_bf16_f32 v211, v146, v147
    v_cvt_pk_bf16_f32 v212, v132, v133
    v_cvt_pk_bf16_f32 v213, v134, v135
    v_permlane16_swap_b32 v208, v210
    v_permlane16_swap_b32 v209, v211
    buffer_store_dwordx4 v[208:211], v21, s[8:11], s44 offen sc1
    v_cvt_pk_bf16_f32 v214, v148, v149
    v_cvt_pk_bf16_f32 v215, v150, v151
    v_cvt_pk_bf16_f32 v216, v136, v137
    v_cvt_pk_bf16_f32 v217, v138, v139
    v_permlane16_swap_b32 v212, v214
    v_permlane16_swap_b32 v213, v215
    buffer_store_dwordx4 v[212:215], v21, s[8:11], s37 offen sc1
    v_cvt_pk_bf16_f32 v218, v152, v153
    v_cvt_pk_bf16_f32 v219, v154, v155
    v_cvt_pk_bf16_f32 v220, v140, v141
    v_cvt_pk_bf16_f32 v221, v142, v143
    v_permlane16_swap_b32 v216, v218
    v_permlane16_swap_b32 v217, v219
    buffer_store_dwordx4 v[216:219], v21, s[8:11], s38 offen sc1
    v_cvt_pk_bf16_f32 v222, v156, v157
    v_cvt_pk_bf16_f32 v223, v158, v159
    s_nop 0
    v_permlane16_swap_b32 v220, v222
    v_permlane16_swap_b32 v221, v223
    buffer_store_dwordx4 v[220:223], v21, s[8:11], s39 offen sc1
    s_add_u32 s35, s35, 1
    s_waitcnt vmcnt(0)
    s_barrier
    s_cmp_lg_u32 s3, 2
    s_cbranch_scc1 L_wf_20
    s_mov_b64 exec, 1
    v_mov_b32 v3, 0
    v_mov_b32_e64 v4, 1
    buffer_atomic_add v4, v3, s[24:27], s60 offen sc1
    s_mov_b64 exec, -1
L_wf_20:
    s_cmp_lg_u32 s3, 0
    s_cbranch_scc1 L_layer
    s_mov_b32 s56, 0
L_poll_21:
    buffer_load_dword v4, v1, s[24:27], s59 offen sc1
    s_add_u32 s56, s56, 1
    s_waitcnt vmcnt(0)
    v_readfirstlane_b32 s30, v4
    s_cmp_ge_u32 s30, 32
    s_cbranch_scc1 L_polld_22
    s_cmp_lt_u32 s56, 400000
    s_cbranch_scc1 L_poll_21
L_polld_22:
    s_branch L_layer
L_last:
    s_load_dwordx2 s[16:17], s[0:1], 80
    s_and_b32 s52, s34, 3
    s_lshl_b32 s52, s52, 8
    s_lshr_b32 s43, s34, 2
    s_lshl_b32 s43, s43, 2
    s_add_u32 s52, s52, s43
    s_lshl_b32 s43, s31, 10
    s_add_u32 s52, s52, s43
    s_add_u32 s52, s52, 32
    s_mov_b32 s49, 0xffff0000
    s_mov_b32 s54, 0x4091afa4
    s_waitcnt vmcnt(0)
    s_barrier
    s_cmp_lg_u32 s3, 0
    s_cbranch_scc1 L_wf_23
    s_mov_b64 exec, 1
    v_mov_b32 v3, 0
    v_mov_b32 v4, 1
    buffer_atomic_add v4, v3, s[24:27], s52 offen sc1
    s_mov_b64 exec, -1
L_wf_23:
    v_permlane16_swap_b32 v128, v144
    v_permlane16_swap_b32 v129, v145
    v_permlane16_swap_b32 v130, v146
    v_permlane16_swap_b32 v131, v147
    v_permlane16_swap_b32 v132, v148
    v_permlane16_swap_b32 v133, v149
    v_permlane16_swap_b32 v134, v150
    v_permlane16_swap_b32 v135, v151
    v_permlane16_swap_b32 v136, v152
    v_permlane16_swap_b32 v137, v153
    v_permlane16_swap_b32 v138, v154
    v_permlane16_swap_b32 v139, v155
    v_permlane16_swap_b32 v140, v156
    v_permlane16_swap_b32 v141, v157
    v_permlane16_swap_b32 v142, v158
    v_permlane16_swap_b32 v143, v159
    v_lshlrev_b32 v32, 16, v208
    v_and_b32 v33, s49, v208
    v_lshlrev_b32 v34, 16, v209
    v_and_b32 v35, s49, v209
    v_lshlrev_b32 v36, 16, v210
    v_and_b32 v37, s49, v210
    v_lshlrev_b32 v38, 16, v211
    v_and_b32 v39, s49, v211
    v_lshlrev_b32 v40, 16, v212
    v_and_b32 v41, s49, v212
    v_lshlrev_b32 v42, 16, v213
    v_and_b32 v43, s49, v213
    v_lshlrev_b32 v44, 16, v214
    v_and_b32 v45, s49, v214
    v_lshlrev_b32 v46, 16, v215
    v_and_b32 v47, s49, v215
    v_lshlrev_b32 v48, 16, v216
    v_and_b32 v49, s49, v216
    v_lshlrev_b32 v50, 16, v217
    v_and_b32 v51, s49, v217
    v_lshlrev_b32 v52, 16, v218
    v_and_b32 v53, s49, v218
    v_lshlrev_b32 v54, 16, v219
    v_and_b32 v55, s49, v219
    v_lshlrev_b32 v56, 16, v220
    v_and_b32 v57, s49, v220
    v_lshlrev_b32 v58, 16, v221
    v_and_b32 v59, s49, v221
    v_lshlrev_b32 v60, 16, v222
    v_and_b32 v61, s49, v222
    v_lshlrev_b32 v62, 16, v223
    v_and_b32_e64 v63, s49, v223
    v_pk_fma_f32 v[128:129], v[128:129], s[54:55], v[32:33] op_sel_hi:[1,0,1]
    v_pk_fma_f32 v[130:131], v[130:131], s[54:55], v[34:35] op_sel_hi:[1,0,1]
    v_pk_fma_f32 v[144:145], v[144:145], s[54:55], v[36:37] op_sel_hi:[1,0,1]
    v_pk_fma_f32 v[146:147], v[146:147], s[54:55], v[38:39] op_sel_hi:[1,0,1]
    v_pk_fma_f32 v[132:133], v[132:133], s[54:55], v[40:41] op_sel_hi:[1,0,1]
    v_pk_fma_f32 v[134:135], v[134:135], s[54:55], v[42:43] op_sel_hi:[1,0,1]
    v_pk_fma_f32 v[148:149], v[148:149], s[54:55], v[44:45] op_sel_hi:[1,0,1]
    v_pk_fma_f32 v[150:151], v[150:151], s[54:55], v[46:47] op_sel_hi:[1,0,1]
    v_pk_fma_f32 v[136:137], v[136:137], s[54:55], v[48:49] op_sel_hi:[1,0,1]
    v_pk_fma_f32 v[138:139], v[138:139], s[54:55], v[50:51] op_sel_hi:[1,0,1]
    v_pk_fma_f32 v[152:153], v[152:153], s[54:55], v[52:53] op_sel_hi:[1,0,1]
    v_pk_fma_f32 v[154:155], v[154:155], s[54:55], v[54:55] op_sel_hi:[1,0,1]
    v_pk_fma_f32 v[140:141], v[140:141], s[54:55], v[56:57] op_sel_hi:[1,0,1]
    v_pk_fma_f32 v[142:143], v[142:143], s[54:55], v[58:59] op_sel_hi:[1,0,1]
    v_pk_fma_f32 v[156:157], v[156:157], s[54:55], v[60:61] op_sel_hi:[1,0,1]
    v_pk_fma_f32 v[158:159], v[158:159], s[54:55], v[62:63] op_sel_hi:[1,0,1]
    s_add_u32 s43, s33, 1
    s_and_b32 s43, s43, 3
    s_lshl_b32 s43, s43, 22
    v_add_u32 v18, s43, v21
    s_add_u32 s43, s33, 2
    s_and_b32 s43, s43, 3
    s_lshl_b32 s43, s43, 22
    v_add_u32 v19, s43, v21
    s_add_u32 s43, s33, 3
    s_and_b32 s43, s43, 3
    s_lshl_b32 s43, s43, 22
    v_add_u32 v20, s43, v21
    s_lshl_b32 s43, s33, 22
    s_sub_u32 s44, s44, s43
    s_sub_u32 s37, s37, s43
    s_sub_u32 s38, s38, s43
    s_sub_u32 s39, s39, s43
    v_and_b32 v22, 15, v0
    v_lshlrev_b32_e64 v22, 11, v22
    v_lshl_add_u32 v22, v6, 4, v22
    s_lshl_b32 s45, s31, 2
    s_add_u32 s45, s45, s3
    s_lshl_b32 s45, s45, 17
    s_lshl_b32 s43, s34, 8
    s_add_u32 s45, s45, s43
    s_lshl_b32 s43, s33, 6
    s_add_u32 s45, s45, s43
    s_waitcnt lgkmcnt(0)
    s_mov_b32 s12, s16
    s_mov_b32 s13, s17
    s_mov_b32 s14, 0x400000
    s_mov_b32 s15, 0x00020000
    s_cmp_lg_u32 s3, 1
    s_cbranch_scc1 L_lastp
    s_mov_b32 s56, 0
L_poll_24:
    buffer_load_dword v4, v1, s[24:27], s52 offen sc1
    s_add_u32 s56, s56, 1
    s_waitcnt vmcnt(0)
    v_readfirstlane_b32 s30, v4
    s_cmp_ge_u32 s30, 4
    s_cbranch_scc1 L_polld_25
    s_cmp_lt_u32 s56, 400000
    s_cbranch_scc1 L_poll_24
L_polld_25:
L_lastp:
    s_barrier
    buffer_load_dwordx4 v[160:163], v18, s[8:11], s44 offen sc1
    buffer_load_dwordx4 v[164:167], v19, s[8:11], s44 offen sc1
    buffer_load_dwordx4 v[168:171], v20, s[8:11], s44 offen sc1
    buffer_load_dwordx4 v[172:175], v18, s[8:11], s37 offen sc1
    buffer_load_dwordx4 v[176:179], v19, s[8:11], s37 offen sc1
    buffer_load_dwordx4 v[180:183], v20, s[8:11], s37 offen sc1
    buffer_load_dwordx4 v[184:187], v18, s[8:11], s38 offen sc1
    buffer_load_dwordx4 v[188:191], v19, s[8:11], s38 offen sc1
    buffer_load_dwordx4 v[192:195], v20, s[8:11], s38 offen sc1
    buffer_load_dwordx4 v[196:199], v18, s[8:11], s39 offen sc1
    buffer_load_dwordx4 v[200:203], v19, s[8:11], s39 offen sc1
    buffer_load_dwordx4 v[204:207], v20, s[8:11], s39 offen sc1
    s_waitcnt vmcnt(11)
    v_lshlrev_b32 v32, 16, v160
    v_and_b32 v33, s49, v160
    v_lshlrev_b32 v34, 16, v161
    v_and_b32 v35, s49, v161
    v_lshlrev_b32 v36, 16, v162
    v_and_b32 v37, s49, v162
    v_lshlrev_b32 v38, 16, v163
    v_and_b32 v39, s49, v163
    s_waitcnt vmcnt(10)
    v_lshlrev_b32 v40, 16, v164
    v_and_b32 v41, s49, v164
    v_lshlrev_b32 v42, 16, v165
    v_and_b32 v43, s49, v165
    v_lshlrev_b32 v44, 16, v166
    v_and_b32 v45, s49, v166
    v_lshlrev_b32 v46, 16, v167
    v_and_b32 v47, s49, v167
    v_pk_add_f32 v[32:33], v[32:33], v[40:41]
    v_pk_add_f32 v[34:35], v[34:35], v[42:43]
    v_pk_add_f32 v[36:37], v[36:37], v[44:45]
    v_pk_add_f32 v[38:39], v[38:39], v[46:47]
    s_waitcnt vmcnt(9)
    v_lshlrev_b32 v40, 16, v168
    v_and_b32 v41, s49, v168
    v_lshlrev_b32 v42, 16, v169
    v_and_b32 v43, s49, v169
    v_lshlrev_b32 v44, 16, v170
    v_and_b32 v45, s49, v170
    v_lshlrev_b32 v46, 16, v171
    v_and_b32_e64 v47, s49, v171
    v_pk_add_f32 v[32:33], v[32:33], v[40:41]
    v_pk_add_f32 v[34:35], v[34:35], v[42:43]
    v_pk_add_f32 v[36:37], v[36:37], v[44:45]
    v_pk_add_f32 v[38:39], v[38:39], v[46:47]
    v_pk_fma_f32 v[128:129], v[32:33], s[54:55], v[128:129] op_sel_hi:[1,0,1]
    v_pk_fma_f32 v[130:131], v[34:35], s[54:55], v[130:131] op_sel_hi:[1,0,1]
    v_pk_fma_f32 v[144:145], v[36:37], s[54:55], v[144:145] op_sel_hi:[1,0,1]
    v_pk_fma_f32 v[146:147], v[38:39], s[54:55], v[146:147] op_sel_hi:[1,0,1]
    v_cvt_pk_bf16_f32 v64, v128, v129
    v_cvt_pk_bf16_f32 v65, v130, v131
    v_cvt_pk_bf16_f32 v66, v144, v145
    v_cvt_pk_bf16_f32 v67, v146, v147
    buffer_store_dwordx4 v[64:67], v22, s[12:15], s45 offen
    s_add_u32 s45, s45, 0x8000
    s_waitcnt vmcnt(9)
    v_lshlrev_b32 v32, 16, v172
    v_and_b32 v33, s49, v172
    v_lshlrev_b32 v34, 16, v173
    v_and_b32 v35, s49, v173
    v_lshlrev_b32 v36, 16, v174
    v_and_b32 v37, s49, v174
    v_lshlrev_b32 v38, 16, v175
    v_and_b32 v39, s49, v175
    s_waitcnt vmcnt(8)
    v_lshlrev_b32 v40, 16, v176
    v_and_b32 v41, s49, v176
    v_lshlrev_b32 v42, 16, v177
    v_and_b32 v43, s49, v177
    v_lshlrev_b32 v44, 16, v178
    v_and_b32 v45, s49, v178
    v_lshlrev_b32 v46, 16, v179
    v_and_b32 v47, s49, v179
    v_pk_add_f32 v[32:33], v[32:33], v[40:41]
    v_pk_add_f32 v[34:35], v[34:35], v[42:43]
    v_pk_add_f32 v[36:37], v[36:37], v[44:45]
    v_pk_add_f32 v[38:39], v[38:39], v[46:47]
    s_waitcnt vmcnt(7)
    v_lshlrev_b32 v40, 16, v180
    v_and_b32 v41, s49, v180
    v_lshlrev_b32 v42, 16, v181
    v_and_b32 v43, s49, v181
    v_lshlrev_b32 v44, 16, v182
    v_and_b32 v45, s49, v182
    v_lshlrev_b32 v46, 16, v183
    v_and_b32_e64 v47, s49, v183
    v_pk_add_f32 v[32:33], v[32:33], v[40:41]
    v_pk_add_f32 v[34:35], v[34:35], v[42:43]
    v_pk_add_f32 v[36:37], v[36:37], v[44:45]
    v_pk_add_f32 v[38:39], v[38:39], v[46:47]
    v_pk_fma_f32 v[132:133], v[32:33], s[54:55], v[132:133] op_sel_hi:[1,0,1]
    v_pk_fma_f32 v[134:135], v[34:35], s[54:55], v[134:135] op_sel_hi:[1,0,1]
    v_pk_fma_f32 v[148:149], v[36:37], s[54:55], v[148:149] op_sel_hi:[1,0,1]
    v_pk_fma_f32 v[150:151], v[38:39], s[54:55], v[150:151] op_sel_hi:[1,0,1]
    v_cvt_pk_bf16_f32 v68, v132, v133
    v_cvt_pk_bf16_f32 v69, v134, v135
    v_cvt_pk_bf16_f32 v70, v148, v149
    v_cvt_pk_bf16_f32 v71, v150, v151
    buffer_store_dwordx4 v[68:71], v22, s[12:15], s45 offen
    s_add_u32 s45, s45, 0x8000
    s_waitcnt vmcnt(7)
    v_lshlrev_b32 v32, 16, v184
    v_and_b32 v33, s49, v184
    v_lshlrev_b32 v34, 16, v185
    v_and_b32 v35, s49, v185
    v_lshlrev_b32 v36, 16, v186
    v_and_b32 v37, s49, v186
    v_lshlrev_b32 v38, 16, v187
    v_and_b32 v39, s49, v187
    s_waitcnt vmcnt(6)
    v_lshlrev_b32 v40, 16, v188
    v_and_b32 v41, s49, v188
    v_lshlrev_b32 v42, 16, v189
    v_and_b32 v43, s49, v189
    v_lshlrev_b32 v44, 16, v190
    v_and_b32 v45, s49, v190
    v_lshlrev_b32 v46, 16, v191
    v_and_b32 v47, s49, v191
    v_pk_add_f32 v[32:33], v[32:33], v[40:41]
    v_pk_add_f32 v[34:35], v[34:35], v[42:43]
    v_pk_add_f32 v[36:37], v[36:37], v[44:45]
    v_pk_add_f32 v[38:39], v[38:39], v[46:47]
    s_waitcnt vmcnt(5)
    v_lshlrev_b32 v40, 16, v192
    v_and_b32 v41, s49, v192
    v_lshlrev_b32 v42, 16, v193
    v_and_b32 v43, s49, v193
    v_lshlrev_b32 v44, 16, v194
    v_and_b32 v45, s49, v194
    v_lshlrev_b32 v46, 16, v195
    v_and_b32_e64 v47, s49, v195
    v_pk_add_f32 v[32:33], v[32:33], v[40:41]
    v_pk_add_f32 v[34:35], v[34:35], v[42:43]
    v_pk_add_f32 v[36:37], v[36:37], v[44:45]
    v_pk_add_f32 v[38:39], v[38:39], v[46:47]
    v_pk_fma_f32 v[136:137], v[32:33], s[54:55], v[136:137] op_sel_hi:[1,0,1]
    v_pk_fma_f32 v[138:139], v[34:35], s[54:55], v[138:139] op_sel_hi:[1,0,1]
    v_pk_fma_f32 v[152:153], v[36:37], s[54:55], v[152:153] op_sel_hi:[1,0,1]
    v_pk_fma_f32 v[154:155], v[38:39], s[54:55], v[154:155] op_sel_hi:[1,0,1]
    v_cvt_pk_bf16_f32 v72, v136, v137
    v_cvt_pk_bf16_f32 v73, v138, v139
    v_cvt_pk_bf16_f32 v74, v152, v153
    v_cvt_pk_bf16_f32 v75, v154, v155
    buffer_store_dwordx4 v[72:75], v22, s[12:15], s45 offen
    s_add_u32 s45, s45, 0x8000
    s_waitcnt vmcnt(5)
    v_lshlrev_b32 v32, 16, v196
    v_and_b32 v33, s49, v196
    v_lshlrev_b32 v34, 16, v197
    v_and_b32 v35, s49, v197
    v_lshlrev_b32 v36, 16, v198
    v_and_b32 v37, s49, v198
    v_lshlrev_b32 v38, 16, v199
    v_and_b32 v39, s49, v199
    s_waitcnt vmcnt(4)
    v_lshlrev_b32 v40, 16, v200
    v_and_b32 v41, s49, v200
    v_lshlrev_b32 v42, 16, v201
    v_and_b32 v43, s49, v201
    v_lshlrev_b32 v44, 16, v202
    v_and_b32 v45, s49, v202
    v_lshlrev_b32 v46, 16, v203
    v_and_b32 v47, s49, v203
    v_pk_add_f32 v[32:33], v[32:33], v[40:41]
    v_pk_add_f32 v[34:35], v[34:35], v[42:43]
    v_pk_add_f32 v[36:37], v[36:37], v[44:45]
    v_pk_add_f32 v[38:39], v[38:39], v[46:47]
    s_waitcnt vmcnt(3)
    v_lshlrev_b32 v40, 16, v204
    v_and_b32 v41, s49, v204
    v_lshlrev_b32 v42, 16, v205
    v_and_b32 v43, s49, v205
    v_lshlrev_b32 v44, 16, v206
    v_and_b32 v45, s49, v206
    v_lshlrev_b32 v46, 16, v207
    v_and_b32_e64 v47, s49, v207
    v_pk_add_f32 v[32:33], v[32:33], v[40:41]
    v_pk_add_f32 v[34:35], v[34:35], v[42:43]
    v_pk_add_f32 v[36:37], v[36:37], v[44:45]
    v_pk_add_f32 v[38:39], v[38:39], v[46:47]
    v_pk_fma_f32 v[140:141], v[32:33], s[54:55], v[140:141] op_sel_hi:[1,0,1]
    v_pk_fma_f32 v[142:143], v[34:35], s[54:55], v[142:143] op_sel_hi:[1,0,1]
    v_pk_fma_f32 v[156:157], v[36:37], s[54:55], v[156:157] op_sel_hi:[1,0,1]
    v_pk_fma_f32 v[158:159], v[38:39], s[54:55], v[158:159] op_sel_hi:[1,0,1]
    v_cvt_pk_bf16_f32 v76, v140, v141
    v_cvt_pk_bf16_f32 v77, v142, v143
    v_cvt_pk_bf16_f32 v78, v156, v157
    v_cvt_pk_bf16_f32 v79, v158, v159
    buffer_store_dwordx4 v[76:79], v22, s[12:15], s45 offen
L_end:
    s_endpgm
.section .rodata,"a"
.p2align 6
.amdhsa_kernel interleave_layers__ssm_conv_h3__geglu_ffn__prompt_kernel
  .amdhsa_next_free_vgpr 512
  .amdhsa_next_free_sgpr 64
  .amdhsa_accum_offset 256
  .amdhsa_group_segment_fixed_size 0
  .amdhsa_kernarg_size 104
  .amdhsa_user_sgpr_count 2
  .amdhsa_user_sgpr_kernarg_segment_ptr 1
  .amdhsa_system_sgpr_workgroup_id_x 1
.end_amdhsa_kernel
```
